```python
import torch

def _softmax(x, axis=-1):
    return torch.softmax(x, dim=axis)
def _gelu(x):
    return torch.nn.functional.gelu(x, approximate="tanh")
def _silu(x):
    return torch.nn.functional.silu(x)
def _sigmoid(x):
    return torch.sigmoid(x)
def _layernorm(x, axis=-1, eps=1e-5):
    m = x.mean(dim=axis, keepdim=True)
    v = x.var(dim=axis, keepdim=True, unbiased=False)
    return (x - m) / torch.sqrt(v + eps)
def _scatter_add(tgt, idx, src, axis=0):
    return tgt.clone().index_add_(axis, idx, src)
def _segment_sum(src, seg, n):
    out = torch.zeros((n,) + src.shape[1:], dtype=src.dtype)
    return out.index_add_(0, seg, src)
def _pad(x, pw):
    flat = tuple(v for pair in reversed(pw) for v in pair)
    return torch.nn.functional.pad(x, flat)

kernel_name = 'recurrent_scan__spectral_gfnet__glu_gated_glu__prompt'

def setup_inputs():

    _w = (lambda a: (lambda t: t.to(torch.bfloat16) if t.is_floating_point() else t)(torch.as_tensor(a)))
    def _A_setup():
        B, S, D = 1, 2048, 576
        Df = D // 2 + 1
        return {
            "x": _w((lambda *s: torch.randn(*s, dtype=torch.bfloat16) * 0.05)(B, S, D)),
            "w_r": _w((lambda *s: torch.randn(*s, dtype=torch.bfloat16) * 0.05)(S, Df) * 0.02),
            "w_i": _w((lambda *s: torch.randn(*s, dtype=torch.bfloat16) * 0.05)(S, Df) * 0.02),
        }
    _A_in = _A_setup()

    def _B_setup():
        B, S, D, F = 1, 2048, 576, 4608
        return {
            "x": _w((lambda *s: torch.randn(*s, dtype=torch.bfloat16) * 0.05)(B, S, D)),
            "w_gate": _w((lambda *s: torch.randn(*s, dtype=torch.bfloat16) * 0.2)(D, F)),
            "w_up": _w((lambda *s: torch.randn(*s, dtype=torch.bfloat16) * 0.05)(D, F)),
            "w_down": _w((lambda *s: torch.randn(*s, dtype=torch.bfloat16) * 0.05)(F, D)),
        }
    _B_in = _B_setup()

    return {
        "A_x": _A_in["x"],
        "A_w_r": _A_in["w_r"],
        "A_w_i": _A_in["w_i"],
        "B_x": _B_in["x"],
        "B_w_gate": _B_in["w_gate"],
        "B_w_up": _B_in["w_up"],
        "B_w_down": _B_in["w_down"],
    }

def reference(A_x, A_w_r, A_w_i, B_x, B_w_gate, B_w_up, B_w_down):
    def _A_ref(x, w_r, w_i):
        B, S, D = x.shape
        X = (lambda x, axes=(-2,-1): torch.fft.rfft2(x.float(), dim=axes))(x, axes=(-2, -1))
        W = w_r + 1j * w_i
        X = X * W
        y = (lambda x, s, axes=(-2,-1): torch.fft.irfft2(x, s=s, dim=axes).to(torch.bfloat16))(X, (S, D), axes=(-2, -1))
        return y

    def _B_ref(x, w_gate, w_up, w_down):
        g = torch.einsum("bsd,df->bsf", x, w_gate)
        u = torch.einsum("bsd,df->bsf", x, w_up)
        h = _sigmoid(g) * u
        return torch.einsum("bsf,fd->bsd", h, w_down)

    x = A_x
    xn = _layernorm(x, axis=-1)
    s = _A_ref(xn, A_w_r, A_w_i)
    g = _silu(_B_ref(xn, B_w_gate, B_w_up, B_w_down))
    return x + s * g
```

```asm
; @launch kernel=k0_kernel grid=(256,1,1) block=(256,1,1) lds=0
; @launch kernel=k1_kernel grid=(256,1,1) block=(256,1,1) lds=143360
; @launch kernel=k2_kernel grid=(256,1,1) block=(256,1,1) lds=153600
.amdgcn_target "amdgcn-amd-amdhsa--gfx950"
.text
.globl k0_kernel
.p2align 8
.type k0_kernel,@function
k0_kernel:
    s_getpc_b64 s[8:9]
K0_pc:
    v_mbcnt_lo_u32_b32 v60, -1, 0
    v_mbcnt_hi_u32_b32 v60, -1, v60
    v_lshlrev_b32 v60, 7, v60
    s_mov_b32 s10, k0_kernel_end-K0_pc-4
    v_min_u32 v60, s10, v60
    v_mov_b32 v61, s9
    v_add_co_u32 v60, s[10:11], s8, v60
    s_nop 1
    v_addc_co_u32 v61, s[10:11], 0, v61, s[10:11]
    global_load_dword v67, v[60:61], off
    s_cmp_ge_u32 s2, 256
    s_cbranch_scc1 K0_exit
    s_load_dwordx2 s[4:5], s[0:1], 0
    s_load_dwordx2 s[6:7], s[0:1], 72
    s_load_dwordx2 s[84:85], s[0:1], 32
    s_load_dwordx2 s[88:89], s[0:1], 40
    v_lshrrev_b32 v1, 5, v0
    v_and_b32 v2, 31, v0
    v_lshrrev_b32 v64, 6, v0
    s_lshr_b32 s16, s2, 2
    s_and_b32 s17, s2, 3
    v_readfirstlane_b32 s42, v64
    s_lshl_b32 s17, s17, 3
    s_lshr_b32 s18, s16, 3
    s_and_b32 s19, s16, 7
    s_and_b32 s20, s18, 3
    s_lshl_b32 s20, s20, 3
    s_add_u32 s20, s20, s19
    s_lshr_b32 s21, s18, 2
    s_lshl_b32 s21, s21, 10
    s_add_u32 s20, s20, s21
    s_lshl_b32 s21, s17, 5
    s_add_u32 s20, s20, s21
    v_lshlrev_b32 v3, 5, v1
    v_add_u32 v3, s20, v3
    v_mul_u32_u24 v3, 1152, v3
    v_lshlrev_b32 v4, 4, v2
    v_add_u32 v3, v3, v4
    v_cmp_gt_u32 vcc, 24, v2
    v_mov_b32 v5, 0x7f000000
    s_waitcnt lgkmcnt(0)
    v_cndmask_b32 v3, v5, v3, vcc
    s_mov_b32 s8, s4
    s_and_b32 s9, s5, 0xffff
    s_mov_b32 s10, 2359296
    s_mov_b32 s11, 0x20000
    buffer_load_dwordx4 v[8:11], v3, s[8:11], 0 offen
    buffer_load_dwordx4 v[12:15], v3, s[8:11], 0 offen offset:384
    buffer_load_dwordx4 v[16:19], v3, s[8:11], 0 offen offset:768
    s_mov_b32 s12, s6
    s_and_b32 s13, s7, 0xffff
    s_mov_b32 s14, 39845888
    s_mov_b32 s15, 0x20000
    s_cmp_ge_u32 s2, 48
    s_cbranch_scc1 K0_noclr
    s_cmp_lg_u32 s42, 0
    s_cbranch_scc1 K0_noclr
    s_lshl_b32 s21, s2, 7
    s_add_u32 s21, s21, 11075584
    v_lshlrev_b32 v60, 2, v0
    v_mov_b32 v61, 0
    v_cmp_gt_u32 s[44:45], 32, v0
    s_nop 1
    v_cndmask_b32 v60, v5, v60, s[44:45]
    s_nop 0
    buffer_store_dword v61, v60, s[12:15], s21 offen
K0_noclr:
    s_lshr_b32 s46, s2, 3
    s_lshl_b32 s46, s46, 2
    s_add_u32 s46, s46, s42
    s_and_b32 s47, s46, 1
    s_lshr_b32 s48, s46, 1
    s_mul_i32 s48, s48, 36
    v_and_b32 v60, 63, v0
    v_add_u32 v61, s48, v60
    s_mov_b32 s49, 0xe38e38f
    v_mul_hi_u32 v62, v61, s49
    v_mul_u32_u24 v63, 18, v62
    v_sub_u32 v63, v61, v63
    v_mul_u32_u24 v62, 9216, v62
    v_lshl_add_u32 v62, v63, 7, v62
    s_and_b32 s49, s2, 7
    s_lshr_b32 s49, s49, 1
    s_mul_i32 s49, s49, 2304
    v_add_u32 v62, s49, v62
    v_cmp_gt_u32 s[44:45], 36, v60
    s_cmp_eq_u32 s47, 0
    s_cselect_b32 s84, s84, s88
    s_cselect_b32 s85, s85, s89
    s_and_b32 s85, s85, 0xffff
    s_mov_b32 s86, 1179648
    s_mov_b32 s87, 0x20000
    v_cndmask_b32 v62, v5, v62, s[44:45]
    buffer_load_dword v64, v62, s[84:87], 0 offen
    s_getpc_b64 s[50:51]
TC_k1_kernel_v65k0:
    s_add_u32 s50, s50, k1_kernel-TC_k1_kernel_v65k0
    s_addc_u32 s51, s51, 0
    s_mov_b32 s52, (k1_kernel_end-k1_kernel+127)/128
    s_add_u32 s52, s52, 127
    s_mov_b32 s53, 33554432
    s_mul_hi_u32 s52, s52, s53
    v_mbcnt_lo_u32_b32 v60, -1, 0
    v_mbcnt_hi_u32_b32 v60, -1, v60
    s_sub_u32 s53, s52, 1
    v_min_u32 v60, s53, v60
    s_mul_i32 s52, s52, s46
    v_add_u32 v60, s52, v60
    v_lshlrev_b32 v60, 7, v60
    s_mov_b32 s53, k1_kernel_end-k1_kernel-4
    v_min_u32 v60, s53, v60
    v_mov_b32 v61, s51
    v_add_co_u32 v60, s[54:55], s50, v60
    s_nop 1
    v_addc_co_u32 v61, s[54:55], 0, v61, s[54:55]
    global_load_dword v65, v[60:61], off
    s_getpc_b64 s[50:51]
    s_add_u32 s50, s50, tab_ff@rel32@lo+4
    s_addc_u32 s51, s51, tab_ff@rel32@hi+12
    s_mul_i32 s56, s46, 14
    v_mbcnt_lo_u32_b32 v60, -1, 0
    v_mbcnt_hi_u32_b32 v60, -1, v60
    v_min_u32 v60, 13, v60
    v_add_u32 v60, s56, v60
    v_min_u32 v60, 1727, v60
    s_and_b32 s56, s2, 7
    s_lshr_b32 s56, s56, 1
    s_mul_i32 s56, s56, 1152
    v_add_u32 v61, s56, v60
    v_add_u32 v62, 3456, v60
    s_mov_b32 s56, 1152
    v_cmp_gt_u32 s[44:45], s56, v60
    s_nop 1
    v_cndmask_b32 v60, v62, v61, s[44:45]
    v_lshlrev_b32 v60, 7, v60
    v_add_co_u32 v62, s[52:53], s50, v60
    v_mov_b32 v63, s51
    s_nop 0
    v_addc_co_u32 v63, s[52:53], 0, v63, s[52:53]
    global_load_dword v66, v[62:63], off
    v_add_u32 v7, s17, v1
    v_lshrrev_b32 v6, 4, v7
    s_lshl_b32 s22, s16, 1
    v_add_u32 v6, s22, v6
    v_mul_u32_u24 v6, 18432, v6
    v_and_b32 v7, 15, v7
    v_and_b32 v44, 3, v2
    v_lshl_add_u32 v7, v44, 4, v7
    v_lshl_add_u32 v6, v7, 4, v6
    v_lshrrev_b32 v44, 2, v2
    v_lshl_add_u32 v6, v44, 10, v6
    v_add_u32 v6, 0, v6
    v_cndmask_b32 v6, v5, v6, vcc
    s_mov_b32 s23, 6144
    s_mov_b32 s24, 12288
    s_mov_b32 s25, 0x3ae38e39
    s_mov_b32 s26, 0x3727c5ac
    s_mov_b32 s27, 0xffff0000
    s_waitcnt vmcnt(3)
    v_mov_b32 v47, 0x3f803f80
    v_mov_b32 v44, 0
    v_mov_b32 v45, 0
    v_mov_b32 v46, 0
    v_dot2c_f32_bf16 v44, v8, v47
    v_dot2c_f32_bf16 v45, v9, v47
    v_dot2c_f32_bf16 v46, v10, v47
    v_dot2c_f32_bf16 v44, v11, v47
    v_dot2c_f32_bf16 v45, v12, v47
    v_dot2c_f32_bf16 v46, v13, v47
    v_dot2c_f32_bf16 v44, v14, v47
    v_dot2c_f32_bf16 v45, v15, v47
    v_dot2c_f32_bf16 v46, v16, v47
    v_dot2c_f32_bf16 v44, v17, v47
    v_dot2c_f32_bf16 v45, v18, v47
    v_dot2c_f32_bf16 v46, v19, v47
    v_lshlrev_b32 v20, 16, v8
    v_and_b32 v21, s27, v8
    v_lshlrev_b32 v22, 16, v9
    v_and_b32 v23, s27, v9
    v_lshlrev_b32 v24, 16, v10
    v_and_b32 v25, s27, v10
    v_lshlrev_b32 v26, 16, v11
    v_and_b32 v27, s27, v11
    v_lshlrev_b32 v28, 16, v12
    v_and_b32 v29, s27, v12
    v_lshlrev_b32 v30, 16, v13
    v_and_b32 v31, s27, v13
    v_lshlrev_b32 v32, 16, v14
    v_and_b32 v33, s27, v14
    v_lshlrev_b32 v34, 16, v15
    v_and_b32 v35, s27, v15
    v_lshlrev_b32 v36, 16, v16
    v_and_b32 v37, s27, v16
    v_lshlrev_b32 v38, 16, v17
    v_and_b32 v39, s27, v17
    v_lshlrev_b32 v40, 16, v18
    v_and_b32 v41, s27, v18
    v_lshlrev_b32 v42, 16, v19
    v_and_b32 v43, s27, v19
    v_add_f32 v44, v44, v45
    v_add_f32 v44, v44, v46
    s_nop 1
    v_add_f32_dpp v44, v44, v44 quad_perm:[1,0,3,2] row_mask:0xf bank_mask:0xf
    s_nop 1
    v_add_f32_dpp v44, v44, v44 quad_perm:[2,3,0,1] row_mask:0xf bank_mask:0xf
    s_nop 1
    v_add_f32_dpp v44, v44, v44 row_half_mirror row_mask:0xf bank_mask:0xf
    s_nop 1
    v_add_f32_dpp v44, v44, v44 row_mirror row_mask:0xf bank_mask:0xf
    ds_swizzle_b32 v45, v44 offset:0x401F
    s_waitcnt lgkmcnt(0)
    v_add_f32 v44, v44, v45
    v_mul_f32 v44, s25, v44
    v_sub_f32 v20, v20, v44
    v_sub_f32 v21, v21, v44
    v_sub_f32 v22, v22, v44
    v_sub_f32 v23, v23, v44
    v_sub_f32 v24, v24, v44
    v_sub_f32 v25, v25, v44
    v_sub_f32 v26, v26, v44
    v_sub_f32 v27, v27, v44
    v_sub_f32 v28, v28, v44
    v_sub_f32 v29, v29, v44
    v_sub_f32 v30, v30, v44
    v_sub_f32 v31, v31, v44
    v_sub_f32 v32, v32, v44
    v_sub_f32 v33, v33, v44
    v_sub_f32 v34, v34, v44
    v_sub_f32 v35, v35, v44
    v_sub_f32 v36, v36, v44
    v_sub_f32 v37, v37, v44
    v_sub_f32 v38, v38, v44
    v_sub_f32 v39, v39, v44
    v_sub_f32 v40, v40, v44
    v_sub_f32 v41, v41, v44
    v_sub_f32 v42, v42, v44
    v_sub_f32 v43, v43, v44
    v_mul_f32 v52, v20, v20
    v_mul_f32 v53, v21, v21
    v_mul_f32 v54, v22, v22
    v_mul_f32 v55, v23, v23
    v_fmac_f32 v52, v24, v24
    v_fmac_f32 v53, v25, v25
    v_fmac_f32 v54, v26, v26
    v_fmac_f32 v55, v27, v27
    v_fmac_f32 v52, v28, v28
    v_fmac_f32 v53, v29, v29
    v_fmac_f32 v54, v30, v30
    v_fmac_f32 v55, v31, v31
    v_fmac_f32 v52, v32, v32
    v_fmac_f32 v53, v33, v33
    v_fmac_f32 v54, v34, v34
    v_fmac_f32 v55, v35, v35
    v_fmac_f32 v52, v36, v36
    v_fmac_f32 v53, v37, v37
    v_fmac_f32 v54, v38, v38
    v_fmac_f32 v55, v39, v39
    v_fmac_f32 v52, v40, v40
    v_fmac_f32 v53, v41, v41
    v_fmac_f32 v54, v42, v42
    v_fmac_f32 v55, v43, v43
    v_add_f32 v52, v52, v53
    v_add_f32 v54, v54, v55
    v_add_f32 v52, v52, v54
    v_cndmask_b32 v52, 0, v52, vcc
    s_nop 1
    v_add_f32_dpp v52, v52, v52 quad_perm:[1,0,3,2] row_mask:0xf bank_mask:0xf
    s_nop 1
    v_add_f32_dpp v52, v52, v52 quad_perm:[2,3,0,1] row_mask:0xf bank_mask:0xf
    s_nop 1
    v_add_f32_dpp v52, v52, v52 row_half_mirror row_mask:0xf bank_mask:0xf
    s_nop 1
    v_add_f32_dpp v52, v52, v52 row_mirror row_mask:0xf bank_mask:0xf
    ds_swizzle_b32 v45, v52 offset:0x401F
    s_waitcnt lgkmcnt(0)
    v_add_f32 v52, v52, v45
    v_mul_f32 v52, s25, v52
    v_cvt_pk_bf16_f32 v46, v44, v52
    v_lshlrev_b32 v45, 16, v46
    v_and_b32 v52, s27, v46
    v_add_f32 v52, s26, v52
    v_cvt_pk_bf16_f32 v52, v52, v52
    v_and_b32 v52, s27, v52
    v_sqrt_f32 v52, v52
    v_sub_f32 v45, v44, v45
    v_cvt_pk_bf16_f32 v52, v52, v52
    v_and_b32 v52, s27, v52
    v_rcp_f32 v52, v52
    s_nop 0
    v_mul_f32 v52, 0xbfb8aa3b, v52
    v_mul_f32 v45, v45, v52
    v_fma_f32 v20, v20, v52, v45
    v_fma_f32 v21, v21, v52, v45
    v_fma_f32 v22, v22, v52, v45
    v_fma_f32 v23, v23, v52, v45
    v_fma_f32 v24, v24, v52, v45
    v_fma_f32 v25, v25, v52, v45
    v_fma_f32 v26, v26, v52, v45
    v_fma_f32 v27, v27, v52, v45
    v_fma_f32 v28, v28, v52, v45
    v_fma_f32 v29, v29, v52, v45
    v_fma_f32 v30, v30, v52, v45
    v_fma_f32 v31, v31, v52, v45
    v_fma_f32 v32, v32, v52, v45
    v_fma_f32 v33, v33, v52, v45
    v_fma_f32 v34, v34, v52, v45
    v_fma_f32 v35, v35, v52, v45
    v_fma_f32 v36, v36, v52, v45
    v_fma_f32 v37, v37, v52, v45
    v_fma_f32 v38, v38, v52, v45
    v_fma_f32 v39, v39, v52, v45
    v_fma_f32 v40, v40, v52, v45
    v_fma_f32 v41, v41, v52, v45
    v_fma_f32 v42, v42, v52, v45
    v_fma_f32 v43, v43, v52, v45
    v_cvt_pk_bf16_f32 v8, v20, v21
    v_cvt_pk_bf16_f32 v9, v22, v23
    v_cvt_pk_bf16_f32 v10, v24, v25
    v_cvt_pk_bf16_f32 v11, v26, v27
    v_cvt_pk_bf16_f32 v12, v28, v29
    v_cvt_pk_bf16_f32 v13, v30, v31
    v_cvt_pk_bf16_f32 v14, v32, v33
    v_cvt_pk_bf16_f32 v15, v34, v35
    v_cvt_pk_bf16_f32 v16, v36, v37
    v_cvt_pk_bf16_f32 v17, v38, v39
    v_cvt_pk_bf16_f32 v18, v40, v41
    v_cvt_pk_bf16_f32 v19, v42, v43
    buffer_store_dwordx4 v[8:11], v6, s[12:15], 0 offen
    buffer_store_dwordx4 v[12:15], v6, s[12:15], s23 offen
    buffer_store_dwordx4 v[16:19], v6, s[12:15], s24 offen
K0_exit:
    s_endpgm
k0_kernel_end:
.globl k1_kernel
.p2align 8
.type k1_kernel,@function
k1_kernel:
    s_load_dwordx2 s[50:51], s[0:1], 72
    s_load_dwordx2 s[4:5], s[0:1], 32
    s_load_dwordx2 s[30:31], s[0:1], 40
    s_load_dwordx2 s[96:97], s[0:1], 48
    s_load_dwordx2 s[6:7], s[0:1], 8
    s_load_dwordx2 s[92:93], s[0:1], 16
    v_lshrrev_b32 v17, 6, v0
    v_and_b32 v1, 63, v0
    s_and_b32 s55, s2, 7
    v_readfirstlane_b32 s52, v17
    s_cmp_ge_u32 s2, 256
    s_cbranch_scc1 K1_exit
    s_lshr_b32 s56, s2, 3
    s_lshr_b32 s53, s55, 1
    s_lshl_b32 s53, s53, 3
    s_and_b32 s54, s56, 7
    s_add_u32 s53, s53, s54
    s_and_b32 s54, s55, 1
    s_lshl_b32 s54, s54, 2
    s_lshr_b32 s55, s56, 3
    s_add_u32 s54, s54, s55
    v_mov_b32 v34, 2130706432
    v_mov_b32 v39, 2130706432
    v_mov_b32 v179, v0
    v_mov_b32 v31, v1
    s_lshl_b32 s55, s54, 4
    s_lshl_b32 s56, s52, 2
    s_add_u32 s55, s55, s56
    s_mul_i32 s56, s55, 18432
    s_add_u32 s56, s56, 0
    v_lshlrev_b32 v16, 4, v31
    v_add_u32 v1, s56, v16
    s_mul_i32 s56, s55, 147456
    s_add_u32 s56, s56, 20971520
    v_add_u32 v14, s56, v16
    s_mov_b32 s39, 0
    s_mov_b32 s40, 18432
    s_mov_b32 s41, 36864
    s_mov_b32 s42, 55296
    s_lshr_b32 s48, s53, 1
    s_mul_i32 s48, s48, 9
    s_and_b32 s49, s53, 1
    s_lshl_b32 s56, s49, 3
    s_lshl_b32 s49, s49, 2
    s_add_u32 s57, s48, 8
    s_lshl_b32 s57, s57, 10
    s_add_u32 s48, s48, s49
    s_lshl_b32 s48, s48, 10
    s_add_u32 s49, s57, s56
    s_mul_i32 s55, s53, 288
    s_mov_b32 s61, 0xe38e38f
    s_add_u32 s56, s52, 0
    s_sub_u32 s57, s56, 9
    s_cmp_lt_u32 s56, 9
    s_cselect_b32 s58, s56, s57
    s_cselect_b32 s59, 0, 9216
    s_lshl_b32 s60, s58, 10
    s_add_u32 s33, s60, s59
    s_lshl_b32 s58, s58, 6
    v_add_u32 v16, s58, v31
    v_mul_hi_u32 v17, v16, s61
    v_mul_u32_u24 v18, 18, v17
    v_sub_u32 v18, v16, v18
    v_and_b32 v19, 0x13, v17
    v_bfe_u32 v20, v17, 2, 1
    v_lshl_or_b32 v19, v20, 3, v19
    v_bfe_u32 v20, v17, 3, 1
    v_lshl_or_b32 v19, v20, 2, v19
    v_mul_u32_u24 v19, 9216, v19
    v_lshl_add_u32 v19, v18, 4, v19
    v_add_u32 v8, s55, v19
    s_add_u32 s56, s52, 4
    s_sub_u32 s57, s56, 9
    s_cmp_lt_u32 s56, 9
    s_cselect_b32 s58, s56, s57
    s_cselect_b32 s59, 0, 9216
    s_lshl_b32 s60, s58, 10
    s_add_u32 s34, s60, s59
    s_lshl_b32 s58, s58, 6
    v_add_u32 v16, s58, v31
    v_mul_hi_u32 v17, v16, s61
    v_mul_u32_u24 v18, 18, v17
    v_sub_u32 v18, v16, v18
    v_and_b32 v19, 0x13, v17
    v_bfe_u32 v20, v17, 2, 1
    v_lshl_or_b32 v19, v20, 3, v19
    v_bfe_u32 v20, v17, 3, 1
    v_lshl_or_b32 v19, v20, 2, v19
    v_mul_u32_u24 v19, 9216, v19
    v_lshl_add_u32 v19, v18, 4, v19
    v_add_u32 v9, s55, v19
    s_add_u32 s56, s52, 8
    s_sub_u32 s57, s56, 9
    s_cmp_lt_u32 s56, 9
    s_cselect_b32 s58, s56, s57
    s_cselect_b32 s59, 0, 9216
    s_lshl_b32 s60, s58, 10
    s_add_u32 s35, s60, s59
    s_lshl_b32 s58, s58, 6
    v_add_u32 v16, s58, v31
    v_mul_hi_u32 v17, v16, s61
    v_mul_u32_u24 v18, 18, v17
    v_sub_u32 v18, v16, v18
    v_and_b32 v19, 0x13, v17
    v_bfe_u32 v20, v17, 2, 1
    v_lshl_or_b32 v19, v20, 3, v19
    v_bfe_u32 v20, v17, 3, 1
    v_lshl_or_b32 v19, v20, 2, v19
    v_mul_u32_u24 v19, 9216, v19
    v_lshl_add_u32 v19, v18, 4, v19
    v_add_u32 v10, s55, v19
    s_add_u32 s56, s52, 12
    s_sub_u32 s57, s56, 9
    s_cmp_lt_u32 s56, 9
    s_cselect_b32 s58, s56, s57
    s_cselect_b32 s59, 0, 9216
    s_lshl_b32 s60, s58, 10
    s_add_u32 s36, s60, s59
    s_lshl_b32 s58, s58, 6
    v_add_u32 v16, s58, v31
    v_mul_hi_u32 v17, v16, s61
    v_mul_u32_u24 v18, 18, v17
    v_sub_u32 v18, v16, v18
    v_and_b32 v19, 0x13, v17
    v_bfe_u32 v20, v17, 2, 1
    v_lshl_or_b32 v19, v20, 3, v19
    v_bfe_u32 v20, v17, 3, 1
    v_lshl_or_b32 v19, v20, 2, v19
    v_mul_u32_u24 v19, 9216, v19
    v_lshl_add_u32 v19, v18, 4, v19
    v_add_u32 v11, s55, v19
    s_add_u32 s56, s52, 16
    s_sub_u32 s57, s56, 9
    s_cmp_lt_u32 s56, 9
    s_cselect_b32 s58, s56, s57
    s_cselect_b32 s59, 0, 9216
    s_lshl_b32 s60, s58, 10
    s_add_u32 s37, s60, s59
    s_lshl_b32 s58, s58, 6
    v_add_u32 v16, s58, v31
    v_mul_hi_u32 v17, v16, s61
    v_mul_u32_u24 v18, 18, v17
    v_sub_u32 v18, v16, v18
    v_and_b32 v19, 0x13, v17
    v_bfe_u32 v20, v17, 2, 1
    v_lshl_or_b32 v19, v20, 3, v19
    v_bfe_u32 v20, v17, 3, 1
    v_lshl_or_b32 v19, v20, 2, v19
    v_mul_u32_u24 v19, 9216, v19
    v_lshl_add_u32 v19, v18, 4, v19
    v_add_u32 v12, s55, v19
    s_waitcnt lgkmcnt(0)
    s_getpc_b64 s[58:59]
    s_add_u32 s58, s58, tab_ff@rel32@lo+4
    s_addc_u32 s59, s59, tab_ff@rel32@hi+12
    s_and_b32 s56, s53, 3
    s_add_u32 s56, s56, 32
    s_cmp_lt_u32 s53, 8
    s_cselect_b32 s56, s56, s53
    s_cmp_eq_u32 s52, 2
    s_cselect_b32 s56, s53, s56
    s_mul_i32 s56, s56, 18432
    v_lshlrev_b32 v16, 4, v31
    v_add_u32 v16, s56, v16
    s_sub_u32 s56, s52, 2
    s_lshl_b32 s56, s56, 10
    s_add_u32 s56, s56, 18432
    s_cmp_lt_u32 s52, 2
    s_cselect_b32 s37, s37, s56
    s_cselect_b32 s58, s30, s58
    s_cselect_b32 s59, s31, s59
    s_cselect_b64 s[60:61], -1, 0
    s_nop 0
    v_cndmask_b32 v16, v16, v12, s[60:61]
    v_add_co_u32 v12, s[60:61], s58, v16
    v_mov_b32 v13, s59
    s_nop 0
    v_addc_co_u32 v13, s[60:61], 0, v13, s[60:61]
    s_mov_b32 s28, 0
    s_lshr_b32 s29, s53, 2
    s_add_u32 s29, s29, 1
    s_cmp_lt_u32 s53, 8
    s_cselect_b32 s29, s29, 0
    s_mov_b32 s38, 1024
    s_cmp_lt_u32 s52, 2
    s_cselect_b32 s38, 294912, s38
    s_waitcnt lgkmcnt(0)
    s_mov_b32 s16, s50
    s_and_b32 s17, s51, 0xffff
    s_mov_b32 s18, 39845888
    s_mov_b32 s19, 0x20000
    s_mov_b32 s8, s4
    s_and_b32 s9, s5, 0xffff
    s_mov_b32 s10, 5308416
    s_mov_b32 s11, 0x20000
    s_mov_b32 s12, s30
    s_and_b32 s13, s31, 0xffff
    s_mov_b32 s14, 5308416
    s_mov_b32 s15, 0x20000
    s_mov_b32 s84, s6
    s_and_b32 s85, s7, 0xffff
    s_mov_b32 s86, 1183744
    s_mov_b32 s87, 0x20000
    s_mov_b32 s88, s92
    s_and_b32 s89, s93, 0xffff
    s_mov_b32 s90, 1183744
    s_mov_b32 s91, 0x20000
    s_cmp_lt_u32 s52, 2
    s_cselect_b32 s92, s8, s12
    s_cselect_b32 s93, s9, s13
    s_cselect_b32 s94, s10, s14
    s_mov_b32 s95, 0x20000
    s_cmp_eq_u32 s52, 0
    s_cselect_b32 s20, s8, s12
    s_cselect_b32 s21, s9, s13
    s_cselect_b32 s22, s10, s14
    s_cmp_lt_u32 s52, 2
    s_cselect_b32 s24, s12, s16
    s_cselect_b32 s25, s13, s17
    s_cselect_b32 s26, s14, s18
    s_mov_b32 s23, 0x20000
    s_mov_b32 s27, 0x20000
    buffer_load_dwordx4 a[96:99], v1, s[16:19], s39 offen offset:0
    buffer_load_dwordx4 a[100:103], v1, s[16:19], s40 offen offset:0
    buffer_load_dwordx4 a[104:107], v1, s[16:19], s41 offen offset:0
    buffer_load_dwordx4 a[108:111], v1, s[16:19], s42 offen offset:0
    s_add_u32 m0, s37, 0
    s_nop 0
    global_load_lds_dwordx4 v[12:13], off
    v_add_co_u32 v12, s[62:63], s38, v12
    s_add_u32 s29, s29, 0
    s_add_u32 s29, s29, 0
    v_addc_co_u32 v13, s[62:63], 0, v13, s[62:63]
    s_add_u32 m0, s33, 0
    s_nop 0
    buffer_load_dwordx4 v8, s[8:11], s28 offen lds
    s_add_u32 m0, s34, 0
    s_nop 0
    buffer_load_dwordx4 v9, s[8:11], s28 offen lds
    s_add_u32 m0, s35, 0
    s_nop 0
    buffer_load_dwordx4 v10, s[20:23], s28 offen lds
    s_add_u32 m0, s36, 0
    s_nop 0
    buffer_load_dwordx4 v11, s[12:15], s28 offen lds
    s_add_u32 s28, s28, 294912
    buffer_load_dwordx4 a[112:115], v1, s[16:19], s39 offen offset:1024
    buffer_load_dwordx4 a[116:119], v1, s[16:19], s40 offen offset:1024
    buffer_load_dwordx4 a[120:123], v1, s[16:19], s41 offen offset:1024
    buffer_load_dwordx4 a[124:127], v1, s[16:19], s42 offen offset:1024
    s_add_u32 m0, s37, 20480
    s_nop 0
    global_load_lds_dwordx4 v[12:13], off
    v_add_co_u32 v12, s[62:63], s38, v12
    s_add_u32 s29, s29, 0
    s_add_u32 s29, s29, 0
    v_addc_co_u32 v13, s[62:63], 0, v13, s[62:63]
    s_add_u32 m0, s33, 20480
    s_nop 0
    buffer_load_dwordx4 v8, s[8:11], s28 offen lds
    s_add_u32 m0, s34, 20480
    s_nop 0
    buffer_load_dwordx4 v9, s[8:11], s28 offen lds
    s_add_u32 m0, s35, 20480
    s_nop 0
    buffer_load_dwordx4 v10, s[20:23], s28 offen lds
    s_add_u32 m0, s36, 20480
    s_nop 0
    buffer_load_dwordx4 v11, s[12:15], s28 offen lds
    s_add_u32 s28, s28, 294912
    buffer_load_dwordx4 a[128:131], v1, s[16:19], s39 offen offset:2048
    buffer_load_dwordx4 a[132:135], v1, s[16:19], s40 offen offset:2048
    buffer_load_dwordx4 a[136:139], v1, s[16:19], s41 offen offset:2048
    buffer_load_dwordx4 a[140:143], v1, s[16:19], s42 offen offset:2048
    s_add_u32 m0, s37, 40960
    s_nop 0
    global_load_lds_dwordx4 v[12:13], off
    v_add_co_u32 v12, s[62:63], s38, v12
    s_add_u32 s29, s29, 0
    s_add_u32 s29, s29, 0
    v_addc_co_u32 v13, s[62:63], 0, v13, s[62:63]
    s_add_u32 m0, s33, 40960
    s_nop 0
    buffer_load_dwordx4 v8, s[8:11], s28 offen lds
    s_add_u32 m0, s34, 40960
    s_nop 0
    buffer_load_dwordx4 v9, s[8:11], s28 offen lds
    s_add_u32 m0, s35, 40960
    s_nop 0
    buffer_load_dwordx4 v10, s[20:23], s28 offen lds
    s_add_u32 m0, s36, 40960
    s_nop 0
    buffer_load_dwordx4 v11, s[12:15], s28 offen lds
    s_add_u32 s28, s28, 294912
    v_and_b32 v16, 15, v31
    s_lshl_b32 s55, s53, 4
    v_add_u32 v17, s55, v16
    v_lshlrev_b32 v17, 12, v17
    v_lshrrev_b32 v18, 5, v31
    v_lshl_add_u32 v17, v18, 10, v17
    v_bfe_u32 v18, v31, 4, 1
    v_lshlrev_b32 v18, 5, v18
    s_and_b32 s56, s54, 3
    s_lshl_b32 s56, s56, 3
    s_lshl_b32 s57, s52, 1
    s_add_u32 s56, s56, s57
    v_add_u32 v18, s56, v18
    v_lshl_add_u32 v17, v18, 4, v17
    s_lshr_b32 s56, s54, 2
    s_lshl_b32 s56, s56, 11
    s_add_u32 s56, s56, 6291456
    v_add_u32 v15, s56, v17
    v_lshrrev_b32 v16, 5, v31
    v_lshlrev_b32 v16, 4, v16
    v_bfe_u32 v17, v31, 4, 1
    v_lshl_add_u32 v16, v17, 2, v16
    v_bfe_u32 v17, v31, 2, 2
    v_add_u32 v16, v16, v17
    v_mul_u32_u24 v16, 288, v16
    v_and_b32 v18, 3, v31
    v_lshl_add_u32 v2, v18, 3, v16
    v_add_u32 v3, 61440, v2
    v_add_u32 v4, 122880, v2
    v_lshlrev_b32 v5, 4, v31
    v_add_u32 v6, 61440, v5
    v_add_u32 v7, 122880, v5
    s_mov_b32 s44, 0xbfb8aa3b
    s_mov_b32 s45, 0xbfb8aa3b
    s_mov_b32 s46, 1.0
    s_mov_b32 s47, 1.0
    s_mov_b32 s55, 0x1c71c71d
    v_mul_hi_u32 v16, v31, s55
    v_mul_u32_u24 v17, 9, v16
    v_sub_u32 v17, v31, v17
    s_and_b32 s55, s52, 1
    s_mul_i32 s55, s55, 9
    v_add_u32 v17, s55, v17
    v_lshlrev_b32 v17, 7, v17
    s_lshr_b32 s55, s2, 3
    s_mul_i32 s55, s55, 9216
    s_and_b32 s56, s2, 7
    s_lshr_b32 s56, s56, 1
    s_mul_i32 s56, s56, 2304
    s_add_u32 s55, s55, s56
    v_add_u32 v17, s55, v17
    s_mov_b32 s55, 294912
    v_mul_lo_u32 v18, v16, s55
    v_add_u32 v18, v17, v18
    v_mov_b32 v19, 2130706432
    v_cmp_gt_u32 s[62:63], 27, v31
    s_nop 0
    s_nop 0
    v_cndmask_b32 v0, v19, v18, s[62:63]
    s_mov_b32 s98, 2654208
    s_mov_b32 s99, 1769472
    s_waitcnt vmcnt(18)
    s_barrier
    ds_read_b64_tr_b16 a[208:209], v2 offset:0
    ds_read_b64_tr_b16 a[210:211], v2 offset:2304
    ds_read_b64_tr_b16 a[212:213], v2 offset:9216
    ds_read_b64_tr_b16 a[214:215], v2 offset:11520
    ds_read_b64_tr_b16 a[216:217], v2 offset:32
    ds_read_b64_tr_b16 a[218:219], v2 offset:2336
    s_waitcnt vmcnt(9)
    s_barrier
    s_waitcnt lgkmcnt(4)
    v_mfma_f32_16x16x32_bf16 v[32:35], a[208:211], a[96:99], 0
    ds_read_b64_tr_b16 a[220:221], v2 offset:9248
    v_mfma_f32_16x16x32_bf16 v[36:39], a[208:211], a[100:103], 0
    ds_read_b64_tr_b16 a[222:223], v2 offset:11552
    v_mfma_f32_16x16x32_bf16 v[40:43], a[208:211], a[104:107], 0
    buffer_load_dwordx4 a[144:147], v1, s[16:19], s39 offen offset:3072
    v_mfma_f32_16x16x32_bf16 v[44:47], a[208:211], a[108:111], 0
    s_add_u32 s39, s39, 4096
    s_waitcnt lgkmcnt(4)
    v_mfma_f32_16x16x32_bf16 v[48:51], a[212:215], a[96:99], 0
    ds_read_b64_tr_b16 a[224:225], v2 offset:64
    v_mfma_f32_16x16x32_bf16 v[52:55], a[212:215], a[100:103], 0
    ds_read_b64_tr_b16 a[226:227], v2 offset:2368
    v_mfma_f32_16x16x32_bf16 v[56:59], a[212:215], a[104:107], 0
    buffer_load_dwordx4 a[148:151], v1, s[16:19], s40 offen offset:3072
    v_mfma_f32_16x16x32_bf16 v[60:63], a[212:215], a[108:111], 0
    s_add_u32 s40, s40, 4096
    s_waitcnt lgkmcnt(4)
    v_mfma_f32_16x16x32_bf16 v[64:67], a[216:219], a[96:99], 0
    ds_read_b64_tr_b16 a[208:209], v2 offset:9280
    v_mfma_f32_16x16x32_bf16 v[68:71], a[216:219], a[100:103], 0
    ds_read_b64_tr_b16 a[210:211], v2 offset:11584
    v_mfma_f32_16x16x32_bf16 v[72:75], a[216:219], a[104:107], 0
    buffer_load_dwordx4 a[152:155], v1, s[16:19], s41 offen offset:3072
    v_mfma_f32_16x16x32_bf16 v[76:79], a[216:219], a[108:111], 0
    s_add_u32 s41, s41, 4096
    s_waitcnt lgkmcnt(4)
    v_mfma_f32_16x16x32_bf16 v[80:83], a[220:223], a[96:99], 0
    ds_read_b64_tr_b16 a[212:213], v2 offset:96
    v_mfma_f32_16x16x32_bf16 v[84:87], a[220:223], a[100:103], 0
    ds_read_b64_tr_b16 a[214:215], v2 offset:2400
    v_mfma_f32_16x16x32_bf16 v[88:91], a[220:223], a[104:107], 0
    buffer_load_dwordx4 a[156:159], v1, s[16:19], s42 offen offset:3072
    v_mfma_f32_16x16x32_bf16 v[92:95], a[220:223], a[108:111], 0
    s_add_u32 s42, s42, 4096
    s_waitcnt lgkmcnt(4)
    v_mfma_f32_16x16x32_bf16 v[96:99], a[224:227], a[96:99], 0
    ds_read_b64_tr_b16 a[216:217], v2 offset:9312
    v_mfma_f32_16x16x32_bf16 v[100:103], a[224:227], a[100:103], 0
    ds_read_b64_tr_b16 a[218:219], v2 offset:11616
    v_mfma_f32_16x16x32_bf16 v[104:107], a[224:227], a[104:107], 0
    s_add_u32 m0, s37, 61440
    v_mfma_f32_16x16x32_bf16 v[108:111], a[224:227], a[108:111], 0
    global_load_lds_dwordx4 v[12:13], off
    s_waitcnt lgkmcnt(4)
    v_mfma_f32_16x16x32_bf16 v[112:115], a[208:211], a[96:99], 0
    ds_read_b64_tr_b16 a[220:221], v2 offset:128
    v_mfma_f32_16x16x32_bf16 v[116:119], a[208:211], a[100:103], 0
    ds_read_b64_tr_b16 a[222:223], v2 offset:2432
    v_mfma_f32_16x16x32_bf16 v[120:123], a[208:211], a[104:107], 0
    v_add_co_u32 v12, s[62:63], s38, v12
    v_mfma_f32_16x16x32_bf16 v[124:127], a[208:211], a[108:111], 0
    s_add_u32 s29, s29, 0
    s_waitcnt lgkmcnt(4)
    v_mfma_f32_16x16x32_bf16 v[128:131], a[212:215], a[96:99], 0
    ds_read_b64_tr_b16 a[224:225], v2 offset:9344
    v_mfma_f32_16x16x32_bf16 v[132:135], a[212:215], a[100:103], 0
    ds_read_b64_tr_b16 a[226:227], v2 offset:11648
    v_mfma_f32_16x16x32_bf16 v[136:139], a[212:215], a[104:107], 0
    s_add_u32 s29, s29, 0
    v_mfma_f32_16x16x32_bf16 v[140:143], a[212:215], a[108:111], 0
    v_addc_co_u32 v13, s[62:63], 0, v13, s[62:63]
    s_waitcnt lgkmcnt(4)
    v_mfma_f32_16x16x32_bf16 v[144:147], a[216:219], a[96:99], 0
    ds_read_b64_tr_b16 a[208:209], v2 offset:160
    v_mfma_f32_16x16x32_bf16 v[148:151], a[216:219], a[100:103], 0
    ds_read_b64_tr_b16 a[210:211], v2 offset:2464
    v_mfma_f32_16x16x32_bf16 v[152:155], a[216:219], a[104:107], 0
    s_add_u32 m0, s33, 61440
    v_mfma_f32_16x16x32_bf16 v[156:159], a[216:219], a[108:111], 0
    buffer_load_dwordx4 v8, s[8:11], s28 offen lds
    s_waitcnt lgkmcnt(4)
    v_mfma_f32_16x16x32_bf16 v[160:163], a[220:223], a[96:99], 0
    ds_read_b64_tr_b16 a[212:213], v2 offset:9376
    v_mfma_f32_16x16x32_bf16 v[164:167], a[220:223], a[100:103], 0
    ds_read_b64_tr_b16 a[214:215], v2 offset:11680
    v_mfma_f32_16x16x32_bf16 v[168:171], a[220:223], a[104:107], 0
    s_add_u32 m0, s34, 61440
    v_mfma_f32_16x16x32_bf16 v[172:175], a[220:223], a[108:111], 0
    buffer_load_dwordx4 v9, s[8:11], s28 offen lds
    s_waitcnt lgkmcnt(4)
    v_mfma_f32_16x16x32_bf16 v[176:179], a[224:227], a[96:99], 0
    ds_read_b64_tr_b16 a[216:217], v2 offset:192
    v_mfma_f32_16x16x32_bf16 v[180:183], a[224:227], a[100:103], 0
    ds_read_b64_tr_b16 a[218:219], v2 offset:2496
    v_mfma_f32_16x16x32_bf16 v[184:187], a[224:227], a[104:107], 0
    s_add_u32 m0, s35, 61440
    v_mfma_f32_16x16x32_bf16 v[188:191], a[224:227], a[108:111], 0
    buffer_load_dwordx4 v10, s[20:23], s28 offen lds
    s_waitcnt lgkmcnt(4)
    v_mfma_f32_16x16x32_bf16 v[192:195], a[208:211], a[96:99], 0
    ds_read_b64_tr_b16 a[220:221], v2 offset:9408
    v_mfma_f32_16x16x32_bf16 v[196:199], a[208:211], a[100:103], 0
    ds_read_b64_tr_b16 a[222:223], v2 offset:11712
    v_mfma_f32_16x16x32_bf16 v[200:203], a[208:211], a[104:107], 0
    s_add_u32 m0, s36, 61440
    v_mfma_f32_16x16x32_bf16 v[204:207], a[208:211], a[108:111], 0
    buffer_load_dwordx4 v11, s[12:15], s28 offen lds
    s_waitcnt lgkmcnt(4)
    v_mfma_f32_16x16x32_bf16 v[208:211], a[212:215], a[96:99], 0
    ds_read_b64_tr_b16 a[224:225], v2 offset:224
    v_mfma_f32_16x16x32_bf16 v[212:215], a[212:215], a[100:103], 0
    ds_read_b64_tr_b16 a[226:227], v2 offset:2528
    v_mfma_f32_16x16x32_bf16 v[216:219], a[212:215], a[104:107], 0
    s_add_u32 s28, s28, 294912
    v_mfma_f32_16x16x32_bf16 v[220:223], a[212:215], a[108:111], 0
    buffer_load_dwordx4 a[160:163], v1, s[16:19], s39 offen offset:0
    s_waitcnt lgkmcnt(4)
    v_mfma_f32_16x16x32_bf16 v[224:227], a[216:219], a[96:99], 0
    ds_read_b64_tr_b16 a[208:209], v2 offset:9440
    v_mfma_f32_16x16x32_bf16 v[228:231], a[216:219], a[100:103], 0
    ds_read_b64_tr_b16 a[210:211], v2 offset:11744
    v_mfma_f32_16x16x32_bf16 v[232:235], a[216:219], a[104:107], 0
    buffer_load_dwordx4 a[164:167], v1, s[16:19], s40 offen offset:0
    v_mfma_f32_16x16x32_bf16 v[236:239], a[216:219], a[108:111], 0
    buffer_load_dwordx4 a[168:171], v1, s[16:19], s41 offen offset:0
    s_waitcnt lgkmcnt(4)
    v_mfma_f32_16x16x32_bf16 v[240:243], a[220:223], a[96:99], 0
    ds_read_b64_tr_b16 a[212:213], v2 offset:256
    v_mfma_f32_16x16x32_bf16 v[244:247], a[220:223], a[100:103], 0
    ds_read_b64_tr_b16 a[214:215], v2 offset:2560
    v_mfma_f32_16x16x32_bf16 v[248:251], a[220:223], a[104:107], 0
    buffer_load_dwordx4 a[172:175], v1, s[16:19], s42 offen offset:0
    v_mfma_f32_16x16x32_bf16 v[252:255], a[220:223], a[108:111], 0
    s_add_u32 m0, s37, 81920
    s_waitcnt lgkmcnt(4)
    v_mfma_f32_16x16x32_bf16 a[0:3], a[224:227], a[96:99], 0
    ds_read_b64_tr_b16 a[216:217], v2 offset:9472
    v_mfma_f32_16x16x32_bf16 a[4:7], a[224:227], a[100:103], 0
    ds_read_b64_tr_b16 a[218:219], v2 offset:11776
    v_mfma_f32_16x16x32_bf16 a[8:11], a[224:227], a[104:107], 0
    global_load_lds_dwordx4 v[12:13], off
    v_mfma_f32_16x16x32_bf16 a[12:15], a[224:227], a[108:111], 0
    v_add_co_u32 v12, s[62:63], s38, v12
    s_waitcnt lgkmcnt(4)
    v_mfma_f32_16x16x32_bf16 a[16:19], a[208:211], a[96:99], 0
    ds_read_b128 a[220:223], v5 offset:18432
    v_mfma_f32_16x16x32_bf16 a[20:23], a[208:211], a[100:103], 0
    s_add_u32 s29, s29, 0
    v_mfma_f32_16x16x32_bf16 a[24:27], a[208:211], a[104:107], 0
    s_add_u32 s29, s29, 0
    v_mfma_f32_16x16x32_bf16 a[28:31], a[208:211], a[108:111], 0
    v_addc_co_u32 v13, s[62:63], 0, v13, s[62:63]
    s_waitcnt lgkmcnt(3)
    v_mfma_f32_16x16x32_bf16 a[32:35], a[212:215], a[96:99], 0
    ds_read_b128 a[224:227], v5 offset:19456
    v_mfma_f32_16x16x32_bf16 a[36:39], a[212:215], a[100:103], 0
    s_add_u32 m0, s33, 81920
    v_mfma_f32_16x16x32_bf16 a[40:43], a[212:215], a[104:107], 0
    buffer_load_dwordx4 v8, s[8:11], s28 offen lds
    v_mfma_f32_16x16x32_bf16 a[44:47], a[212:215], a[108:111], 0
    s_add_u32 m0, s34, 81920
    s_waitcnt lgkmcnt(2)
    v_mfma_f32_16x16x32_bf16 a[48:51], a[216:219], a[96:99], 0
    ds_read_b64_tr_b16 a[208:209], v2 offset:20480
    v_mfma_f32_16x16x32_bf16 a[52:55], a[216:219], a[100:103], 0
    ds_read_b64_tr_b16 a[210:211], v2 offset:22784
    v_mfma_f32_16x16x32_bf16 a[56:59], a[216:219], a[104:107], 0
    buffer_load_dwordx4 v9, s[8:11], s28 offen lds
    v_mfma_f32_16x16x32_bf16 a[60:63], a[216:219], a[108:111], 0
    s_add_u32 m0, s35, 81920
    s_waitcnt lgkmcnt(3)
    v_mfma_f32_16x16x32_bf16 a[64:67], a[96:99], a[220:223], 0
    ds_read_b64_tr_b16 a[212:213], v2 offset:29696
    v_mfma_f32_16x16x32_bf16 a[68:71], a[100:103], a[220:223], 0
    ds_read_b64_tr_b16 a[214:215], v2 offset:32000
    v_mfma_f32_16x16x32_bf16 a[72:75], a[104:107], a[220:223], 0
    buffer_load_dwordx4 v10, s[20:23], s28 offen lds
    v_mfma_f32_16x16x32_bf16 a[76:79], a[108:111], a[220:223], 0
    s_add_u32 m0, s36, 81920
    s_waitcnt lgkmcnt(4)
    s_cmp_lg_u32 s29, 1
    s_cbranch_scc1 K1_skip0_0
    v_mfma_f32_16x16x32_bf16 a[80:83], a[96:99], a[224:227], 0
    v_mfma_f32_16x16x32_bf16 a[84:87], a[100:103], a[224:227], 0
K1_skip0_0:
    s_cmp_lg_u32 s29, 2
    s_cbranch_scc1 K1_skip0_1
    v_mfma_f32_16x16x32_bf16 a[88:91], a[104:107], a[224:227], 0
    v_mfma_f32_16x16x32_bf16 a[92:95], a[108:111], a[224:227], 0
K1_skip0_1:
    ds_read_b64_tr_b16 a[216:217], v2 offset:20512
    ds_read_b64_tr_b16 a[218:219], v2 offset:22816
    buffer_load_dwordx4 v11, s[12:15], s28 offen lds
    s_add_u32 s28, s28, 294912
    s_waitcnt vmcnt(18)
    s_barrier
    s_waitcnt lgkmcnt(4)
    v_mfma_f32_16x16x32_bf16 v[32:35], a[208:211], a[112:115], v[32:35]
    ds_read_b64_tr_b16 a[220:221], v2 offset:29728
    v_mfma_f32_16x16x32_bf16 v[36:39], a[208:211], a[116:119], v[36:39]
    ds_read_b64_tr_b16 a[222:223], v2 offset:32032
    v_mfma_f32_16x16x32_bf16 v[40:43], a[208:211], a[120:123], v[40:43]
    buffer_load_dwordx4 a[176:179], v1, s[16:19], s39 offen offset:1024
    v_mfma_f32_16x16x32_bf16 v[44:47], a[208:211], a[124:127], v[44:47]
    s_waitcnt lgkmcnt(4)
    v_mfma_f32_16x16x32_bf16 v[48:51], a[212:215], a[112:115], v[48:51]
    ds_read_b64_tr_b16 a[224:225], v2 offset:20544
    v_mfma_f32_16x16x32_bf16 v[52:55], a[212:215], a[116:119], v[52:55]
    ds_read_b64_tr_b16 a[226:227], v2 offset:22848
    v_mfma_f32_16x16x32_bf16 v[56:59], a[212:215], a[120:123], v[56:59]
    buffer_load_dwordx4 a[180:183], v1, s[16:19], s40 offen offset:1024
    v_mfma_f32_16x16x32_bf16 v[60:63], a[212:215], a[124:127], v[60:63]
    s_waitcnt lgkmcnt(4)
    v_mfma_f32_16x16x32_bf16 v[64:67], a[216:219], a[112:115], v[64:67]
    ds_read_b64_tr_b16 a[208:209], v2 offset:29760
    v_mfma_f32_16x16x32_bf16 v[68:71], a[216:219], a[116:119], v[68:71]
    ds_read_b64_tr_b16 a[210:211], v2 offset:32064
    v_mfma_f32_16x16x32_bf16 v[72:75], a[216:219], a[120:123], v[72:75]
    buffer_load_dwordx4 a[184:187], v1, s[16:19], s41 offen offset:1024
    v_mfma_f32_16x16x32_bf16 v[76:79], a[216:219], a[124:127], v[76:79]
    s_waitcnt lgkmcnt(4)
    v_mfma_f32_16x16x32_bf16 v[80:83], a[220:223], a[112:115], v[80:83]
    ds_read_b64_tr_b16 a[212:213], v2 offset:20576
    v_mfma_f32_16x16x32_bf16 v[84:87], a[220:223], a[116:119], v[84:87]
    ds_read_b64_tr_b16 a[214:215], v2 offset:22880
    v_mfma_f32_16x16x32_bf16 v[88:91], a[220:223], a[120:123], v[88:91]
    buffer_load_dwordx4 a[188:191], v1, s[16:19], s42 offen offset:1024
    v_mfma_f32_16x16x32_bf16 v[92:95], a[220:223], a[124:127], v[92:95]
    s_waitcnt lgkmcnt(4)
    v_mfma_f32_16x16x32_bf16 v[96:99], a[224:227], a[112:115], v[96:99]
    ds_read_b64_tr_b16 a[216:217], v2 offset:29792
    v_mfma_f32_16x16x32_bf16 v[100:103], a[224:227], a[116:119], v[100:103]
    ds_read_b64_tr_b16 a[218:219], v2 offset:32096
    v_mfma_f32_16x16x32_bf16 v[104:107], a[224:227], a[120:123], v[104:107]
    s_add_u32 m0, s37, 102400
    v_mfma_f32_16x16x32_bf16 v[108:111], a[224:227], a[124:127], v[108:111]
    s_waitcnt lgkmcnt(4)
    v_mfma_f32_16x16x32_bf16 v[112:115], a[208:211], a[112:115], v[112:115]
    ds_read_b64_tr_b16 a[220:221], v2 offset:20608
    v_mfma_f32_16x16x32_bf16 v[116:119], a[208:211], a[116:119], v[116:119]
    ds_read_b64_tr_b16 a[222:223], v2 offset:22912
    v_mfma_f32_16x16x32_bf16 v[120:123], a[208:211], a[120:123], v[120:123]
    global_load_lds_dwordx4 v[12:13], off
    v_mfma_f32_16x16x32_bf16 v[124:127], a[208:211], a[124:127], v[124:127]
    s_waitcnt lgkmcnt(4)
    v_mfma_f32_16x16x32_bf16 v[128:131], a[212:215], a[112:115], v[128:131]
    ds_read_b64_tr_b16 a[224:225], v2 offset:29824
    v_mfma_f32_16x16x32_bf16 v[132:135], a[212:215], a[116:119], v[132:135]
    ds_read_b64_tr_b16 a[226:227], v2 offset:32128
    v_mfma_f32_16x16x32_bf16 v[136:139], a[212:215], a[120:123], v[136:139]
    v_add_co_u32 v12, s[62:63], s38, v12
    v_mfma_f32_16x16x32_bf16 v[140:143], a[212:215], a[124:127], v[140:143]
    s_waitcnt lgkmcnt(4)
    v_mfma_f32_16x16x32_bf16 v[144:147], a[216:219], a[112:115], v[144:147]
    ds_read_b64_tr_b16 a[208:209], v2 offset:20640
    v_mfma_f32_16x16x32_bf16 v[148:151], a[216:219], a[116:119], v[148:151]
    ds_read_b64_tr_b16 a[210:211], v2 offset:22944
    v_mfma_f32_16x16x32_bf16 v[152:155], a[216:219], a[120:123], v[152:155]
    s_add_u32 s29, s29, 0
    v_mfma_f32_16x16x32_bf16 v[156:159], a[216:219], a[124:127], v[156:159]
    s_waitcnt lgkmcnt(4)
    v_mfma_f32_16x16x32_bf16 v[160:163], a[220:223], a[112:115], v[160:163]
    ds_read_b64_tr_b16 a[212:213], v2 offset:29856
    v_mfma_f32_16x16x32_bf16 v[164:167], a[220:223], a[116:119], v[164:167]
    ds_read_b64_tr_b16 a[214:215], v2 offset:32160
    v_mfma_f32_16x16x32_bf16 v[168:171], a[220:223], a[120:123], v[168:171]
    s_add_u32 s29, s29, 0
    v_mfma_f32_16x16x32_bf16 v[172:175], a[220:223], a[124:127], v[172:175]
    s_waitcnt lgkmcnt(4)
    v_mfma_f32_16x16x32_bf16 v[176:179], a[224:227], a[112:115], v[176:179]
    ds_read_b64_tr_b16 a[216:217], v2 offset:20672
    v_mfma_f32_16x16x32_bf16 v[180:183], a[224:227], a[116:119], v[180:183]
    ds_read_b64_tr_b16 a[218:219], v2 offset:22976
    v_mfma_f32_16x16x32_bf16 v[184:187], a[224:227], a[120:123], v[184:187]
    v_addc_co_u32 v13, s[62:63], 0, v13, s[62:63]
    v_mfma_f32_16x16x32_bf16 v[188:191], a[224:227], a[124:127], v[188:191]
    s_waitcnt lgkmcnt(4)
    v_mfma_f32_16x16x32_bf16 v[192:195], a[208:211], a[112:115], v[192:195]
    ds_read_b64_tr_b16 a[220:221], v2 offset:29888
    v_mfma_f32_16x16x32_bf16 v[196:199], a[208:211], a[116:119], v[196:199]
    ds_read_b64_tr_b16 a[222:223], v2 offset:32192
    v_mfma_f32_16x16x32_bf16 v[200:203], a[208:211], a[120:123], v[200:203]
    s_add_u32 m0, s33, 102400
    v_mfma_f32_16x16x32_bf16 v[204:207], a[208:211], a[124:127], v[204:207]
    s_waitcnt lgkmcnt(4)
    v_mfma_f32_16x16x32_bf16 v[208:211], a[212:215], a[112:115], v[208:211]
    ds_read_b64_tr_b16 a[224:225], v2 offset:20704
    v_mfma_f32_16x16x32_bf16 v[212:215], a[212:215], a[116:119], v[212:215]
    ds_read_b64_tr_b16 a[226:227], v2 offset:23008
    v_mfma_f32_16x16x32_bf16 v[216:219], a[212:215], a[120:123], v[216:219]
    buffer_load_dwordx4 v8, s[8:11], s28 offen lds
    v_mfma_f32_16x16x32_bf16 v[220:223], a[212:215], a[124:127], v[220:223]
    s_waitcnt lgkmcnt(4)
    v_mfma_f32_16x16x32_bf16 v[224:227], a[216:219], a[112:115], v[224:227]
    ds_read_b64_tr_b16 a[208:209], v2 offset:29920
    v_mfma_f32_16x16x32_bf16 v[228:231], a[216:219], a[116:119], v[228:231]
    ds_read_b64_tr_b16 a[210:211], v2 offset:32224
    v_mfma_f32_16x16x32_bf16 v[232:235], a[216:219], a[120:123], v[232:235]
    s_add_u32 m0, s34, 102400
    v_mfma_f32_16x16x32_bf16 v[236:239], a[216:219], a[124:127], v[236:239]
    s_waitcnt lgkmcnt(4)
    v_mfma_f32_16x16x32_bf16 v[240:243], a[220:223], a[112:115], v[240:243]
    ds_read_b64_tr_b16 a[212:213], v2 offset:20736
    v_mfma_f32_16x16x32_bf16 v[244:247], a[220:223], a[116:119], v[244:247]
    ds_read_b64_tr_b16 a[214:215], v2 offset:23040
    v_mfma_f32_16x16x32_bf16 v[248:251], a[220:223], a[120:123], v[248:251]
    buffer_load_dwordx4 v9, s[8:11], s28 offen lds
    v_mfma_f32_16x16x32_bf16 v[252:255], a[220:223], a[124:127], v[252:255]
    s_waitcnt lgkmcnt(4)
    v_mfma_f32_16x16x32_bf16 a[0:3], a[224:227], a[112:115], a[0:3]
    ds_read_b64_tr_b16 a[216:217], v2 offset:29952
    v_mfma_f32_16x16x32_bf16 a[4:7], a[224:227], a[116:119], a[4:7]
    ds_read_b64_tr_b16 a[218:219], v2 offset:32256
    v_mfma_f32_16x16x32_bf16 a[8:11], a[224:227], a[120:123], a[8:11]
    s_add_u32 m0, s35, 102400
    v_mfma_f32_16x16x32_bf16 a[12:15], a[224:227], a[124:127], a[12:15]
    s_waitcnt lgkmcnt(4)
    v_mfma_f32_16x16x32_bf16 a[16:19], a[208:211], a[112:115], a[16:19]
    ds_read_b128 a[220:223], v5 offset:38912
    v_mfma_f32_16x16x32_bf16 a[20:23], a[208:211], a[116:119], a[20:23]
    buffer_load_dwordx4 v10, s[20:23], s28 offen lds
    v_mfma_f32_16x16x32_bf16 a[24:27], a[208:211], a[120:123], a[24:27]
    s_add_u32 m0, s36, 102400
    v_mfma_f32_16x16x32_bf16 a[28:31], a[208:211], a[124:127], a[28:31]
    s_waitcnt lgkmcnt(3)
    v_mfma_f32_16x16x32_bf16 a[32:35], a[212:215], a[112:115], a[32:35]
    ds_read_b128 a[224:227], v5 offset:39936
    v_mfma_f32_16x16x32_bf16 a[36:39], a[212:215], a[116:119], a[36:39]
    buffer_load_dwordx4 v11, s[12:15], s28 offen lds
    v_mfma_f32_16x16x32_bf16 a[40:43], a[212:215], a[120:123], a[40:43]
    s_add_u32 s28, s28, 294912
    v_mfma_f32_16x16x32_bf16 a[44:47], a[212:215], a[124:127], a[44:47]
    s_waitcnt lgkmcnt(2)
    v_mfma_f32_16x16x32_bf16 a[48:51], a[216:219], a[112:115], a[48:51]
    ds_read_b64_tr_b16 a[208:209], v2 offset:40960
    v_mfma_f32_16x16x32_bf16 a[52:55], a[216:219], a[116:119], a[52:55]
    ds_read_b64_tr_b16 a[210:211], v2 offset:43264
    v_mfma_f32_16x16x32_bf16 a[56:59], a[216:219], a[120:123], a[56:59]
    v_mfma_f32_16x16x32_bf16 a[60:63], a[216:219], a[124:127], a[60:63]
    s_waitcnt lgkmcnt(3)
    v_mfma_f32_16x16x32_bf16 a[64:67], a[112:115], a[220:223], a[64:67]
    ds_read_b64_tr_b16 a[212:213], v2 offset:50176
    v_mfma_f32_16x16x32_bf16 a[68:71], a[116:119], a[220:223], a[68:71]
    ds_read_b64_tr_b16 a[214:215], v2 offset:52480
    v_mfma_f32_16x16x32_bf16 a[72:75], a[120:123], a[220:223], a[72:75]
    v_mfma_f32_16x16x32_bf16 a[76:79], a[124:127], a[220:223], a[76:79]
    s_waitcnt lgkmcnt(4)
    s_cmp_lg_u32 s29, 1
    s_cbranch_scc1 K1_skip1_0
    v_mfma_f32_16x16x32_bf16 a[80:83], a[112:115], a[224:227], a[80:83]
    v_mfma_f32_16x16x32_bf16 a[84:87], a[116:119], a[224:227], a[84:87]
K1_skip1_0:
    s_cmp_lg_u32 s29, 2
    s_cbranch_scc1 K1_skip1_1
    v_mfma_f32_16x16x32_bf16 a[88:91], a[120:123], a[224:227], a[88:91]
    v_mfma_f32_16x16x32_bf16 a[92:95], a[124:127], a[224:227], a[92:95]
K1_skip1_1:
    ds_read_b64_tr_b16 a[216:217], v2 offset:40992
    ds_read_b64_tr_b16 a[218:219], v2 offset:43296
    s_waitcnt vmcnt(18)
    s_barrier
    s_waitcnt lgkmcnt(4)
    v_mfma_f32_16x16x32_bf16 v[32:35], a[208:211], a[128:131], v[32:35]
    ds_read_b64_tr_b16 a[220:221], v2 offset:50208
    v_mfma_f32_16x16x32_bf16 v[36:39], a[208:211], a[132:135], v[36:39]
    ds_read_b64_tr_b16 a[222:223], v2 offset:52512
    v_mfma_f32_16x16x32_bf16 v[40:43], a[208:211], a[136:139], v[40:43]
    buffer_load_dwordx4 a[192:195], v1, s[16:19], s39 offen offset:2048
    v_mfma_f32_16x16x32_bf16 v[44:47], a[208:211], a[140:143], v[44:47]
    s_waitcnt lgkmcnt(4)
    v_mfma_f32_16x16x32_bf16 v[48:51], a[212:215], a[128:131], v[48:51]
    ds_read_b64_tr_b16 a[224:225], v2 offset:41024
    v_mfma_f32_16x16x32_bf16 v[52:55], a[212:215], a[132:135], v[52:55]
    ds_read_b64_tr_b16 a[226:227], v2 offset:43328
    v_mfma_f32_16x16x32_bf16 v[56:59], a[212:215], a[136:139], v[56:59]
    buffer_load_dwordx4 a[196:199], v1, s[16:19], s40 offen offset:2048
    v_mfma_f32_16x16x32_bf16 v[60:63], a[212:215], a[140:143], v[60:63]
    s_waitcnt lgkmcnt(4)
    v_mfma_f32_16x16x32_bf16 v[64:67], a[216:219], a[128:131], v[64:67]
    ds_read_b64_tr_b16 a[208:209], v2 offset:50240
    v_mfma_f32_16x16x32_bf16 v[68:71], a[216:219], a[132:135], v[68:71]
    ds_read_b64_tr_b16 a[210:211], v2 offset:52544
    v_mfma_f32_16x16x32_bf16 v[72:75], a[216:219], a[136:139], v[72:75]
    buffer_load_dwordx4 a[200:203], v1, s[16:19], s41 offen offset:2048
    v_mfma_f32_16x16x32_bf16 v[76:79], a[216:219], a[140:143], v[76:79]
    s_waitcnt lgkmcnt(4)
    v_mfma_f32_16x16x32_bf16 v[80:83], a[220:223], a[128:131], v[80:83]
    ds_read_b64_tr_b16 a[212:213], v2 offset:41056
    v_mfma_f32_16x16x32_bf16 v[84:87], a[220:223], a[132:135], v[84:87]
    ds_read_b64_tr_b16 a[214:215], v2 offset:43360
    v_mfma_f32_16x16x32_bf16 v[88:91], a[220:223], a[136:139], v[88:91]
    buffer_load_dwordx4 a[204:207], v1, s[16:19], s42 offen offset:2048
    v_mfma_f32_16x16x32_bf16 v[92:95], a[220:223], a[140:143], v[92:95]
    s_waitcnt lgkmcnt(4)
    v_mfma_f32_16x16x32_bf16 v[96:99], a[224:227], a[128:131], v[96:99]
    ds_read_b64_tr_b16 a[216:217], v2 offset:50272
    v_mfma_f32_16x16x32_bf16 v[100:103], a[224:227], a[132:135], v[100:103]
    ds_read_b64_tr_b16 a[218:219], v2 offset:52576
    v_mfma_f32_16x16x32_bf16 v[104:107], a[224:227], a[136:139], v[104:107]
    s_add_u32 m0, s37, 122880
    v_mfma_f32_16x16x32_bf16 v[108:111], a[224:227], a[140:143], v[108:111]
    s_waitcnt lgkmcnt(4)
    v_mfma_f32_16x16x32_bf16 v[112:115], a[208:211], a[128:131], v[112:115]
    ds_read_b64_tr_b16 a[220:221], v2 offset:41088
    v_mfma_f32_16x16x32_bf16 v[116:119], a[208:211], a[132:135], v[116:119]
    ds_read_b64_tr_b16 a[222:223], v2 offset:43392
    v_mfma_f32_16x16x32_bf16 v[120:123], a[208:211], a[136:139], v[120:123]
    global_load_lds_dwordx4 v[12:13], off
    v_mfma_f32_16x16x32_bf16 v[124:127], a[208:211], a[140:143], v[124:127]
    s_waitcnt lgkmcnt(4)
    v_mfma_f32_16x16x32_bf16 v[128:131], a[212:215], a[128:131], v[128:131]
    ds_read_b64_tr_b16 a[224:225], v2 offset:50304
    v_mfma_f32_16x16x32_bf16 v[132:135], a[212:215], a[132:135], v[132:135]
    ds_read_b64_tr_b16 a[226:227], v2 offset:52608
    v_mfma_f32_16x16x32_bf16 v[136:139], a[212:215], a[136:139], v[136:139]
    v_add_co_u32 v12, s[62:63], s38, v12
    v_mfma_f32_16x16x32_bf16 v[140:143], a[212:215], a[140:143], v[140:143]
    s_waitcnt lgkmcnt(4)
    v_mfma_f32_16x16x32_bf16 v[144:147], a[216:219], a[128:131], v[144:147]
    ds_read_b64_tr_b16 a[208:209], v2 offset:41120
    v_mfma_f32_16x16x32_bf16 v[148:151], a[216:219], a[132:135], v[148:151]
    ds_read_b64_tr_b16 a[210:211], v2 offset:43424
    v_mfma_f32_16x16x32_bf16 v[152:155], a[216:219], a[136:139], v[152:155]
    s_add_u32 s29, s29, 0
    v_mfma_f32_16x16x32_bf16 v[156:159], a[216:219], a[140:143], v[156:159]
    s_waitcnt lgkmcnt(4)
    v_mfma_f32_16x16x32_bf16 v[160:163], a[220:223], a[128:131], v[160:163]
    ds_read_b64_tr_b16 a[212:213], v2 offset:50336
    v_mfma_f32_16x16x32_bf16 v[164:167], a[220:223], a[132:135], v[164:167]
    ds_read_b64_tr_b16 a[214:215], v2 offset:52640
    v_mfma_f32_16x16x32_bf16 v[168:171], a[220:223], a[136:139], v[168:171]
    s_add_u32 s29, s29, 0
    v_mfma_f32_16x16x32_bf16 v[172:175], a[220:223], a[140:143], v[172:175]
    s_waitcnt lgkmcnt(4)
    v_mfma_f32_16x16x32_bf16 v[176:179], a[224:227], a[128:131], v[176:179]
    ds_read_b64_tr_b16 a[216:217], v2 offset:41152
    v_mfma_f32_16x16x32_bf16 v[180:183], a[224:227], a[132:135], v[180:183]
    ds_read_b64_tr_b16 a[218:219], v2 offset:43456
    v_mfma_f32_16x16x32_bf16 v[184:187], a[224:227], a[136:139], v[184:187]
    v_addc_co_u32 v13, s[62:63], 0, v13, s[62:63]
    v_mfma_f32_16x16x32_bf16 v[188:191], a[224:227], a[140:143], v[188:191]
    s_waitcnt lgkmcnt(4)
    v_mfma_f32_16x16x32_bf16 v[192:195], a[208:211], a[128:131], v[192:195]
    ds_read_b64_tr_b16 a[220:221], v2 offset:50368
    v_mfma_f32_16x16x32_bf16 v[196:199], a[208:211], a[132:135], v[196:199]
    ds_read_b64_tr_b16 a[222:223], v2 offset:52672
    v_mfma_f32_16x16x32_bf16 v[200:203], a[208:211], a[136:139], v[200:203]
    s_add_u32 m0, s33, 122880
    v_mfma_f32_16x16x32_bf16 v[204:207], a[208:211], a[140:143], v[204:207]
    s_waitcnt lgkmcnt(4)
    v_mfma_f32_16x16x32_bf16 v[208:211], a[212:215], a[128:131], v[208:211]
    ds_read_b64_tr_b16 a[224:225], v2 offset:41184
    v_mfma_f32_16x16x32_bf16 v[212:215], a[212:215], a[132:135], v[212:215]
    ds_read_b64_tr_b16 a[226:227], v2 offset:43488
    v_mfma_f32_16x16x32_bf16 v[216:219], a[212:215], a[136:139], v[216:219]
    buffer_load_dwordx4 v8, s[8:11], s28 offen lds
    v_mfma_f32_16x16x32_bf16 v[220:223], a[212:215], a[140:143], v[220:223]
    s_waitcnt lgkmcnt(4)
    v_mfma_f32_16x16x32_bf16 v[224:227], a[216:219], a[128:131], v[224:227]
    ds_read_b64_tr_b16 a[208:209], v2 offset:50400
    v_mfma_f32_16x16x32_bf16 v[228:231], a[216:219], a[132:135], v[228:231]
    ds_read_b64_tr_b16 a[210:211], v2 offset:52704
    v_mfma_f32_16x16x32_bf16 v[232:235], a[216:219], a[136:139], v[232:235]
    s_add_u32 m0, s34, 122880
    v_mfma_f32_16x16x32_bf16 v[236:239], a[216:219], a[140:143], v[236:239]
    s_waitcnt lgkmcnt(4)
    v_mfma_f32_16x16x32_bf16 v[240:243], a[220:223], a[128:131], v[240:243]
    ds_read_b64_tr_b16 a[212:213], v2 offset:41216
    v_mfma_f32_16x16x32_bf16 v[244:247], a[220:223], a[132:135], v[244:247]
    ds_read_b64_tr_b16 a[214:215], v2 offset:43520
    v_mfma_f32_16x16x32_bf16 v[248:251], a[220:223], a[136:139], v[248:251]
    buffer_load_dwordx4 v9, s[8:11], s28 offen lds
    v_mfma_f32_16x16x32_bf16 v[252:255], a[220:223], a[140:143], v[252:255]
    s_waitcnt lgkmcnt(4)
    v_mfma_f32_16x16x32_bf16 a[0:3], a[224:227], a[128:131], a[0:3]
    ds_read_b64_tr_b16 a[216:217], v2 offset:50432
    v_mfma_f32_16x16x32_bf16 a[4:7], a[224:227], a[132:135], a[4:7]
    ds_read_b64_tr_b16 a[218:219], v2 offset:52736
    v_mfma_f32_16x16x32_bf16 a[8:11], a[224:227], a[136:139], a[8:11]
    s_add_u32 m0, s35, 122880
    v_mfma_f32_16x16x32_bf16 a[12:15], a[224:227], a[140:143], a[12:15]
    s_waitcnt lgkmcnt(4)
    v_mfma_f32_16x16x32_bf16 a[16:19], a[208:211], a[128:131], a[16:19]
    ds_read_b128 a[220:223], v5 offset:59392
    v_mfma_f32_16x16x32_bf16 a[20:23], a[208:211], a[132:135], a[20:23]
    buffer_load_dwordx4 v10, s[20:23], s28 offen lds
    v_mfma_f32_16x16x32_bf16 a[24:27], a[208:211], a[136:139], a[24:27]
    s_add_u32 m0, s36, 122880
    v_mfma_f32_16x16x32_bf16 a[28:31], a[208:211], a[140:143], a[28:31]
    s_waitcnt lgkmcnt(3)
    v_mfma_f32_16x16x32_bf16 a[32:35], a[212:215], a[128:131], a[32:35]
    ds_read_b128 a[224:227], v5 offset:60416
    v_mfma_f32_16x16x32_bf16 a[36:39], a[212:215], a[132:135], a[36:39]
    buffer_load_dwordx4 v11, s[12:15], s28 offen lds
    v_mfma_f32_16x16x32_bf16 a[40:43], a[212:215], a[136:139], a[40:43]
    s_add_u32 s28, s28, 294912
    v_mfma_f32_16x16x32_bf16 a[44:47], a[212:215], a[140:143], a[44:47]
    s_waitcnt lgkmcnt(2)
    v_mfma_f32_16x16x32_bf16 a[48:51], a[216:219], a[128:131], a[48:51]
    ds_read_b64_tr_b16 a[208:209], v3 offset:0
    v_mfma_f32_16x16x32_bf16 a[52:55], a[216:219], a[132:135], a[52:55]
    ds_read_b64_tr_b16 a[210:211], v3 offset:2304
    v_mfma_f32_16x16x32_bf16 a[56:59], a[216:219], a[136:139], a[56:59]
    v_mfma_f32_16x16x32_bf16 a[60:63], a[216:219], a[140:143], a[60:63]
    s_waitcnt lgkmcnt(3)
    v_mfma_f32_16x16x32_bf16 a[64:67], a[128:131], a[220:223], a[64:67]
    ds_read_b64_tr_b16 a[212:213], v3 offset:9216
    v_mfma_f32_16x16x32_bf16 a[68:71], a[132:135], a[220:223], a[68:71]
    ds_read_b64_tr_b16 a[214:215], v3 offset:11520
    v_mfma_f32_16x16x32_bf16 a[72:75], a[136:139], a[220:223], a[72:75]
    v_mfma_f32_16x16x32_bf16 a[76:79], a[140:143], a[220:223], a[76:79]
    s_waitcnt lgkmcnt(4)
    s_cmp_lg_u32 s29, 1
    s_cbranch_scc1 K1_skip2_0
    v_mfma_f32_16x16x32_bf16 a[80:83], a[128:131], a[224:227], a[80:83]
    v_mfma_f32_16x16x32_bf16 a[84:87], a[132:135], a[224:227], a[84:87]
K1_skip2_0:
    s_cmp_lg_u32 s29, 2
    s_cbranch_scc1 K1_skip2_1
    v_mfma_f32_16x16x32_bf16 a[88:91], a[136:139], a[224:227], a[88:91]
    v_mfma_f32_16x16x32_bf16 a[92:95], a[140:143], a[224:227], a[92:95]
K1_skip2_1:
    ds_read_b64_tr_b16 a[216:217], v3 offset:32
    ds_read_b64_tr_b16 a[218:219], v3 offset:2336
    s_waitcnt vmcnt(18)
    s_barrier
    s_waitcnt lgkmcnt(4)
    v_mfma_f32_16x16x32_bf16 v[32:35], a[208:211], a[144:147], v[32:35]
    ds_read_b64_tr_b16 a[220:221], v3 offset:9248
    v_mfma_f32_16x16x32_bf16 v[36:39], a[208:211], a[148:151], v[36:39]
    ds_read_b64_tr_b16 a[222:223], v3 offset:11552
    v_mfma_f32_16x16x32_bf16 v[40:43], a[208:211], a[152:155], v[40:43]
    buffer_load_dwordx4 a[96:99], v1, s[16:19], s39 offen offset:3072
    v_mfma_f32_16x16x32_bf16 v[44:47], a[208:211], a[156:159], v[44:47]
    s_add_u32 s39, s39, 4096
    s_waitcnt lgkmcnt(4)
    v_mfma_f32_16x16x32_bf16 v[48:51], a[212:215], a[144:147], v[48:51]
    ds_read_b64_tr_b16 a[224:225], v3 offset:64
    v_mfma_f32_16x16x32_bf16 v[52:55], a[212:215], a[148:151], v[52:55]
    ds_read_b64_tr_b16 a[226:227], v3 offset:2368
    v_mfma_f32_16x16x32_bf16 v[56:59], a[212:215], a[152:155], v[56:59]
    buffer_load_dwordx4 a[100:103], v1, s[16:19], s40 offen offset:3072
    v_mfma_f32_16x16x32_bf16 v[60:63], a[212:215], a[156:159], v[60:63]
    s_add_u32 s40, s40, 4096
    s_waitcnt lgkmcnt(4)
    v_mfma_f32_16x16x32_bf16 v[64:67], a[216:219], a[144:147], v[64:67]
    ds_read_b64_tr_b16 a[208:209], v3 offset:9280
    v_mfma_f32_16x16x32_bf16 v[68:71], a[216:219], a[148:151], v[68:71]
    ds_read_b64_tr_b16 a[210:211], v3 offset:11584
    v_mfma_f32_16x16x32_bf16 v[72:75], a[216:219], a[152:155], v[72:75]
    buffer_load_dwordx4 a[104:107], v1, s[16:19], s41 offen offset:3072
    v_mfma_f32_16x16x32_bf16 v[76:79], a[216:219], a[156:159], v[76:79]
    s_add_u32 s41, s41, 4096
    s_waitcnt lgkmcnt(4)
    v_mfma_f32_16x16x32_bf16 v[80:83], a[220:223], a[144:147], v[80:83]
    ds_read_b64_tr_b16 a[212:213], v3 offset:96
    v_mfma_f32_16x16x32_bf16 v[84:87], a[220:223], a[148:151], v[84:87]
    ds_read_b64_tr_b16 a[214:215], v3 offset:2400
    v_mfma_f32_16x16x32_bf16 v[88:91], a[220:223], a[152:155], v[88:91]
    buffer_load_dwordx4 a[108:111], v1, s[16:19], s42 offen offset:3072
    v_mfma_f32_16x16x32_bf16 v[92:95], a[220:223], a[156:159], v[92:95]
    s_add_u32 s42, s42, 4096
    s_waitcnt lgkmcnt(4)
    v_mfma_f32_16x16x32_bf16 v[96:99], a[224:227], a[144:147], v[96:99]
    ds_read_b64_tr_b16 a[216:217], v3 offset:9312
    v_mfma_f32_16x16x32_bf16 v[100:103], a[224:227], a[148:151], v[100:103]
    ds_read_b64_tr_b16 a[218:219], v3 offset:11616
    v_mfma_f32_16x16x32_bf16 v[104:107], a[224:227], a[152:155], v[104:107]
    s_add_u32 m0, s37, 0
    v_mfma_f32_16x16x32_bf16 v[108:111], a[224:227], a[156:159], v[108:111]
    global_load_lds_dwordx4 v[12:13], off
    s_waitcnt lgkmcnt(4)
    v_mfma_f32_16x16x32_bf16 v[112:115], a[208:211], a[144:147], v[112:115]
    ds_read_b64_tr_b16 a[220:221], v3 offset:128
    v_mfma_f32_16x16x32_bf16 v[116:119], a[208:211], a[148:151], v[116:119]
    ds_read_b64_tr_b16 a[222:223], v3 offset:2432
    v_mfma_f32_16x16x32_bf16 v[120:123], a[208:211], a[152:155], v[120:123]
    v_add_co_u32 v12, s[62:63], s38, v12
    v_mfma_f32_16x16x32_bf16 v[124:127], a[208:211], a[156:159], v[124:127]
    s_add_u32 s29, s29, 0
    s_waitcnt lgkmcnt(4)
    v_mfma_f32_16x16x32_bf16 v[128:131], a[212:215], a[144:147], v[128:131]
    ds_read_b64_tr_b16 a[224:225], v3 offset:9344
    v_mfma_f32_16x16x32_bf16 v[132:135], a[212:215], a[148:151], v[132:135]
    ds_read_b64_tr_b16 a[226:227], v3 offset:11648
    v_mfma_f32_16x16x32_bf16 v[136:139], a[212:215], a[152:155], v[136:139]
    s_add_u32 s29, s29, 0
    v_mfma_f32_16x16x32_bf16 v[140:143], a[212:215], a[156:159], v[140:143]
    v_addc_co_u32 v13, s[62:63], 0, v13, s[62:63]
    s_waitcnt lgkmcnt(4)
    v_mfma_f32_16x16x32_bf16 v[144:147], a[216:219], a[144:147], v[144:147]
    ds_read_b64_tr_b16 a[208:209], v3 offset:160
    v_mfma_f32_16x16x32_bf16 v[148:151], a[216:219], a[148:151], v[148:151]
    ds_read_b64_tr_b16 a[210:211], v3 offset:2464
    v_mfma_f32_16x16x32_bf16 v[152:155], a[216:219], a[152:155], v[152:155]
    s_add_u32 m0, s33, 0
    v_mfma_f32_16x16x32_bf16 v[156:159], a[216:219], a[156:159], v[156:159]
    buffer_load_dwordx4 v8, s[8:11], s28 offen lds
    s_waitcnt lgkmcnt(4)
    v_mfma_f32_16x16x32_bf16 v[160:163], a[220:223], a[144:147], v[160:163]
    ds_read_b64_tr_b16 a[212:213], v3 offset:9376
    v_mfma_f32_16x16x32_bf16 v[164:167], a[220:223], a[148:151], v[164:167]
    ds_read_b64_tr_b16 a[214:215], v3 offset:11680
    v_mfma_f32_16x16x32_bf16 v[168:171], a[220:223], a[152:155], v[168:171]
    s_add_u32 m0, s34, 0
    v_mfma_f32_16x16x32_bf16 v[172:175], a[220:223], a[156:159], v[172:175]
    buffer_load_dwordx4 v9, s[8:11], s28 offen lds
    s_waitcnt lgkmcnt(4)
    v_mfma_f32_16x16x32_bf16 v[176:179], a[224:227], a[144:147], v[176:179]
    ds_read_b64_tr_b16 a[216:217], v3 offset:192
    v_mfma_f32_16x16x32_bf16 v[180:183], a[224:227], a[148:151], v[180:183]
    ds_read_b64_tr_b16 a[218:219], v3 offset:2496
    v_mfma_f32_16x16x32_bf16 v[184:187], a[224:227], a[152:155], v[184:187]
    s_add_u32 m0, s35, 0
    v_mfma_f32_16x16x32_bf16 v[188:191], a[224:227], a[156:159], v[188:191]
    buffer_load_dwordx4 v10, s[20:23], s28 offen lds
    s_waitcnt lgkmcnt(4)
    v_mfma_f32_16x16x32_bf16 v[192:195], a[208:211], a[144:147], v[192:195]
    ds_read_b64_tr_b16 a[220:221], v3 offset:9408
    v_mfma_f32_16x16x32_bf16 v[196:199], a[208:211], a[148:151], v[196:199]
    ds_read_b64_tr_b16 a[222:223], v3 offset:11712
    v_mfma_f32_16x16x32_bf16 v[200:203], a[208:211], a[152:155], v[200:203]
    s_add_u32 m0, s36, 0
    v_mfma_f32_16x16x32_bf16 v[204:207], a[208:211], a[156:159], v[204:207]
    buffer_load_dwordx4 v11, s[12:15], s28 offen lds
    s_waitcnt lgkmcnt(4)
    v_mfma_f32_16x16x32_bf16 v[208:211], a[212:215], a[144:147], v[208:211]
    ds_read_b64_tr_b16 a[224:225], v3 offset:224
    v_mfma_f32_16x16x32_bf16 v[212:215], a[212:215], a[148:151], v[212:215]
    ds_read_b64_tr_b16 a[226:227], v3 offset:2528
    v_mfma_f32_16x16x32_bf16 v[216:219], a[212:215], a[152:155], v[216:219]
    s_add_u32 s28, s28, 294912
    v_mfma_f32_16x16x32_bf16 v[220:223], a[212:215], a[156:159], v[220:223]
    s_waitcnt lgkmcnt(4)
    v_mfma_f32_16x16x32_bf16 v[224:227], a[216:219], a[144:147], v[224:227]
    ds_read_b64_tr_b16 a[208:209], v3 offset:9440
    v_mfma_f32_16x16x32_bf16 v[228:231], a[216:219], a[148:151], v[228:231]
    ds_read_b64_tr_b16 a[210:211], v3 offset:11744
    v_mfma_f32_16x16x32_bf16 v[232:235], a[216:219], a[152:155], v[232:235]
    v_mfma_f32_16x16x32_bf16 v[236:239], a[216:219], a[156:159], v[236:239]
    s_waitcnt lgkmcnt(4)
    v_mfma_f32_16x16x32_bf16 v[240:243], a[220:223], a[144:147], v[240:243]
    ds_read_b64_tr_b16 a[212:213], v3 offset:256
    v_mfma_f32_16x16x32_bf16 v[244:247], a[220:223], a[148:151], v[244:247]
    ds_read_b64_tr_b16 a[214:215], v3 offset:2560
    v_mfma_f32_16x16x32_bf16 v[248:251], a[220:223], a[152:155], v[248:251]
    v_mfma_f32_16x16x32_bf16 v[252:255], a[220:223], a[156:159], v[252:255]
    s_waitcnt lgkmcnt(4)
    v_mfma_f32_16x16x32_bf16 a[0:3], a[224:227], a[144:147], a[0:3]
    ds_read_b64_tr_b16 a[216:217], v3 offset:9472
    v_mfma_f32_16x16x32_bf16 a[4:7], a[224:227], a[148:151], a[4:7]
    ds_read_b64_tr_b16 a[218:219], v3 offset:11776
    v_mfma_f32_16x16x32_bf16 a[8:11], a[224:227], a[152:155], a[8:11]
    v_mfma_f32_16x16x32_bf16 a[12:15], a[224:227], a[156:159], a[12:15]
    s_waitcnt lgkmcnt(4)
    v_mfma_f32_16x16x32_bf16 a[16:19], a[208:211], a[144:147], a[16:19]
    ds_read_b128 a[220:223], v6 offset:18432
    v_mfma_f32_16x16x32_bf16 a[20:23], a[208:211], a[148:151], a[20:23]
    v_mfma_f32_16x16x32_bf16 a[24:27], a[208:211], a[152:155], a[24:27]
    v_mfma_f32_16x16x32_bf16 a[28:31], a[208:211], a[156:159], a[28:31]
    s_waitcnt lgkmcnt(3)
    v_mfma_f32_16x16x32_bf16 a[32:35], a[212:215], a[144:147], a[32:35]
    ds_read_b128 a[224:227], v6 offset:19456
    v_mfma_f32_16x16x32_bf16 a[36:39], a[212:215], a[148:151], a[36:39]
    v_mfma_f32_16x16x32_bf16 a[40:43], a[212:215], a[152:155], a[40:43]
    v_mfma_f32_16x16x32_bf16 a[44:47], a[212:215], a[156:159], a[44:47]
    s_waitcnt lgkmcnt(2)
    v_mfma_f32_16x16x32_bf16 a[48:51], a[216:219], a[144:147], a[48:51]
    ds_read_b64_tr_b16 a[208:209], v3 offset:20480
    v_mfma_f32_16x16x32_bf16 a[52:55], a[216:219], a[148:151], a[52:55]
    ds_read_b64_tr_b16 a[210:211], v3 offset:22784
    v_mfma_f32_16x16x32_bf16 a[56:59], a[216:219], a[152:155], a[56:59]
    v_mfma_f32_16x16x32_bf16 a[60:63], a[216:219], a[156:159], a[60:63]
    s_waitcnt lgkmcnt(3)
    v_mfma_f32_16x16x32_bf16 a[64:67], a[144:147], a[220:223], a[64:67]
    ds_read_b64_tr_b16 a[212:213], v3 offset:29696
    v_mfma_f32_16x16x32_bf16 a[68:71], a[148:151], a[220:223], a[68:71]
    ds_read_b64_tr_b16 a[214:215], v3 offset:32000
    v_mfma_f32_16x16x32_bf16 a[72:75], a[152:155], a[220:223], a[72:75]
    v_mfma_f32_16x16x32_bf16 a[76:79], a[156:159], a[220:223], a[76:79]
    s_waitcnt lgkmcnt(4)
    s_cmp_lg_u32 s29, 1
    s_cbranch_scc1 K1_skip3_0
    v_mfma_f32_16x16x32_bf16 a[80:83], a[144:147], a[224:227], a[80:83]
    v_mfma_f32_16x16x32_bf16 a[84:87], a[148:151], a[224:227], a[84:87]
K1_skip3_0:
    s_cmp_lg_u32 s29, 2
    s_cbranch_scc1 K1_skip3_1
    v_mfma_f32_16x16x32_bf16 a[88:91], a[152:155], a[224:227], a[88:91]
    v_mfma_f32_16x16x32_bf16 a[92:95], a[156:159], a[224:227], a[92:95]
K1_skip3_1:
    ds_read_b64_tr_b16 a[216:217], v3 offset:20512
    ds_read_b64_tr_b16 a[218:219], v3 offset:22816
    s_waitcnt vmcnt(18)
    s_barrier
    s_waitcnt lgkmcnt(4)
    v_mfma_f32_16x16x32_bf16 v[32:35], a[208:211], a[160:163], v[32:35]
    ds_read_b64_tr_b16 a[220:221], v3 offset:29728
    v_mfma_f32_16x16x32_bf16 v[36:39], a[208:211], a[164:167], v[36:39]
    ds_read_b64_tr_b16 a[222:223], v3 offset:32032
    v_mfma_f32_16x16x32_bf16 v[40:43], a[208:211], a[168:171], v[40:43]
    buffer_load_dwordx4 a[112:115], v1, s[16:19], s39 offen offset:0
    v_mfma_f32_16x16x32_bf16 v[44:47], a[208:211], a[172:175], v[44:47]
    s_waitcnt lgkmcnt(4)
    v_mfma_f32_16x16x32_bf16 v[48:51], a[212:215], a[160:163], v[48:51]
    ds_read_b64_tr_b16 a[224:225], v3 offset:20544
    v_mfma_f32_16x16x32_bf16 v[52:55], a[212:215], a[164:167], v[52:55]
    ds_read_b64_tr_b16 a[226:227], v3 offset:22848
    v_mfma_f32_16x16x32_bf16 v[56:59], a[212:215], a[168:171], v[56:59]
    buffer_load_dwordx4 a[116:119], v1, s[16:19], s40 offen offset:0
    v_mfma_f32_16x16x32_bf16 v[60:63], a[212:215], a[172:175], v[60:63]
    s_waitcnt lgkmcnt(4)
    v_mfma_f32_16x16x32_bf16 v[64:67], a[216:219], a[160:163], v[64:67]
    ds_read_b64_tr_b16 a[208:209], v3 offset:29760
    v_mfma_f32_16x16x32_bf16 v[68:71], a[216:219], a[164:167], v[68:71]
    ds_read_b64_tr_b16 a[210:211], v3 offset:32064
    v_mfma_f32_16x16x32_bf16 v[72:75], a[216:219], a[168:171], v[72:75]
    buffer_load_dwordx4 a[120:123], v1, s[16:19], s41 offen offset:0
    v_mfma_f32_16x16x32_bf16 v[76:79], a[216:219], a[172:175], v[76:79]
    s_waitcnt lgkmcnt(4)
    v_mfma_f32_16x16x32_bf16 v[80:83], a[220:223], a[160:163], v[80:83]
    ds_read_b64_tr_b16 a[212:213], v3 offset:20576
    v_mfma_f32_16x16x32_bf16 v[84:87], a[220:223], a[164:167], v[84:87]
    ds_read_b64_tr_b16 a[214:215], v3 offset:22880
    v_mfma_f32_16x16x32_bf16 v[88:91], a[220:223], a[168:171], v[88:91]
    buffer_load_dwordx4 a[124:127], v1, s[16:19], s42 offen offset:0
    v_mfma_f32_16x16x32_bf16 v[92:95], a[220:223], a[172:175], v[92:95]
    s_waitcnt lgkmcnt(4)
    v_mfma_f32_16x16x32_bf16 v[96:99], a[224:227], a[160:163], v[96:99]
    ds_read_b64_tr_b16 a[216:217], v3 offset:29792
    v_mfma_f32_16x16x32_bf16 v[100:103], a[224:227], a[164:167], v[100:103]
    ds_read_b64_tr_b16 a[218:219], v3 offset:32096
    v_mfma_f32_16x16x32_bf16 v[104:107], a[224:227], a[168:171], v[104:107]
    s_add_u32 m0, s37, 20480
    v_mfma_f32_16x16x32_bf16 v[108:111], a[224:227], a[172:175], v[108:111]
    s_waitcnt lgkmcnt(4)
    v_mfma_f32_16x16x32_bf16 v[112:115], a[208:211], a[160:163], v[112:115]
    ds_read_b64_tr_b16 a[220:221], v3 offset:20608
    v_mfma_f32_16x16x32_bf16 v[116:119], a[208:211], a[164:167], v[116:119]
    ds_read_b64_tr_b16 a[222:223], v3 offset:22912
    v_mfma_f32_16x16x32_bf16 v[120:123], a[208:211], a[168:171], v[120:123]
    global_load_lds_dwordx4 v[12:13], off
    v_mfma_f32_16x16x32_bf16 v[124:127], a[208:211], a[172:175], v[124:127]
    s_waitcnt lgkmcnt(4)
    v_mfma_f32_16x16x32_bf16 v[128:131], a[212:215], a[160:163], v[128:131]
    ds_read_b64_tr_b16 a[224:225], v3 offset:29824
    v_mfma_f32_16x16x32_bf16 v[132:135], a[212:215], a[164:167], v[132:135]
    ds_read_b64_tr_b16 a[226:227], v3 offset:32128
    v_mfma_f32_16x16x32_bf16 v[136:139], a[212:215], a[168:171], v[136:139]
    v_add_co_u32 v12, s[62:63], s38, v12
    v_mfma_f32_16x16x32_bf16 v[140:143], a[212:215], a[172:175], v[140:143]
    s_waitcnt lgkmcnt(4)
    v_mfma_f32_16x16x32_bf16 v[144:147], a[216:219], a[160:163], v[144:147]
    ds_read_b64_tr_b16 a[208:209], v3 offset:20640
    v_mfma_f32_16x16x32_bf16 v[148:151], a[216:219], a[164:167], v[148:151]
    ds_read_b64_tr_b16 a[210:211], v3 offset:22944
    v_mfma_f32_16x16x32_bf16 v[152:155], a[216:219], a[168:171], v[152:155]
    s_add_u32 s29, s29, 0
    v_mfma_f32_16x16x32_bf16 v[156:159], a[216:219], a[172:175], v[156:159]
    s_waitcnt lgkmcnt(4)
    v_mfma_f32_16x16x32_bf16 v[160:163], a[220:223], a[160:163], v[160:163]
    ds_read_b64_tr_b16 a[212:213], v3 offset:29856
    v_mfma_f32_16x16x32_bf16 v[164:167], a[220:223], a[164:167], v[164:167]
    ds_read_b64_tr_b16 a[214:215], v3 offset:32160
    v_mfma_f32_16x16x32_bf16 v[168:171], a[220:223], a[168:171], v[168:171]
    s_add_u32 s29, s29, 0
    v_mfma_f32_16x16x32_bf16 v[172:175], a[220:223], a[172:175], v[172:175]
    s_waitcnt lgkmcnt(4)
    v_mfma_f32_16x16x32_bf16 v[176:179], a[224:227], a[160:163], v[176:179]
    ds_read_b64_tr_b16 a[216:217], v3 offset:20672
    v_mfma_f32_16x16x32_bf16 v[180:183], a[224:227], a[164:167], v[180:183]
    ds_read_b64_tr_b16 a[218:219], v3 offset:22976
    v_mfma_f32_16x16x32_bf16 v[184:187], a[224:227], a[168:171], v[184:187]
    v_addc_co_u32 v13, s[62:63], 0, v13, s[62:63]
    v_mfma_f32_16x16x32_bf16 v[188:191], a[224:227], a[172:175], v[188:191]
    s_waitcnt lgkmcnt(4)
    v_mfma_f32_16x16x32_bf16 v[192:195], a[208:211], a[160:163], v[192:195]
    ds_read_b64_tr_b16 a[220:221], v3 offset:29888
    v_mfma_f32_16x16x32_bf16 v[196:199], a[208:211], a[164:167], v[196:199]
    ds_read_b64_tr_b16 a[222:223], v3 offset:32192
    v_mfma_f32_16x16x32_bf16 v[200:203], a[208:211], a[168:171], v[200:203]
    s_add_u32 m0, s33, 20480
    v_mfma_f32_16x16x32_bf16 v[204:207], a[208:211], a[172:175], v[204:207]
    s_waitcnt lgkmcnt(4)
    v_mfma_f32_16x16x32_bf16 v[208:211], a[212:215], a[160:163], v[208:211]
    ds_read_b64_tr_b16 a[224:225], v3 offset:20704
    v_mfma_f32_16x16x32_bf16 v[212:215], a[212:215], a[164:167], v[212:215]
    ds_read_b64_tr_b16 a[226:227], v3 offset:23008
    v_mfma_f32_16x16x32_bf16 v[216:219], a[212:215], a[168:171], v[216:219]
    buffer_load_dwordx4 v8, s[8:11], s28 offen lds
    v_mfma_f32_16x16x32_bf16 v[220:223], a[212:215], a[172:175], v[220:223]
    s_waitcnt lgkmcnt(4)
    v_mfma_f32_16x16x32_bf16 v[224:227], a[216:219], a[160:163], v[224:227]
    ds_read_b64_tr_b16 a[208:209], v3 offset:29920
    v_mfma_f32_16x16x32_bf16 v[228:231], a[216:219], a[164:167], v[228:231]
    ds_read_b64_tr_b16 a[210:211], v3 offset:32224
    v_mfma_f32_16x16x32_bf16 v[232:235], a[216:219], a[168:171], v[232:235]
    s_add_u32 m0, s34, 20480
    v_mfma_f32_16x16x32_bf16 v[236:239], a[216:219], a[172:175], v[236:239]
    s_waitcnt lgkmcnt(4)
    v_mfma_f32_16x16x32_bf16 v[240:243], a[220:223], a[160:163], v[240:243]
    ds_read_b64_tr_b16 a[212:213], v3 offset:20736
    v_mfma_f32_16x16x32_bf16 v[244:247], a[220:223], a[164:167], v[244:247]
    ds_read_b64_tr_b16 a[214:215], v3 offset:23040
    v_mfma_f32_16x16x32_bf16 v[248:251], a[220:223], a[168:171], v[248:251]
    buffer_load_dwordx4 v9, s[8:11], s28 offen lds
    v_mfma_f32_16x16x32_bf16 v[252:255], a[220:223], a[172:175], v[252:255]
    s_waitcnt lgkmcnt(4)
    v_mfma_f32_16x16x32_bf16 a[0:3], a[224:227], a[160:163], a[0:3]
    ds_read_b64_tr_b16 a[216:217], v3 offset:29952
    v_mfma_f32_16x16x32_bf16 a[4:7], a[224:227], a[164:167], a[4:7]
    ds_read_b64_tr_b16 a[218:219], v3 offset:32256
    v_mfma_f32_16x16x32_bf16 a[8:11], a[224:227], a[168:171], a[8:11]
    s_add_u32 m0, s35, 20480
    v_mfma_f32_16x16x32_bf16 a[12:15], a[224:227], a[172:175], a[12:15]
    s_waitcnt lgkmcnt(4)
    v_mfma_f32_16x16x32_bf16 a[16:19], a[208:211], a[160:163], a[16:19]
    ds_read_b128 a[220:223], v6 offset:38912
    v_mfma_f32_16x16x32_bf16 a[20:23], a[208:211], a[164:167], a[20:23]
    buffer_load_dwordx4 v10, s[20:23], s28 offen lds
    v_mfma_f32_16x16x32_bf16 a[24:27], a[208:211], a[168:171], a[24:27]
    s_add_u32 m0, s36, 20480
    v_mfma_f32_16x16x32_bf16 a[28:31], a[208:211], a[172:175], a[28:31]
    s_waitcnt lgkmcnt(3)
    v_mfma_f32_16x16x32_bf16 a[32:35], a[212:215], a[160:163], a[32:35]
    ds_read_b128 a[224:227], v6 offset:39936
    v_mfma_f32_16x16x32_bf16 a[36:39], a[212:215], a[164:167], a[36:39]
    buffer_load_dwordx4 v11, s[12:15], s28 offen lds
    v_mfma_f32_16x16x32_bf16 a[40:43], a[212:215], a[168:171], a[40:43]
    s_add_u32 s28, s28, 294912
    v_mfma_f32_16x16x32_bf16 a[44:47], a[212:215], a[172:175], a[44:47]
    s_waitcnt lgkmcnt(2)
    v_mfma_f32_16x16x32_bf16 a[48:51], a[216:219], a[160:163], a[48:51]
    ds_read_b64_tr_b16 a[208:209], v3 offset:40960
    v_mfma_f32_16x16x32_bf16 a[52:55], a[216:219], a[164:167], a[52:55]
    ds_read_b64_tr_b16 a[210:211], v3 offset:43264
    v_mfma_f32_16x16x32_bf16 a[56:59], a[216:219], a[168:171], a[56:59]
    v_mfma_f32_16x16x32_bf16 a[60:63], a[216:219], a[172:175], a[60:63]
    s_waitcnt lgkmcnt(3)
    v_mfma_f32_16x16x32_bf16 a[64:67], a[160:163], a[220:223], a[64:67]
    ds_read_b64_tr_b16 a[212:213], v3 offset:50176
    v_mfma_f32_16x16x32_bf16 a[68:71], a[164:167], a[220:223], a[68:71]
    ds_read_b64_tr_b16 a[214:215], v3 offset:52480
    v_mfma_f32_16x16x32_bf16 a[72:75], a[168:171], a[220:223], a[72:75]
    v_mfma_f32_16x16x32_bf16 a[76:79], a[172:175], a[220:223], a[76:79]
    s_waitcnt lgkmcnt(4)
    s_cmp_lg_u32 s29, 1
    s_cbranch_scc1 K1_skip4_0
    v_mfma_f32_16x16x32_bf16 a[80:83], a[160:163], a[224:227], a[80:83]
    v_mfma_f32_16x16x32_bf16 a[84:87], a[164:167], a[224:227], a[84:87]
K1_skip4_0:
    s_cmp_lg_u32 s29, 2
    s_cbranch_scc1 K1_skip4_1
    v_mfma_f32_16x16x32_bf16 a[88:91], a[168:171], a[224:227], a[88:91]
    v_mfma_f32_16x16x32_bf16 a[92:95], a[172:175], a[224:227], a[92:95]
K1_skip4_1:
    ds_read_b64_tr_b16 a[216:217], v3 offset:40992
    ds_read_b64_tr_b16 a[218:219], v3 offset:43296
    s_waitcnt vmcnt(18)
    s_barrier
    s_waitcnt lgkmcnt(4)
    v_mfma_f32_16x16x32_bf16 v[32:35], a[208:211], a[176:179], v[32:35]
    ds_read_b64_tr_b16 a[220:221], v3 offset:50208
    v_mfma_f32_16x16x32_bf16 v[36:39], a[208:211], a[180:183], v[36:39]
    ds_read_b64_tr_b16 a[222:223], v3 offset:52512
    v_mfma_f32_16x16x32_bf16 v[40:43], a[208:211], a[184:187], v[40:43]
    buffer_load_dwordx4 a[128:131], v1, s[16:19], s39 offen offset:1024
    v_mfma_f32_16x16x32_bf16 v[44:47], a[208:211], a[188:191], v[44:47]
    buffer_load_dwordx4 a[132:135], v1, s[16:19], s40 offen offset:1024
    s_waitcnt lgkmcnt(4)
    v_mfma_f32_16x16x32_bf16 v[48:51], a[212:215], a[176:179], v[48:51]
    ds_read_b64_tr_b16 a[224:225], v3 offset:41024
    v_mfma_f32_16x16x32_bf16 v[52:55], a[212:215], a[180:183], v[52:55]
    ds_read_b64_tr_b16 a[226:227], v3 offset:43328
    v_mfma_f32_16x16x32_bf16 v[56:59], a[212:215], a[184:187], v[56:59]
    buffer_load_dwordx4 a[136:139], v1, s[16:19], s41 offen offset:1024
    v_mfma_f32_16x16x32_bf16 v[60:63], a[212:215], a[188:191], v[60:63]
    buffer_load_dwordx4 a[140:143], v1, s[16:19], s42 offen offset:1024
    s_waitcnt lgkmcnt(4)
    v_mfma_f32_16x16x32_bf16 v[64:67], a[216:219], a[176:179], v[64:67]
    ds_read_b64_tr_b16 a[208:209], v3 offset:50240
    v_mfma_f32_16x16x32_bf16 v[68:71], a[216:219], a[180:183], v[68:71]
    ds_read_b64_tr_b16 a[210:211], v3 offset:52544
    v_mfma_f32_16x16x32_bf16 v[72:75], a[216:219], a[184:187], v[72:75]
    s_add_u32 m0, s37, 40960
    v_mfma_f32_16x16x32_bf16 v[76:79], a[216:219], a[188:191], v[76:79]
    global_load_lds_dwordx4 v[12:13], off
    s_waitcnt lgkmcnt(4)
    v_mfma_f32_16x16x32_bf16 v[80:83], a[220:223], a[176:179], v[80:83]
    ds_read_b64_tr_b16 a[212:213], v3 offset:41056
    v_mfma_f32_16x16x32_bf16 v[84:87], a[220:223], a[180:183], v[84:87]
    ds_read_b64_tr_b16 a[214:215], v3 offset:43360
    v_mfma_f32_16x16x32_bf16 v[88:91], a[220:223], a[184:187], v[88:91]
    v_add_co_u32 v12, s[62:63], s38, v12
    v_mfma_f32_16x16x32_bf16 v[92:95], a[220:223], a[188:191], v[92:95]
    s_add_u32 s29, s29, 0
    s_waitcnt lgkmcnt(4)
    v_mfma_f32_16x16x32_bf16 v[96:99], a[224:227], a[176:179], v[96:99]
    ds_read_b64_tr_b16 a[216:217], v3 offset:50272
    v_mfma_f32_16x16x32_bf16 v[100:103], a[224:227], a[180:183], v[100:103]
    ds_read_b64_tr_b16 a[218:219], v3 offset:52576
    v_mfma_f32_16x16x32_bf16 v[104:107], a[224:227], a[184:187], v[104:107]
    s_add_u32 s29, s29, 0
    v_mfma_f32_16x16x32_bf16 v[108:111], a[224:227], a[188:191], v[108:111]
    v_addc_co_u32 v13, s[62:63], 0, v13, s[62:63]
    s_waitcnt lgkmcnt(4)
    v_mfma_f32_16x16x32_bf16 v[112:115], a[208:211], a[176:179], v[112:115]
    ds_read_b64_tr_b16 a[220:221], v3 offset:41088
    v_mfma_f32_16x16x32_bf16 v[116:119], a[208:211], a[180:183], v[116:119]
    ds_read_b64_tr_b16 a[222:223], v3 offset:43392
    v_mfma_f32_16x16x32_bf16 v[120:123], a[208:211], a[184:187], v[120:123]
    s_add_u32 m0, s33, 40960
    v_mfma_f32_16x16x32_bf16 v[124:127], a[208:211], a[188:191], v[124:127]
    buffer_load_dwordx4 v8, s[8:11], s28 offen lds
    s_waitcnt lgkmcnt(4)
    v_mfma_f32_16x16x32_bf16 v[128:131], a[212:215], a[176:179], v[128:131]
    ds_read_b64_tr_b16 a[224:225], v3 offset:50304
    v_mfma_f32_16x16x32_bf16 v[132:135], a[212:215], a[180:183], v[132:135]
    ds_read_b64_tr_b16 a[226:227], v3 offset:52608
    v_mfma_f32_16x16x32_bf16 v[136:139], a[212:215], a[184:187], v[136:139]
    s_add_u32 m0, s34, 40960
    v_mfma_f32_16x16x32_bf16 v[140:143], a[212:215], a[188:191], v[140:143]
    buffer_load_dwordx4 v9, s[8:11], s28 offen lds
    s_waitcnt lgkmcnt(4)
    v_mfma_f32_16x16x32_bf16 v[144:147], a[216:219], a[176:179], v[144:147]
    ds_read_b64_tr_b16 a[208:209], v3 offset:41120
    v_mfma_f32_16x16x32_bf16 v[148:151], a[216:219], a[180:183], v[148:151]
    ds_read_b64_tr_b16 a[210:211], v3 offset:43424
    v_mfma_f32_16x16x32_bf16 v[152:155], a[216:219], a[184:187], v[152:155]
    s_add_u32 m0, s35, 40960
    v_mfma_f32_16x16x32_bf16 v[156:159], a[216:219], a[188:191], v[156:159]
    buffer_load_dwordx4 v10, s[20:23], s28 offen lds
    s_waitcnt lgkmcnt(4)
    v_mfma_f32_16x16x32_bf16 v[160:163], a[220:223], a[176:179], v[160:163]
    ds_read_b64_tr_b16 a[212:213], v3 offset:50336
    v_mfma_f32_16x16x32_bf16 v[164:167], a[220:223], a[180:183], v[164:167]
    ds_read_b64_tr_b16 a[214:215], v3 offset:52640
    v_mfma_f32_16x16x32_bf16 v[168:171], a[220:223], a[184:187], v[168:171]
    s_add_u32 m0, s36, 40960
    v_mfma_f32_16x16x32_bf16 v[172:175], a[220:223], a[188:191], v[172:175]
    buffer_load_dwordx4 v11, s[12:15], s28 offen lds
    s_waitcnt lgkmcnt(4)
    v_mfma_f32_16x16x32_bf16 v[176:179], a[224:227], a[176:179], v[176:179]
    ds_read_b64_tr_b16 a[216:217], v3 offset:41152
    v_mfma_f32_16x16x32_bf16 v[180:183], a[224:227], a[180:183], v[180:183]
    ds_read_b64_tr_b16 a[218:219], v3 offset:43456
    v_mfma_f32_16x16x32_bf16 v[184:187], a[224:227], a[184:187], v[184:187]
    s_add_u32 s28, s28, 294912
    v_mfma_f32_16x16x32_bf16 v[188:191], a[224:227], a[188:191], v[188:191]
    buffer_load_dwordx4 a[144:147], v1, s[16:19], s39 offen offset:2048
    s_waitcnt lgkmcnt(4)
    v_mfma_f32_16x16x32_bf16 v[192:195], a[208:211], a[176:179], v[192:195]
    ds_read_b64_tr_b16 a[220:221], v3 offset:50368
    v_mfma_f32_16x16x32_bf16 v[196:199], a[208:211], a[180:183], v[196:199]
    ds_read_b64_tr_b16 a[222:223], v3 offset:52672
    v_mfma_f32_16x16x32_bf16 v[200:203], a[208:211], a[184:187], v[200:203]
    buffer_load_dwordx4 a[148:151], v1, s[16:19], s40 offen offset:2048
    v_mfma_f32_16x16x32_bf16 v[204:207], a[208:211], a[188:191], v[204:207]
    buffer_load_dwordx4 a[152:155], v1, s[16:19], s41 offen offset:2048
    s_waitcnt lgkmcnt(4)
    v_mfma_f32_16x16x32_bf16 v[208:211], a[212:215], a[176:179], v[208:211]
    ds_read_b64_tr_b16 a[224:225], v3 offset:41184
    v_mfma_f32_16x16x32_bf16 v[212:215], a[212:215], a[180:183], v[212:215]
    ds_read_b64_tr_b16 a[226:227], v3 offset:43488
    v_mfma_f32_16x16x32_bf16 v[216:219], a[212:215], a[184:187], v[216:219]
    buffer_load_dwordx4 a[156:159], v1, s[16:19], s42 offen offset:2048
    v_mfma_f32_16x16x32_bf16 v[220:223], a[212:215], a[188:191], v[220:223]
    s_add_u32 m0, s37, 61440
    s_waitcnt lgkmcnt(4)
    v_mfma_f32_16x16x32_bf16 v[224:227], a[216:219], a[176:179], v[224:227]
    ds_read_b64_tr_b16 a[208:209], v3 offset:50400
    v_mfma_f32_16x16x32_bf16 v[228:231], a[216:219], a[180:183], v[228:231]
    ds_read_b64_tr_b16 a[210:211], v3 offset:52704
    v_mfma_f32_16x16x32_bf16 v[232:235], a[216:219], a[184:187], v[232:235]
    global_load_lds_dwordx4 v[12:13], off
    v_mfma_f32_16x16x32_bf16 v[236:239], a[216:219], a[188:191], v[236:239]
    v_add_co_u32 v12, s[62:63], s38, v12
    s_waitcnt lgkmcnt(4)
    v_mfma_f32_16x16x32_bf16 v[240:243], a[220:223], a[176:179], v[240:243]
    ds_read_b64_tr_b16 a[212:213], v3 offset:41216
    v_mfma_f32_16x16x32_bf16 v[244:247], a[220:223], a[180:183], v[244:247]
    ds_read_b64_tr_b16 a[214:215], v3 offset:43520
    v_mfma_f32_16x16x32_bf16 v[248:251], a[220:223], a[184:187], v[248:251]
    s_add_u32 s29, s29, 0
    v_mfma_f32_16x16x32_bf16 v[252:255], a[220:223], a[188:191], v[252:255]
    s_add_u32 s29, s29, 0
    s_waitcnt lgkmcnt(4)
    v_mfma_f32_16x16x32_bf16 a[0:3], a[224:227], a[176:179], a[0:3]
    ds_read_b64_tr_b16 a[216:217], v3 offset:50432
    v_mfma_f32_16x16x32_bf16 a[4:7], a[224:227], a[180:183], a[4:7]
    ds_read_b64_tr_b16 a[218:219], v3 offset:52736
    v_mfma_f32_16x16x32_bf16 a[8:11], a[224:227], a[184:187], a[8:11]
    v_addc_co_u32 v13, s[62:63], 0, v13, s[62:63]
    v_mfma_f32_16x16x32_bf16 a[12:15], a[224:227], a[188:191], a[12:15]
    s_add_u32 m0, s33, 61440
    s_waitcnt lgkmcnt(4)
    v_mfma_f32_16x16x32_bf16 a[16:19], a[208:211], a[176:179], a[16:19]
    ds_read_b128 a[220:223], v6 offset:59392
    v_mfma_f32_16x16x32_bf16 a[20:23], a[208:211], a[180:183], a[20:23]
    buffer_load_dwordx4 v8, s[8:11], s28 offen lds
    v_mfma_f32_16x16x32_bf16 a[24:27], a[208:211], a[184:187], a[24:27]
    s_add_u32 m0, s34, 61440
    v_mfma_f32_16x16x32_bf16 a[28:31], a[208:211], a[188:191], a[28:31]
    buffer_load_dwordx4 v9, s[8:11], s28 offen lds
    s_waitcnt lgkmcnt(3)
    v_mfma_f32_16x16x32_bf16 a[32:35], a[212:215], a[176:179], a[32:35]
    ds_read_b128 a[224:227], v6 offset:60416
    v_mfma_f32_16x16x32_bf16 a[36:39], a[212:215], a[180:183], a[36:39]
    s_add_u32 m0, s35, 61440
    v_mfma_f32_16x16x32_bf16 a[40:43], a[212:215], a[184:187], a[40:43]
    buffer_load_dwordx4 v10, s[20:23], s28 offen lds
    v_mfma_f32_16x16x32_bf16 a[44:47], a[212:215], a[188:191], a[44:47]
    s_add_u32 m0, s36, 61440
    s_waitcnt lgkmcnt(2)
    v_mfma_f32_16x16x32_bf16 a[48:51], a[216:219], a[176:179], a[48:51]
    ds_read_b64_tr_b16 a[208:209], v4 offset:0
    v_mfma_f32_16x16x32_bf16 a[52:55], a[216:219], a[180:183], a[52:55]
    ds_read_b64_tr_b16 a[210:211], v4 offset:2304
    v_mfma_f32_16x16x32_bf16 a[56:59], a[216:219], a[184:187], a[56:59]
    buffer_load_dwordx4 v11, s[12:15], s28 offen lds
    v_mfma_f32_16x16x32_bf16 a[60:63], a[216:219], a[188:191], a[60:63]
    s_add_u32 s28, s28, 294912
    s_waitcnt lgkmcnt(3)
    v_mfma_f32_16x16x32_bf16 a[64:67], a[176:179], a[220:223], a[64:67]
    ds_read_b64_tr_b16 a[212:213], v4 offset:9216
    v_mfma_f32_16x16x32_bf16 a[68:71], a[180:183], a[220:223], a[68:71]
    ds_read_b64_tr_b16 a[214:215], v4 offset:11520
    v_mfma_f32_16x16x32_bf16 a[72:75], a[184:187], a[220:223], a[72:75]
    v_mfma_f32_16x16x32_bf16 a[76:79], a[188:191], a[220:223], a[76:79]
    s_waitcnt lgkmcnt(4)
    s_cmp_lg_u32 s29, 1
    s_cbranch_scc1 K1_skip5_0
    v_mfma_f32_16x16x32_bf16 a[80:83], a[176:179], a[224:227], a[80:83]
    v_mfma_f32_16x16x32_bf16 a[84:87], a[180:183], a[224:227], a[84:87]
K1_skip5_0:
    s_cmp_lg_u32 s29, 2
    s_cbranch_scc1 K1_skip5_1
    v_mfma_f32_16x16x32_bf16 a[88:91], a[184:187], a[224:227], a[88:91]
    v_mfma_f32_16x16x32_bf16 a[92:95], a[188:191], a[224:227], a[92:95]
K1_skip5_1:
    ds_read_b64_tr_b16 a[216:217], v4 offset:32
    ds_read_b64_tr_b16 a[218:219], v4 offset:2336
    s_waitcnt vmcnt(27)
    s_barrier
    s_waitcnt lgkmcnt(4)
    v_mfma_f32_16x16x32_bf16 v[32:35], a[208:211], a[192:195], v[32:35]
    ds_read_b64_tr_b16 a[220:221], v4 offset:9248
    v_mfma_f32_16x16x32_bf16 v[36:39], a[208:211], a[196:199], v[36:39]
    ds_read_b64_tr_b16 a[222:223], v4 offset:11552
    v_mfma_f32_16x16x32_bf16 v[40:43], a[208:211], a[200:203], v[40:43]
    buffer_load_dwordx4 a[160:163], v1, s[16:19], s39 offen offset:3072
    v_mfma_f32_16x16x32_bf16 v[44:47], a[208:211], a[204:207], v[44:47]
    s_add_u32 s39, s39, 4096
    s_waitcnt lgkmcnt(4)
    v_mfma_f32_16x16x32_bf16 v[48:51], a[212:215], a[192:195], v[48:51]
    ds_read_b64_tr_b16 a[224:225], v4 offset:64
    v_mfma_f32_16x16x32_bf16 v[52:55], a[212:215], a[196:199], v[52:55]
    ds_read_b64_tr_b16 a[226:227], v4 offset:2368
    v_mfma_f32_16x16x32_bf16 v[56:59], a[212:215], a[200:203], v[56:59]
    buffer_load_dwordx4 a[164:167], v1, s[16:19], s40 offen offset:3072
    v_mfma_f32_16x16x32_bf16 v[60:63], a[212:215], a[204:207], v[60:63]
    s_add_u32 s40, s40, 4096
    s_waitcnt lgkmcnt(4)
    v_mfma_f32_16x16x32_bf16 v[64:67], a[216:219], a[192:195], v[64:67]
    ds_read_b64_tr_b16 a[208:209], v4 offset:9280
    v_mfma_f32_16x16x32_bf16 v[68:71], a[216:219], a[196:199], v[68:71]
    ds_read_b64_tr_b16 a[210:211], v4 offset:11584
    v_mfma_f32_16x16x32_bf16 v[72:75], a[216:219], a[200:203], v[72:75]
    buffer_load_dwordx4 a[168:171], v1, s[16:19], s41 offen offset:3072
    v_mfma_f32_16x16x32_bf16 v[76:79], a[216:219], a[204:207], v[76:79]
    s_add_u32 s41, s41, 4096
    s_waitcnt lgkmcnt(4)
    v_mfma_f32_16x16x32_bf16 v[80:83], a[220:223], a[192:195], v[80:83]
    ds_read_b64_tr_b16 a[212:213], v4 offset:96
    v_mfma_f32_16x16x32_bf16 v[84:87], a[220:223], a[196:199], v[84:87]
    ds_read_b64_tr_b16 a[214:215], v4 offset:2400
    v_mfma_f32_16x16x32_bf16 v[88:91], a[220:223], a[200:203], v[88:91]
    buffer_load_dwordx4 a[172:175], v1, s[16:19], s42 offen offset:3072
    v_mfma_f32_16x16x32_bf16 v[92:95], a[220:223], a[204:207], v[92:95]
    s_add_u32 s42, s42, 4096
    s_waitcnt lgkmcnt(4)
    v_mfma_f32_16x16x32_bf16 v[96:99], a[224:227], a[192:195], v[96:99]
    ds_read_b64_tr_b16 a[216:217], v4 offset:9312
    v_mfma_f32_16x16x32_bf16 v[100:103], a[224:227], a[196:199], v[100:103]
    ds_read_b64_tr_b16 a[218:219], v4 offset:11616
    v_mfma_f32_16x16x32_bf16 v[104:107], a[224:227], a[200:203], v[104:107]
    s_add_u32 m0, s37, 81920
    v_mfma_f32_16x16x32_bf16 v[108:111], a[224:227], a[204:207], v[108:111]
    global_load_lds_dwordx4 v[12:13], off
    s_waitcnt lgkmcnt(4)
    v_mfma_f32_16x16x32_bf16 v[112:115], a[208:211], a[192:195], v[112:115]
    ds_read_b64_tr_b16 a[220:221], v4 offset:128
    v_mfma_f32_16x16x32_bf16 v[116:119], a[208:211], a[196:199], v[116:119]
    ds_read_b64_tr_b16 a[222:223], v4 offset:2432
    v_mfma_f32_16x16x32_bf16 v[120:123], a[208:211], a[200:203], v[120:123]
    v_add_co_u32 v12, s[62:63], s38, v12
    v_mfma_f32_16x16x32_bf16 v[124:127], a[208:211], a[204:207], v[124:127]
    s_add_u32 s29, s29, 0
    s_waitcnt lgkmcnt(4)
    v_mfma_f32_16x16x32_bf16 v[128:131], a[212:215], a[192:195], v[128:131]
    ds_read_b64_tr_b16 a[224:225], v4 offset:9344
    v_mfma_f32_16x16x32_bf16 v[132:135], a[212:215], a[196:199], v[132:135]
    ds_read_b64_tr_b16 a[226:227], v4 offset:11648
    v_mfma_f32_16x16x32_bf16 v[136:139], a[212:215], a[200:203], v[136:139]
    s_add_u32 s29, s29, 0
    v_mfma_f32_16x16x32_bf16 v[140:143], a[212:215], a[204:207], v[140:143]
    v_addc_co_u32 v13, s[62:63], 0, v13, s[62:63]
    s_waitcnt lgkmcnt(4)
    v_mfma_f32_16x16x32_bf16 v[144:147], a[216:219], a[192:195], v[144:147]
    ds_read_b64_tr_b16 a[208:209], v4 offset:160
    v_mfma_f32_16x16x32_bf16 v[148:151], a[216:219], a[196:199], v[148:151]
    ds_read_b64_tr_b16 a[210:211], v4 offset:2464
    v_mfma_f32_16x16x32_bf16 v[152:155], a[216:219], a[200:203], v[152:155]
    s_add_u32 m0, s33, 81920
    v_mfma_f32_16x16x32_bf16 v[156:159], a[216:219], a[204:207], v[156:159]
    buffer_load_dwordx4 v8, s[8:11], s28 offen lds
    s_waitcnt lgkmcnt(4)
    v_mfma_f32_16x16x32_bf16 v[160:163], a[220:223], a[192:195], v[160:163]
    ds_read_b64_tr_b16 a[212:213], v4 offset:9376
    v_mfma_f32_16x16x32_bf16 v[164:167], a[220:223], a[196:199], v[164:167]
    ds_read_b64_tr_b16 a[214:215], v4 offset:11680
    v_mfma_f32_16x16x32_bf16 v[168:171], a[220:223], a[200:203], v[168:171]
    s_add_u32 m0, s34, 81920
    v_mfma_f32_16x16x32_bf16 v[172:175], a[220:223], a[204:207], v[172:175]
    buffer_load_dwordx4 v9, s[8:11], s28 offen lds
    s_waitcnt lgkmcnt(4)
    v_mfma_f32_16x16x32_bf16 v[176:179], a[224:227], a[192:195], v[176:179]
    ds_read_b64_tr_b16 a[216:217], v4 offset:192
    v_mfma_f32_16x16x32_bf16 v[180:183], a[224:227], a[196:199], v[180:183]
    ds_read_b64_tr_b16 a[218:219], v4 offset:2496
    v_mfma_f32_16x16x32_bf16 v[184:187], a[224:227], a[200:203], v[184:187]
    s_add_u32 m0, s35, 81920
    v_mfma_f32_16x16x32_bf16 v[188:191], a[224:227], a[204:207], v[188:191]
    buffer_load_dwordx4 v10, s[20:23], s28 offen lds
    s_waitcnt lgkmcnt(4)
    v_mfma_f32_16x16x32_bf16 v[192:195], a[208:211], a[192:195], v[192:195]
    ds_read_b64_tr_b16 a[220:221], v4 offset:9408
    v_mfma_f32_16x16x32_bf16 v[196:199], a[208:211], a[196:199], v[196:199]
    ds_read_b64_tr_b16 a[222:223], v4 offset:11712
    v_mfma_f32_16x16x32_bf16 v[200:203], a[208:211], a[200:203], v[200:203]
    s_add_u32 m0, s36, 81920
    v_mfma_f32_16x16x32_bf16 v[204:207], a[208:211], a[204:207], v[204:207]
    buffer_load_dwordx4 v11, s[12:15], s28 offen lds
    s_waitcnt lgkmcnt(4)
    v_mfma_f32_16x16x32_bf16 v[208:211], a[212:215], a[192:195], v[208:211]
    ds_read_b64_tr_b16 a[224:225], v4 offset:224
    v_mfma_f32_16x16x32_bf16 v[212:215], a[212:215], a[196:199], v[212:215]
    ds_read_b64_tr_b16 a[226:227], v4 offset:2528
    v_mfma_f32_16x16x32_bf16 v[216:219], a[212:215], a[200:203], v[216:219]
    s_add_u32 s28, s28, 294912
    v_mfma_f32_16x16x32_bf16 v[220:223], a[212:215], a[204:207], v[220:223]
    s_waitcnt lgkmcnt(4)
    v_mfma_f32_16x16x32_bf16 v[224:227], a[216:219], a[192:195], v[224:227]
    ds_read_b64_tr_b16 a[208:209], v4 offset:9440
    v_mfma_f32_16x16x32_bf16 v[228:231], a[216:219], a[196:199], v[228:231]
    ds_read_b64_tr_b16 a[210:211], v4 offset:11744
    v_mfma_f32_16x16x32_bf16 v[232:235], a[216:219], a[200:203], v[232:235]
    v_mfma_f32_16x16x32_bf16 v[236:239], a[216:219], a[204:207], v[236:239]
    s_waitcnt lgkmcnt(4)
    v_mfma_f32_16x16x32_bf16 v[240:243], a[220:223], a[192:195], v[240:243]
    ds_read_b64_tr_b16 a[212:213], v4 offset:256
    v_mfma_f32_16x16x32_bf16 v[244:247], a[220:223], a[196:199], v[244:247]
    ds_read_b64_tr_b16 a[214:215], v4 offset:2560
    v_mfma_f32_16x16x32_bf16 v[248:251], a[220:223], a[200:203], v[248:251]
    v_mfma_f32_16x16x32_bf16 v[252:255], a[220:223], a[204:207], v[252:255]
    s_waitcnt lgkmcnt(4)
    v_mfma_f32_16x16x32_bf16 a[0:3], a[224:227], a[192:195], a[0:3]
    ds_read_b64_tr_b16 a[216:217], v4 offset:9472
    v_mfma_f32_16x16x32_bf16 a[4:7], a[224:227], a[196:199], a[4:7]
    ds_read_b64_tr_b16 a[218:219], v4 offset:11776
    v_mfma_f32_16x16x32_bf16 a[8:11], a[224:227], a[200:203], a[8:11]
    v_mfma_f32_16x16x32_bf16 a[12:15], a[224:227], a[204:207], a[12:15]
    s_waitcnt lgkmcnt(4)
    v_mfma_f32_16x16x32_bf16 a[16:19], a[208:211], a[192:195], a[16:19]
    ds_read_b128 a[220:223], v7 offset:18432
    v_mfma_f32_16x16x32_bf16 a[20:23], a[208:211], a[196:199], a[20:23]
    v_mfma_f32_16x16x32_bf16 a[24:27], a[208:211], a[200:203], a[24:27]
    v_mfma_f32_16x16x32_bf16 a[28:31], a[208:211], a[204:207], a[28:31]
    s_waitcnt lgkmcnt(3)
    v_mfma_f32_16x16x32_bf16 a[32:35], a[212:215], a[192:195], a[32:35]
    ds_read_b128 a[224:227], v7 offset:19456
    v_mfma_f32_16x16x32_bf16 a[36:39], a[212:215], a[196:199], a[36:39]
    v_mfma_f32_16x16x32_bf16 a[40:43], a[212:215], a[200:203], a[40:43]
    v_mfma_f32_16x16x32_bf16 a[44:47], a[212:215], a[204:207], a[44:47]
    s_waitcnt lgkmcnt(2)
    v_mfma_f32_16x16x32_bf16 a[48:51], a[216:219], a[192:195], a[48:51]
    ds_read_b64_tr_b16 a[208:209], v2 offset:0
    v_mfma_f32_16x16x32_bf16 a[52:55], a[216:219], a[196:199], a[52:55]
    ds_read_b64_tr_b16 a[210:211], v2 offset:2304
    v_mfma_f32_16x16x32_bf16 a[56:59], a[216:219], a[200:203], a[56:59]
    v_mfma_f32_16x16x32_bf16 a[60:63], a[216:219], a[204:207], a[60:63]
    s_waitcnt lgkmcnt(3)
    v_mfma_f32_16x16x32_bf16 a[64:67], a[192:195], a[220:223], a[64:67]
    ds_read_b64_tr_b16 a[212:213], v2 offset:9216
    v_mfma_f32_16x16x32_bf16 a[68:71], a[196:199], a[220:223], a[68:71]
    ds_read_b64_tr_b16 a[214:215], v2 offset:11520
    v_mfma_f32_16x16x32_bf16 a[72:75], a[200:203], a[220:223], a[72:75]
    v_mfma_f32_16x16x32_bf16 a[76:79], a[204:207], a[220:223], a[76:79]
    s_waitcnt lgkmcnt(4)
    s_cmp_lg_u32 s29, 1
    s_cbranch_scc1 K1_skip6_0
    v_mfma_f32_16x16x32_bf16 a[80:83], a[192:195], a[224:227], a[80:83]
    v_mfma_f32_16x16x32_bf16 a[84:87], a[196:199], a[224:227], a[84:87]
K1_skip6_0:
    s_cmp_lg_u32 s29, 2
    s_cbranch_scc1 K1_skip6_1
    v_mfma_f32_16x16x32_bf16 a[88:91], a[200:203], a[224:227], a[88:91]
    v_mfma_f32_16x16x32_bf16 a[92:95], a[204:207], a[224:227], a[92:95]
K1_skip6_1:
    ds_read_b64_tr_b16 a[216:217], v2 offset:32
    ds_read_b64_tr_b16 a[218:219], v2 offset:2336
    s_waitcnt vmcnt(27)
    s_barrier
    s_waitcnt lgkmcnt(4)
    v_mfma_f32_16x16x32_bf16 v[32:35], a[208:211], a[96:99], v[32:35]
    ds_read_b64_tr_b16 a[220:221], v2 offset:9248
    v_mfma_f32_16x16x32_bf16 v[36:39], a[208:211], a[100:103], v[36:39]
    ds_read_b64_tr_b16 a[222:223], v2 offset:11552
    v_mfma_f32_16x16x32_bf16 v[40:43], a[208:211], a[104:107], v[40:43]
    buffer_load_dwordx4 a[176:179], v1, s[16:19], s39 offen offset:0
    v_mfma_f32_16x16x32_bf16 v[44:47], a[208:211], a[108:111], v[44:47]
    buffer_load_dwordx4 a[180:183], v1, s[16:19], s40 offen offset:0
    s_waitcnt lgkmcnt(4)
    v_mfma_f32_16x16x32_bf16 v[48:51], a[212:215], a[96:99], v[48:51]
    ds_read_b64_tr_b16 a[224:225], v2 offset:64
    v_mfma_f32_16x16x32_bf16 v[52:55], a[212:215], a[100:103], v[52:55]
    ds_read_b64_tr_b16 a[226:227], v2 offset:2368
    v_mfma_f32_16x16x32_bf16 v[56:59], a[212:215], a[104:107], v[56:59]
    buffer_load_dwordx4 a[184:187], v1, s[16:19], s41 offen offset:0
    v_mfma_f32_16x16x32_bf16 v[60:63], a[212:215], a[108:111], v[60:63]
    buffer_load_dwordx4 a[188:191], v1, s[16:19], s42 offen offset:0
    s_waitcnt lgkmcnt(4)
    v_mfma_f32_16x16x32_bf16 v[64:67], a[216:219], a[96:99], v[64:67]
    ds_read_b64_tr_b16 a[208:209], v2 offset:9280
    v_mfma_f32_16x16x32_bf16 v[68:71], a[216:219], a[100:103], v[68:71]
    ds_read_b64_tr_b16 a[210:211], v2 offset:11584
    v_mfma_f32_16x16x32_bf16 v[72:75], a[216:219], a[104:107], v[72:75]
    s_add_u32 m0, s37, 102400
    v_mfma_f32_16x16x32_bf16 v[76:79], a[216:219], a[108:111], v[76:79]
    global_load_lds_dwordx4 v[12:13], off
    s_waitcnt lgkmcnt(4)
    v_mfma_f32_16x16x32_bf16 v[80:83], a[220:223], a[96:99], v[80:83]
    ds_read_b64_tr_b16 a[212:213], v2 offset:96
    v_mfma_f32_16x16x32_bf16 v[84:87], a[220:223], a[100:103], v[84:87]
    ds_read_b64_tr_b16 a[214:215], v2 offset:2400
    v_mfma_f32_16x16x32_bf16 v[88:91], a[220:223], a[104:107], v[88:91]
    v_add_co_u32 v12, s[62:63], s38, v12
    v_mfma_f32_16x16x32_bf16 v[92:95], a[220:223], a[108:111], v[92:95]
    s_add_u32 s29, s29, 0
    s_waitcnt lgkmcnt(4)
    v_mfma_f32_16x16x32_bf16 v[96:99], a[224:227], a[96:99], v[96:99]
    ds_read_b64_tr_b16 a[216:217], v2 offset:9312
    v_mfma_f32_16x16x32_bf16 v[100:103], a[224:227], a[100:103], v[100:103]
    ds_read_b64_tr_b16 a[218:219], v2 offset:11616
    v_mfma_f32_16x16x32_bf16 v[104:107], a[224:227], a[104:107], v[104:107]
    s_add_u32 s29, s29, 0
    v_mfma_f32_16x16x32_bf16 v[108:111], a[224:227], a[108:111], v[108:111]
    v_addc_co_u32 v13, s[62:63], 0, v13, s[62:63]
    s_waitcnt lgkmcnt(4)
    v_mfma_f32_16x16x32_bf16 v[112:115], a[208:211], a[96:99], v[112:115]
    ds_read_b64_tr_b16 a[220:221], v2 offset:128
    v_mfma_f32_16x16x32_bf16 v[116:119], a[208:211], a[100:103], v[116:119]
    ds_read_b64_tr_b16 a[222:223], v2 offset:2432
    v_mfma_f32_16x16x32_bf16 v[120:123], a[208:211], a[104:107], v[120:123]
    s_add_u32 m0, s33, 102400
    v_mfma_f32_16x16x32_bf16 v[124:127], a[208:211], a[108:111], v[124:127]
    buffer_load_dwordx4 v8, s[8:11], s28 offen lds
    s_waitcnt lgkmcnt(4)
    v_mfma_f32_16x16x32_bf16 v[128:131], a[212:215], a[96:99], v[128:131]
    ds_read_b64_tr_b16 a[224:225], v2 offset:9344
    v_mfma_f32_16x16x32_bf16 v[132:135], a[212:215], a[100:103], v[132:135]
    ds_read_b64_tr_b16 a[226:227], v2 offset:11648
    v_mfma_f32_16x16x32_bf16 v[136:139], a[212:215], a[104:107], v[136:139]
    s_add_u32 m0, s34, 102400
    v_mfma_f32_16x16x32_bf16 v[140:143], a[212:215], a[108:111], v[140:143]
    buffer_load_dwordx4 v9, s[8:11], s28 offen lds
    s_waitcnt lgkmcnt(4)
    v_mfma_f32_16x16x32_bf16 v[144:147], a[216:219], a[96:99], v[144:147]
    ds_read_b64_tr_b16 a[208:209], v2 offset:160
    v_mfma_f32_16x16x32_bf16 v[148:151], a[216:219], a[100:103], v[148:151]
    ds_read_b64_tr_b16 a[210:211], v2 offset:2464
    v_mfma_f32_16x16x32_bf16 v[152:155], a[216:219], a[104:107], v[152:155]
    s_add_u32 m0, s35, 102400
    v_mfma_f32_16x16x32_bf16 v[156:159], a[216:219], a[108:111], v[156:159]
    buffer_load_dwordx4 v10, s[20:23], s28 offen lds
    s_waitcnt lgkmcnt(4)
    v_mfma_f32_16x16x32_bf16 v[160:163], a[220:223], a[96:99], v[160:163]
    ds_read_b64_tr_b16 a[212:213], v2 offset:9376
    v_mfma_f32_16x16x32_bf16 v[164:167], a[220:223], a[100:103], v[164:167]
    ds_read_b64_tr_b16 a[214:215], v2 offset:11680
    v_mfma_f32_16x16x32_bf16 v[168:171], a[220:223], a[104:107], v[168:171]
    s_add_u32 m0, s36, 102400
    v_mfma_f32_16x16x32_bf16 v[172:175], a[220:223], a[108:111], v[172:175]
    buffer_load_dwordx4 v11, s[12:15], s28 offen lds
    s_waitcnt lgkmcnt(4)
    v_mfma_f32_16x16x32_bf16 v[176:179], a[224:227], a[96:99], v[176:179]
    ds_read_b64_tr_b16 a[216:217], v2 offset:192
    v_mfma_f32_16x16x32_bf16 v[180:183], a[224:227], a[100:103], v[180:183]
    ds_read_b64_tr_b16 a[218:219], v2 offset:2496
    v_mfma_f32_16x16x32_bf16 v[184:187], a[224:227], a[104:107], v[184:187]
    s_add_u32 s28, s28, 294912
    v_mfma_f32_16x16x32_bf16 v[188:191], a[224:227], a[108:111], v[188:191]
    s_lshr_b32 s55, s2, 3
    s_waitcnt lgkmcnt(4)
    v_mfma_f32_16x16x32_bf16 v[192:195], a[208:211], a[96:99], v[192:195]
    ds_read_b64_tr_b16 a[220:221], v2 offset:9408
    v_mfma_f32_16x16x32_bf16 v[196:199], a[208:211], a[100:103], v[196:199]
    ds_read_b64_tr_b16 a[222:223], v2 offset:11712
    v_mfma_f32_16x16x32_bf16 v[200:203], a[208:211], a[104:107], v[200:203]
    s_lshl_b32 s55, s55, 2
    v_mfma_f32_16x16x32_bf16 v[204:207], a[208:211], a[108:111], v[204:207]
    s_add_u32 s55, s55, s52
    s_waitcnt lgkmcnt(4)
    v_mfma_f32_16x16x32_bf16 v[208:211], a[212:215], a[96:99], v[208:211]
    ds_read_b64_tr_b16 a[224:225], v2 offset:224
    v_mfma_f32_16x16x32_bf16 v[212:215], a[212:215], a[100:103], v[212:215]
    ds_read_b64_tr_b16 a[226:227], v2 offset:2528
    v_mfma_f32_16x16x32_bf16 v[216:219], a[212:215], a[104:107], v[216:219]
    s_getpc_b64 s[56:57]
TC_K1_phase2_a246p2:
    v_mfma_f32_16x16x32_bf16 v[220:223], a[212:215], a[108:111], v[220:223]
    s_add_u32 s56, s56, K1_phase2-TC_K1_phase2_a246p2
    s_waitcnt lgkmcnt(4)
    v_mfma_f32_16x16x32_bf16 v[224:227], a[216:219], a[96:99], v[224:227]
    ds_read_b64_tr_b16 a[208:209], v2 offset:9440
    v_mfma_f32_16x16x32_bf16 v[228:231], a[216:219], a[100:103], v[228:231]
    ds_read_b64_tr_b16 a[210:211], v2 offset:11744
    v_mfma_f32_16x16x32_bf16 v[232:235], a[216:219], a[104:107], v[232:235]
    s_addc_u32 s57, s57, 0
    v_mfma_f32_16x16x32_bf16 v[236:239], a[216:219], a[108:111], v[236:239]
    s_mov_b32 s58, (k1_kernel_end-K1_phase2+127)/128
    s_waitcnt lgkmcnt(4)
    v_mfma_f32_16x16x32_bf16 v[240:243], a[220:223], a[96:99], v[240:243]
    ds_read_b64_tr_b16 a[212:213], v2 offset:256
    v_mfma_f32_16x16x32_bf16 v[244:247], a[220:223], a[100:103], v[244:247]
    ds_read_b64_tr_b16 a[214:215], v2 offset:2560
    v_mfma_f32_16x16x32_bf16 v[248:251], a[220:223], a[104:107], v[248:251]
    s_add_u32 s58, s58, 127
    v_mfma_f32_16x16x32_bf16 v[252:255], a[220:223], a[108:111], v[252:255]
    s_mov_b32 s59, 33554432
    s_waitcnt lgkmcnt(4)
    v_mfma_f32_16x16x32_bf16 a[0:3], a[224:227], a[96:99], a[0:3]
    ds_read_b64_tr_b16 a[216:217], v2 offset:9472
    v_mfma_f32_16x16x32_bf16 a[4:7], a[224:227], a[100:103], a[4:7]
    ds_read_b64_tr_b16 a[218:219], v2 offset:11776
    v_mfma_f32_16x16x32_bf16 a[8:11], a[224:227], a[104:107], a[8:11]
    s_mul_hi_u32 s58, s58, s59
    v_mfma_f32_16x16x32_bf16 a[12:15], a[224:227], a[108:111], a[12:15]
    v_mbcnt_lo_u32_b32 v16, -1, 0
    s_waitcnt lgkmcnt(4)
    v_mfma_f32_16x16x32_bf16 a[16:19], a[208:211], a[96:99], a[16:19]
    ds_read_b128 a[220:223], v5 offset:18432
    v_mfma_f32_16x16x32_bf16 a[20:23], a[208:211], a[100:103], a[20:23]
    v_mbcnt_hi_u32_b32 v16, -1, v16
    v_mfma_f32_16x16x32_bf16 a[24:27], a[208:211], a[104:107], a[24:27]
    s_sub_u32 s59, s58, 1
    v_mfma_f32_16x16x32_bf16 a[28:31], a[208:211], a[108:111], a[28:31]
    v_min_u32 v16, s59, v16
    s_waitcnt lgkmcnt(3)
    v_mfma_f32_16x16x32_bf16 a[32:35], a[212:215], a[96:99], a[32:35]
    ds_read_b128 a[224:227], v5 offset:19456
    v_mfma_f32_16x16x32_bf16 a[36:39], a[212:215], a[100:103], a[36:39]
    s_mul_i32 s58, s58, s55
    v_mfma_f32_16x16x32_bf16 a[40:43], a[212:215], a[104:107], a[40:43]
    v_add_u32 v16, s58, v16
    v_mfma_f32_16x16x32_bf16 a[44:47], a[212:215], a[108:111], a[44:47]
    v_lshlrev_b32 v16, 7, v16
    s_waitcnt lgkmcnt(2)
    v_mfma_f32_16x16x32_bf16 a[48:51], a[216:219], a[96:99], a[48:51]
    ds_read_b64_tr_b16 a[208:209], v2 offset:20480
    v_mfma_f32_16x16x32_bf16 a[52:55], a[216:219], a[100:103], a[52:55]
    ds_read_b64_tr_b16 a[210:211], v2 offset:22784
    v_mfma_f32_16x16x32_bf16 a[56:59], a[216:219], a[104:107], a[56:59]
    s_mov_b32 s59, k1_kernel_end-K1_phase2-4
    v_mfma_f32_16x16x32_bf16 a[60:63], a[216:219], a[108:111], a[60:63]
    v_min_u32 v16, s59, v16
    s_waitcnt lgkmcnt(3)
    v_mfma_f32_16x16x32_bf16 a[64:67], a[96:99], a[220:223], a[64:67]
    ds_read_b64_tr_b16 a[212:213], v2 offset:29696
    v_mfma_f32_16x16x32_bf16 a[68:71], a[100:103], a[220:223], a[68:71]
    ds_read_b64_tr_b16 a[214:215], v2 offset:32000
    v_mfma_f32_16x16x32_bf16 a[72:75], a[104:107], a[220:223], a[72:75]
    v_mov_b32 v17, s57
    v_mfma_f32_16x16x32_bf16 a[76:79], a[108:111], a[220:223], a[76:79]
    v_add_co_u32 v16, s[60:61], s56, v16
    s_waitcnt lgkmcnt(4)
    s_cmp_lg_u32 s29, 1
    s_cbranch_scc1 K1_skip7_0
    v_mfma_f32_16x16x32_bf16 a[80:83], a[96:99], a[224:227], a[80:83]
    v_mfma_f32_16x16x32_bf16 a[84:87], a[100:103], a[224:227], a[84:87]
K1_skip7_0:
    s_cmp_lg_u32 s29, 2
    s_cbranch_scc1 K1_skip7_1
    v_mfma_f32_16x16x32_bf16 a[88:91], a[104:107], a[224:227], a[88:91]
    v_mfma_f32_16x16x32_bf16 a[92:95], a[108:111], a[224:227], a[92:95]
K1_skip7_1:
    ds_read_b64_tr_b16 a[216:217], v2 offset:20512
    ds_read_b64_tr_b16 a[218:219], v2 offset:22816
    s_nop 1
    v_addc_co_u32 v17, s[60:61], 0, v17, s[60:61]
    global_load_dword a246, v[16:17], off
    s_waitcnt vmcnt(28)
    s_barrier
    s_waitcnt lgkmcnt(4)
    v_mfma_f32_16x16x32_bf16 v[32:35], a[208:211], a[112:115], v[32:35]
    ds_read_b64_tr_b16 a[220:221], v2 offset:29728
    v_mfma_f32_16x16x32_bf16 v[36:39], a[208:211], a[116:119], v[36:39]
    ds_read_b64_tr_b16 a[222:223], v2 offset:32032
    v_mfma_f32_16x16x32_bf16 v[40:43], a[208:211], a[120:123], v[40:43]
    buffer_load_dwordx4 a[192:195], v1, s[16:19], s39 offen offset:1024
    v_mfma_f32_16x16x32_bf16 v[44:47], a[208:211], a[124:127], v[44:47]
    buffer_load_dwordx4 a[196:199], v1, s[16:19], s40 offen offset:1024
    s_waitcnt lgkmcnt(4)
    v_mfma_f32_16x16x32_bf16 v[48:51], a[212:215], a[112:115], v[48:51]
    ds_read_b64_tr_b16 a[224:225], v2 offset:20544
    v_mfma_f32_16x16x32_bf16 v[52:55], a[212:215], a[116:119], v[52:55]
    ds_read_b64_tr_b16 a[226:227], v2 offset:22848
    v_mfma_f32_16x16x32_bf16 v[56:59], a[212:215], a[120:123], v[56:59]
    buffer_load_dwordx4 a[200:203], v1, s[16:19], s41 offen offset:1024
    v_mfma_f32_16x16x32_bf16 v[60:63], a[212:215], a[124:127], v[60:63]
    buffer_load_dwordx4 a[204:207], v1, s[16:19], s42 offen offset:1024
    s_waitcnt lgkmcnt(4)
    v_mfma_f32_16x16x32_bf16 v[64:67], a[216:219], a[112:115], v[64:67]
    ds_read_b64_tr_b16 a[208:209], v2 offset:29760
    v_mfma_f32_16x16x32_bf16 v[68:71], a[216:219], a[116:119], v[68:71]
    ds_read_b64_tr_b16 a[210:211], v2 offset:32064
    v_mfma_f32_16x16x32_bf16 v[72:75], a[216:219], a[120:123], v[72:75]
    s_add_u32 m0, s37, 122880
    v_mfma_f32_16x16x32_bf16 v[76:79], a[216:219], a[124:127], v[76:79]
    global_load_lds_dwordx4 v[12:13], off
    s_waitcnt lgkmcnt(4)
    v_mfma_f32_16x16x32_bf16 v[80:83], a[220:223], a[112:115], v[80:83]
    ds_read_b64_tr_b16 a[212:213], v2 offset:20576
    v_mfma_f32_16x16x32_bf16 v[84:87], a[220:223], a[116:119], v[84:87]
    ds_read_b64_tr_b16 a[214:215], v2 offset:22880
    v_mfma_f32_16x16x32_bf16 v[88:91], a[220:223], a[120:123], v[88:91]
    v_add_co_u32 v12, s[62:63], s38, v12
    v_mfma_f32_16x16x32_bf16 v[92:95], a[220:223], a[124:127], v[92:95]
    s_add_u32 s29, s29, 0
    s_waitcnt lgkmcnt(4)
    v_mfma_f32_16x16x32_bf16 v[96:99], a[224:227], a[112:115], v[96:99]
    ds_read_b64_tr_b16 a[216:217], v2 offset:29792
    v_mfma_f32_16x16x32_bf16 v[100:103], a[224:227], a[116:119], v[100:103]
    ds_read_b64_tr_b16 a[218:219], v2 offset:32096
    v_mfma_f32_16x16x32_bf16 v[104:107], a[224:227], a[120:123], v[104:107]
    s_add_u32 s29, s29, 0
    v_mfma_f32_16x16x32_bf16 v[108:111], a[224:227], a[124:127], v[108:111]
    v_addc_co_u32 v13, s[62:63], 0, v13, s[62:63]
    s_waitcnt lgkmcnt(4)
    v_mfma_f32_16x16x32_bf16 v[112:115], a[208:211], a[112:115], v[112:115]
    ds_read_b64_tr_b16 a[220:221], v2 offset:20608
    v_mfma_f32_16x16x32_bf16 v[116:119], a[208:211], a[116:119], v[116:119]
    ds_read_b64_tr_b16 a[222:223], v2 offset:22912
    v_mfma_f32_16x16x32_bf16 v[120:123], a[208:211], a[120:123], v[120:123]
    s_add_u32 m0, s33, 122880
    v_mfma_f32_16x16x32_bf16 v[124:127], a[208:211], a[124:127], v[124:127]
    buffer_load_dwordx4 v8, s[8:11], s28 offen lds
    s_waitcnt lgkmcnt(4)
    v_mfma_f32_16x16x32_bf16 v[128:131], a[212:215], a[112:115], v[128:131]
    ds_read_b64_tr_b16 a[224:225], v2 offset:29824
    v_mfma_f32_16x16x32_bf16 v[132:135], a[212:215], a[116:119], v[132:135]
    ds_read_b64_tr_b16 a[226:227], v2 offset:32128
    v_mfma_f32_16x16x32_bf16 v[136:139], a[212:215], a[120:123], v[136:139]
    s_add_u32 m0, s34, 122880
    v_mfma_f32_16x16x32_bf16 v[140:143], a[212:215], a[124:127], v[140:143]
    buffer_load_dwordx4 v9, s[8:11], s28 offen lds
    s_waitcnt lgkmcnt(4)
    v_mfma_f32_16x16x32_bf16 v[144:147], a[216:219], a[112:115], v[144:147]
    ds_read_b64_tr_b16 a[208:209], v2 offset:20640
    v_mfma_f32_16x16x32_bf16 v[148:151], a[216:219], a[116:119], v[148:151]
    ds_read_b64_tr_b16 a[210:211], v2 offset:22944
    v_mfma_f32_16x16x32_bf16 v[152:155], a[216:219], a[120:123], v[152:155]
    s_add_u32 m0, s35, 122880
    v_mfma_f32_16x16x32_bf16 v[156:159], a[216:219], a[124:127], v[156:159]
    buffer_load_dwordx4 v10, s[20:23], s28 offen lds
    s_waitcnt lgkmcnt(4)
    v_mfma_f32_16x16x32_bf16 v[160:163], a[220:223], a[112:115], v[160:163]
    ds_read_b64_tr_b16 a[212:213], v2 offset:29856
    v_mfma_f32_16x16x32_bf16 v[164:167], a[220:223], a[116:119], v[164:167]
    ds_read_b64_tr_b16 a[214:215], v2 offset:32160
    v_mfma_f32_16x16x32_bf16 v[168:171], a[220:223], a[120:123], v[168:171]
    s_add_u32 m0, s36, 122880
    v_mfma_f32_16x16x32_bf16 v[172:175], a[220:223], a[124:127], v[172:175]
    buffer_load_dwordx4 v11, s[12:15], s28 offen lds
    s_waitcnt lgkmcnt(4)
    v_mfma_f32_16x16x32_bf16 v[176:179], a[224:227], a[112:115], v[176:179]
    ds_read_b64_tr_b16 a[216:217], v2 offset:20672
    v_mfma_f32_16x16x32_bf16 v[180:183], a[224:227], a[116:119], v[180:183]
    ds_read_b64_tr_b16 a[218:219], v2 offset:22976
    v_mfma_f32_16x16x32_bf16 v[184:187], a[224:227], a[120:123], v[184:187]
    s_add_u32 s28, s28, 294912
    v_mfma_f32_16x16x32_bf16 v[188:191], a[224:227], a[124:127], v[188:191]
    buffer_load_dwordx4 a[96:99], v1, s[16:19], s39 offen offset:2048
    s_waitcnt lgkmcnt(4)
    v_mfma_f32_16x16x32_bf16 v[192:195], a[208:211], a[112:115], v[192:195]
    ds_read_b64_tr_b16 a[220:221], v2 offset:29888
    v_mfma_f32_16x16x32_bf16 v[196:199], a[208:211], a[116:119], v[196:199]
    ds_read_b64_tr_b16 a[222:223], v2 offset:32192
    v_mfma_f32_16x16x32_bf16 v[200:203], a[208:211], a[120:123], v[200:203]
    buffer_load_dwordx4 a[100:103], v1, s[16:19], s40 offen offset:2048
    v_mfma_f32_16x16x32_bf16 v[204:207], a[208:211], a[124:127], v[204:207]
    buffer_load_dwordx4 a[104:107], v1, s[16:19], s41 offen offset:2048
    s_waitcnt lgkmcnt(4)
    v_mfma_f32_16x16x32_bf16 v[208:211], a[212:215], a[112:115], v[208:211]
    ds_read_b64_tr_b16 a[224:225], v2 offset:20704
    v_mfma_f32_16x16x32_bf16 v[212:215], a[212:215], a[116:119], v[212:215]
    ds_read_b64_tr_b16 a[226:227], v2 offset:23008
    v_mfma_f32_16x16x32_bf16 v[216:219], a[212:215], a[120:123], v[216:219]
    buffer_load_dwordx4 a[108:111], v1, s[16:19], s42 offen offset:2048
    v_mfma_f32_16x16x32_bf16 v[220:223], a[212:215], a[124:127], v[220:223]
    s_add_u32 m0, s37, 0
    s_waitcnt lgkmcnt(4)
    v_mfma_f32_16x16x32_bf16 v[224:227], a[216:219], a[112:115], v[224:227]
    ds_read_b64_tr_b16 a[208:209], v2 offset:29920
    v_mfma_f32_16x16x32_bf16 v[228:231], a[216:219], a[116:119], v[228:231]
    ds_read_b64_tr_b16 a[210:211], v2 offset:32224
    v_mfma_f32_16x16x32_bf16 v[232:235], a[216:219], a[120:123], v[232:235]
    global_load_lds_dwordx4 v[12:13], off
    v_mfma_f32_16x16x32_bf16 v[236:239], a[216:219], a[124:127], v[236:239]
    v_add_co_u32 v12, s[62:63], s38, v12
    s_waitcnt lgkmcnt(4)
    v_mfma_f32_16x16x32_bf16 v[240:243], a[220:223], a[112:115], v[240:243]
    ds_read_b64_tr_b16 a[212:213], v2 offset:20736
    v_mfma_f32_16x16x32_bf16 v[244:247], a[220:223], a[116:119], v[244:247]
    ds_read_b64_tr_b16 a[214:215], v2 offset:23040
    v_mfma_f32_16x16x32_bf16 v[248:251], a[220:223], a[120:123], v[248:251]
    s_add_u32 s29, s29, 0
    v_mfma_f32_16x16x32_bf16 v[252:255], a[220:223], a[124:127], v[252:255]
    s_add_u32 s29, s29, 0
    s_waitcnt lgkmcnt(4)
    v_mfma_f32_16x16x32_bf16 a[0:3], a[224:227], a[112:115], a[0:3]
    ds_read_b64_tr_b16 a[216:217], v2 offset:29952
    v_mfma_f32_16x16x32_bf16 a[4:7], a[224:227], a[116:119], a[4:7]
    ds_read_b64_tr_b16 a[218:219], v2 offset:32256
    v_mfma_f32_16x16x32_bf16 a[8:11], a[224:227], a[120:123], a[8:11]
    v_addc_co_u32 v13, s[62:63], 0, v13, s[62:63]
    v_mfma_f32_16x16x32_bf16 a[12:15], a[224:227], a[124:127], a[12:15]
    s_add_u32 m0, s33, 0
    s_waitcnt lgkmcnt(4)
    v_mfma_f32_16x16x32_bf16 a[16:19], a[208:211], a[112:115], a[16:19]
    ds_read_b128 a[220:223], v5 offset:38912
    v_mfma_f32_16x16x32_bf16 a[20:23], a[208:211], a[116:119], a[20:23]
    buffer_load_dwordx4 v8, s[8:11], s28 offen lds
    v_mfma_f32_16x16x32_bf16 a[24:27], a[208:211], a[120:123], a[24:27]
    s_add_u32 m0, s34, 0
    v_mfma_f32_16x16x32_bf16 a[28:31], a[208:211], a[124:127], a[28:31]
    buffer_load_dwordx4 v9, s[8:11], s28 offen lds
    s_waitcnt lgkmcnt(3)
    v_mfma_f32_16x16x32_bf16 a[32:35], a[212:215], a[112:115], a[32:35]
    ds_read_b128 a[224:227], v5 offset:39936
    v_mfma_f32_16x16x32_bf16 a[36:39], a[212:215], a[116:119], a[36:39]
    s_add_u32 m0, s35, 0
    v_mfma_f32_16x16x32_bf16 a[40:43], a[212:215], a[120:123], a[40:43]
    buffer_load_dwordx4 v10, s[20:23], s28 offen lds
    v_mfma_f32_16x16x32_bf16 a[44:47], a[212:215], a[124:127], a[44:47]
    s_add_u32 m0, s36, 0
    s_waitcnt lgkmcnt(2)
    v_mfma_f32_16x16x32_bf16 a[48:51], a[216:219], a[112:115], a[48:51]
    ds_read_b64_tr_b16 a[208:209], v2 offset:40960
    v_mfma_f32_16x16x32_bf16 a[52:55], a[216:219], a[116:119], a[52:55]
    ds_read_b64_tr_b16 a[210:211], v2 offset:43264
    v_mfma_f32_16x16x32_bf16 a[56:59], a[216:219], a[120:123], a[56:59]
    buffer_load_dwordx4 v11, s[12:15], s28 offen lds
    v_mfma_f32_16x16x32_bf16 a[60:63], a[216:219], a[124:127], a[60:63]
    s_add_u32 s28, s28, 294912
    s_waitcnt lgkmcnt(3)
    v_mfma_f32_16x16x32_bf16 a[64:67], a[112:115], a[220:223], a[64:67]
    ds_read_b64_tr_b16 a[212:213], v2 offset:50176
    v_mfma_f32_16x16x32_bf16 a[68:71], a[116:119], a[220:223], a[68:71]
    ds_read_b64_tr_b16 a[214:215], v2 offset:52480
    v_mfma_f32_16x16x32_bf16 a[72:75], a[120:123], a[220:223], a[72:75]
    v_mfma_f32_16x16x32_bf16 a[76:79], a[124:127], a[220:223], a[76:79]
    s_waitcnt lgkmcnt(4)
    s_cmp_lg_u32 s29, 1
    s_cbranch_scc1 K1_skip8_0
    v_mfma_f32_16x16x32_bf16 a[80:83], a[112:115], a[224:227], a[80:83]
    v_mfma_f32_16x16x32_bf16 a[84:87], a[116:119], a[224:227], a[84:87]
K1_skip8_0:
    s_cmp_lg_u32 s29, 2
    s_cbranch_scc1 K1_skip8_1
    v_mfma_f32_16x16x32_bf16 a[88:91], a[120:123], a[224:227], a[88:91]
    v_mfma_f32_16x16x32_bf16 a[92:95], a[124:127], a[224:227], a[92:95]
K1_skip8_1:
    ds_read_b64_tr_b16 a[216:217], v2 offset:40992
    ds_read_b64_tr_b16 a[218:219], v2 offset:43296
    s_waitcnt vmcnt(37)
    s_barrier
    s_waitcnt lgkmcnt(4)
    v_mfma_f32_16x16x32_bf16 v[32:35], a[208:211], a[128:131], v[32:35]
    ds_read_b64_tr_b16 a[220:221], v2 offset:50208
    v_mfma_f32_16x16x32_bf16 v[36:39], a[208:211], a[132:135], v[36:39]
    ds_read_b64_tr_b16 a[222:223], v2 offset:52512
    v_mfma_f32_16x16x32_bf16 v[40:43], a[208:211], a[136:139], v[40:43]
    buffer_load_dwordx4 a[112:115], v1, s[16:19], s39 offen offset:3072
    v_mfma_f32_16x16x32_bf16 v[44:47], a[208:211], a[140:143], v[44:47]
    s_add_u32 s39, s39, 4096
    s_waitcnt lgkmcnt(4)
    v_mfma_f32_16x16x32_bf16 v[48:51], a[212:215], a[128:131], v[48:51]
    ds_read_b64_tr_b16 a[224:225], v2 offset:41024
    v_mfma_f32_16x16x32_bf16 v[52:55], a[212:215], a[132:135], v[52:55]
    ds_read_b64_tr_b16 a[226:227], v2 offset:43328
    v_mfma_f32_16x16x32_bf16 v[56:59], a[212:215], a[136:139], v[56:59]
    buffer_load_dwordx4 a[116:119], v1, s[16:19], s40 offen offset:3072
    v_mfma_f32_16x16x32_bf16 v[60:63], a[212:215], a[140:143], v[60:63]
    s_add_u32 s40, s40, 4096
    s_waitcnt lgkmcnt(4)
    v_mfma_f32_16x16x32_bf16 v[64:67], a[216:219], a[128:131], v[64:67]
    ds_read_b64_tr_b16 a[208:209], v2 offset:50240
    v_mfma_f32_16x16x32_bf16 v[68:71], a[216:219], a[132:135], v[68:71]
    ds_read_b64_tr_b16 a[210:211], v2 offset:52544
    v_mfma_f32_16x16x32_bf16 v[72:75], a[216:219], a[136:139], v[72:75]
    buffer_load_dwordx4 a[120:123], v1, s[16:19], s41 offen offset:3072
    v_mfma_f32_16x16x32_bf16 v[76:79], a[216:219], a[140:143], v[76:79]
    s_add_u32 s41, s41, 4096
    s_waitcnt lgkmcnt(4)
    v_mfma_f32_16x16x32_bf16 v[80:83], a[220:223], a[128:131], v[80:83]
    ds_read_b64_tr_b16 a[212:213], v2 offset:41056
    v_mfma_f32_16x16x32_bf16 v[84:87], a[220:223], a[132:135], v[84:87]
    ds_read_b64_tr_b16 a[214:215], v2 offset:43360
    v_mfma_f32_16x16x32_bf16 v[88:91], a[220:223], a[136:139], v[88:91]
    buffer_load_dwordx4 a[124:127], v1, s[16:19], s42 offen offset:3072
    v_mfma_f32_16x16x32_bf16 v[92:95], a[220:223], a[140:143], v[92:95]
    s_add_u32 s42, s42, 4096
    s_waitcnt lgkmcnt(4)
    v_mfma_f32_16x16x32_bf16 v[96:99], a[224:227], a[128:131], v[96:99]
    ds_read_b64_tr_b16 a[216:217], v2 offset:50272
    v_mfma_f32_16x16x32_bf16 v[100:103], a[224:227], a[132:135], v[100:103]
    ds_read_b64_tr_b16 a[218:219], v2 offset:52576
    v_mfma_f32_16x16x32_bf16 v[104:107], a[224:227], a[136:139], v[104:107]
    s_add_u32 m0, s37, 20480
    v_mfma_f32_16x16x32_bf16 v[108:111], a[224:227], a[140:143], v[108:111]
    global_load_lds_dwordx4 v[12:13], off
    s_waitcnt lgkmcnt(4)
    v_mfma_f32_16x16x32_bf16 v[112:115], a[208:211], a[128:131], v[112:115]
    ds_read_b64_tr_b16 a[220:221], v2 offset:41088
    v_mfma_f32_16x16x32_bf16 v[116:119], a[208:211], a[132:135], v[116:119]
    ds_read_b64_tr_b16 a[222:223], v2 offset:43392
    v_mfma_f32_16x16x32_bf16 v[120:123], a[208:211], a[136:139], v[120:123]
    v_add_co_u32 v12, s[62:63], s38, v12
    v_mfma_f32_16x16x32_bf16 v[124:127], a[208:211], a[140:143], v[124:127]
    s_add_u32 s29, s29, 0
    s_waitcnt lgkmcnt(4)
    v_mfma_f32_16x16x32_bf16 v[128:131], a[212:215], a[128:131], v[128:131]
    ds_read_b64_tr_b16 a[224:225], v2 offset:50304
    v_mfma_f32_16x16x32_bf16 v[132:135], a[212:215], a[132:135], v[132:135]
    ds_read_b64_tr_b16 a[226:227], v2 offset:52608
    v_mfma_f32_16x16x32_bf16 v[136:139], a[212:215], a[136:139], v[136:139]
    s_add_u32 s29, s29, 0
    v_mfma_f32_16x16x32_bf16 v[140:143], a[212:215], a[140:143], v[140:143]
    v_addc_co_u32 v13, s[62:63], 0, v13, s[62:63]
    s_waitcnt lgkmcnt(4)
    v_mfma_f32_16x16x32_bf16 v[144:147], a[216:219], a[128:131], v[144:147]
    ds_read_b64_tr_b16 a[208:209], v2 offset:41120
    v_mfma_f32_16x16x32_bf16 v[148:151], a[216:219], a[132:135], v[148:151]
    ds_read_b64_tr_b16 a[210:211], v2 offset:43424
    v_mfma_f32_16x16x32_bf16 v[152:155], a[216:219], a[136:139], v[152:155]
    s_add_u32 m0, s33, 20480
    v_mfma_f32_16x16x32_bf16 v[156:159], a[216:219], a[140:143], v[156:159]
    buffer_load_dwordx4 v8, s[8:11], s28 offen lds
    s_waitcnt lgkmcnt(4)
    v_mfma_f32_16x16x32_bf16 v[160:163], a[220:223], a[128:131], v[160:163]
    ds_read_b64_tr_b16 a[212:213], v2 offset:50336
    v_mfma_f32_16x16x32_bf16 v[164:167], a[220:223], a[132:135], v[164:167]
    ds_read_b64_tr_b16 a[214:215], v2 offset:52640
    v_mfma_f32_16x16x32_bf16 v[168:171], a[220:223], a[136:139], v[168:171]
    s_add_u32 m0, s34, 20480
    v_mfma_f32_16x16x32_bf16 v[172:175], a[220:223], a[140:143], v[172:175]
    buffer_load_dwordx4 v9, s[8:11], s28 offen lds
    s_waitcnt lgkmcnt(4)
    v_mfma_f32_16x16x32_bf16 v[176:179], a[224:227], a[128:131], v[176:179]
    ds_read_b64_tr_b16 a[216:217], v2 offset:41152
    v_mfma_f32_16x16x32_bf16 v[180:183], a[224:227], a[132:135], v[180:183]
    ds_read_b64_tr_b16 a[218:219], v2 offset:43456
    v_mfma_f32_16x16x32_bf16 v[184:187], a[224:227], a[136:139], v[184:187]
    s_add_u32 m0, s35, 20480
    v_mfma_f32_16x16x32_bf16 v[188:191], a[224:227], a[140:143], v[188:191]
    buffer_load_dwordx4 v10, s[20:23], s28 offen lds
    s_waitcnt lgkmcnt(4)
    v_mfma_f32_16x16x32_bf16 v[192:195], a[208:211], a[128:131], v[192:195]
    ds_read_b64_tr_b16 a[220:221], v2 offset:50368
    v_mfma_f32_16x16x32_bf16 v[196:199], a[208:211], a[132:135], v[196:199]
    ds_read_b64_tr_b16 a[222:223], v2 offset:52672
    v_mfma_f32_16x16x32_bf16 v[200:203], a[208:211], a[136:139], v[200:203]
    s_add_u32 m0, s36, 20480
    v_mfma_f32_16x16x32_bf16 v[204:207], a[208:211], a[140:143], v[204:207]
    buffer_load_dwordx4 v11, s[12:15], s28 offen lds
    s_waitcnt lgkmcnt(4)
    v_mfma_f32_16x16x32_bf16 v[208:211], a[212:215], a[128:131], v[208:211]
    ds_read_b64_tr_b16 a[224:225], v2 offset:41184
    v_mfma_f32_16x16x32_bf16 v[212:215], a[212:215], a[132:135], v[212:215]
    ds_read_b64_tr_b16 a[226:227], v2 offset:43488
    v_mfma_f32_16x16x32_bf16 v[216:219], a[212:215], a[136:139], v[216:219]
    s_add_u32 s28, s28, 294912
    v_mfma_f32_16x16x32_bf16 v[220:223], a[212:215], a[140:143], v[220:223]
    s_waitcnt lgkmcnt(4)
    v_mfma_f32_16x16x32_bf16 v[224:227], a[216:219], a[128:131], v[224:227]
    ds_read_b64_tr_b16 a[208:209], v2 offset:50400
    v_mfma_f32_16x16x32_bf16 v[228:231], a[216:219], a[132:135], v[228:231]
    ds_read_b64_tr_b16 a[210:211], v2 offset:52704
    v_mfma_f32_16x16x32_bf16 v[232:235], a[216:219], a[136:139], v[232:235]
    v_mfma_f32_16x16x32_bf16 v[236:239], a[216:219], a[140:143], v[236:239]
    s_waitcnt lgkmcnt(4)
    v_mfma_f32_16x16x32_bf16 v[240:243], a[220:223], a[128:131], v[240:243]
    ds_read_b64_tr_b16 a[212:213], v2 offset:41216
    v_mfma_f32_16x16x32_bf16 v[244:247], a[220:223], a[132:135], v[244:247]
    ds_read_b64_tr_b16 a[214:215], v2 offset:43520
    v_mfma_f32_16x16x32_bf16 v[248:251], a[220:223], a[136:139], v[248:251]
    v_mfma_f32_16x16x32_bf16 v[252:255], a[220:223], a[140:143], v[252:255]
    s_waitcnt lgkmcnt(4)
    v_mfma_f32_16x16x32_bf16 a[0:3], a[224:227], a[128:131], a[0:3]
    ds_read_b64_tr_b16 a[216:217], v2 offset:50432
    v_mfma_f32_16x16x32_bf16 a[4:7], a[224:227], a[132:135], a[4:7]
    ds_read_b64_tr_b16 a[218:219], v2 offset:52736
    v_mfma_f32_16x16x32_bf16 a[8:11], a[224:227], a[136:139], a[8:11]
    v_mfma_f32_16x16x32_bf16 a[12:15], a[224:227], a[140:143], a[12:15]
    s_waitcnt lgkmcnt(4)
    v_mfma_f32_16x16x32_bf16 a[16:19], a[208:211], a[128:131], a[16:19]
    ds_read_b128 a[220:223], v5 offset:59392
    v_mfma_f32_16x16x32_bf16 a[20:23], a[208:211], a[132:135], a[20:23]
    v_mfma_f32_16x16x32_bf16 a[24:27], a[208:211], a[136:139], a[24:27]
    v_mfma_f32_16x16x32_bf16 a[28:31], a[208:211], a[140:143], a[28:31]
    s_waitcnt lgkmcnt(3)
    v_mfma_f32_16x16x32_bf16 a[32:35], a[212:215], a[128:131], a[32:35]
    ds_read_b128 a[224:227], v5 offset:60416
    v_mfma_f32_16x16x32_bf16 a[36:39], a[212:215], a[132:135], a[36:39]
    v_mfma_f32_16x16x32_bf16 a[40:43], a[212:215], a[136:139], a[40:43]
    v_mfma_f32_16x16x32_bf16 a[44:47], a[212:215], a[140:143], a[44:47]
    s_waitcnt lgkmcnt(2)
    v_mfma_f32_16x16x32_bf16 a[48:51], a[216:219], a[128:131], a[48:51]
    ds_read_b64_tr_b16 a[208:209], v3 offset:0
    v_mfma_f32_16x16x32_bf16 a[52:55], a[216:219], a[132:135], a[52:55]
    ds_read_b64_tr_b16 a[210:211], v3 offset:2304
    v_mfma_f32_16x16x32_bf16 a[56:59], a[216:219], a[136:139], a[56:59]
    v_mfma_f32_16x16x32_bf16 a[60:63], a[216:219], a[140:143], a[60:63]
    s_waitcnt lgkmcnt(3)
    v_mfma_f32_16x16x32_bf16 a[64:67], a[128:131], a[220:223], a[64:67]
    ds_read_b64_tr_b16 a[212:213], v3 offset:9216
    v_mfma_f32_16x16x32_bf16 a[68:71], a[132:135], a[220:223], a[68:71]
    ds_read_b64_tr_b16 a[214:215], v3 offset:11520
    v_mfma_f32_16x16x32_bf16 a[72:75], a[136:139], a[220:223], a[72:75]
    v_mfma_f32_16x16x32_bf16 a[76:79], a[140:143], a[220:223], a[76:79]
    s_waitcnt lgkmcnt(4)
    s_cmp_lg_u32 s29, 1
    s_cbranch_scc1 K1_skip9_0
    v_mfma_f32_16x16x32_bf16 a[80:83], a[128:131], a[224:227], a[80:83]
    v_mfma_f32_16x16x32_bf16 a[84:87], a[132:135], a[224:227], a[84:87]
K1_skip9_0:
    s_cmp_lg_u32 s29, 2
    s_cbranch_scc1 K1_skip9_1
    v_mfma_f32_16x16x32_bf16 a[88:91], a[136:139], a[224:227], a[88:91]
    v_mfma_f32_16x16x32_bf16 a[92:95], a[140:143], a[224:227], a[92:95]
K1_skip9_1:
    ds_read_b64_tr_b16 a[216:217], v3 offset:32
    ds_read_b64_tr_b16 a[218:219], v3 offset:2336
    s_waitcnt vmcnt(37)
    s_barrier
    s_waitcnt lgkmcnt(4)
    v_mfma_f32_16x16x32_bf16 v[32:35], a[208:211], a[144:147], v[32:35]
    ds_read_b64_tr_b16 a[220:221], v3 offset:9248
    v_mfma_f32_16x16x32_bf16 v[36:39], a[208:211], a[148:151], v[36:39]
    ds_read_b64_tr_b16 a[222:223], v3 offset:11552
    v_mfma_f32_16x16x32_bf16 v[40:43], a[208:211], a[152:155], v[40:43]
    buffer_load_dwordx4 a[128:131], v1, s[16:19], s39 offen offset:0
    v_mfma_f32_16x16x32_bf16 v[44:47], a[208:211], a[156:159], v[44:47]
    buffer_load_dwordx4 a[132:135], v1, s[16:19], s40 offen offset:0
    s_waitcnt lgkmcnt(4)
    v_mfma_f32_16x16x32_bf16 v[48:51], a[212:215], a[144:147], v[48:51]
    ds_read_b64_tr_b16 a[224:225], v3 offset:64
    v_mfma_f32_16x16x32_bf16 v[52:55], a[212:215], a[148:151], v[52:55]
    ds_read_b64_tr_b16 a[226:227], v3 offset:2368
    v_mfma_f32_16x16x32_bf16 v[56:59], a[212:215], a[152:155], v[56:59]
    buffer_load_dwordx4 a[136:139], v1, s[16:19], s41 offen offset:0
    v_mfma_f32_16x16x32_bf16 v[60:63], a[212:215], a[156:159], v[60:63]
    buffer_load_dwordx4 a[140:143], v1, s[16:19], s42 offen offset:0
    s_waitcnt lgkmcnt(4)
    v_mfma_f32_16x16x32_bf16 v[64:67], a[216:219], a[144:147], v[64:67]
    ds_read_b64_tr_b16 a[208:209], v3 offset:9280
    v_mfma_f32_16x16x32_bf16 v[68:71], a[216:219], a[148:151], v[68:71]
    ds_read_b64_tr_b16 a[210:211], v3 offset:11584
    v_mfma_f32_16x16x32_bf16 v[72:75], a[216:219], a[152:155], v[72:75]
    s_add_u32 m0, s37, 40960
    v_mfma_f32_16x16x32_bf16 v[76:79], a[216:219], a[156:159], v[76:79]
    global_load_lds_dwordx4 v[12:13], off
    s_waitcnt lgkmcnt(4)
    v_mfma_f32_16x16x32_bf16 v[80:83], a[220:223], a[144:147], v[80:83]
    ds_read_b64_tr_b16 a[212:213], v3 offset:96
    v_mfma_f32_16x16x32_bf16 v[84:87], a[220:223], a[148:151], v[84:87]
    ds_read_b64_tr_b16 a[214:215], v3 offset:2400
    v_mfma_f32_16x16x32_bf16 v[88:91], a[220:223], a[152:155], v[88:91]
    v_add_co_u32 v12, s[62:63], s38, v12
    v_mfma_f32_16x16x32_bf16 v[92:95], a[220:223], a[156:159], v[92:95]
    s_add_u32 s29, s29, 0
    s_waitcnt lgkmcnt(4)
    v_mfma_f32_16x16x32_bf16 v[96:99], a[224:227], a[144:147], v[96:99]
    ds_read_b64_tr_b16 a[216:217], v3 offset:9312
    v_mfma_f32_16x16x32_bf16 v[100:103], a[224:227], a[148:151], v[100:103]
    ds_read_b64_tr_b16 a[218:219], v3 offset:11616
    v_mfma_f32_16x16x32_bf16 v[104:107], a[224:227], a[152:155], v[104:107]
    s_add_u32 s29, s29, 0
    v_mfma_f32_16x16x32_bf16 v[108:111], a[224:227], a[156:159], v[108:111]
    v_addc_co_u32 v13, s[62:63], 0, v13, s[62:63]
    s_waitcnt lgkmcnt(4)
    v_mfma_f32_16x16x32_bf16 v[112:115], a[208:211], a[144:147], v[112:115]
    ds_read_b64_tr_b16 a[220:221], v3 offset:128
    v_mfma_f32_16x16x32_bf16 v[116:119], a[208:211], a[148:151], v[116:119]
    ds_read_b64_tr_b16 a[222:223], v3 offset:2432
    v_mfma_f32_16x16x32_bf16 v[120:123], a[208:211], a[152:155], v[120:123]
    s_add_u32 m0, s33, 40960
    v_mfma_f32_16x16x32_bf16 v[124:127], a[208:211], a[156:159], v[124:127]
    buffer_load_dwordx4 v8, s[8:11], s28 offen lds
    s_waitcnt lgkmcnt(4)
    v_mfma_f32_16x16x32_bf16 v[128:131], a[212:215], a[144:147], v[128:131]
    ds_read_b64_tr_b16 a[224:225], v3 offset:9344
    v_mfma_f32_16x16x32_bf16 v[132:135], a[212:215], a[148:151], v[132:135]
    ds_read_b64_tr_b16 a[226:227], v3 offset:11648
    v_mfma_f32_16x16x32_bf16 v[136:139], a[212:215], a[152:155], v[136:139]
    s_add_u32 m0, s34, 40960
    v_mfma_f32_16x16x32_bf16 v[140:143], a[212:215], a[156:159], v[140:143]
    buffer_load_dwordx4 v9, s[8:11], s28 offen lds
    s_waitcnt lgkmcnt(4)
    v_mfma_f32_16x16x32_bf16 v[144:147], a[216:219], a[144:147], v[144:147]
    ds_read_b64_tr_b16 a[208:209], v3 offset:160
    v_mfma_f32_16x16x32_bf16 v[148:151], a[216:219], a[148:151], v[148:151]
    ds_read_b64_tr_b16 a[210:211], v3 offset:2464
    v_mfma_f32_16x16x32_bf16 v[152:155], a[216:219], a[152:155], v[152:155]
    s_add_u32 m0, s35, 40960
    v_mfma_f32_16x16x32_bf16 v[156:159], a[216:219], a[156:159], v[156:159]
    buffer_load_dwordx4 v10, s[20:23], s28 offen lds
    s_waitcnt lgkmcnt(4)
    v_mfma_f32_16x16x32_bf16 v[160:163], a[220:223], a[144:147], v[160:163]
    ds_read_b64_tr_b16 a[212:213], v3 offset:9376
    v_mfma_f32_16x16x32_bf16 v[164:167], a[220:223], a[148:151], v[164:167]
    ds_read_b64_tr_b16 a[214:215], v3 offset:11680
    v_mfma_f32_16x16x32_bf16 v[168:171], a[220:223], a[152:155], v[168:171]
    s_add_u32 m0, s36, 40960
    v_mfma_f32_16x16x32_bf16 v[172:175], a[220:223], a[156:159], v[172:175]
    buffer_load_dwordx4 v11, s[12:15], s28 offen lds
    s_waitcnt lgkmcnt(4)
    v_mfma_f32_16x16x32_bf16 v[176:179], a[224:227], a[144:147], v[176:179]
    ds_read_b64_tr_b16 a[216:217], v3 offset:192
    v_mfma_f32_16x16x32_bf16 v[180:183], a[224:227], a[148:151], v[180:183]
    ds_read_b64_tr_b16 a[218:219], v3 offset:2496
    v_mfma_f32_16x16x32_bf16 v[184:187], a[224:227], a[152:155], v[184:187]
    s_add_u32 s28, s28, 294912
    v_mfma_f32_16x16x32_bf16 v[188:191], a[224:227], a[156:159], v[188:191]
    s_lshr_b32 s55, s2, 3
    s_waitcnt lgkmcnt(4)
    v_mfma_f32_16x16x32_bf16 v[192:195], a[208:211], a[144:147], v[192:195]
    ds_read_b64_tr_b16 a[220:221], v3 offset:9408
    v_mfma_f32_16x16x32_bf16 v[196:199], a[208:211], a[148:151], v[196:199]
    ds_read_b64_tr_b16 a[222:223], v3 offset:11712
    v_mfma_f32_16x16x32_bf16 v[200:203], a[208:211], a[152:155], v[200:203]
    s_lshl_b32 s55, s55, 2
    v_mfma_f32_16x16x32_bf16 v[204:207], a[208:211], a[156:159], v[204:207]
    s_add_u32 s55, s55, s52
    s_waitcnt lgkmcnt(4)
    v_mfma_f32_16x16x32_bf16 v[208:211], a[212:215], a[144:147], v[208:211]
    ds_read_b64_tr_b16 a[224:225], v3 offset:224
    v_mfma_f32_16x16x32_bf16 v[212:215], a[212:215], a[148:151], v[212:215]
    ds_read_b64_tr_b16 a[226:227], v3 offset:2528
    v_mfma_f32_16x16x32_bf16 v[216:219], a[212:215], a[152:155], v[216:219]
    s_getpc_b64 s[56:57]
TC_k2_kernel_a243:
    v_mfma_f32_16x16x32_bf16 v[220:223], a[212:215], a[156:159], v[220:223]
    s_add_u32 s56, s56, k2_kernel-TC_k2_kernel_a243
    s_waitcnt lgkmcnt(4)
    v_mfma_f32_16x16x32_bf16 v[224:227], a[216:219], a[144:147], v[224:227]
    ds_read_b64_tr_b16 a[208:209], v3 offset:9440
    v_mfma_f32_16x16x32_bf16 v[228:231], a[216:219], a[148:151], v[228:231]
    ds_read_b64_tr_b16 a[210:211], v3 offset:11744
    v_mfma_f32_16x16x32_bf16 v[232:235], a[216:219], a[152:155], v[232:235]
    s_addc_u32 s57, s57, 0
    v_mfma_f32_16x16x32_bf16 v[236:239], a[216:219], a[156:159], v[236:239]
    s_mov_b32 s58, (k2_kernel_end-k2_kernel+127)/128
    s_waitcnt lgkmcnt(4)
    v_mfma_f32_16x16x32_bf16 v[240:243], a[220:223], a[144:147], v[240:243]
    ds_read_b64_tr_b16 a[212:213], v3 offset:256
    v_mfma_f32_16x16x32_bf16 v[244:247], a[220:223], a[148:151], v[244:247]
    ds_read_b64_tr_b16 a[214:215], v3 offset:2560
    v_mfma_f32_16x16x32_bf16 v[248:251], a[220:223], a[152:155], v[248:251]
    s_add_u32 s58, s58, 127
    v_mfma_f32_16x16x32_bf16 v[252:255], a[220:223], a[156:159], v[252:255]
    s_mov_b32 s59, 33554432
    s_waitcnt lgkmcnt(4)
    v_mfma_f32_16x16x32_bf16 a[0:3], a[224:227], a[144:147], a[0:3]
    ds_read_b64_tr_b16 a[216:217], v3 offset:9472
    v_mfma_f32_16x16x32_bf16 a[4:7], a[224:227], a[148:151], a[4:7]
    ds_read_b64_tr_b16 a[218:219], v3 offset:11776
    v_mfma_f32_16x16x32_bf16 a[8:11], a[224:227], a[152:155], a[8:11]
    s_mul_hi_u32 s58, s58, s59
    v_mfma_f32_16x16x32_bf16 a[12:15], a[224:227], a[156:159], a[12:15]
    v_mbcnt_lo_u32_b32 v16, -1, 0
    s_waitcnt lgkmcnt(4)
    v_mfma_f32_16x16x32_bf16 a[16:19], a[208:211], a[144:147], a[16:19]
    ds_read_b128 a[220:223], v6 offset:18432
    v_mfma_f32_16x16x32_bf16 a[20:23], a[208:211], a[148:151], a[20:23]
    v_mbcnt_hi_u32_b32 v16, -1, v16
    v_mfma_f32_16x16x32_bf16 a[24:27], a[208:211], a[152:155], a[24:27]
    s_sub_u32 s59, s58, 1
    v_mfma_f32_16x16x32_bf16 a[28:31], a[208:211], a[156:159], a[28:31]
    v_min_u32 v16, s59, v16
    s_waitcnt lgkmcnt(3)
    v_mfma_f32_16x16x32_bf16 a[32:35], a[212:215], a[144:147], a[32:35]
    ds_read_b128 a[224:227], v6 offset:19456
    v_mfma_f32_16x16x32_bf16 a[36:39], a[212:215], a[148:151], a[36:39]
    s_mul_i32 s58, s58, s55
    v_mfma_f32_16x16x32_bf16 a[40:43], a[212:215], a[152:155], a[40:43]
    v_add_u32 v16, s58, v16
    v_mfma_f32_16x16x32_bf16 a[44:47], a[212:215], a[156:159], a[44:47]
    v_lshlrev_b32 v16, 7, v16
    s_waitcnt lgkmcnt(2)
    v_mfma_f32_16x16x32_bf16 a[48:51], a[216:219], a[144:147], a[48:51]
    ds_read_b64_tr_b16 a[208:209], v3 offset:20480
    v_mfma_f32_16x16x32_bf16 a[52:55], a[216:219], a[148:151], a[52:55]
    ds_read_b64_tr_b16 a[210:211], v3 offset:22784
    v_mfma_f32_16x16x32_bf16 a[56:59], a[216:219], a[152:155], a[56:59]
    s_mov_b32 s59, k2_kernel_end-k2_kernel-4
    v_mfma_f32_16x16x32_bf16 a[60:63], a[216:219], a[156:159], a[60:63]
    v_min_u32 v16, s59, v16
    s_waitcnt lgkmcnt(3)
    v_mfma_f32_16x16x32_bf16 a[64:67], a[144:147], a[220:223], a[64:67]
    ds_read_b64_tr_b16 a[212:213], v3 offset:29696
    v_mfma_f32_16x16x32_bf16 a[68:71], a[148:151], a[220:223], a[68:71]
    ds_read_b64_tr_b16 a[214:215], v3 offset:32000
    v_mfma_f32_16x16x32_bf16 a[72:75], a[152:155], a[220:223], a[72:75]
    v_mov_b32 v17, s57
    v_mfma_f32_16x16x32_bf16 a[76:79], a[156:159], a[220:223], a[76:79]
    v_add_co_u32 v16, s[60:61], s56, v16
    s_waitcnt lgkmcnt(4)
    s_cmp_lg_u32 s29, 1
    s_cbranch_scc1 K1_skip10_0
    v_mfma_f32_16x16x32_bf16 a[80:83], a[144:147], a[224:227], a[80:83]
    v_mfma_f32_16x16x32_bf16 a[84:87], a[148:151], a[224:227], a[84:87]
K1_skip10_0:
    s_cmp_lg_u32 s29, 2
    s_cbranch_scc1 K1_skip10_1
    v_mfma_f32_16x16x32_bf16 a[88:91], a[152:155], a[224:227], a[88:91]
    v_mfma_f32_16x16x32_bf16 a[92:95], a[156:159], a[224:227], a[92:95]
K1_skip10_1:
    ds_read_b64_tr_b16 a[216:217], v3 offset:20512
    ds_read_b64_tr_b16 a[218:219], v3 offset:22816
    s_nop 1
    v_addc_co_u32 v17, s[60:61], 0, v17, s[60:61]
    global_load_dword a243, v[16:17], off
    s_waitcnt vmcnt(38)
    s_barrier
    s_waitcnt lgkmcnt(4)
    v_mfma_f32_16x16x32_bf16 v[32:35], a[208:211], a[160:163], v[32:35]
    ds_read_b64_tr_b16 a[220:221], v3 offset:29728
    v_mfma_f32_16x16x32_bf16 v[36:39], a[208:211], a[164:167], v[36:39]
    ds_read_b64_tr_b16 a[222:223], v3 offset:32032
    v_mfma_f32_16x16x32_bf16 v[40:43], a[208:211], a[168:171], v[40:43]
    buffer_load_dwordx4 a[144:147], v1, s[16:19], s39 offen offset:1024
    v_mfma_f32_16x16x32_bf16 v[44:47], a[208:211], a[172:175], v[44:47]
    s_waitcnt lgkmcnt(4)
    v_mfma_f32_16x16x32_bf16 v[48:51], a[212:215], a[160:163], v[48:51]
    ds_read_b64_tr_b16 a[224:225], v3 offset:20544
    v_mfma_f32_16x16x32_bf16 v[52:55], a[212:215], a[164:167], v[52:55]
    ds_read_b64_tr_b16 a[226:227], v3 offset:22848
    v_mfma_f32_16x16x32_bf16 v[56:59], a[212:215], a[168:171], v[56:59]
    buffer_load_dwordx4 a[148:151], v1, s[16:19], s40 offen offset:1024
    v_mfma_f32_16x16x32_bf16 v[60:63], a[212:215], a[172:175], v[60:63]
    s_waitcnt lgkmcnt(4)
    v_mfma_f32_16x16x32_bf16 v[64:67], a[216:219], a[160:163], v[64:67]
    ds_read_b64_tr_b16 a[208:209], v3 offset:29760
    v_mfma_f32_16x16x32_bf16 v[68:71], a[216:219], a[164:167], v[68:71]
    ds_read_b64_tr_b16 a[210:211], v3 offset:32064
    v_mfma_f32_16x16x32_bf16 v[72:75], a[216:219], a[168:171], v[72:75]
    buffer_load_dwordx4 a[152:155], v1, s[16:19], s41 offen offset:1024
    v_mfma_f32_16x16x32_bf16 v[76:79], a[216:219], a[172:175], v[76:79]
    s_waitcnt lgkmcnt(4)
    v_mfma_f32_16x16x32_bf16 v[80:83], a[220:223], a[160:163], v[80:83]
    ds_read_b64_tr_b16 a[212:213], v3 offset:20576
    v_mfma_f32_16x16x32_bf16 v[84:87], a[220:223], a[164:167], v[84:87]
    ds_read_b64_tr_b16 a[214:215], v3 offset:22880
    v_mfma_f32_16x16x32_bf16 v[88:91], a[220:223], a[168:171], v[88:91]
    buffer_load_dwordx4 a[156:159], v1, s[16:19], s42 offen offset:1024
    v_mfma_f32_16x16x32_bf16 v[92:95], a[220:223], a[172:175], v[92:95]
    s_waitcnt lgkmcnt(4)
    v_mfma_f32_16x16x32_bf16 v[96:99], a[224:227], a[160:163], v[96:99]
    ds_read_b64_tr_b16 a[216:217], v3 offset:29792
    v_mfma_f32_16x16x32_bf16 v[100:103], a[224:227], a[164:167], v[100:103]
    ds_read_b64_tr_b16 a[218:219], v3 offset:32096
    v_mfma_f32_16x16x32_bf16 v[104:107], a[224:227], a[168:171], v[104:107]
    s_add_u32 m0, s37, 61440
    v_mfma_f32_16x16x32_bf16 v[108:111], a[224:227], a[172:175], v[108:111]
    s_waitcnt lgkmcnt(4)
    v_mfma_f32_16x16x32_bf16 v[112:115], a[208:211], a[160:163], v[112:115]
    ds_read_b64_tr_b16 a[220:221], v3 offset:20608
    v_mfma_f32_16x16x32_bf16 v[116:119], a[208:211], a[164:167], v[116:119]
    ds_read_b64_tr_b16 a[222:223], v3 offset:22912
    v_mfma_f32_16x16x32_bf16 v[120:123], a[208:211], a[168:171], v[120:123]
    global_load_lds_dwordx4 v[12:13], off
    v_mfma_f32_16x16x32_bf16 v[124:127], a[208:211], a[172:175], v[124:127]
    s_waitcnt lgkmcnt(4)
    v_mfma_f32_16x16x32_bf16 v[128:131], a[212:215], a[160:163], v[128:131]
    ds_read_b64_tr_b16 a[224:225], v3 offset:29824
    v_mfma_f32_16x16x32_bf16 v[132:135], a[212:215], a[164:167], v[132:135]
    ds_read_b64_tr_b16 a[226:227], v3 offset:32128
    v_mfma_f32_16x16x32_bf16 v[136:139], a[212:215], a[168:171], v[136:139]
    v_add_co_u32 v12, s[62:63], s38, v12
    v_mfma_f32_16x16x32_bf16 v[140:143], a[212:215], a[172:175], v[140:143]
    s_waitcnt lgkmcnt(4)
    v_mfma_f32_16x16x32_bf16 v[144:147], a[216:219], a[160:163], v[144:147]
    ds_read_b64_tr_b16 a[208:209], v3 offset:20640
    v_mfma_f32_16x16x32_bf16 v[148:151], a[216:219], a[164:167], v[148:151]
    ds_read_b64_tr_b16 a[210:211], v3 offset:22944
    v_mfma_f32_16x16x32_bf16 v[152:155], a[216:219], a[168:171], v[152:155]
    s_add_u32 s29, s29, 0
    v_mfma_f32_16x16x32_bf16 v[156:159], a[216:219], a[172:175], v[156:159]
    s_waitcnt lgkmcnt(4)
    v_mfma_f32_16x16x32_bf16 v[160:163], a[220:223], a[160:163], v[160:163]
    ds_read_b64_tr_b16 a[212:213], v3 offset:29856
    v_mfma_f32_16x16x32_bf16 v[164:167], a[220:223], a[164:167], v[164:167]
    ds_read_b64_tr_b16 a[214:215], v3 offset:32160
    v_mfma_f32_16x16x32_bf16 v[168:171], a[220:223], a[168:171], v[168:171]
    s_add_u32 s29, s29, 0
    v_mfma_f32_16x16x32_bf16 v[172:175], a[220:223], a[172:175], v[172:175]
    s_waitcnt lgkmcnt(4)
    v_mfma_f32_16x16x32_bf16 v[176:179], a[224:227], a[160:163], v[176:179]
    ds_read_b64_tr_b16 a[216:217], v3 offset:20672
    v_mfma_f32_16x16x32_bf16 v[180:183], a[224:227], a[164:167], v[180:183]
    ds_read_b64_tr_b16 a[218:219], v3 offset:22976
    v_mfma_f32_16x16x32_bf16 v[184:187], a[224:227], a[168:171], v[184:187]
    v_addc_co_u32 v13, s[62:63], 0, v13, s[62:63]
    v_mfma_f32_16x16x32_bf16 v[188:191], a[224:227], a[172:175], v[188:191]
    s_waitcnt lgkmcnt(4)
    v_mfma_f32_16x16x32_bf16 v[192:195], a[208:211], a[160:163], v[192:195]
    ds_read_b64_tr_b16 a[220:221], v3 offset:29888
    v_mfma_f32_16x16x32_bf16 v[196:199], a[208:211], a[164:167], v[196:199]
    ds_read_b64_tr_b16 a[222:223], v3 offset:32192
    v_mfma_f32_16x16x32_bf16 v[200:203], a[208:211], a[168:171], v[200:203]
    s_add_u32 m0, s33, 61440
    v_mfma_f32_16x16x32_bf16 v[204:207], a[208:211], a[172:175], v[204:207]
    s_waitcnt lgkmcnt(4)
    v_mfma_f32_16x16x32_bf16 v[208:211], a[212:215], a[160:163], v[208:211]
    ds_read_b64_tr_b16 a[224:225], v3 offset:20704
    v_mfma_f32_16x16x32_bf16 v[212:215], a[212:215], a[164:167], v[212:215]
    ds_read_b64_tr_b16 a[226:227], v3 offset:23008
    v_mfma_f32_16x16x32_bf16 v[216:219], a[212:215], a[168:171], v[216:219]
    buffer_load_dwordx4 v8, s[8:11], s28 offen lds
    v_mfma_f32_16x16x32_bf16 v[220:223], a[212:215], a[172:175], v[220:223]
    s_waitcnt lgkmcnt(4)
    v_mfma_f32_16x16x32_bf16 v[224:227], a[216:219], a[160:163], v[224:227]
    ds_read_b64_tr_b16 a[208:209], v3 offset:29920
    v_mfma_f32_16x16x32_bf16 v[228:231], a[216:219], a[164:167], v[228:231]
    ds_read_b64_tr_b16 a[210:211], v3 offset:32224
    v_mfma_f32_16x16x32_bf16 v[232:235], a[216:219], a[168:171], v[232:235]
    s_add_u32 m0, s34, 61440
    v_mfma_f32_16x16x32_bf16 v[236:239], a[216:219], a[172:175], v[236:239]
    s_waitcnt lgkmcnt(4)
    v_mfma_f32_16x16x32_bf16 v[240:243], a[220:223], a[160:163], v[240:243]
    ds_read_b64_tr_b16 a[212:213], v3 offset:20736
    v_mfma_f32_16x16x32_bf16 v[244:247], a[220:223], a[164:167], v[244:247]
    ds_read_b64_tr_b16 a[214:215], v3 offset:23040
    v_mfma_f32_16x16x32_bf16 v[248:251], a[220:223], a[168:171], v[248:251]
    buffer_load_dwordx4 v9, s[8:11], s28 offen lds
    v_mfma_f32_16x16x32_bf16 v[252:255], a[220:223], a[172:175], v[252:255]
    s_waitcnt lgkmcnt(4)
    v_mfma_f32_16x16x32_bf16 a[0:3], a[224:227], a[160:163], a[0:3]
    ds_read_b64_tr_b16 a[216:217], v3 offset:29952
    v_mfma_f32_16x16x32_bf16 a[4:7], a[224:227], a[164:167], a[4:7]
    ds_read_b64_tr_b16 a[218:219], v3 offset:32256
    v_mfma_f32_16x16x32_bf16 a[8:11], a[224:227], a[168:171], a[8:11]
    s_add_u32 m0, s35, 61440
    v_mfma_f32_16x16x32_bf16 a[12:15], a[224:227], a[172:175], a[12:15]
    s_waitcnt lgkmcnt(4)
    v_mfma_f32_16x16x32_bf16 a[16:19], a[208:211], a[160:163], a[16:19]
    ds_read_b128 a[220:223], v6 offset:38912
    v_mfma_f32_16x16x32_bf16 a[20:23], a[208:211], a[164:167], a[20:23]
    buffer_load_dwordx4 v10, s[20:23], s28 offen lds
    v_mfma_f32_16x16x32_bf16 a[24:27], a[208:211], a[168:171], a[24:27]
    s_add_u32 m0, s36, 61440
    v_mfma_f32_16x16x32_bf16 a[28:31], a[208:211], a[172:175], a[28:31]
    s_waitcnt lgkmcnt(3)
    v_mfma_f32_16x16x32_bf16 a[32:35], a[212:215], a[160:163], a[32:35]
    ds_read_b128 a[224:227], v6 offset:39936
    v_mfma_f32_16x16x32_bf16 a[36:39], a[212:215], a[164:167], a[36:39]
    buffer_load_dwordx4 v11, s[12:15], s28 offen lds
    v_mfma_f32_16x16x32_bf16 a[40:43], a[212:215], a[168:171], a[40:43]
    s_add_u32 s28, s28, 294912
    v_mfma_f32_16x16x32_bf16 a[44:47], a[212:215], a[172:175], a[44:47]
    s_waitcnt lgkmcnt(2)
    v_mfma_f32_16x16x32_bf16 a[48:51], a[216:219], a[160:163], a[48:51]
    ds_read_b64_tr_b16 a[208:209], v3 offset:40960
    v_mfma_f32_16x16x32_bf16 a[52:55], a[216:219], a[164:167], a[52:55]
    ds_read_b64_tr_b16 a[210:211], v3 offset:43264
    v_mfma_f32_16x16x32_bf16 a[56:59], a[216:219], a[168:171], a[56:59]
    v_mfma_f32_16x16x32_bf16 a[60:63], a[216:219], a[172:175], a[60:63]
    s_waitcnt lgkmcnt(3)
    v_mfma_f32_16x16x32_bf16 a[64:67], a[160:163], a[220:223], a[64:67]
    ds_read_b64_tr_b16 a[212:213], v3 offset:50176
    v_mfma_f32_16x16x32_bf16 a[68:71], a[164:167], a[220:223], a[68:71]
    ds_read_b64_tr_b16 a[214:215], v3 offset:52480
    v_mfma_f32_16x16x32_bf16 a[72:75], a[168:171], a[220:223], a[72:75]
    v_mfma_f32_16x16x32_bf16 a[76:79], a[172:175], a[220:223], a[76:79]
    s_waitcnt lgkmcnt(4)
    s_cmp_lg_u32 s29, 1
    s_cbranch_scc1 K1_skip11_0
    v_mfma_f32_16x16x32_bf16 a[80:83], a[160:163], a[224:227], a[80:83]
    v_mfma_f32_16x16x32_bf16 a[84:87], a[164:167], a[224:227], a[84:87]
K1_skip11_0:
    s_cmp_lg_u32 s29, 2
    s_cbranch_scc1 K1_skip11_1
    v_mfma_f32_16x16x32_bf16 a[88:91], a[168:171], a[224:227], a[88:91]
    v_mfma_f32_16x16x32_bf16 a[92:95], a[172:175], a[224:227], a[92:95]
K1_skip11_1:
    s_waitcnt vmcnt(37)
    s_barrier
    ds_read_b64_tr_b16 a[216:217], v4 offset:0
    ds_read_b64_tr_b16 a[218:219], v4 offset:2304
K1_phase2:
    v_mov_b32 v0, s44
    s_waitcnt lgkmcnt(4)
    v_mfma_f32_16x16x32_bf16 v[32:35], a[208:211], a[176:179], v[32:35]
    ds_read_b64_tr_b16 a[220:221], v4 offset:9216
    v_mfma_f32_16x16x32_bf16 v[36:39], a[208:211], a[180:183], v[36:39]
    ds_read_b64_tr_b16 a[222:223], v4 offset:11520
    v_mfma_f32_16x16x32_bf16 v[40:43], a[208:211], a[184:187], v[40:43]
    v_mfma_f32_16x16x32_bf16 v[44:47], a[208:211], a[188:191], v[44:47]
    s_waitcnt lgkmcnt(4)
    v_mfma_f32_16x16x32_bf16 v[48:51], a[212:215], a[176:179], v[48:51]
    s_waitcnt vmcnt(28)
    s_barrier
    ds_read_b64_tr_b16 a[224:225], v2 offset:0
    v_mfma_f32_16x16x32_bf16 v[52:55], a[212:215], a[180:183], v[52:55]
    ds_read_b64_tr_b16 a[226:227], v2 offset:2304
    v_mfma_f32_16x16x32_bf16 v[56:59], a[212:215], a[184:187], v[56:59]
    v_mfma_f32_16x16x32_bf16 v[60:63], a[212:215], a[188:191], v[60:63]
    s_waitcnt lgkmcnt(4)
    v_mfma_f32_16x16x32_bf16 v[32:35], a[216:219], a[192:195], v[32:35]
    ds_read_b64_tr_b16 a[208:209], v2 offset:9216
    v_mfma_f32_16x16x32_bf16 v[36:39], a[216:219], a[196:199], v[36:39]
    ds_read_b64_tr_b16 a[210:211], v2 offset:11520
    v_mfma_f32_16x16x32_bf16 v[40:43], a[216:219], a[200:203], v[40:43]
    v_mfma_f32_16x16x32_bf16 v[44:47], a[216:219], a[204:207], v[44:47]
    s_waitcnt lgkmcnt(4)
    v_mfma_f32_16x16x32_bf16 v[48:51], a[220:223], a[192:195], v[48:51]
    s_waitcnt vmcnt(19)
    s_barrier
    ds_read_b64_tr_b16 a[212:213], v2 offset:20480
    v_mfma_f32_16x16x32_bf16 v[52:55], a[220:223], a[196:199], v[52:55]
    ds_read_b64_tr_b16 a[214:215], v2 offset:22784
    v_mfma_f32_16x16x32_bf16 v[56:59], a[220:223], a[200:203], v[56:59]
    v_mfma_f32_16x16x32_bf16 v[60:63], a[220:223], a[204:207], v[60:63]
    s_waitcnt lgkmcnt(4)
    v_mfma_f32_16x16x32_bf16 v[32:35], a[224:227], a[96:99], v[32:35]
    ds_read_b64_tr_b16 a[216:217], v2 offset:29696
    v_mfma_f32_16x16x32_bf16 v[36:39], a[224:227], a[100:103], v[36:39]
    ds_read_b64_tr_b16 a[218:219], v2 offset:32000
    v_mfma_f32_16x16x32_bf16 v[40:43], a[224:227], a[104:107], v[40:43]
    v_mfma_f32_16x16x32_bf16 v[44:47], a[224:227], a[108:111], v[44:47]
    s_waitcnt lgkmcnt(4)
    v_mfma_f32_16x16x32_bf16 v[48:51], a[208:211], a[96:99], v[48:51]
    s_waitcnt vmcnt(10)
    s_barrier
    ds_read_b64_tr_b16 a[220:221], v2 offset:40960
    v_mfma_f32_16x16x32_bf16 v[52:55], a[208:211], a[100:103], v[52:55]
    ds_read_b64_tr_b16 a[222:223], v2 offset:43264
    v_mfma_f32_16x16x32_bf16 v[56:59], a[208:211], a[104:107], v[56:59]
    v_mfma_f32_16x16x32_bf16 v[60:63], a[208:211], a[108:111], v[60:63]
    s_waitcnt lgkmcnt(4)
    v_mfma_f32_16x16x32_bf16 v[32:35], a[212:215], a[112:115], v[32:35]
    ds_read_b64_tr_b16 a[224:225], v2 offset:50176
    v_mfma_f32_16x16x32_bf16 v[36:39], a[212:215], a[116:119], v[36:39]
    ds_read_b64_tr_b16 a[226:227], v2 offset:52480
    v_mfma_f32_16x16x32_bf16 v[40:43], a[212:215], a[120:123], v[40:43]
    v_mfma_f32_16x16x32_bf16 v[44:47], a[212:215], a[124:127], v[44:47]
    s_waitcnt lgkmcnt(4)
    v_mfma_f32_16x16x32_bf16 v[48:51], a[216:219], a[112:115], v[48:51]
    s_waitcnt vmcnt(0)
    s_barrier
    ds_read_b64_tr_b16 a[208:209], v3 offset:0
    v_mfma_f32_16x16x32_bf16 v[52:55], a[216:219], a[116:119], v[52:55]
    ds_read_b64_tr_b16 a[210:211], v3 offset:2304
    v_mfma_f32_16x16x32_bf16 v[56:59], a[216:219], a[120:123], v[56:59]
    v_mfma_f32_16x16x32_bf16 v[60:63], a[216:219], a[124:127], v[60:63]
    s_waitcnt lgkmcnt(4)
    v_mfma_f32_16x16x32_bf16 v[32:35], a[220:223], a[128:131], v[32:35]
    ds_read_b64_tr_b16 a[212:213], v3 offset:9216
    v_mfma_f32_16x16x32_bf16 v[36:39], a[220:223], a[132:135], v[36:39]
    ds_read_b64_tr_b16 a[214:215], v3 offset:11520
    v_mfma_f32_16x16x32_bf16 v[40:43], a[220:223], a[136:139], v[40:43]
    v_mfma_f32_16x16x32_bf16 v[44:47], a[220:223], a[140:143], v[44:47]
    s_waitcnt lgkmcnt(4)
    v_mfma_f32_16x16x32_bf16 v[48:51], a[224:227], a[128:131], v[48:51]
    ds_read_b64_tr_b16 a[216:217], v3 offset:40992
    v_mfma_f32_16x16x32_bf16 v[52:55], a[224:227], a[132:135], v[52:55]
    ds_read_b64_tr_b16 a[218:219], v3 offset:43296
    v_mfma_f32_16x16x32_bf16 v[56:59], a[224:227], a[136:139], v[56:59]
    v_mfma_f32_16x16x32_bf16 v[60:63], a[224:227], a[140:143], v[60:63]
    s_waitcnt lgkmcnt(4)
    v_mfma_f32_16x16x32_bf16 v[32:35], a[208:211], a[144:147], v[32:35]
    ds_read_b64_tr_b16 a[220:221], v3 offset:50208
    v_mfma_f32_16x16x32_bf16 v[36:39], a[208:211], a[148:151], v[36:39]
    ds_read_b64_tr_b16 a[222:223], v3 offset:52512
    v_mfma_f32_16x16x32_bf16 v[40:43], a[208:211], a[152:155], v[40:43]
    v_mfma_f32_16x16x32_bf16 v[44:47], a[208:211], a[156:159], v[44:47]
    s_waitcnt lgkmcnt(4)
    v_mfma_f32_16x16x32_bf16 v[48:51], a[212:215], a[144:147], v[48:51]
    ds_read_b64_tr_b16 a[224:225], v4 offset:32
    v_mfma_f32_16x16x32_bf16 v[52:55], a[212:215], a[148:151], v[52:55]
    ds_read_b64_tr_b16 a[226:227], v4 offset:2336
    v_mfma_f32_16x16x32_bf16 v[56:59], a[212:215], a[152:155], v[56:59]
    v_mfma_f32_16x16x32_bf16 v[60:63], a[212:215], a[156:159], v[60:63]
    s_waitcnt lgkmcnt(4)
    v_mfma_f32_16x16x32_bf16 v[64:67], a[216:219], a[176:179], v[64:67]
    ds_read_b64_tr_b16 a[208:209], v4 offset:9248
    v_mfma_f32_16x16x32_bf16 v[68:71], a[216:219], a[180:183], v[68:71]
    ds_read_b64_tr_b16 a[210:211], v4 offset:11552
    v_mfma_f32_16x16x32_bf16 v[72:75], a[216:219], a[184:187], v[72:75]
    v_mfma_f32_16x16x32_bf16 v[76:79], a[216:219], a[188:191], v[76:79]
    s_waitcnt lgkmcnt(4)
    v_mfma_f32_16x16x32_bf16 v[80:83], a[220:223], a[176:179], v[80:83]
    ds_read_b64_tr_b16 a[212:213], v2 offset:32
    v_mfma_f32_16x16x32_bf16 v[84:87], a[220:223], a[180:183], v[84:87]
    ds_read_b64_tr_b16 a[214:215], v2 offset:2336
    v_mfma_f32_16x16x32_bf16 v[88:91], a[220:223], a[184:187], v[88:91]
    v_mfma_f32_16x16x32_bf16 v[92:95], a[220:223], a[188:191], v[92:95]
    s_waitcnt lgkmcnt(4)
    v_mfma_f32_16x16x32_bf16 v[64:67], a[224:227], a[192:195], v[64:67]
    ds_read_b64_tr_b16 a[216:217], v2 offset:9248
    s_lshr_b32 s55, s2, 3
    v_mbcnt_lo_u32_b32 v12, -1, 0
    v_mov_b32 v11, 2130706432
    v_mfma_f32_16x16x32_bf16 v[68:71], a[224:227], a[196:199], v[68:71]
    ds_read_b64_tr_b16 a[218:219], v2 offset:11552
    s_lshl_b32 s55, s55, 2
    v_mbcnt_hi_u32_b32 v12, -1, v12
    v_mfma_f32_16x16x32_bf16 v[72:75], a[224:227], a[200:203], v[72:75]
    v_cmp_gt_u32 s[62:63], 14, v12
    s_add_u32 s55, s55, s52
    v_mfma_f32_16x16x32_bf16 v[76:79], a[224:227], a[204:207], v[76:79]
    s_waitcnt lgkmcnt(4)
    v_mfma_f32_16x16x32_bf16 v[80:83], a[208:211], a[192:195], v[80:83]
    ds_read_b64_tr_b16 a[220:221], v2 offset:20512
    v_mfma_f32_16x16x32_bf16 v[84:87], a[208:211], a[196:199], v[84:87]
    ds_read_b64_tr_b16 a[222:223], v2 offset:22816
    s_mul_i32 s55, s55, 81
    v_mfma_f32_16x16x32_bf16 v[88:91], a[208:211], a[200:203], v[88:91]
    v_mfma_f32_16x16x32_bf16 v[92:95], a[208:211], a[204:207], v[92:95]
    s_waitcnt lgkmcnt(4)
    v_mfma_f32_16x16x32_bf16 v[64:67], a[212:215], a[96:99], v[64:67]
    ds_read_b64_tr_b16 a[224:225], v2 offset:29728
    v_add_u32 v12, s55, v12
    s_and_b32 s55, s2, 7
    v_lshlrev_b32 v12, 7, v12
    v_mfma_f32_16x16x32_bf16 v[68:71], a[212:215], a[100:103], v[68:71]
    ds_read_b64_tr_b16 a[226:227], v2 offset:32032
    v_exp_f32 v32, v32
    s_lshr_b32 s55, s55, 1
    v_mfma_f32_16x16x32_bf16 v[72:75], a[212:215], a[104:107], v[72:75]
    v_exp_f32 v33, v33
    v_exp_f32 v34, v34
    s_mul_i32 s55, s55, 1327104
    s_mov_b32 s100, 0
    s_mov_b32 s56, s96
    s_and_b32 s57, s97, 0xffff
    s_mov_b32 s58, 5308416
    s_mov_b32 s59, 0x20000
    v_mfma_f32_16x16x32_bf16 v[76:79], a[212:215], a[108:111], v[76:79]
    v_exp_f32 v35, v35
    v_exp_f32 v36, v36
    s_waitcnt lgkmcnt(4)
    v_mfma_f32_16x16x32_bf16 v[80:83], a[216:219], a[96:99], v[80:83]
    ds_read_b64_tr_b16 a[208:209], v2 offset:40992
    v_exp_f32 v37, v37
    v_add_u32 v12, s55, v12
    v_mfma_f32_16x16x32_bf16 v[84:87], a[216:219], a[100:103], v[84:87]
    ds_read_b64_tr_b16 a[210:211], v2 offset:43296
    v_exp_f32 v38, v38
    v_cndmask_b32 v13, v11, v12, s[62:63]
    v_mfma_f32_16x16x32_bf16 v[88:91], a[216:219], a[104:107], v[88:91]
    v_exp_f32 v39, v39
    buffer_load_dword a241, v13, s[56:59], s100 offen
    s_add_u32 s100, s100, 1792
    v_fma_f32 v32, v32, v0, v0
    v_mfma_f32_16x16x32_bf16 v[92:95], a[216:219], a[108:111], v[92:95]
    v_rcp_f32 v32, v32
    v_fma_f32 v33, v33, v0, v0
    v_fma_f32 v34, v34, v0, v0
    s_waitcnt lgkmcnt(4)
    v_mfma_f32_16x16x32_bf16 v[64:67], a[220:223], a[112:115], v[64:67]
    ds_read_b64_tr_b16 a[212:213], v2 offset:50208
    v_rcp_f32 v33, v33
    v_fma_f32 v35, v35, v0, v0
    v_mfma_f32_16x16x32_bf16 v[68:71], a[220:223], a[116:119], v[68:71]
    ds_read_b64_tr_b16 a[214:215], v2 offset:52512
    v_rcp_f32 v34, v34
    v_fma_f32 v36, v36, v0, v0
    v_mfma_f32_16x16x32_bf16 v[72:75], a[220:223], a[120:123], v[72:75]
    v_rcp_f32 v35, v35
    v_rcp_f32 v36, v36
    v_mfma_f32_16x16x32_bf16 v[76:79], a[220:223], a[124:127], v[76:79]
    v_fma_f32 v37, v37, v0, v0
    v_fma_f32 v38, v38, v0, v0
    v_rcp_f32 v37, v37
    s_waitcnt lgkmcnt(4)
    v_mfma_f32_16x16x32_bf16 v[80:83], a[224:227], a[112:115], v[80:83]
    ds_read_b64_tr_b16 a[216:217], v3 offset:32
    v_rcp_f32 v38, v38
    v_fma_f32 v39, v39, v0, v0
    v_mfma_f32_16x16x32_bf16 v[84:87], a[224:227], a[116:119], v[84:87]
    ds_read_b64_tr_b16 a[218:219], v3 offset:2336
    v_rcp_f32 v39, v39
    v_mul_f32 v48, v48, v32
    v_mfma_f32_16x16x32_bf16 v[88:91], a[224:227], a[120:123], v[88:91]
    v_exp_f32 v40, v40
    v_exp_f32 v41, v41
    v_mfma_f32_16x16x32_bf16 v[92:95], a[224:227], a[124:127], v[92:95]
    v_exp_f32 v42, v42
    v_exp_f32 v43, v43
    s_waitcnt lgkmcnt(4)
    v_mfma_f32_16x16x32_bf16 v[64:67], a[208:211], a[128:131], v[64:67]
    ds_read_b64_tr_b16 a[220:221], v3 offset:9248
    v_exp_f32 v44, v44
    v_mul_f32 v49, v49, v33
    v_mfma_f32_16x16x32_bf16 v[68:71], a[208:211], a[132:135], v[68:71]
    ds_read_b64_tr_b16 a[222:223], v3 offset:11552
    v_exp_f32 v45, v45
    v_mul_f32 v50, v50, v34
    v_mfma_f32_16x16x32_bf16 v[72:75], a[208:211], a[136:139], v[72:75]
    v_exp_f32 v46, v46
    v_exp_f32 v47, v47
    v_mfma_f32_16x16x32_bf16 v[76:79], a[208:211], a[140:143], v[76:79]
    v_mul_f32 v51, v51, v35
    v_mul_f32 v52, v52, v36
    v_mul_f32 v53, v53, v37
    v_mul_f32 v54, v54, v38
    s_waitcnt lgkmcnt(4)
    v_mfma_f32_16x16x32_bf16 v[80:83], a[212:215], a[128:131], v[80:83]
    ds_read_b64_tr_b16 a[224:225], v3 offset:41024
    v_mul_f32 v55, v55, v39
    v_cvt_pk_bf16_f32 v32, v48, v49
    v_cvt_pk_bf16_f32 v33, v50, v51
    v_mfma_f32_16x16x32_bf16 v[84:87], a[212:215], a[132:135], v[84:87]
    ds_read_b64_tr_b16 a[226:227], v3 offset:43328
    v_cvt_pk_bf16_f32 v36, v52, v53
    v_cvt_pk_bf16_f32 v37, v54, v55
    v_fma_f32 v40, v40, v0, v0
    v_mfma_f32_16x16x32_bf16 v[88:91], a[212:215], a[136:139], v[88:91]
    v_rcp_f32 v40, v40
    v_fma_f32 v41, v41, v0, v0
    v_fma_f32 v42, v42, v0, v0
    v_mfma_f32_16x16x32_bf16 v[92:95], a[212:215], a[140:143], v[92:95]
    v_rcp_f32 v41, v41
    v_rcp_f32 v42, v42
    s_waitcnt lgkmcnt(4)
    v_mfma_f32_16x16x32_bf16 v[64:67], a[216:219], a[144:147], v[64:67]
    ds_read_b64_tr_b16 a[208:209], v3 offset:50240
    v_fma_f32 v43, v43, v0, v0
    v_fma_f32 v44, v44, v0, v0
    v_fma_f32 v45, v45, v0, v0
    v_mfma_f32_16x16x32_bf16 v[68:71], a[216:219], a[148:151], v[68:71]
    ds_read_b64_tr_b16 a[210:211], v3 offset:52544
    v_rcp_f32 v43, v43
    v_fma_f32 v46, v46, v0, v0
    v_mfma_f32_16x16x32_bf16 v[72:75], a[216:219], a[152:155], v[72:75]
    v_rcp_f32 v44, v44
    v_rcp_f32 v45, v45
    v_mfma_f32_16x16x32_bf16 v[76:79], a[216:219], a[156:159], v[76:79]
    v_rcp_f32 v46, v46
    v_fma_f32 v47, v47, v0, v0
    v_mul_f32 v56, v56, v40
    s_waitcnt lgkmcnt(4)
    v_mfma_f32_16x16x32_bf16 v[80:83], a[220:223], a[144:147], v[80:83]
    ds_read_b64_tr_b16 a[212:213], v4 offset:64
    v_rcp_f32 v47, v47
    v_mfma_f32_16x16x32_bf16 v[84:87], a[220:223], a[148:151], v[84:87]
    ds_read_b64_tr_b16 a[214:215], v4 offset:2368
    v_mul_f32 v57, v57, v41
    v_mul_f32 v58, v58, v42
    v_mul_f32 v59, v59, v43
    v_mfma_f32_16x16x32_bf16 v[88:91], a[220:223], a[152:155], v[88:91]
    v_mul_f32 v60, v60, v44
    v_mul_f32 v61, v61, v45
    v_mul_f32 v62, v62, v46
    v_mul_f32 v63, v63, v47
    v_mfma_f32_16x16x32_bf16 v[92:95], a[220:223], a[156:159], v[92:95]
    v_cvt_pk_bf16_f32 v40, v56, v57
    v_cvt_pk_bf16_f32 v41, v58, v59
    v_cvt_pk_bf16_f32 v44, v60, v61
    v_cvt_pk_bf16_f32 v45, v62, v63
    s_waitcnt lgkmcnt(4)
    v_mfma_f32_16x16x32_bf16 v[96:99], a[224:227], a[176:179], v[96:99]
    ds_read_b64_tr_b16 a[216:217], v4 offset:9280
    v_mfma_f32_16x16x32_bf16 v[100:103], a[224:227], a[180:183], v[100:103]
    ds_read_b64_tr_b16 a[218:219], v4 offset:11584
    v_mfma_f32_16x16x32_bf16 v[104:107], a[224:227], a[184:187], v[104:107]
    v_mfma_f32_16x16x32_bf16 v[108:111], a[224:227], a[188:191], v[108:111]
    s_waitcnt lgkmcnt(4)
    v_mfma_f32_16x16x32_bf16 v[112:115], a[208:211], a[176:179], v[112:115]
    ds_read_b64_tr_b16 a[220:221], v2 offset:64
    v_mfma_f32_16x16x32_bf16 v[116:119], a[208:211], a[180:183], v[116:119]
    ds_read_b64_tr_b16 a[222:223], v2 offset:2368
    v_mfma_f32_16x16x32_bf16 v[120:123], a[208:211], a[184:187], v[120:123]
    v_mfma_f32_16x16x32_bf16 v[124:127], a[208:211], a[188:191], v[124:127]
    s_waitcnt lgkmcnt(4)
    v_mfma_f32_16x16x32_bf16 v[96:99], a[212:215], a[192:195], v[96:99]
    ds_read_b64_tr_b16 a[224:225], v2 offset:9280
    v_exp_f32 v64, v64
    v_mfma_f32_16x16x32_bf16 v[100:103], a[212:215], a[196:199], v[100:103]
    ds_read_b64_tr_b16 a[226:227], v2 offset:11584
    v_exp_f32 v65, v65
    v_mfma_f32_16x16x32_bf16 v[104:107], a[212:215], a[200:203], v[104:107]
    v_exp_f32 v66, v66
    buffer_load_dword a241, v13, s[56:59], s100 offen
    s_add_u32 s100, s100, 1792
    v_mfma_f32_16x16x32_bf16 v[108:111], a[212:215], a[204:207], v[108:111]
    v_exp_f32 v67, v67
    v_fma_f32 v64, v64, v0, v0
    s_waitcnt lgkmcnt(4)
    v_mfma_f32_16x16x32_bf16 v[112:115], a[216:219], a[192:195], v[112:115]
    ds_read_b64_tr_b16 a[208:209], v2 offset:20544
    v_exp_f32 v68, v68
    v_mfma_f32_16x16x32_bf16 v[116:119], a[216:219], a[196:199], v[116:119]
    ds_read_b64_tr_b16 a[210:211], v2 offset:22848
    v_exp_f32 v69, v69
    v_mfma_f32_16x16x32_bf16 v[120:123], a[216:219], a[200:203], v[120:123]
    v_exp_f32 v70, v70
    v_fma_f32 v65, v65, v0, v0
    v_mfma_f32_16x16x32_bf16 v[124:127], a[216:219], a[204:207], v[124:127]
    v_exp_f32 v71, v71
    v_fma_f32 v66, v66, v0, v0
    s_waitcnt lgkmcnt(4)
    v_mfma_f32_16x16x32_bf16 v[96:99], a[220:223], a[96:99], v[96:99]
    ds_read_b64_tr_b16 a[212:213], v2 offset:29760
    v_rcp_f32 v64, v64
    v_mfma_f32_16x16x32_bf16 v[100:103], a[220:223], a[100:103], v[100:103]
    ds_read_b64_tr_b16 a[214:215], v2 offset:32064
    v_rcp_f32 v65, v65
    v_mfma_f32_16x16x32_bf16 v[104:107], a[220:223], a[104:107], v[104:107]
    v_rcp_f32 v66, v66
    v_fma_f32 v67, v67, v0, v0
    v_mfma_f32_16x16x32_bf16 v[108:111], a[220:223], a[108:111], v[108:111]
    v_rcp_f32 v67, v67
    v_fma_f32 v68, v68, v0, v0
    s_waitcnt lgkmcnt(4)
    v_mfma_f32_16x16x32_bf16 v[112:115], a[224:227], a[96:99], v[112:115]
    ds_read_b64_tr_b16 a[216:217], v2 offset:41024
    v_rcp_f32 v68, v68
    v_mfma_f32_16x16x32_bf16 v[116:119], a[224:227], a[100:103], v[116:119]
    ds_read_b64_tr_b16 a[218:219], v2 offset:43328
    v_fma_f32 v69, v69, v0, v0
    v_fma_f32 v70, v70, v0, v0
    v_mfma_f32_16x16x32_bf16 v[120:123], a[224:227], a[104:107], v[120:123]
    v_rcp_f32 v69, v69
    v_fma_f32 v71, v71, v0, v0
    v_mfma_f32_16x16x32_bf16 v[124:127], a[224:227], a[108:111], v[124:127]
    v_rcp_f32 v70, v70
    v_mul_f32 v80, v80, v64
    s_waitcnt lgkmcnt(4)
    v_mfma_f32_16x16x32_bf16 v[96:99], a[208:211], a[112:115], v[96:99]
    ds_read_b64_tr_b16 a[220:221], v2 offset:50240
    v_rcp_f32 v71, v71
    s_add_u32 s43, s48, 0
    v_mfma_f32_16x16x32_bf16 v[100:103], a[208:211], a[116:119], v[100:103]
    ds_read_b64_tr_b16 a[222:223], v2 offset:52544
    v_mul_f32 v81, v81, v65
    v_mul_f32 v82, v82, v66
    v_mfma_f32_16x16x32_bf16 v[104:107], a[208:211], a[120:123], v[104:107]
    v_mul_f32 v83, v83, v67
    v_exp_f32 v72, v72
    v_mfma_f32_16x16x32_bf16 v[108:111], a[208:211], a[124:127], v[108:111]
    v_exp_f32 v73, v73
    v_mul_f32 v84, v84, v68
    s_waitcnt lgkmcnt(4)
    v_mfma_f32_16x16x32_bf16 v[112:115], a[212:215], a[112:115], v[112:115]
    ds_read_b64_tr_b16 a[224:225], v3 offset:64
    v_exp_f32 v74, v74
    v_mfma_f32_16x16x32_bf16 v[116:119], a[212:215], a[116:119], v[116:119]
    ds_read_b64_tr_b16 a[226:227], v3 offset:2368
    v_exp_f32 v75, v75
    v_mfma_f32_16x16x32_bf16 v[120:123], a[212:215], a[120:123], v[120:123]
    v_exp_f32 v76, v76
    v_mul_f32 v85, v85, v69
    v_mfma_f32_16x16x32_bf16 v[124:127], a[212:215], a[124:127], v[124:127]
    v_exp_f32 v77, v77
    v_mul_f32 v86, v86, v70
    s_waitcnt lgkmcnt(4)
    v_mfma_f32_16x16x32_bf16 v[96:99], a[216:219], a[128:131], v[96:99]
    ds_read_b64_tr_b16 a[208:209], v3 offset:9280
    v_exp_f32 v78, v78
    v_mfma_f32_16x16x32_bf16 v[100:103], a[216:219], a[132:135], v[100:103]
    ds_read_b64_tr_b16 a[210:211], v3 offset:11584
    v_exp_f32 v79, v79
    v_mfma_f32_16x16x32_bf16 v[104:107], a[216:219], a[136:139], v[104:107]
    v_mul_f32 v87, v87, v71
    v_cvt_pk_bf16_f32 v34, v80, v81
    v_cvt_pk_bf16_f32 v35, v82, v83
    v_mfma_f32_16x16x32_bf16 v[108:111], a[216:219], a[140:143], v[108:111]
    v_cvt_pk_bf16_f32 v38, v84, v85
    v_cvt_pk_bf16_f32 v39, v86, v87
    buffer_store_dwordx4 v[32:35], v14, s[16:19], s43 offen sc1
    s_add_u32 s43, s48, 147456
    s_waitcnt lgkmcnt(4)
    v_mfma_f32_16x16x32_bf16 v[112:115], a[220:223], a[128:131], v[112:115]
    ds_read_b64_tr_b16 a[212:213], v3 offset:41056
    v_fma_f32 v72, v72, v0, v0
    v_fma_f32 v73, v73, v0, v0
    v_mfma_f32_16x16x32_bf16 v[116:119], a[220:223], a[132:135], v[116:119]
    ds_read_b64_tr_b16 a[214:215], v3 offset:43360
    v_rcp_f32 v72, v72
    buffer_store_dwordx4 v[36:39], v14, s[16:19], s43 offen sc1
    v_mfma_f32_16x16x32_bf16 v[120:123], a[220:223], a[136:139], v[120:123]
    v_rcp_f32 v73, v73
    v_fma_f32 v74, v74, v0, v0
    v_fma_f32 v75, v75, v0, v0
    v_mfma_f32_16x16x32_bf16 v[124:127], a[220:223], a[140:143], v[124:127]
    v_rcp_f32 v74, v74
    v_rcp_f32 v75, v75
    s_waitcnt lgkmcnt(4)
    v_mfma_f32_16x16x32_bf16 v[96:99], a[224:227], a[144:147], v[96:99]
    ds_read_b64_tr_b16 a[216:217], v3 offset:50272
    v_fma_f32 v76, v76, v0, v0
    v_fma_f32 v77, v77, v0, v0
    v_mfma_f32_16x16x32_bf16 v[100:103], a[224:227], a[148:151], v[100:103]
    ds_read_b64_tr_b16 a[218:219], v3 offset:52576
    v_rcp_f32 v76, v76
    v_fma_f32 v78, v78, v0, v0
    v_mfma_f32_16x16x32_bf16 v[104:107], a[224:227], a[152:155], v[104:107]
    v_rcp_f32 v77, v77
    v_rcp_f32 v78, v78
    v_mfma_f32_16x16x32_bf16 v[108:111], a[224:227], a[156:159], v[108:111]
    v_fma_f32 v79, v79, v0, v0
    v_mul_f32 v88, v88, v72
    v_rcp_f32 v79, v79
    s_add_u32 s43, s48, 294912
    s_waitcnt lgkmcnt(4)
    v_mfma_f32_16x16x32_bf16 v[112:115], a[208:211], a[144:147], v[112:115]
    ds_read_b64_tr_b16 a[220:221], v4 offset:96
    v_mul_f32 v89, v89, v73
    v_mul_f32 v90, v90, v74
    v_mfma_f32_16x16x32_bf16 v[116:119], a[208:211], a[148:151], v[116:119]
    ds_read_b64_tr_b16 a[222:223], v4 offset:2400
    v_mul_f32 v91, v91, v75
    v_mul_f32 v92, v92, v76
    v_mul_f32 v93, v93, v77
    v_mfma_f32_16x16x32_bf16 v[120:123], a[208:211], a[152:155], v[120:123]
    v_mul_f32 v94, v94, v78
    v_mul_f32 v95, v95, v79
    v_cvt_pk_bf16_f32 v42, v88, v89
    v_cvt_pk_bf16_f32 v43, v90, v91
    v_mfma_f32_16x16x32_bf16 v[124:127], a[208:211], a[156:159], v[124:127]
    v_cvt_pk_bf16_f32 v46, v92, v93
    v_cvt_pk_bf16_f32 v47, v94, v95
    buffer_store_dwordx4 v[40:43], v14, s[16:19], s43 offen sc1
    s_add_u32 s43, s48, 442368
    buffer_store_dwordx4 v[44:47], v14, s[16:19], s43 offen sc1
    s_waitcnt lgkmcnt(4)
    v_mfma_f32_16x16x32_bf16 v[128:131], a[212:215], a[176:179], v[128:131]
    ds_read_b64_tr_b16 a[224:225], v4 offset:9312
    v_mfma_f32_16x16x32_bf16 v[132:135], a[212:215], a[180:183], v[132:135]
    ds_read_b64_tr_b16 a[226:227], v4 offset:11616
    v_mfma_f32_16x16x32_bf16 v[136:139], a[212:215], a[184:187], v[136:139]
    v_mfma_f32_16x16x32_bf16 v[140:143], a[212:215], a[188:191], v[140:143]
    s_waitcnt lgkmcnt(4)
    v_mfma_f32_16x16x32_bf16 v[144:147], a[216:219], a[176:179], v[144:147]
    ds_read_b64_tr_b16 a[208:209], v2 offset:96
    v_mfma_f32_16x16x32_bf16 v[148:151], a[216:219], a[180:183], v[148:151]
    ds_read_b64_tr_b16 a[210:211], v2 offset:2400
    v_mfma_f32_16x16x32_bf16 v[152:155], a[216:219], a[184:187], v[152:155]
    v_mfma_f32_16x16x32_bf16 v[156:159], a[216:219], a[188:191], v[156:159]
    s_waitcnt lgkmcnt(4)
    v_mfma_f32_16x16x32_bf16 v[128:131], a[220:223], a[192:195], v[128:131]
    ds_read_b64_tr_b16 a[212:213], v2 offset:9312
    v_exp_f32 v96, v96
    v_mfma_f32_16x16x32_bf16 v[132:135], a[220:223], a[196:199], v[132:135]
    ds_read_b64_tr_b16 a[214:215], v2 offset:11616
    v_exp_f32 v97, v97
    v_mfma_f32_16x16x32_bf16 v[136:139], a[220:223], a[200:203], v[136:139]
    v_exp_f32 v98, v98
    buffer_load_dword a241, v13, s[56:59], s100 offen
    s_add_u32 s100, s100, 1792
    v_mfma_f32_16x16x32_bf16 v[140:143], a[220:223], a[204:207], v[140:143]
    v_exp_f32 v99, v99
    v_fma_f32 v96, v96, v0, v0
    s_waitcnt lgkmcnt(4)
    v_mfma_f32_16x16x32_bf16 v[144:147], a[224:227], a[192:195], v[144:147]
    ds_read_b64_tr_b16 a[216:217], v2 offset:20576
    v_exp_f32 v100, v100
    v_mfma_f32_16x16x32_bf16 v[148:151], a[224:227], a[196:199], v[148:151]
    ds_read_b64_tr_b16 a[218:219], v2 offset:22880
    v_exp_f32 v101, v101
    v_mfma_f32_16x16x32_bf16 v[152:155], a[224:227], a[200:203], v[152:155]
    v_exp_f32 v102, v102
    v_fma_f32 v97, v97, v0, v0
    v_mfma_f32_16x16x32_bf16 v[156:159], a[224:227], a[204:207], v[156:159]
    v_exp_f32 v103, v103
    v_fma_f32 v98, v98, v0, v0
    s_waitcnt lgkmcnt(4)
    v_mfma_f32_16x16x32_bf16 v[128:131], a[208:211], a[96:99], v[128:131]
    ds_read_b64_tr_b16 a[220:221], v2 offset:29792
    v_rcp_f32 v96, v96
    v_mfma_f32_16x16x32_bf16 v[132:135], a[208:211], a[100:103], v[132:135]
    ds_read_b64_tr_b16 a[222:223], v2 offset:32096
    v_rcp_f32 v97, v97
    v_mfma_f32_16x16x32_bf16 v[136:139], a[208:211], a[104:107], v[136:139]
    v_rcp_f32 v98, v98
    v_fma_f32 v99, v99, v0, v0
    v_mfma_f32_16x16x32_bf16 v[140:143], a[208:211], a[108:111], v[140:143]
    v_rcp_f32 v99, v99
    v_fma_f32 v100, v100, v0, v0
    s_waitcnt lgkmcnt(4)
    v_mfma_f32_16x16x32_bf16 v[144:147], a[212:215], a[96:99], v[144:147]
    ds_read_b64_tr_b16 a[224:225], v2 offset:41056
    v_rcp_f32 v100, v100
    v_mfma_f32_16x16x32_bf16 v[148:151], a[212:215], a[100:103], v[148:151]
    ds_read_b64_tr_b16 a[226:227], v2 offset:43360
    v_fma_f32 v101, v101, v0, v0
    v_fma_f32 v102, v102, v0, v0
    v_mfma_f32_16x16x32_bf16 v[152:155], a[212:215], a[104:107], v[152:155]
    v_rcp_f32 v101, v101
    v_fma_f32 v103, v103, v0, v0
    v_mfma_f32_16x16x32_bf16 v[156:159], a[212:215], a[108:111], v[156:159]
    v_rcp_f32 v102, v102
    v_mul_f32 v112, v112, v96
    s_waitcnt lgkmcnt(4)
    v_mfma_f32_16x16x32_bf16 v[128:131], a[216:219], a[112:115], v[128:131]
    ds_read_b64_tr_b16 a[208:209], v2 offset:50272
    v_rcp_f32 v103, v103
    v_mfma_f32_16x16x32_bf16 v[132:135], a[216:219], a[116:119], v[132:135]
    ds_read_b64_tr_b16 a[210:211], v2 offset:52576
    v_exp_f32 v104, v104
    v_mfma_f32_16x16x32_bf16 v[136:139], a[216:219], a[120:123], v[136:139]
    v_exp_f32 v105, v105
    v_mul_f32 v113, v113, v97
    v_mfma_f32_16x16x32_bf16 v[140:143], a[216:219], a[124:127], v[140:143]
    v_exp_f32 v106, v106
    v_mul_f32 v114, v114, v98
    s_waitcnt lgkmcnt(4)
    v_mfma_f32_16x16x32_bf16 v[144:147], a[220:223], a[112:115], v[144:147]
    ds_read_b64_tr_b16 a[212:213], v3 offset:96
    v_exp_f32 v107, v107
    v_mfma_f32_16x16x32_bf16 v[148:151], a[220:223], a[116:119], v[148:151]
    ds_read_b64_tr_b16 a[214:215], v3 offset:2400
    v_exp_f32 v108, v108
    v_mfma_f32_16x16x32_bf16 v[152:155], a[220:223], a[120:123], v[152:155]
    v_exp_f32 v109, v109
    v_mul_f32 v115, v115, v99
    v_mfma_f32_16x16x32_bf16 v[156:159], a[220:223], a[124:127], v[156:159]
    v_exp_f32 v110, v110
    v_mul_f32 v116, v116, v100
    s_waitcnt lgkmcnt(4)
    v_mfma_f32_16x16x32_bf16 v[128:131], a[224:227], a[128:131], v[128:131]
    ds_read_b64_tr_b16 a[216:217], v3 offset:9312
    v_exp_f32 v111, v111
    v_mfma_f32_16x16x32_bf16 v[132:135], a[224:227], a[132:135], v[132:135]
    ds_read_b64_tr_b16 a[218:219], v3 offset:11616
    v_mul_f32 v117, v117, v101
    v_mul_f32 v118, v118, v102
    v_mfma_f32_16x16x32_bf16 v[136:139], a[224:227], a[136:139], v[136:139]
    v_mul_f32 v119, v119, v103
    v_cvt_pk_bf16_f32 v96, v112, v113
    v_cvt_pk_bf16_f32 v97, v114, v115
    v_mfma_f32_16x16x32_bf16 v[140:143], a[224:227], a[140:143], v[140:143]
    v_cvt_pk_bf16_f32 v100, v116, v117
    v_cvt_pk_bf16_f32 v101, v118, v119
    v_fma_f32 v104, v104, v0, v0
    s_waitcnt lgkmcnt(4)
    v_mfma_f32_16x16x32_bf16 v[144:147], a[208:211], a[128:131], v[144:147]
    ds_read_b64_tr_b16 a[220:221], v3 offset:41088
    v_rcp_f32 v104, v104
    v_mfma_f32_16x16x32_bf16 v[148:151], a[208:211], a[132:135], v[148:151]
    ds_read_b64_tr_b16 a[222:223], v3 offset:43392
    v_fma_f32 v105, v105, v0, v0
    v_fma_f32 v106, v106, v0, v0
    v_mfma_f32_16x16x32_bf16 v[152:155], a[208:211], a[136:139], v[152:155]
    v_rcp_f32 v105, v105
    v_fma_f32 v107, v107, v0, v0
    v_mfma_f32_16x16x32_bf16 v[156:159], a[208:211], a[140:143], v[156:159]
    v_rcp_f32 v106, v106
    v_fma_f32 v108, v108, v0, v0
    s_waitcnt lgkmcnt(4)
    v_mfma_f32_16x16x32_bf16 v[128:131], a[212:215], a[144:147], v[128:131]
    ds_read_b64_tr_b16 a[224:225], v3 offset:50304
    v_rcp_f32 v107, v107
    v_mfma_f32_16x16x32_bf16 v[132:135], a[212:215], a[148:151], v[132:135]
    ds_read_b64_tr_b16 a[226:227], v3 offset:52608
    v_rcp_f32 v108, v108
    v_mfma_f32_16x16x32_bf16 v[136:139], a[212:215], a[152:155], v[136:139]
    v_fma_f32 v109, v109, v0, v0
    v_fma_f32 v110, v110, v0, v0
    v_rcp_f32 v109, v109
    v_mfma_f32_16x16x32_bf16 v[140:143], a[212:215], a[156:159], v[140:143]
    v_rcp_f32 v110, v110
    v_fma_f32 v111, v111, v0, v0
    v_mul_f32 v120, v120, v104
    s_waitcnt lgkmcnt(4)
    v_mfma_f32_16x16x32_bf16 v[144:147], a[216:219], a[144:147], v[144:147]
    ds_read_b64_tr_b16 a[208:209], v4 offset:128
    v_rcp_f32 v111, v111
    v_mfma_f32_16x16x32_bf16 v[148:151], a[216:219], a[148:151], v[148:151]
    ds_read_b64_tr_b16 a[210:211], v4 offset:2432
    v_mul_f32 v121, v121, v105
    v_mul_f32 v122, v122, v106
    v_mul_f32 v123, v123, v107
    v_mfma_f32_16x16x32_bf16 v[152:155], a[216:219], a[152:155], v[152:155]
    v_mul_f32 v124, v124, v108
    v_mul_f32 v125, v125, v109
    v_mul_f32 v126, v126, v110
    v_mul_f32 v127, v127, v111
    v_mfma_f32_16x16x32_bf16 v[156:159], a[216:219], a[156:159], v[156:159]
    v_cvt_pk_bf16_f32 v104, v120, v121
    v_cvt_pk_bf16_f32 v105, v122, v123
    v_cvt_pk_bf16_f32 v108, v124, v125
    v_cvt_pk_bf16_f32 v109, v126, v127
    s_waitcnt lgkmcnt(4)
    v_mfma_f32_16x16x32_bf16 v[160:163], a[220:223], a[176:179], v[160:163]
    ds_read_b64_tr_b16 a[212:213], v4 offset:9344
    v_mfma_f32_16x16x32_bf16 v[164:167], a[220:223], a[180:183], v[164:167]
    ds_read_b64_tr_b16 a[214:215], v4 offset:11648
    v_mfma_f32_16x16x32_bf16 v[168:171], a[220:223], a[184:187], v[168:171]
    v_mfma_f32_16x16x32_bf16 v[172:175], a[220:223], a[188:191], v[172:175]
    s_waitcnt lgkmcnt(4)
    v_mfma_f32_16x16x32_bf16 v[176:179], a[224:227], a[176:179], v[176:179]
    ds_read_b64_tr_b16 a[216:217], v2 offset:128
    v_mfma_f32_16x16x32_bf16 v[180:183], a[224:227], a[180:183], v[180:183]
    ds_read_b64_tr_b16 a[218:219], v2 offset:2432
    v_mfma_f32_16x16x32_bf16 v[184:187], a[224:227], a[184:187], v[184:187]
    v_mfma_f32_16x16x32_bf16 v[188:191], a[224:227], a[188:191], v[188:191]
    s_waitcnt lgkmcnt(4)
    v_mfma_f32_16x16x32_bf16 v[160:163], a[208:211], a[192:195], v[160:163]
    ds_read_b64_tr_b16 a[220:221], v2 offset:9344
    s_and_b32 s3, s2, 7
    s_lshr_b32 s4, s2, 3
    v_mfma_f32_16x16x32_bf16 v[164:167], a[208:211], a[196:199], v[164:167]
    ds_read_b64_tr_b16 a[222:223], v2 offset:11648
    v_mfma_f32_16x16x32_bf16 v[168:171], a[208:211], a[200:203], v[168:171]
    s_and_b32 s5, s3, 3
    s_lshr_b32 s6, s3, 2
    v_mfma_f32_16x16x32_bf16 v[172:175], a[208:211], a[204:207], v[172:175]
    s_waitcnt lgkmcnt(4)
    v_mfma_f32_16x16x32_bf16 v[176:179], a[212:215], a[192:195], v[176:179]
    ds_read_b64_tr_b16 a[224:225], v2 offset:20608
    s_lshl_b32 s5, s5, 3
    s_and_b32 s7, s4, 7
    v_mfma_f32_16x16x32_bf16 v[180:183], a[212:215], a[196:199], v[180:183]
    ds_read_b64_tr_b16 a[226:227], v2 offset:22912
    v_mfma_f32_16x16x32_bf16 v[184:187], a[212:215], a[200:203], v[184:187]
    v_mfma_f32_16x16x32_bf16 v[188:191], a[212:215], a[204:207], v[188:191]
    s_add_u32 s5, s5, s7
    s_lshr_b32 s7, s4, 3
    s_waitcnt lgkmcnt(4)
    v_mfma_f32_16x16x32_bf16 v[160:163], a[216:219], a[96:99], v[160:163]
    ds_read_b64_tr_b16 a[208:209], v2 offset:29824
    v_mfma_f32_16x16x32_bf16 v[164:167], a[216:219], a[100:103], v[164:167]
    ds_read_b64_tr_b16 a[210:211], v2 offset:32128
    v_mfma_f32_16x16x32_bf16 v[168:171], a[216:219], a[104:107], v[168:171]
    s_and_b32 s7, s7, 1
    s_lshr_b32 s4, s4, 4
    v_mfma_f32_16x16x32_bf16 v[172:175], a[216:219], a[108:111], v[172:175]
    s_waitcnt lgkmcnt(4)
    v_mfma_f32_16x16x32_bf16 v[176:179], a[220:223], a[96:99], v[176:179]
    ds_read_b64_tr_b16 a[212:213], v2 offset:41088
    v_mfma_f32_16x16x32_bf16 v[180:183], a[220:223], a[100:103], v[180:183]
    ds_read_b64_tr_b16 a[214:215], v2 offset:43392
    s_lshl_b32 s30, s4, 10
    s_lshl_b32 s31, s6, 8
    v_mfma_f32_16x16x32_bf16 v[184:187], a[220:223], a[104:107], v[184:187]
    v_mfma_f32_16x16x32_bf16 v[188:191], a[220:223], a[108:111], v[188:191]
    s_waitcnt lgkmcnt(4)
    v_mfma_f32_16x16x32_bf16 v[160:163], a[224:227], a[112:115], v[160:163]
    ds_read_b64_tr_b16 a[216:217], v2 offset:50304
    s_add_u32 s30, s30, s31
    s_lshl_b32 s31, s7, 5
    v_mfma_f32_16x16x32_bf16 v[164:167], a[224:227], a[116:119], v[164:167]
    ds_read_b64_tr_b16 a[218:219], v2 offset:52608
    v_mfma_f32_16x16x32_bf16 v[168:171], a[224:227], a[120:123], v[168:171]
    v_mfma_f32_16x16x32_bf16 v[172:175], a[224:227], a[124:127], v[172:175]
    s_add_u32 s30, s30, s31
    s_waitcnt lgkmcnt(4)
    v_mfma_f32_16x16x32_bf16 v[176:179], a[208:211], a[112:115], v[176:179]
    ds_read_b64_tr_b16 a[220:221], v3 offset:128
    v_mfma_f32_16x16x32_bf16 v[180:183], a[208:211], a[116:119], v[180:183]
    ds_read_b64_tr_b16 a[222:223], v3 offset:2432
    v_mfma_f32_16x16x32_bf16 v[184:187], a[208:211], a[120:123], v[184:187]
    s_add_u32 s30, s30, s5
    v_mfma_f32_16x16x32_bf16 v[188:191], a[208:211], a[124:127], v[188:191]
    s_waitcnt lgkmcnt(4)
    v_mfma_f32_16x16x32_bf16 v[160:163], a[212:215], a[128:131], v[160:163]
    ds_read_b64_tr_b16 a[224:225], v3 offset:9344
    v_mfma_f32_16x16x32_bf16 v[164:167], a[212:215], a[132:135], v[164:167]
    ds_read_b64_tr_b16 a[226:227], v3 offset:11648
    s_mul_i32 s30, s30, 578
    s_lshl_b32 s7, s7, 8
    s_lshl_b32 s4, s4, 6
    v_mfma_f32_16x16x32_bf16 v[168:171], a[212:215], a[136:139], v[168:171]
    v_mfma_f32_16x16x32_bf16 v[172:175], a[212:215], a[140:143], v[172:175]
    s_waitcnt lgkmcnt(4)
    v_mfma_f32_16x16x32_bf16 v[176:179], a[216:219], a[128:131], v[176:179]
    ds_read_b64_tr_b16 a[208:209], v3 offset:41120
    s_add_u32 s7, s7, s4
    s_lshl_b32 s6, s6, 5
    v_mbcnt_lo_u32_b32 v48, -1, 0
    v_mfma_f32_16x16x32_bf16 v[180:183], a[216:219], a[132:135], v[180:183]
    ds_read_b64_tr_b16 a[210:211], v3 offset:43424
    v_mbcnt_hi_u32_b32 v48, -1, v48
    s_add_u32 s6, s6, s5
    v_mfma_f32_16x16x32_bf16 v[184:187], a[216:219], a[136:139], v[184:187]
    v_mfma_f32_16x16x32_bf16 v[188:191], a[216:219], a[140:143], v[188:191]
    s_waitcnt lgkmcnt(4)
    v_mfma_f32_16x16x32_bf16 v[160:163], a[220:223], a[144:147], v[160:163]
    ds_read_b64_tr_b16 a[212:213], v3 offset:50336
    s_add_u32 s7, s7, s6
    v_mfma_f32_16x16x32_bf16 v[164:167], a[220:223], a[148:151], v[164:167]
    ds_read_b64_tr_b16 a[214:215], v3 offset:52640
    v_mfma_f32_16x16x32_bf16 v[168:171], a[220:223], a[152:155], v[168:171]
    v_mfma_f32_16x16x32_bf16 v[172:175], a[220:223], a[156:159], v[172:175]
    s_mul_i32 s7, s7, 4736
    s_waitcnt lgkmcnt(4)
    v_mfma_f32_16x16x32_bf16 v[176:179], a[224:227], a[144:147], v[176:179]
    ds_read_b64_tr_b16 a[216:217], v4 offset:160
    v_mfma_f32_16x16x32_bf16 v[180:183], a[224:227], a[148:151], v[180:183]
    ds_read_b64_tr_b16 a[218:219], v4 offset:2464
    v_mfma_f32_16x16x32_bf16 v[184:187], a[224:227], a[152:155], v[184:187]
    s_add_u32 s32, s7, 2359296
    v_mfma_f32_16x16x32_bf16 v[188:191], a[224:227], a[156:159], v[188:191]
    s_add_u32 s101, s32, 606208
    s_and_b32 s5, s5, 1
    v_mov_b32 v51, 2130706432
    s_lshl_b32 s6, s5, 1
    s_sub_u32 s30, s30, s6
    s_lshl_b32 s5, s5, 4
    s_lshl_b32 s3, s52, 6
    v_add_u32 v48, s3, v48
    s_movk_i32 s3, 145
    v_lshlrev_b32 v49, 5, v48
    v_cmp_gt_u32 s[6:7], s3, v48
    s_movk_i32 s3, 4624
    s_nop 0
    s_nop 0
    v_lshlrev_b32 v48, 2, v48
    v_subrev_u32 v49, s5, v49
    v_cndmask_b32 v48, v51, v48, s[6:7]
    v_add_u32 v50, 16, v49
    v_cmp_gt_u32 s[4:5], s3, v49
    v_cmp_gt_u32 s[60:61], s3, v50
    s_and_b64 s[4:5], s[4:5], s[6:7]
    s_and_b64 s[60:61], s[60:61], s[6:7]
    s_add_u32 s31, s30, 0
    v_cndmask_b32 v49, v51, v49, s[4:5]
    v_cndmask_b32 v50, v51, v50, s[60:61]
    buffer_load_dword v32, v48, s[84:87], s31 offen
    buffer_load_dword v40, v48, s[88:91], s31 offen
    s_add_u32 s31, s30, 36992
    buffer_load_dword v33, v48, s[84:87], s31 offen
    buffer_load_dword v41, v48, s[88:91], s31 offen
    s_add_u32 s31, s30, 73984
    buffer_load_dword v34, v48, s[84:87], s31 offen
    buffer_load_dword v42, v48, s[88:91], s31 offen
    s_add_u32 s31, s30, 110976
    buffer_load_dword v35, v48, s[84:87], s31 offen
    buffer_load_dword v43, v48, s[88:91], s31 offen
    s_add_u32 s31, s30, 295936
    buffer_load_dword v36, v48, s[84:87], s31 offen
    buffer_load_dword v44, v48, s[88:91], s31 offen
    s_add_u32 s31, s30, 332928
    v_exp_f32 v128, v128
    v_exp_f32 v129, v129
    v_exp_f32 v130, v130
    v_exp_f32 v131, v131
    v_exp_f32 v132, v132
    v_exp_f32 v133, v133
    v_exp_f32 v134, v134
    v_exp_f32 v135, v135
    buffer_load_dword v37, v48, s[84:87], s31 offen
    buffer_load_dword v45, v48, s[88:91], s31 offen
    s_add_u32 s31, s30, 369920
    v_fma_f32 v128, v128, v0, v0
    v_fma_f32 v129, v129, v0, v0
    v_fma_f32 v130, v130, v0, v0
    buffer_load_dword v38, v48, s[84:87], s31 offen
    v_rcp_f32 v128, v128
    v_rcp_f32 v129, v129
    v_rcp_f32 v130, v130
    buffer_load_dword v46, v48, s[88:91], s31 offen
    s_add_u32 s31, s30, 406912
    v_fma_f32 v131, v131, v0, v0
    v_fma_f32 v132, v132, v0, v0
    v_rcp_f32 v131, v131
    v_rcp_f32 v132, v132
    buffer_load_dword v39, v48, s[84:87], s31 offen
    buffer_load_dword v47, v48, s[88:91], s31 offen
    buffer_load_dword a241, v13, s[56:59], s100 offen
    s_add_u32 s100, s100, 1792
    v_fma_f32 v133, v133, v0, v0
    v_fma_f32 v134, v134, v0, v0
    v_rcp_f32 v133, v133
    v_rcp_f32 v134, v134
    v_fma_f32 v135, v135, v0, v0
    v_mul_f32 v144, v144, v128
    v_rcp_f32 v135, v135
    s_add_u32 s43, s48, 1024
    v_mul_f32 v145, v145, v129
    v_mul_f32 v146, v146, v130
    v_mul_f32 v147, v147, v131
    v_exp_f32 v136, v136
    v_exp_f32 v137, v137
    v_exp_f32 v138, v138
    v_exp_f32 v139, v139
    v_exp_f32 v140, v140
    v_exp_f32 v141, v141
    v_exp_f32 v142, v142
    v_exp_f32 v143, v143
    v_mul_f32 v148, v148, v132
    v_mul_f32 v149, v149, v133
    v_mul_f32 v150, v150, v134
    v_mul_f32 v151, v151, v135
    v_cvt_pk_bf16_f32 v98, v144, v145
    v_cvt_pk_bf16_f32 v99, v146, v147
    v_cvt_pk_bf16_f32 v102, v148, v149
    v_cvt_pk_bf16_f32 v103, v150, v151
    buffer_store_dwordx4 v[96:99], v14, s[16:19], s43 offen sc1
    s_add_u32 s43, s48, 148480
    v_fma_f32 v136, v136, v0, v0
    v_fma_f32 v137, v137, v0, v0
    v_rcp_f32 v136, v136
    v_rcp_f32 v137, v137
    buffer_store_dwordx4 v[100:103], v14, s[16:19], s43 offen sc1
    v_fma_f32 v138, v138, v0, v0
    v_fma_f32 v139, v139, v0, v0
    v_rcp_f32 v138, v138
    v_rcp_f32 v139, v139
    v_fma_f32 v140, v140, v0, v0
    v_fma_f32 v141, v141, v0, v0
    v_rcp_f32 v140, v140
    v_rcp_f32 v141, v141
    v_fma_f32 v142, v142, v0, v0
    v_fma_f32 v143, v143, v0, v0
    v_rcp_f32 v142, v142
    v_rcp_f32 v143, v143
    v_mul_f32 v152, v152, v136
    s_add_u32 s43, s48, 295936
    v_mul_f32 v153, v153, v137
    v_mul_f32 v154, v154, v138
    v_mul_f32 v155, v155, v139
    v_mul_f32 v156, v156, v140
    v_mul_f32 v157, v157, v141
    v_mul_f32 v158, v158, v142
    v_mul_f32 v159, v159, v143
    v_cvt_pk_bf16_f32 v106, v152, v153
    v_cvt_pk_bf16_f32 v107, v154, v155
    v_cvt_pk_bf16_f32 v110, v156, v157
    v_cvt_pk_bf16_f32 v111, v158, v159
    buffer_store_dwordx4 v[104:107], v14, s[16:19], s43 offen sc1
    s_add_u32 s43, s48, 443392
    buffer_store_dwordx4 v[108:111], v14, s[16:19], s43 offen sc1
    s_waitcnt lgkmcnt(4)
    v_mfma_f32_16x16x32_bf16 v[192:195], a[208:211], a[176:179], v[192:195]
    ds_read_b64_tr_b16 a[220:221], v4 offset:9376
    v_mfma_f32_16x16x32_bf16 v[196:199], a[208:211], a[180:183], v[196:199]
    ds_read_b64_tr_b16 a[222:223], v4 offset:11680
    v_mfma_f32_16x16x32_bf16 v[200:203], a[208:211], a[184:187], v[200:203]
    v_mfma_f32_16x16x32_bf16 v[204:207], a[208:211], a[188:191], v[204:207]
    s_waitcnt lgkmcnt(4)
    v_mfma_f32_16x16x32_bf16 v[208:211], a[212:215], a[176:179], v[208:211]
    ds_read_b64_tr_b16 a[224:225], v2 offset:160
    v_mfma_f32_16x16x32_bf16 v[212:215], a[212:215], a[180:183], v[212:215]
    ds_read_b64_tr_b16 a[226:227], v2 offset:2464
    v_mfma_f32_16x16x32_bf16 v[216:219], a[212:215], a[184:187], v[216:219]
    v_mfma_f32_16x16x32_bf16 v[220:223], a[212:215], a[188:191], v[220:223]
    s_waitcnt lgkmcnt(4)
    v_mfma_f32_16x16x32_bf16 v[192:195], a[216:219], a[192:195], v[192:195]
    ds_read_b64_tr_b16 a[208:209], v2 offset:9376
    v_exp_f32 v160, v160
    v_mfma_f32_16x16x32_bf16 v[196:199], a[216:219], a[196:199], v[196:199]
    ds_read_b64_tr_b16 a[210:211], v2 offset:11680
    v_exp_f32 v161, v161
    v_mfma_f32_16x16x32_bf16 v[200:203], a[216:219], a[200:203], v[200:203]
    v_exp_f32 v162, v162
    buffer_load_dword a241, v13, s[56:59], s100 offen
    s_add_u32 s100, s100, 1792
    v_mfma_f32_16x16x32_bf16 v[204:207], a[216:219], a[204:207], v[204:207]
    v_exp_f32 v163, v163
    v_fma_f32 v160, v160, v0, v0
    s_waitcnt lgkmcnt(4)
    v_mfma_f32_16x16x32_bf16 v[208:211], a[220:223], a[192:195], v[208:211]
    ds_read_b64_tr_b16 a[212:213], v2 offset:20640
    v_exp_f32 v164, v164
    v_mfma_f32_16x16x32_bf16 v[212:215], a[220:223], a[196:199], v[212:215]
    ds_read_b64_tr_b16 a[214:215], v2 offset:22944
    v_exp_f32 v165, v165
    v_mfma_f32_16x16x32_bf16 v[216:219], a[220:223], a[200:203], v[216:219]
    v_exp_f32 v166, v166
    v_fma_f32 v161, v161, v0, v0
    v_mfma_f32_16x16x32_bf16 v[220:223], a[220:223], a[204:207], v[220:223]
    v_exp_f32 v167, v167
    v_fma_f32 v162, v162, v0, v0
    s_waitcnt lgkmcnt(4)
    v_mfma_f32_16x16x32_bf16 v[192:195], a[224:227], a[96:99], v[192:195]
    ds_read_b64_tr_b16 a[216:217], v2 offset:29856
    v_rcp_f32 v160, v160
    v_mfma_f32_16x16x32_bf16 v[196:199], a[224:227], a[100:103], v[196:199]
    ds_read_b64_tr_b16 a[218:219], v2 offset:32160
    v_rcp_f32 v161, v161
    v_mfma_f32_16x16x32_bf16 v[200:203], a[224:227], a[104:107], v[200:203]
    v_rcp_f32 v162, v162
    v_fma_f32 v163, v163, v0, v0
    v_mfma_f32_16x16x32_bf16 v[204:207], a[224:227], a[108:111], v[204:207]
    v_rcp_f32 v163, v163
    v_fma_f32 v164, v164, v0, v0
    s_waitcnt lgkmcnt(4)
    v_mfma_f32_16x16x32_bf16 v[208:211], a[208:211], a[96:99], v[208:211]
    ds_read_b64_tr_b16 a[220:221], v2 offset:41120
    v_rcp_f32 v164, v164
    v_mfma_f32_16x16x32_bf16 v[212:215], a[208:211], a[100:103], v[212:215]
    ds_read_b64_tr_b16 a[222:223], v2 offset:43424
    v_fma_f32 v165, v165, v0, v0
    v_fma_f32 v166, v166, v0, v0
    v_mfma_f32_16x16x32_bf16 v[216:219], a[208:211], a[104:107], v[216:219]
    v_rcp_f32 v165, v165
    v_fma_f32 v167, v167, v0, v0
    v_mfma_f32_16x16x32_bf16 v[220:223], a[208:211], a[108:111], v[220:223]
    v_rcp_f32 v166, v166
    v_mul_f32 v176, v176, v160
    s_waitcnt lgkmcnt(4)
    v_mfma_f32_16x16x32_bf16 v[192:195], a[212:215], a[112:115], v[192:195]
    ds_read_b64_tr_b16 a[224:225], v2 offset:50336
    v_rcp_f32 v167, v167
    v_mfma_f32_16x16x32_bf16 v[196:199], a[212:215], a[116:119], v[196:199]
    ds_read_b64_tr_b16 a[226:227], v2 offset:52640
    v_exp_f32 v168, v168
    v_mfma_f32_16x16x32_bf16 v[200:203], a[212:215], a[120:123], v[200:203]
    v_exp_f32 v169, v169
    v_mul_f32 v177, v177, v161
    v_mfma_f32_16x16x32_bf16 v[204:207], a[212:215], a[124:127], v[204:207]
    v_exp_f32 v170, v170
    v_mul_f32 v178, v178, v162
    s_waitcnt lgkmcnt(4)
    v_mfma_f32_16x16x32_bf16 v[208:211], a[216:219], a[112:115], v[208:211]
    ds_read_b64_tr_b16 a[208:209], v3 offset:160
    v_exp_f32 v171, v171
    v_mfma_f32_16x16x32_bf16 v[212:215], a[216:219], a[116:119], v[212:215]
    ds_read_b64_tr_b16 a[210:211], v3 offset:2464
    v_exp_f32 v172, v172
    v_mfma_f32_16x16x32_bf16 v[216:219], a[216:219], a[120:123], v[216:219]
    v_exp_f32 v173, v173
    v_mul_f32 v179, v179, v163
    v_mfma_f32_16x16x32_bf16 v[220:223], a[216:219], a[124:127], v[220:223]
    v_exp_f32 v174, v174
    v_mul_f32 v180, v180, v164
    s_waitcnt lgkmcnt(4)
    v_mfma_f32_16x16x32_bf16 v[192:195], a[220:223], a[128:131], v[192:195]
    ds_read_b64_tr_b16 a[212:213], v3 offset:9376
    v_exp_f32 v175, v175
    v_mfma_f32_16x16x32_bf16 v[196:199], a[220:223], a[132:135], v[196:199]
    ds_read_b64_tr_b16 a[214:215], v3 offset:11680
    v_mul_f32 v181, v181, v165
    v_mul_f32 v182, v182, v166
    v_mfma_f32_16x16x32_bf16 v[200:203], a[220:223], a[136:139], v[200:203]
    v_mul_f32 v183, v183, v167
    v_cvt_pk_bf16_f32 v160, v176, v177
    v_cvt_pk_bf16_f32 v161, v178, v179
    v_mfma_f32_16x16x32_bf16 v[204:207], a[220:223], a[140:143], v[204:207]
    v_cvt_pk_bf16_f32 v164, v180, v181
    v_cvt_pk_bf16_f32 v165, v182, v183
    v_fma_f32 v168, v168, v0, v0
    s_waitcnt lgkmcnt(4)
    v_mfma_f32_16x16x32_bf16 v[208:211], a[224:227], a[128:131], v[208:211]
    ds_read_b64_tr_b16 a[216:217], v3 offset:41152
    v_rcp_f32 v168, v168
    v_mfma_f32_16x16x32_bf16 v[212:215], a[224:227], a[132:135], v[212:215]
    ds_read_b64_tr_b16 a[218:219], v3 offset:43456
    v_fma_f32 v169, v169, v0, v0
    v_fma_f32 v170, v170, v0, v0
    v_mfma_f32_16x16x32_bf16 v[216:219], a[224:227], a[136:139], v[216:219]
    v_rcp_f32 v169, v169
    v_fma_f32 v171, v171, v0, v0
    v_mfma_f32_16x16x32_bf16 v[220:223], a[224:227], a[140:143], v[220:223]
    v_rcp_f32 v170, v170
    v_fma_f32 v172, v172, v0, v0
    s_waitcnt lgkmcnt(4)
    v_mfma_f32_16x16x32_bf16 v[192:195], a[208:211], a[144:147], v[192:195]
    ds_read_b64_tr_b16 a[220:221], v3 offset:50368
    v_rcp_f32 v171, v171
    v_mfma_f32_16x16x32_bf16 v[196:199], a[208:211], a[148:151], v[196:199]
    ds_read_b64_tr_b16 a[222:223], v3 offset:52672
    v_rcp_f32 v172, v172
    v_mfma_f32_16x16x32_bf16 v[200:203], a[208:211], a[152:155], v[200:203]
    v_fma_f32 v173, v173, v0, v0
    v_fma_f32 v174, v174, v0, v0
    v_rcp_f32 v173, v173
    v_mfma_f32_16x16x32_bf16 v[204:207], a[208:211], a[156:159], v[204:207]
    v_rcp_f32 v174, v174
    v_fma_f32 v175, v175, v0, v0
    v_mul_f32 v184, v184, v168
    s_waitcnt lgkmcnt(4)
    v_mfma_f32_16x16x32_bf16 v[208:211], a[212:215], a[144:147], v[208:211]
    ds_read_b64_tr_b16 a[224:225], v4 offset:192
    v_rcp_f32 v175, v175
    v_mfma_f32_16x16x32_bf16 v[212:215], a[212:215], a[148:151], v[212:215]
    ds_read_b64_tr_b16 a[226:227], v4 offset:2496
    v_mul_f32 v185, v185, v169
    v_mul_f32 v186, v186, v170
    v_mul_f32 v187, v187, v171
    v_mfma_f32_16x16x32_bf16 v[216:219], a[212:215], a[152:155], v[216:219]
    v_mul_f32 v188, v188, v172
    v_mul_f32 v189, v189, v173
    v_mul_f32 v190, v190, v174
    v_mul_f32 v191, v191, v175
    v_mfma_f32_16x16x32_bf16 v[220:223], a[212:215], a[156:159], v[220:223]
    v_cvt_pk_bf16_f32 v168, v184, v185
    v_cvt_pk_bf16_f32 v169, v186, v187
    v_cvt_pk_bf16_f32 v172, v188, v189
    v_cvt_pk_bf16_f32 v173, v190, v191
    s_waitcnt lgkmcnt(4)
    v_mfma_f32_16x16x32_bf16 v[224:227], a[216:219], a[176:179], v[224:227]
    ds_read_b64_tr_b16 a[208:209], v4 offset:9408
    v_mfma_f32_16x16x32_bf16 v[228:231], a[216:219], a[180:183], v[228:231]
    ds_read_b64_tr_b16 a[210:211], v4 offset:11712
    v_mfma_f32_16x16x32_bf16 v[232:235], a[216:219], a[184:187], v[232:235]
    v_mfma_f32_16x16x32_bf16 v[236:239], a[216:219], a[188:191], v[236:239]
    s_waitcnt lgkmcnt(4)
    v_mfma_f32_16x16x32_bf16 v[240:243], a[220:223], a[176:179], v[240:243]
    ds_read_b64_tr_b16 a[212:213], v2 offset:192
    v_mfma_f32_16x16x32_bf16 v[244:247], a[220:223], a[180:183], v[244:247]
    ds_read_b64_tr_b16 a[214:215], v2 offset:2496
    v_mfma_f32_16x16x32_bf16 v[248:251], a[220:223], a[184:187], v[248:251]
    v_mfma_f32_16x16x32_bf16 v[252:255], a[220:223], a[188:191], v[252:255]
    s_waitcnt lgkmcnt(4)
    v_mfma_f32_16x16x32_bf16 v[224:227], a[224:227], a[192:195], v[224:227]
    ds_read_b64_tr_b16 a[216:217], v2 offset:9408
    v_exp_f32 v192, v192
    v_mfma_f32_16x16x32_bf16 v[228:231], a[224:227], a[196:199], v[228:231]
    ds_read_b64_tr_b16 a[218:219], v2 offset:11712
    v_exp_f32 v193, v193
    v_mfma_f32_16x16x32_bf16 v[232:235], a[224:227], a[200:203], v[232:235]
    v_exp_f32 v194, v194
    buffer_load_dword a241, v13, s[56:59], s100 offen
    s_add_u32 s100, s100, 1792
    v_mfma_f32_16x16x32_bf16 v[236:239], a[224:227], a[204:207], v[236:239]
    v_exp_f32 v195, v195
    v_fma_f32 v192, v192, v0, v0
    s_waitcnt lgkmcnt(4)
    v_mfma_f32_16x16x32_bf16 v[240:243], a[208:211], a[192:195], v[240:243]
    ds_read_b64_tr_b16 a[220:221], v2 offset:20672
    v_exp_f32 v196, v196
    v_mfma_f32_16x16x32_bf16 v[244:247], a[208:211], a[196:199], v[244:247]
    ds_read_b64_tr_b16 a[222:223], v2 offset:22976
    v_exp_f32 v197, v197
    v_mfma_f32_16x16x32_bf16 v[248:251], a[208:211], a[200:203], v[248:251]
    v_exp_f32 v198, v198
    v_fma_f32 v193, v193, v0, v0
    v_mfma_f32_16x16x32_bf16 v[252:255], a[208:211], a[204:207], v[252:255]
    v_exp_f32 v199, v199
    v_fma_f32 v194, v194, v0, v0
    s_waitcnt lgkmcnt(4)
    v_mfma_f32_16x16x32_bf16 v[224:227], a[212:215], a[96:99], v[224:227]
    ds_read_b64_tr_b16 a[224:225], v2 offset:29888
    v_rcp_f32 v192, v192
    v_mfma_f32_16x16x32_bf16 v[228:231], a[212:215], a[100:103], v[228:231]
    ds_read_b64_tr_b16 a[226:227], v2 offset:32192
    v_rcp_f32 v193, v193
    v_mfma_f32_16x16x32_bf16 v[232:235], a[212:215], a[104:107], v[232:235]
    v_rcp_f32 v194, v194
    v_fma_f32 v195, v195, v0, v0
    v_mfma_f32_16x16x32_bf16 v[236:239], a[212:215], a[108:111], v[236:239]
    v_rcp_f32 v195, v195
    v_fma_f32 v196, v196, v0, v0
    s_waitcnt lgkmcnt(4)
    v_mfma_f32_16x16x32_bf16 v[240:243], a[216:219], a[96:99], v[240:243]
    ds_read_b64_tr_b16 a[208:209], v2 offset:41152
    v_rcp_f32 v196, v196
    v_mfma_f32_16x16x32_bf16 v[244:247], a[216:219], a[100:103], v[244:247]
    ds_read_b64_tr_b16 a[210:211], v2 offset:43456
    v_fma_f32 v197, v197, v0, v0
    v_fma_f32 v198, v198, v0, v0
    v_mfma_f32_16x16x32_bf16 v[248:251], a[216:219], a[104:107], v[248:251]
    v_rcp_f32 v197, v197
    v_fma_f32 v199, v199, v0, v0
    v_mfma_f32_16x16x32_bf16 v[252:255], a[216:219], a[108:111], v[252:255]
    v_rcp_f32 v198, v198
    v_mul_f32 v208, v208, v192
    s_waitcnt lgkmcnt(4)
    v_mfma_f32_16x16x32_bf16 v[224:227], a[220:223], a[112:115], v[224:227]
    ds_read_b64_tr_b16 a[212:213], v2 offset:50368
    v_rcp_f32 v199, v199
    s_add_u32 s43, s48, 2048
    v_mfma_f32_16x16x32_bf16 v[228:231], a[220:223], a[116:119], v[228:231]
    ds_read_b64_tr_b16 a[214:215], v2 offset:52672
    v_mul_f32 v209, v209, v193
    v_mul_f32 v210, v210, v194
    v_mfma_f32_16x16x32_bf16 v[232:235], a[220:223], a[120:123], v[232:235]
    v_mul_f32 v211, v211, v195
    v_exp_f32 v200, v200
    v_mfma_f32_16x16x32_bf16 v[236:239], a[220:223], a[124:127], v[236:239]
    v_exp_f32 v201, v201
    v_mul_f32 v212, v212, v196
    s_waitcnt lgkmcnt(4)
    v_mfma_f32_16x16x32_bf16 v[240:243], a[224:227], a[112:115], v[240:243]
    ds_read_b64_tr_b16 a[216:217], v3 offset:192
    v_exp_f32 v202, v202
    v_mfma_f32_16x16x32_bf16 v[244:247], a[224:227], a[116:119], v[244:247]
    ds_read_b64_tr_b16 a[218:219], v3 offset:2496
    v_exp_f32 v203, v203
    v_mfma_f32_16x16x32_bf16 v[248:251], a[224:227], a[120:123], v[248:251]
    v_exp_f32 v204, v204
    v_mul_f32 v213, v213, v197
    v_mfma_f32_16x16x32_bf16 v[252:255], a[224:227], a[124:127], v[252:255]
    v_exp_f32 v205, v205
    v_mul_f32 v214, v214, v198
    s_waitcnt lgkmcnt(4)
    v_mfma_f32_16x16x32_bf16 v[224:227], a[208:211], a[128:131], v[224:227]
    ds_read_b64_tr_b16 a[220:221], v3 offset:9408
    v_exp_f32 v206, v206
    v_mfma_f32_16x16x32_bf16 v[228:231], a[208:211], a[132:135], v[228:231]
    ds_read_b64_tr_b16 a[222:223], v3 offset:11712
    v_exp_f32 v207, v207
    v_mfma_f32_16x16x32_bf16 v[232:235], a[208:211], a[136:139], v[232:235]
    v_mul_f32 v215, v215, v199
    v_cvt_pk_bf16_f32 v162, v208, v209
    v_cvt_pk_bf16_f32 v163, v210, v211
    v_mfma_f32_16x16x32_bf16 v[236:239], a[208:211], a[140:143], v[236:239]
    v_cvt_pk_bf16_f32 v166, v212, v213
    v_cvt_pk_bf16_f32 v167, v214, v215
    buffer_store_dwordx4 v[160:163], v14, s[16:19], s43 offen sc1
    s_add_u32 s43, s48, 149504
    s_waitcnt lgkmcnt(4)
    v_mfma_f32_16x16x32_bf16 v[240:243], a[212:215], a[128:131], v[240:243]
    ds_read_b64_tr_b16 a[224:225], v3 offset:41184
    v_fma_f32 v200, v200, v0, v0
    v_fma_f32 v201, v201, v0, v0
    v_mfma_f32_16x16x32_bf16 v[244:247], a[212:215], a[132:135], v[244:247]
    ds_read_b64_tr_b16 a[226:227], v3 offset:43488
    v_rcp_f32 v200, v200
    buffer_store_dwordx4 v[164:167], v14, s[16:19], s43 offen sc1
    v_mfma_f32_16x16x32_bf16 v[248:251], a[212:215], a[136:139], v[248:251]
    v_rcp_f32 v201, v201
    v_fma_f32 v202, v202, v0, v0
    v_fma_f32 v203, v203, v0, v0
    v_mfma_f32_16x16x32_bf16 v[252:255], a[212:215], a[140:143], v[252:255]
    v_rcp_f32 v202, v202
    v_rcp_f32 v203, v203
    s_waitcnt lgkmcnt(4)
    v_mfma_f32_16x16x32_bf16 v[224:227], a[216:219], a[144:147], v[224:227]
    ds_read_b64_tr_b16 a[208:209], v3 offset:50400
    v_fma_f32 v204, v204, v0, v0
    v_fma_f32 v205, v205, v0, v0
    v_mfma_f32_16x16x32_bf16 v[228:231], a[216:219], a[148:151], v[228:231]
    ds_read_b64_tr_b16 a[210:211], v3 offset:52704
    v_rcp_f32 v204, v204
    v_fma_f32 v206, v206, v0, v0
    v_mfma_f32_16x16x32_bf16 v[232:235], a[216:219], a[152:155], v[232:235]
    v_rcp_f32 v205, v205
    v_rcp_f32 v206, v206
    v_mfma_f32_16x16x32_bf16 v[236:239], a[216:219], a[156:159], v[236:239]
    v_fma_f32 v207, v207, v0, v0
    v_mul_f32 v216, v216, v200
    v_rcp_f32 v207, v207
    s_add_u32 s43, s48, 296960
    s_waitcnt lgkmcnt(4)
    v_mfma_f32_16x16x32_bf16 v[240:243], a[220:223], a[144:147], v[240:243]
    ds_read_b64_tr_b16 a[212:213], v4 offset:224
    v_mul_f32 v217, v217, v201
    v_mul_f32 v218, v218, v202
    v_mfma_f32_16x16x32_bf16 v[244:247], a[220:223], a[148:151], v[244:247]
    ds_read_b64_tr_b16 a[214:215], v4 offset:2528
    v_mul_f32 v219, v219, v203
    v_mul_f32 v220, v220, v204
    v_mul_f32 v221, v221, v205
    v_mfma_f32_16x16x32_bf16 v[248:251], a[220:223], a[152:155], v[248:251]
    v_mul_f32 v222, v222, v206
    v_mul_f32 v223, v223, v207
    v_cvt_pk_bf16_f32 v170, v216, v217
    v_cvt_pk_bf16_f32 v171, v218, v219
    v_mfma_f32_16x16x32_bf16 v[252:255], a[220:223], a[156:159], v[252:255]
    v_cvt_pk_bf16_f32 v174, v220, v221
    v_cvt_pk_bf16_f32 v175, v222, v223
    buffer_store_dwordx4 v[168:171], v14, s[16:19], s43 offen sc1
    s_add_u32 s43, s48, 444416
    buffer_store_dwordx4 v[172:175], v14, s[16:19], s43 offen sc1
    s_waitcnt lgkmcnt(4)
    v_mfma_f32_16x16x32_bf16 a[0:3], a[224:227], a[176:179], a[0:3]
    ds_read_b64_tr_b16 a[216:217], v4 offset:9440
    v_mfma_f32_16x16x32_bf16 a[4:7], a[224:227], a[180:183], a[4:7]
    ds_read_b64_tr_b16 a[218:219], v4 offset:11744
    v_mfma_f32_16x16x32_bf16 a[8:11], a[224:227], a[184:187], a[8:11]
    v_mfma_f32_16x16x32_bf16 a[12:15], a[224:227], a[188:191], a[12:15]
    s_waitcnt lgkmcnt(4)
    v_mfma_f32_16x16x32_bf16 a[16:19], a[208:211], a[176:179], a[16:19]
    ds_read_b64_tr_b16 a[220:221], v2 offset:224
    v_mfma_f32_16x16x32_bf16 a[20:23], a[208:211], a[180:183], a[20:23]
    ds_read_b64_tr_b16 a[222:223], v2 offset:2528
    v_mfma_f32_16x16x32_bf16 a[24:27], a[208:211], a[184:187], a[24:27]
    v_mfma_f32_16x16x32_bf16 a[28:31], a[208:211], a[188:191], a[28:31]
    s_waitcnt lgkmcnt(4)
    v_mfma_f32_16x16x32_bf16 a[0:3], a[212:215], a[192:195], a[0:3]
    ds_read_b64_tr_b16 a[224:225], v2 offset:9440
    s_lshl_b32 s55, s2, 2
    v_mbcnt_lo_u32_b32 v12, -1, 0
    v_mfma_f32_16x16x32_bf16 a[4:7], a[212:215], a[196:199], a[4:7]
    ds_read_b64_tr_b16 a[226:227], v2 offset:11744
    v_mbcnt_hi_u32_b32 v12, -1, v12
    s_add_u32 s55, s55, s52
    v_min_u32 v12, 5, v12
    v_mfma_f32_16x16x32_bf16 a[8:11], a[212:215], a[200:203], a[8:11]
    v_mfma_f32_16x16x32_bf16 a[12:15], a[212:215], a[204:207], a[12:15]
    s_mul_i32 s55, s55, 6
    s_getpc_b64 s[56:57]
    s_add_u32 s56, s56, tab_fi@rel32@lo+4
    s_addc_u32 s57, s57, tab_fi@rel32@hi+12
    s_mov_b32 s58, tab_end-tab_fi-4
    s_nop 0
    s_nop 0
    v_exp_f32 v224, v224
    v_add_u32 v12, s55, v12
    s_waitcnt lgkmcnt(4)
    v_mfma_f32_16x16x32_bf16 a[16:19], a[216:219], a[192:195], a[16:19]
    ds_read_b64_tr_b16 a[208:209], v2 offset:20704
    v_exp_f32 v225, v225
    v_mfma_f32_16x16x32_bf16 a[20:23], a[216:219], a[196:199], a[20:23]
    ds_read_b64_tr_b16 a[210:211], v2 offset:23008
    v_exp_f32 v226, v226
    v_mfma_f32_16x16x32_bf16 a[24:27], a[216:219], a[200:203], a[24:27]
    v_exp_f32 v227, v227
    v_lshlrev_b32 v11, 7, v12
    v_mfma_f32_16x16x32_bf16 a[28:31], a[216:219], a[204:207], a[28:31]
    v_exp_f32 v228, v228
    v_min_u32 v11, s58, v11
    s_waitcnt lgkmcnt(4)
    v_mfma_f32_16x16x32_bf16 a[0:3], a[220:223], a[96:99], a[0:3]
    ds_read_b64_tr_b16 a[212:213], v2 offset:29920
    v_exp_f32 v229, v229
    v_mfma_f32_16x16x32_bf16 a[4:7], a[220:223], a[100:103], a[4:7]
    ds_read_b64_tr_b16 a[214:215], v2 offset:32224
    v_exp_f32 v230, v230
    v_mfma_f32_16x16x32_bf16 a[8:11], a[220:223], a[104:107], a[8:11]
    v_exp_f32 v231, v231
    v_mov_b32 v13, s57
    v_mfma_f32_16x16x32_bf16 a[12:15], a[220:223], a[108:111], a[12:15]
    v_add_co_u32 v12, s[58:59], s56, v11
    v_fma_f32 v224, v224, v0, v0
    v_fma_f32 v225, v225, v0, v0
    s_waitcnt lgkmcnt(4)
    v_mfma_f32_16x16x32_bf16 a[16:19], a[224:227], a[96:99], a[16:19]
    ds_read_b64_tr_b16 a[216:217], v2 offset:41184
    v_rcp_f32 v224, v224
    v_mfma_f32_16x16x32_bf16 a[20:23], a[224:227], a[100:103], a[20:23]
    ds_read_b64_tr_b16 a[218:219], v2 offset:43488
    v_rcp_f32 v225, v225
    v_mfma_f32_16x16x32_bf16 a[24:27], a[224:227], a[104:107], a[24:27]
    v_addc_co_u32 v13, s[58:59], 0, v13, s[58:59]
    v_fma_f32 v226, v226, v0, v0
    global_load_dword a242, v[12:13], off
    v_mfma_f32_16x16x32_bf16 a[28:31], a[224:227], a[108:111], a[28:31]
    v_rcp_f32 v226, v226
    v_fma_f32 v227, v227, v0, v0
    s_waitcnt lgkmcnt(4)
    v_mfma_f32_16x16x32_bf16 a[0:3], a[208:211], a[112:115], a[0:3]
    ds_read_b64_tr_b16 a[220:221], v2 offset:50400
    v_rcp_f32 v227, v227
    v_mfma_f32_16x16x32_bf16 a[4:7], a[208:211], a[116:119], a[4:7]
    ds_read_b64_tr_b16 a[222:223], v2 offset:52704
    v_fma_f32 v228, v228, v0, v0
    v_fma_f32 v229, v229, v0, v0
    v_fma_f32 v230, v230, v0, v0
    v_mfma_f32_16x16x32_bf16 a[8:11], a[208:211], a[120:123], a[8:11]
    v_rcp_f32 v228, v228
    v_rcp_f32 v229, v229
    v_mfma_f32_16x16x32_bf16 a[12:15], a[208:211], a[124:127], a[12:15]
    v_rcp_f32 v230, v230
    v_fma_f32 v231, v231, v0, v0
    v_mul_f32 v240, v240, v224
    s_waitcnt lgkmcnt(4)
    v_mfma_f32_16x16x32_bf16 a[16:19], a[212:215], a[112:115], a[16:19]
    ds_read_b64_tr_b16 a[224:225], v3 offset:224
    v_rcp_f32 v231, v231
    v_mfma_f32_16x16x32_bf16 a[20:23], a[212:215], a[116:119], a[20:23]
    ds_read_b64_tr_b16 a[226:227], v3 offset:2528
    v_exp_f32 v232, v232
    v_mul_f32 v241, v241, v225
    v_mfma_f32_16x16x32_bf16 a[24:27], a[212:215], a[120:123], a[24:27]
    v_exp_f32 v233, v233
    v_exp_f32 v234, v234
    v_mfma_f32_16x16x32_bf16 a[28:31], a[212:215], a[124:127], a[28:31]
    v_exp_f32 v235, v235
    v_exp_f32 v236, v236
    s_waitcnt lgkmcnt(4)
    v_mfma_f32_16x16x32_bf16 a[0:3], a[216:219], a[128:131], a[0:3]
    ds_read_b64_tr_b16 a[208:209], v3 offset:9440
    v_exp_f32 v237, v237
    v_mfma_f32_16x16x32_bf16 a[4:7], a[216:219], a[132:135], a[4:7]
    ds_read_b64_tr_b16 a[210:211], v3 offset:11744
    v_exp_f32 v238, v238
    v_mul_f32 v242, v242, v226
    v_mfma_f32_16x16x32_bf16 a[8:11], a[216:219], a[136:139], a[8:11]
    v_exp_f32 v239, v239
    v_mul_f32 v243, v243, v227
    v_mul_f32 v244, v244, v228
    v_mfma_f32_16x16x32_bf16 a[12:15], a[216:219], a[140:143], a[12:15]
    v_mul_f32 v245, v245, v229
    v_mul_f32 v246, v246, v230
    v_mul_f32 v247, v247, v231
    v_cvt_pk_bf16_f32 v224, v240, v241
    s_waitcnt lgkmcnt(4)
    v_mfma_f32_16x16x32_bf16 a[16:19], a[220:223], a[128:131], a[16:19]
    ds_read_b64_tr_b16 a[212:213], v3 offset:41216
    v_cvt_pk_bf16_f32 v225, v242, v243
    v_cvt_pk_bf16_f32 v228, v244, v245
    v_mfma_f32_16x16x32_bf16 a[20:23], a[220:223], a[132:135], a[20:23]
    ds_read_b64_tr_b16 a[214:215], v3 offset:43520
    v_cvt_pk_bf16_f32 v229, v246, v247
    v_fma_f32 v232, v232, v0, v0
    v_fma_f32 v233, v233, v0, v0
    v_mfma_f32_16x16x32_bf16 a[24:27], a[220:223], a[136:139], a[24:27]
    v_rcp_f32 v232, v232
    v_rcp_f32 v233, v233
    v_mfma_f32_16x16x32_bf16 a[28:31], a[220:223], a[140:143], a[28:31]
    v_fma_f32 v234, v234, v0, v0
    v_fma_f32 v235, v235, v0, v0
    v_rcp_f32 v234, v234
    s_waitcnt lgkmcnt(4)
    v_mfma_f32_16x16x32_bf16 a[0:3], a[224:227], a[144:147], a[0:3]
    ds_read_b64_tr_b16 a[216:217], v3 offset:50432
    v_rcp_f32 v235, v235
    v_mfma_f32_16x16x32_bf16 a[4:7], a[224:227], a[148:151], a[4:7]
    ds_read_b64_tr_b16 a[218:219], v3 offset:52736
    v_fma_f32 v236, v236, v0, v0
    v_fma_f32 v237, v237, v0, v0
    v_fma_f32 v238, v238, v0, v0
    v_mfma_f32_16x16x32_bf16 a[8:11], a[224:227], a[152:155], a[8:11]
    v_rcp_f32 v236, v236
    v_rcp_f32 v237, v237
    v_mfma_f32_16x16x32_bf16 a[12:15], a[224:227], a[156:159], a[12:15]
    v_rcp_f32 v238, v238
    v_fma_f32 v239, v239, v0, v0
    v_mul_f32 v248, v248, v232
    s_waitcnt lgkmcnt(4)
    v_mfma_f32_16x16x32_bf16 a[16:19], a[208:211], a[144:147], a[16:19]
    ds_read_b64_tr_b16 a[220:221], v4 offset:256
    v_rcp_f32 v239, v239
    v_mfma_f32_16x16x32_bf16 a[20:23], a[208:211], a[148:151], a[20:23]
    ds_read_b64_tr_b16 a[222:223], v4 offset:2560
    v_mul_f32 v249, v249, v233
    v_mul_f32 v250, v250, v234
    v_mul_f32 v251, v251, v235
    v_mfma_f32_16x16x32_bf16 a[24:27], a[208:211], a[152:155], a[24:27]
    v_mul_f32 v252, v252, v236
    v_mul_f32 v253, v253, v237
    v_mul_f32 v254, v254, v238
    v_mul_f32 v255, v255, v239
    v_mfma_f32_16x16x32_bf16 a[28:31], a[208:211], a[156:159], a[28:31]
    v_cvt_pk_bf16_f32 v232, v248, v249
    v_cvt_pk_bf16_f32 v233, v250, v251
    v_cvt_pk_bf16_f32 v236, v252, v253
    v_cvt_pk_bf16_f32 v237, v254, v255
    s_waitcnt vmcnt(12)
    s_waitcnt lgkmcnt(4)
    v_mfma_f32_16x16x32_bf16 a[32:35], a[212:215], a[176:179], a[32:35]
    ds_read_b64_tr_b16 a[224:225], v4 offset:9472
    v_mfma_f32_16x16x32_bf16 a[36:39], a[212:215], a[180:183], a[36:39]
    ds_read_b64_tr_b16 a[226:227], v4 offset:11776
    v_mfma_f32_16x16x32_bf16 a[40:43], a[212:215], a[184:187], a[40:43]
    v_mfma_f32_16x16x32_bf16 a[44:47], a[212:215], a[188:191], a[44:47]
    s_waitcnt lgkmcnt(4)
    v_mfma_f32_16x16x32_bf16 a[48:51], a[216:219], a[176:179], a[48:51]
    ds_read_b64_tr_b16 a[208:209], v2 offset:256
    v_mfma_f32_16x16x32_bf16 a[52:55], a[216:219], a[180:183], a[52:55]
    ds_read_b64_tr_b16 a[210:211], v2 offset:2560
    v_mfma_f32_16x16x32_bf16 a[56:59], a[216:219], a[184:187], a[56:59]
    v_mfma_f32_16x16x32_bf16 a[60:63], a[216:219], a[188:191], a[60:63]
    s_waitcnt lgkmcnt(4)
    v_mfma_f32_16x16x32_bf16 a[32:35], a[220:223], a[192:195], a[32:35]
    ds_read_b64_tr_b16 a[212:213], v2 offset:9472
    s_mov_b32 s6, 0x05040100
    s_mov_b32 s7, 0x07060302
    v_mfma_f32_16x16x32_bf16 a[36:39], a[220:223], a[196:199], a[36:39]
    ds_read_b64_tr_b16 a[214:215], v2 offset:11776
    v_mfma_f32_16x16x32_bf16 a[40:43], a[220:223], a[200:203], a[40:43]
    v_perm_b32 v52, v33, v32, s6
    v_perm_b32 v53, v35, v34, s6
    v_perm_b32 v54, v37, v36, s6
    v_perm_b32 v55, v39, v38, s6
    v_mfma_f32_16x16x32_bf16 a[44:47], a[220:223], a[204:207], a[44:47]
    v_perm_b32 v56, v41, v40, s6
    v_perm_b32 v57, v43, v42, s6
    v_perm_b32 v58, v45, v44, s6
    v_perm_b32 v59, v47, v46, s6
    s_waitcnt lgkmcnt(4)
    v_mfma_f32_16x16x32_bf16 a[48:51], a[224:227], a[192:195], a[48:51]
    ds_read_b64_tr_b16 a[216:217], v2 offset:20736
    buffer_store_dwordx4 v[52:55], v49, s[16:19], s32 offen sc1
    buffer_store_dwordx4 v[56:59], v49, s[16:19], s101 offen sc1
    v_perm_b32 v60, v33, v32, s7
    v_mfma_f32_16x16x32_bf16 a[52:55], a[224:227], a[196:199], a[52:55]
    ds_read_b64_tr_b16 a[218:219], v2 offset:23040
    v_perm_b32 v61, v35, v34, s7
    v_perm_b32 v62, v37, v36, s7
    v_perm_b32 v63, v39, v38, s7
    v_mfma_f32_16x16x32_bf16 a[56:59], a[224:227], a[200:203], a[56:59]
    v_perm_b32 v64, v41, v40, s7
    v_perm_b32 v65, v43, v42, s7
    v_perm_b32 v66, v45, v44, s7
    v_perm_b32 v67, v47, v46, s7
    buffer_store_dwordx4 v[60:63], v50, s[16:19], s32 offen sc1
    v_mfma_f32_16x16x32_bf16 a[60:63], a[224:227], a[204:207], a[60:63]
    buffer_store_dwordx4 v[64:67], v50, s[16:19], s101 offen sc1
    v_accvgpr_read_b32 v16, a0
    v_accvgpr_read_b32 v17, a1
    v_exp_f32 v16, v16
    s_waitcnt lgkmcnt(4)
    v_mfma_f32_16x16x32_bf16 a[32:35], a[208:211], a[96:99], a[32:35]
    ds_read_b64_tr_b16 a[220:221], v2 offset:29952
    v_exp_f32 v17, v17
    v_accvgpr_read_b32 v18, a2
    v_mfma_f32_16x16x32_bf16 a[36:39], a[208:211], a[100:103], a[36:39]
    ds_read_b64_tr_b16 a[222:223], v2 offset:32256
    v_exp_f32 v18, v18
    v_accvgpr_read_b32 v19, a3
    v_accvgpr_read_b32 v20, a4
    v_mfma_f32_16x16x32_bf16 a[40:43], a[208:211], a[104:107], a[40:43]
    v_exp_f32 v19, v19
    v_exp_f32 v20, v20
    v_accvgpr_read_b32 v21, a5
    v_mfma_f32_16x16x32_bf16 a[44:47], a[208:211], a[108:111], a[44:47]
    v_exp_f32 v21, v21
    v_accvgpr_read_b32 v22, a6
    v_accvgpr_read_b32 v23, a7
    v_fma_f32 v16, v16, v0, v0
    s_waitcnt lgkmcnt(4)
    v_mfma_f32_16x16x32_bf16 a[48:51], a[212:215], a[96:99], a[48:51]
    ds_read_b64_tr_b16 a[224:225], v2 offset:41216
    v_exp_f32 v22, v22
    v_fma_f32 v17, v17, v0, v0
    v_mfma_f32_16x16x32_bf16 a[52:55], a[212:215], a[100:103], a[52:55]
    ds_read_b64_tr_b16 a[226:227], v2 offset:43520
    v_exp_f32 v23, v23
    v_rcp_f32 v16, v16
    v_mfma_f32_16x16x32_bf16 a[56:59], a[212:215], a[104:107], a[56:59]
    v_rcp_f32 v17, v17
    v_fma_f32 v18, v18, v0, v0
    v_fma_f32 v19, v19, v0, v0
    v_fma_f32 v20, v20, v0, v0
    v_mfma_f32_16x16x32_bf16 a[60:63], a[212:215], a[108:111], a[60:63]
    v_rcp_f32 v18, v18
    v_rcp_f32 v19, v19
    v_fma_f32 v21, v21, v0, v0
    s_waitcnt lgkmcnt(4)
    v_mfma_f32_16x16x32_bf16 a[32:35], a[216:219], a[112:115], a[32:35]
    ds_read_b64_tr_b16 a[208:209], v2 offset:50432
    v_rcp_f32 v20, v20
    v_fma_f32 v22, v22, v0, v0
    v_mfma_f32_16x16x32_bf16 a[36:39], a[216:219], a[116:119], a[36:39]
    ds_read_b64_tr_b16 a[210:211], v2 offset:52736
    v_rcp_f32 v21, v21
    v_rcp_f32 v22, v22
    v_mfma_f32_16x16x32_bf16 a[40:43], a[216:219], a[120:123], a[40:43]
    v_fma_f32 v23, v23, v0, v0
    v_accvgpr_read_b32 v24, a16
    v_rcp_f32 v23, v23
    v_accvgpr_read_b32 v25, a17
    v_mfma_f32_16x16x32_bf16 a[44:47], a[216:219], a[124:127], a[44:47]
    v_accvgpr_read_b32 v26, a18
    v_accvgpr_read_b32 v27, a19
    v_accvgpr_read_b32 v28, a20
    v_accvgpr_read_b32 v29, a21
    v_accvgpr_read_b32 v30, a22
    s_waitcnt lgkmcnt(4)
    v_mfma_f32_16x16x32_bf16 a[48:51], a[220:223], a[112:115], a[48:51]
    ds_read_b64_tr_b16 a[212:213], v3 offset:256
    v_accvgpr_read_b32 v31, a23
    v_mul_f32 v24, v24, v16
    s_add_u32 s43, s48, 3072
    v_mul_f32 v25, v25, v17
    v_mfma_f32_16x16x32_bf16 a[52:55], a[220:223], a[116:119], a[52:55]
    ds_read_b64_tr_b16 a[214:215], v3 offset:2560
    v_mul_f32 v26, v26, v18
    v_mul_f32 v27, v27, v19
    v_mul_f32 v28, v28, v20
    v_mul_f32 v29, v29, v21
    v_mfma_f32_16x16x32_bf16 a[56:59], a[220:223], a[120:123], a[56:59]
    v_mul_f32 v30, v30, v22
    v_mul_f32 v31, v31, v23
    v_cvt_pk_bf16_f32 v226, v24, v25
    v_cvt_pk_bf16_f32 v227, v26, v27
    v_cvt_pk_bf16_f32 v230, v28, v29
    v_mfma_f32_16x16x32_bf16 a[60:63], a[220:223], a[124:127], a[60:63]
    v_cvt_pk_bf16_f32 v231, v30, v31
    buffer_store_dwordx4 v[224:227], v14, s[16:19], s43 offen sc1
    s_add_u32 s43, s48, 150528
    v_accvgpr_read_b32 v24, a8
    v_accvgpr_read_b32 v25, a9
    v_accvgpr_read_b32 v26, a10
    s_waitcnt lgkmcnt(4)
    v_mfma_f32_16x16x32_bf16 a[32:35], a[224:227], a[128:131], a[32:35]
    ds_read_b64_tr_b16 a[216:217], v3 offset:9472
    v_exp_f32 v24, v24
    buffer_store_dwordx4 v[228:231], v14, s[16:19], s43 offen sc1
    v_mfma_f32_16x16x32_bf16 a[36:39], a[224:227], a[132:135], a[36:39]
    ds_read_b64_tr_b16 a[218:219], v3 offset:11776
    v_exp_f32 v25, v25
    v_exp_f32 v26, v26
    v_mfma_f32_16x16x32_bf16 a[40:43], a[224:227], a[136:139], a[40:43]
    v_accvgpr_read_b32 v27, a11
    v_accvgpr_read_b32 v28, a12
    v_exp_f32 v27, v27
    v_accvgpr_read_b32 v29, a13
    v_mfma_f32_16x16x32_bf16 a[44:47], a[224:227], a[140:143], a[44:47]
    v_exp_f32 v28, v28
    v_exp_f32 v29, v29
    v_accvgpr_read_b32 v30, a14
    s_waitcnt lgkmcnt(4)
    v_mfma_f32_16x16x32_bf16 a[48:51], a[208:211], a[128:131], a[48:51]
    ds_read_b128 a[220:223], v6 offset:59392
    v_exp_f32 v30, v30
    v_accvgpr_read_b32 v31, a15
    v_mfma_f32_16x16x32_bf16 a[52:55], a[208:211], a[132:135], a[52:55]
    v_exp_f32 v31, v31
    v_fma_f32 v24, v24, v0, v0
    v_fma_f32 v25, v25, v0, v0
    v_fma_f32 v26, v26, v0, v0
    v_mfma_f32_16x16x32_bf16 a[56:59], a[208:211], a[136:139], a[56:59]
    v_rcp_f32 v24, v24
    v_rcp_f32 v25, v25
    v_fma_f32 v27, v27, v0, v0
    v_mfma_f32_16x16x32_bf16 a[60:63], a[208:211], a[140:143], a[60:63]
    v_rcp_f32 v26, v26
    v_rcp_f32 v27, v27
    v_fma_f32 v28, v28, v0, v0
    s_waitcnt lgkmcnt(3)
    v_mfma_f32_16x16x32_bf16 a[32:35], a[212:215], a[144:147], a[32:35]
    ds_read_b128 a[224:227], v7 offset:18432
    v_rcp_f32 v28, v28
    v_fma_f32 v29, v29, v0, v0
    v_mfma_f32_16x16x32_bf16 a[36:39], a[212:215], a[148:151], a[36:39]
    v_rcp_f32 v29, v29
    v_fma_f32 v30, v30, v0, v0
    v_fma_f32 v31, v31, v0, v0
    v_accvgpr_read_b32 v16, a24
    v_mfma_f32_16x16x32_bf16 a[40:43], a[212:215], a[152:155], a[40:43]
    v_rcp_f32 v30, v30
    v_rcp_f32 v31, v31
    v_accvgpr_read_b32 v17, a25
    v_mfma_f32_16x16x32_bf16 a[44:47], a[212:215], a[156:159], a[44:47]
    v_accvgpr_read_b32 v18, a26
    v_accvgpr_read_b32 v19, a27
    v_accvgpr_read_b32 v20, a28
    v_accvgpr_read_b32 v21, a29
    v_accvgpr_read_b32 v22, a30
    s_waitcnt lgkmcnt(2)
    v_mfma_f32_16x16x32_bf16 a[48:51], a[216:219], a[144:147], a[48:51]
    ds_read_b128 a[208:211], v5 offset:18432
    v_accvgpr_read_b32 v23, a31
    v_mul_f32 v16, v16, v24
    s_add_u32 s43, s48, 297984
    v_mul_f32 v17, v17, v25
    v_mfma_f32_16x16x32_bf16 a[52:55], a[216:219], a[148:151], a[52:55]
    v_mul_f32 v18, v18, v26
    v_mul_f32 v19, v19, v27
    v_mul_f32 v20, v20, v28
    v_mul_f32 v21, v21, v29
    v_mul_f32 v22, v22, v30
    v_mfma_f32_16x16x32_bf16 a[56:59], a[216:219], a[152:155], a[56:59]
    v_mul_f32 v23, v23, v31
    v_cvt_pk_bf16_f32 v234, v16, v17
    v_cvt_pk_bf16_f32 v235, v18, v19
    v_cvt_pk_bf16_f32 v238, v20, v21
    v_cvt_pk_bf16_f32 v239, v22, v23
    v_mfma_f32_16x16x32_bf16 a[60:63], a[216:219], a[156:159], a[60:63]
    buffer_store_dwordx4 v[232:235], v14, s[16:19], s43 offen sc1
    s_add_u32 s43, s48, 445440
    buffer_store_dwordx4 v[236:239], v14, s[16:19], s43 offen sc1
    s_waitcnt lgkmcnt(2)
    v_mfma_f32_16x16x32_bf16 a[64:67], a[176:179], a[220:223], a[64:67]
    ds_read_b128 a[212:215], v5 offset:38912
    v_mfma_f32_16x16x32_bf16 a[68:71], a[180:183], a[220:223], a[68:71]
    v_mfma_f32_16x16x32_bf16 a[72:75], a[184:187], a[220:223], a[72:75]
    v_mfma_f32_16x16x32_bf16 a[76:79], a[188:191], a[220:223], a[76:79]
    s_waitcnt lgkmcnt(2)
    v_mfma_f32_16x16x32_bf16 a[64:67], a[192:195], a[224:227], a[64:67]
    ds_read_b128 a[216:219], v5 offset:59392
    v_mfma_f32_16x16x32_bf16 a[68:71], a[196:199], a[224:227], a[68:71]
    v_mfma_f32_16x16x32_bf16 a[72:75], a[200:203], a[224:227], a[72:75]
    v_mfma_f32_16x16x32_bf16 a[76:79], a[204:207], a[224:227], a[76:79]
    s_waitcnt lgkmcnt(2)
    v_mfma_f32_16x16x32_bf16 a[64:67], a[96:99], a[208:211], a[64:67]
    ds_read_b128 a[220:223], v6 offset:18432
    v_accvgpr_read_b32 v16, a32
    v_accvgpr_read_b32 v17, a33
    v_exp_f32 v16, v16
    v_exp_f32 v17, v17
    v_accvgpr_read_b32 v18, a34
    v_accvgpr_read_b32 v19, a35
    v_mfma_f32_16x16x32_bf16 a[68:71], a[100:103], a[208:211], a[68:71]
    v_exp_f32 v18, v18
    v_exp_f32 v19, v19
    v_accvgpr_read_b32 v20, a36
    v_accvgpr_read_b32 v21, a37
    v_exp_f32 v20, v20
    v_accvgpr_read_b32 v22, a38
    v_mfma_f32_16x16x32_bf16 a[72:75], a[104:107], a[208:211], a[72:75]
    v_exp_f32 v21, v21
    v_exp_f32 v22, v22
    v_accvgpr_read_b32 v23, a39
    v_fma_f32 v16, v16, v0, v0
    v_exp_f32 v23, v23
    v_fma_f32 v17, v17, v0, v0
    v_mfma_f32_16x16x32_bf16 a[76:79], a[108:111], a[208:211], a[76:79]
    v_rcp_f32 v16, v16
    v_rcp_f32 v17, v17
    v_fma_f32 v18, v18, v0, v0
    v_fma_f32 v19, v19, v0, v0
    v_rcp_f32 v18, v18
    v_fma_f32 v20, v20, v0, v0
    s_waitcnt lgkmcnt(2)
    v_mfma_f32_16x16x32_bf16 a[64:67], a[112:115], a[212:215], a[64:67]
    v_rcp_f32 v19, v19
    v_rcp_f32 v20, v20
    v_fma_f32 v21, v21, v0, v0
    v_fma_f32 v22, v22, v0, v0
    v_rcp_f32 v21, v21
    v_fma_f32 v23, v23, v0, v0
    v_mfma_f32_16x16x32_bf16 a[68:71], a[116:119], a[212:215], a[68:71]
    v_rcp_f32 v22, v22
    v_rcp_f32 v23, v23
    v_accvgpr_read_b32 v24, a48
    v_accvgpr_read_b32 v25, a49
    v_accvgpr_read_b32 v26, a50
    v_accvgpr_read_b32 v27, a51
    v_accvgpr_read_b32 v28, a52
    v_mfma_f32_16x16x32_bf16 a[72:75], a[120:123], a[212:215], a[72:75]
    v_accvgpr_read_b32 v29, a53
    v_accvgpr_read_b32 v30, a54
    v_accvgpr_read_b32 v31, a55
    v_mul_f32 v24, v24, v16
    s_add_u32 s43, s49, 0
    v_mul_f32 v25, v25, v17
    v_mul_f32 v26, v26, v18
    v_mul_f32 v27, v27, v19
    v_mul_f32 v28, v28, v20
    v_mul_f32 v29, v29, v21
    v_mfma_f32_16x16x32_bf16 a[76:79], a[124:127], a[212:215], a[76:79]
    v_mul_f32 v30, v30, v22
    v_mul_f32 v31, v31, v23
    v_cvt_pk_bf16_f32 v16, v24, v25
    v_cvt_pk_bf16_f32 v17, v26, v27
    v_cvt_pk_bf16_f32 v20, v28, v29
    v_cvt_pk_bf16_f32 v21, v30, v31
    buffer_store_dwordx2 v[16:17], v14, s[16:19], s43 offen
    s_add_u32 s43, s49, 147456
    v_accvgpr_read_b32 v24, a40
    v_accvgpr_read_b32 v25, a41
    s_waitcnt lgkmcnt(1)
    v_mfma_f32_16x16x32_bf16 a[64:67], a[128:131], a[216:219], a[64:67]
    v_exp_f32 v24, v24
    v_exp_f32 v25, v25
    buffer_store_dwordx2 v[20:21], v14, s[16:19], s43 offen
    v_accvgpr_read_b32 v26, a42
    v_accvgpr_read_b32 v27, a43
    v_exp_f32 v26, v26
    v_mfma_f32_16x16x32_bf16 a[68:71], a[132:135], a[216:219], a[68:71]
    v_exp_f32 v27, v27
    v_accvgpr_read_b32 v28, a44
    v_accvgpr_read_b32 v29, a45
    v_exp_f32 v28, v28
    v_exp_f32 v29, v29
    v_accvgpr_read_b32 v30, a46
    v_mfma_f32_16x16x32_bf16 a[72:75], a[136:139], a[216:219], a[72:75]
    v_exp_f32 v30, v30
    v_accvgpr_read_b32 v31, a47
    v_fma_f32 v24, v24, v0, v0
    v_exp_f32 v31, v31
    v_rcp_f32 v24, v24
    v_fma_f32 v25, v25, v0, v0
    v_mfma_f32_16x16x32_bf16 a[76:79], a[140:143], a[216:219], a[76:79]
    v_rcp_f32 v25, v25
    v_fma_f32 v26, v26, v0, v0
    v_fma_f32 v27, v27, v0, v0
    v_rcp_f32 v26, v26
    v_rcp_f32 v27, v27
    v_fma_f32 v28, v28, v0, v0
    v_fma_f32 v29, v29, v0, v0
    s_waitcnt lgkmcnt(0)
    v_mfma_f32_16x16x32_bf16 a[64:67], a[144:147], a[220:223], a[64:67]
    v_rcp_f32 v28, v28
    v_rcp_f32 v29, v29
    v_fma_f32 v30, v30, v0, v0
    v_fma_f32 v31, v31, v0, v0
    v_rcp_f32 v30, v30
    v_accvgpr_read_b32 v16, a56
    v_mfma_f32_16x16x32_bf16 a[68:71], a[148:151], a[220:223], a[68:71]
    v_rcp_f32 v31, v31
    v_accvgpr_read_b32 v17, a57
    v_accvgpr_read_b32 v18, a58
    v_accvgpr_read_b32 v19, a59
    v_accvgpr_read_b32 v20, a60
    v_accvgpr_read_b32 v21, a61
    v_accvgpr_read_b32 v22, a62
    v_accvgpr_read_b32 v23, a63
    v_mul_f32 v16, v16, v24
    s_add_u32 s43, s49, 294912
    v_mfma_f32_16x16x32_bf16 a[72:75], a[152:155], a[220:223], a[72:75]
    v_mul_f32 v17, v17, v25
    v_mul_f32 v18, v18, v26
    v_mul_f32 v19, v19, v27
    v_mul_f32 v20, v20, v28
    v_mul_f32 v21, v21, v29
    v_mul_f32 v22, v22, v30
    v_mul_f32 v23, v23, v31
    v_cvt_pk_bf16_f32 v24, v16, v17
    v_cvt_pk_bf16_f32 v25, v18, v19
    v_cvt_pk_bf16_f32 v28, v20, v21
    v_mfma_f32_16x16x32_bf16 a[76:79], a[156:159], a[220:223], a[76:79]
    v_cvt_pk_bf16_f32 v29, v22, v23
    buffer_store_dwordx2 v[24:25], v14, s[16:19], s43 offen
    s_add_u32 s43, s49, 442368
    buffer_store_dwordx2 v[28:29], v14, s[16:19], s43 offen
    s_nop 7
    v_accvgpr_read_b32 v16, a64
    v_accvgpr_read_b32 v17, a65
    v_accvgpr_read_b32 v18, a66
    v_accvgpr_read_b32 v19, a67
    v_accvgpr_read_b32 v20, a68
    v_accvgpr_read_b32 v21, a69
    v_accvgpr_read_b32 v22, a70
    v_accvgpr_read_b32 v23, a71
    v_cvt_pk_bf16_f32 v16, v16, v17
    v_cvt_pk_bf16_f32 v17, v18, v19
    v_cvt_pk_bf16_f32 v18, v20, v21
    v_cvt_pk_bf16_f32 v19, v22, v23
    s_mov_b32 s43, 0
    buffer_store_dwordx4 v[16:19], v15, s[16:19], s43 offen offset:0
    v_accvgpr_read_b32 v24, a72
    v_accvgpr_read_b32 v25, a73
    v_accvgpr_read_b32 v26, a74
    v_accvgpr_read_b32 v27, a75
    v_accvgpr_read_b32 v28, a76
    v_accvgpr_read_b32 v29, a77
    v_accvgpr_read_b32 v30, a78
    v_accvgpr_read_b32 v31, a79
    v_cvt_pk_bf16_f32 v24, v24, v25
    v_cvt_pk_bf16_f32 v25, v26, v27
    v_cvt_pk_bf16_f32 v26, v28, v29
    v_cvt_pk_bf16_f32 v27, v30, v31
    s_mov_b32 s43, 0
    buffer_store_dwordx4 v[24:27], v15, s[16:19], s43 offen offset:16
    s_cmp_eq_u32 s29, 0
    s_cbranch_scc1 K1_nob
    ds_read_b128 a[208:211], v6 offset:60416
    ds_read_b128 a[212:215], v7 offset:19456
    ds_read_b128 a[216:219], v5 offset:19456
    ds_read_b128 a[220:223], v5 offset:39936
    ds_read_b128 a[224:227], v5 offset:60416
    s_lshr_b32 s55, s53, 2
    s_lshl_b32 s55, s55, 18
    s_sub_u32 s55, 0x200000, s55
    s_cmp_lg_u32 s29, 1
    s_cbranch_scc1 K1_nob0
    s_waitcnt lgkmcnt(4)
    v_mfma_f32_16x16x32_bf16 a[80:83], a[176:179], a[208:211], a[80:83]
    v_mfma_f32_16x16x32_bf16 a[84:87], a[180:183], a[208:211], a[84:87]
    ds_read_b128 a[208:211], v6 offset:19456
    s_waitcnt lgkmcnt(4)
    v_mfma_f32_16x16x32_bf16 a[80:83], a[192:195], a[212:215], a[80:83]
    v_mfma_f32_16x16x32_bf16 a[84:87], a[196:199], a[212:215], a[84:87]
    s_waitcnt lgkmcnt(3)
    v_mfma_f32_16x16x32_bf16 a[80:83], a[96:99], a[216:219], a[80:83]
    v_mfma_f32_16x16x32_bf16 a[84:87], a[100:103], a[216:219], a[84:87]
    s_waitcnt lgkmcnt(2)
    v_mfma_f32_16x16x32_bf16 a[80:83], a[112:115], a[220:223], a[80:83]
    v_mfma_f32_16x16x32_bf16 a[84:87], a[116:119], a[220:223], a[84:87]
    s_waitcnt lgkmcnt(1)
    v_mfma_f32_16x16x32_bf16 a[80:83], a[128:131], a[224:227], a[80:83]
    v_mfma_f32_16x16x32_bf16 a[84:87], a[132:135], a[224:227], a[84:87]
    s_waitcnt lgkmcnt(0)
    v_mfma_f32_16x16x32_bf16 a[80:83], a[144:147], a[208:211], a[80:83]
    v_mfma_f32_16x16x32_bf16 a[84:87], a[148:151], a[208:211], a[84:87]
    s_nop 7
    v_accvgpr_read_b32 v16, a80
    v_accvgpr_read_b32 v17, a81
    v_accvgpr_read_b32 v18, a82
    v_accvgpr_read_b32 v19, a83
    v_accvgpr_read_b32 v20, a84
    v_accvgpr_read_b32 v21, a85
    v_accvgpr_read_b32 v22, a86
    v_accvgpr_read_b32 v23, a87
    v_cvt_pk_bf16_f32 v16, v16, v17
    v_cvt_pk_bf16_f32 v17, v18, v19
    v_cvt_pk_bf16_f32 v18, v20, v21
    v_cvt_pk_bf16_f32 v19, v22, v23
    buffer_store_dwordx4 v[16:19], v15, s[16:19], s55 offen offset:0
    s_branch K1_nob
K1_nob0:
    s_cmp_lg_u32 s29, 2
    s_cbranch_scc1 K1_nob1
    s_waitcnt lgkmcnt(4)
    v_mfma_f32_16x16x32_bf16 a[88:91], a[184:187], a[208:211], a[88:91]
    v_mfma_f32_16x16x32_bf16 a[92:95], a[188:191], a[208:211], a[92:95]
    ds_read_b128 a[208:211], v6 offset:19456
    s_waitcnt lgkmcnt(4)
    v_mfma_f32_16x16x32_bf16 a[88:91], a[200:203], a[212:215], a[88:91]
    v_mfma_f32_16x16x32_bf16 a[92:95], a[204:207], a[212:215], a[92:95]
    s_waitcnt lgkmcnt(3)
    v_mfma_f32_16x16x32_bf16 a[88:91], a[104:107], a[216:219], a[88:91]
    v_mfma_f32_16x16x32_bf16 a[92:95], a[108:111], a[216:219], a[92:95]
    s_waitcnt lgkmcnt(2)
    v_mfma_f32_16x16x32_bf16 a[88:91], a[120:123], a[220:223], a[88:91]
    v_mfma_f32_16x16x32_bf16 a[92:95], a[124:127], a[220:223], a[92:95]
    s_waitcnt lgkmcnt(1)
    v_mfma_f32_16x16x32_bf16 a[88:91], a[136:139], a[224:227], a[88:91]
    v_mfma_f32_16x16x32_bf16 a[92:95], a[140:143], a[224:227], a[92:95]
    s_waitcnt lgkmcnt(0)
    v_mfma_f32_16x16x32_bf16 a[88:91], a[152:155], a[208:211], a[88:91]
    v_mfma_f32_16x16x32_bf16 a[92:95], a[156:159], a[208:211], a[92:95]
    s_nop 7
    v_accvgpr_read_b32 v16, a88
    v_accvgpr_read_b32 v17, a89
    v_accvgpr_read_b32 v18, a90
    v_accvgpr_read_b32 v19, a91
    v_accvgpr_read_b32 v20, a92
    v_accvgpr_read_b32 v21, a93
    v_accvgpr_read_b32 v22, a94
    v_accvgpr_read_b32 v23, a95
    v_cvt_pk_bf16_f32 v16, v16, v17
    v_cvt_pk_bf16_f32 v17, v18, v19
    v_cvt_pk_bf16_f32 v18, v20, v21
    v_cvt_pk_bf16_f32 v19, v22, v23
    buffer_store_dwordx4 v[16:19], v15, s[16:19], s55 offen offset:16
    s_branch K1_nob
K1_nob1:
K1_nob:
K1_exit:
    s_endpgm
k1_kernel_end:
.globl k2_kernel
.p2align 8
.type k2_kernel,@function
k2_kernel:
    s_cmp_ge_u32 s2, 256
    s_cbranch_scc1 K2_exit
    s_cmp_ge_u32 s2, 229
    s_cbranch_scc1 K2_idle
    s_cmp_ge_u32 s2, 192
    s_cbranch_scc1 K2_p3
    s_load_dwordx2 s[4:5], s[0:1], 48
    s_load_dwordx2 s[50:51], s[0:1], 72
    s_load_dwordx2 s[96:97], s[0:1], 0
    v_and_b32 v1, 63, v0
    v_lshrrev_b32 v32, 6, v0
    s_and_b32 s55, s2, 7
    s_lshr_b32 s56, s2, 3
    v_readfirstlane_b32 s52, v32
    s_lshr_b32 s53, s55, 1
    s_and_b32 s54, s55, 1
    s_lshl_b32 s54, s54, 3
    s_and_b32 s57, s56, 7
    s_add_u32 s54, s54, s57
    s_lshr_b32 s57, s56, 3
    s_mul_i32 s58, s53, 1327104
    s_mul_i32 s59, s57, 384
    s_add_u32 s58, s58, s59
    s_mov_b32 s61, 0xaaaaaab
    s_add_u32 s56, s52, 0
    s_lshl_b32 s33, s56, 10
    s_lshl_b32 s56, s56, 6
    v_add_u32 v32, s56, v1
    v_mul_hi_u32 v33, v32, s61
    v_mov_b32 v36, v33
    v_mul_u32_u24 v34, 24, v33
    v_sub_u32 v34, v32, v34
    v_bfe_u32 v35, v33, 1, 2
    v_lshlrev_b32 v35, 1, v35
    v_xor_b32 v34, v34, v35
    v_mul_u32_u24 v33, 1152, v33
    v_lshl_add_u32 v33, v34, 4, v33
    v_add_u32 v23, s58, v33
    v_cmp_le_u32 vcc, 16, v36
    v_add_u32 v34, 147456, v23
    s_nop 0
    v_cndmask_b32 v29, v23, v34, vcc
    s_add_u32 s56, s52, 4
    s_lshl_b32 s34, s56, 10
    s_lshl_b32 s56, s56, 6
    v_add_u32 v32, s56, v1
    v_mul_hi_u32 v33, v32, s61
    v_mov_b32 v36, v33
    v_mul_u32_u24 v34, 24, v33
    v_sub_u32 v34, v32, v34
    v_bfe_u32 v35, v33, 1, 2
    v_lshlrev_b32 v35, 1, v35
    v_xor_b32 v34, v34, v35
    v_mul_u32_u24 v33, 1152, v33
    v_lshl_add_u32 v33, v34, 4, v33
    v_add_u32 v24, s58, v33
    v_cmp_le_u32 vcc, 16, v36
    v_add_u32 v34, 147456, v24
    s_nop 0
    v_cndmask_b32 v30, v24, v34, vcc
    s_add_u32 s56, s52, 8
    s_lshl_b32 s35, s56, 10
    s_lshl_b32 s56, s56, 6
    v_add_u32 v32, s56, v1
    v_mul_hi_u32 v33, v32, s61
    v_mov_b32 v36, v33
    v_mul_u32_u24 v34, 24, v33
    v_sub_u32 v34, v32, v34
    v_bfe_u32 v35, v33, 1, 2
    v_lshlrev_b32 v35, 1, v35
    v_xor_b32 v34, v34, v35
    v_mul_u32_u24 v33, 1152, v33
    v_lshl_add_u32 v33, v34, 4, v33
    v_add_u32 v25, s58, v33
    v_cmp_le_u32 vcc, 16, v36
    v_add_u32 v34, 147456, v25
    s_nop 0
    v_cndmask_b32 v31, v25, v34, vcc
    s_lshl_b32 s58, s54, 3
    s_add_u32 s58, s58, s52
    s_mul_i32 s58, s58, 144
    s_mul_i32 s59, s53, 36
    s_add_u32 s58, s58, s59
    s_lshl_b32 s58, s58, 10
    s_add_u32 s58, s58, 20971520
    v_lshlrev_b32 v32, 4, v1
    v_add_u32 v26, s58, v32
    v_add_u32 v27, 589824, v26
    s_add_u32 s56, s52, 12
    s_lshl_b32 s36, s56, 10
    s_add_u32 s37, s36, 4096
    s_mov_b32 s28, 0
    s_mov_b32 s29, 0
    s_waitcnt lgkmcnt(0)
    s_mov_b32 s8, s4
    s_and_b32 s9, s5, 0xffff
    s_mov_b32 s10, 5308416
    s_mov_b32 s11, 0x20000
    s_mov_b32 s16, s50
    s_and_b32 s17, s51, 0xffff
    s_mov_b32 s18, 39845888
    s_mov_b32 s19, 0x20000
    s_mov_b32 s28, 0
    s_add_u32 m0, s33, 0
    s_nop 0
    buffer_load_dwordx4 v23, s[8:11], s28 offen lds
    s_add_u32 m0, s34, 0
    s_nop 0
    buffer_load_dwordx4 v24, s[8:11], s28 offen lds
    s_add_u32 m0, s35, 0
    s_nop 0
    buffer_load_dwordx4 v25, s[8:11], s28 offen lds
    s_add_u32 m0, s36, 0
    s_nop 0
    buffer_load_dwordx4 v26, s[16:19], s29 offen lds
    s_add_u32 m0, s37, 0
    s_nop 0
    buffer_load_dwordx4 v27, s[16:19], s29 offen lds
    s_add_u32 s29, s29, 1024
    s_mov_b32 s28, 36864
    s_add_u32 m0, s33, 20480
    s_nop 0
    buffer_load_dwordx4 v23, s[8:11], s28 offen lds
    s_add_u32 m0, s34, 20480
    s_nop 0
    buffer_load_dwordx4 v24, s[8:11], s28 offen lds
    s_add_u32 m0, s35, 20480
    s_nop 0
    buffer_load_dwordx4 v25, s[8:11], s28 offen lds
    s_add_u32 m0, s36, 20480
    s_nop 0
    buffer_load_dwordx4 v26, s[16:19], s29 offen lds
    s_add_u32 m0, s37, 20480
    s_nop 0
    buffer_load_dwordx4 v27, s[16:19], s29 offen lds
    s_add_u32 s29, s29, 1024
    s_mov_b32 s28, 73728
    s_add_u32 m0, s33, 40960
    s_nop 0
    buffer_load_dwordx4 v23, s[8:11], s28 offen lds
    s_add_u32 m0, s34, 40960
    s_nop 0
    buffer_load_dwordx4 v24, s[8:11], s28 offen lds
    s_add_u32 m0, s35, 40960
    s_nop 0
    buffer_load_dwordx4 v25, s[8:11], s28 offen lds
    s_add_u32 m0, s36, 40960
    s_nop 0
    buffer_load_dwordx4 v26, s[16:19], s29 offen lds
    s_add_u32 m0, s37, 40960
    s_nop 0
    buffer_load_dwordx4 v27, s[16:19], s29 offen lds
    s_add_u32 s29, s29, 1024
    s_lshr_b32 s58, s52, 1
    s_and_b32 s59, s52, 1
    s_mul_i32 s60, s59, 6
    v_lshrrev_b32 v32, 4, v1
    v_bfe_u32 v33, v1, 2, 2
    v_lshl_add_u32 v34, v32, 2, v33
    v_mul_u32_u24 v34, 384, v34
    v_and_b32 v35, 3, v1
    v_lshl_add_u32 v34, v35, 3, v34
    v_and_b32 v32, 1, v32
    v_lshrrev_b32 v33, 1, v33
    v_lshl_or_b32 v33, v32, 1, v33
    s_add_u32 s56, s60, 0
    v_xor_b32 v35, s56, v33
    v_lshl_add_u32 v2, v35, 5, v34
    v_add_u32 v3, 61440, v2
    v_add_u32 v4, 122880, v2
    s_add_u32 s56, s60, 1
    v_xor_b32 v35, s56, v33
    v_lshl_add_u32 v5, v35, 5, v34
    v_add_u32 v6, 61440, v5
    v_add_u32 v7, 122880, v5
    s_add_u32 s56, s60, 2
    v_xor_b32 v35, s56, v33
    v_lshl_add_u32 v8, v35, 5, v34
    v_add_u32 v9, 61440, v8
    v_add_u32 v10, 122880, v8
    s_add_u32 s56, s60, 3
    v_xor_b32 v35, s56, v33
    v_lshl_add_u32 v11, v35, 5, v34
    v_add_u32 v12, 61440, v11
    v_add_u32 v13, 122880, v11
    s_add_u32 s56, s60, 4
    v_xor_b32 v35, s56, v33
    v_lshl_add_u32 v14, v35, 5, v34
    v_add_u32 v15, 61440, v14
    v_add_u32 v16, 122880, v14
    s_add_u32 s56, s60, 5
    v_xor_b32 v35, s56, v33
    v_lshl_add_u32 v17, v35, 5, v34
    v_add_u32 v18, 61440, v17
    v_add_u32 v19, 122880, v17
    s_lshl_b32 s56, s58, 12
    s_add_u32 s56, s56, 12288
    v_lshlrev_b32 v32, 4, v1
    v_add_u32 v20, s56, v32
    v_add_u32 v21, 61440, v20
    v_add_u32 v22, 122880, v20
    s_lshl_b32 s56, s53, 7
    s_lshl_b32 s59, s54, 3
    s_add_u32 s56, s56, s59
    s_lshl_b32 s59, s58, 2
    s_add_u32 s56, s56, s59
    s_mul_i32 s56, s56, 36
    s_mul_i32 s59, s57, 12
    s_add_u32 s56, s56, s59
    s_add_u32 s56, s56, s60
    s_lshl_b32 s56, s56, 9
    s_add_u32 s56, s56, 11534336
    v_lshlrev_b32 v32, 3, v1
    v_add_u32 v28, s56, v32
    s_mov_b32 s98, s53
    s_mov_b32 s99, s54
    s_mov_b32 s100, s57
    v_mov_b32 v50, v1
    v_lshlrev_b32 v51, 4, v1
    s_and_b32 s55, s2, 7
    s_lshr_b32 s56, s2, 3
    s_and_b32 s53, s56, 3
    s_lshr_b32 s54, s56, 2
    s_lshl_b32 s55, s55, 3
    s_add_u32 s54, s54, s55
    s_mul_i32 s57, s52, 5
    s_cmp_eq_u32 s52, 3
    s_cselect_b32 s57, 14, s57
    s_getpc_b64 s[58:59]
    s_add_u32 s58, s58, tab_fi@rel32@lo+4
    s_addc_u32 s59, s59, tab_fi@rel32@hi+12
    s_mul_i32 s40, s53, 165888
    s_lshl_b32 s41, s57, 10
    s_add_u32 s40, s40, s41
    v_add_u32 v52, s40, v51
    v_add_co_u32 v252, s[60:61], s58, v52
    v_mov_b32 v253, s59
    s_nop 0
    v_addc_co_u32 v253, s[60:61], 0, v253, s[60:61]
    s_mov_b32 s41, 4096
    s_cmp_eq_u32 s52, 3
    s_cselect_b32 s41, 3072, s41
    v_add_u32 v52, s41, v52
    v_add_co_u32 v254, s[60:61], s58, v52
    v_mov_b32 v255, s59
    s_nop 0
    v_addc_co_u32 v255, s[60:61], 0, v255, s[60:61]
    v_and_b32 v52, 15, v50
    v_lshrrev_b32 v53, 4, v50
    v_lshlrev_b32 v48, 15, v53
    v_lshl_add_u32 v48, v52, 4, v48
    s_lshl_b32 s41, s54, 9
    s_lshl_b32 s42, s57, 17
    s_add_u32 s41, s41, s42
    s_add_u32 s41, s41, 8650752
    v_add_u32 v48, s41, v48
    v_add_u32 v49, 524288, v48
    s_cmp_lt_u32 s52, 2
    s_cselect_b64 s[30:31], -1, 0
    v_mov_b32 v52, 2130706432
    s_nop 0
    v_cndmask_b32 v49, v52, v49, s[30:31]
    s_mov_b32 s47, 18432
    s_mov_b32 s53, s98
    s_mov_b32 s54, s99
    s_mov_b32 s57, s100
    s_waitcnt vmcnt(10)
    s_barrier
    ds_read_b128 v[180:183], v20 offset:0
    ds_read_b128 v[184:187], v20 offset:1024
    ds_read_b128 v[188:191], v20 offset:2048
    ds_read_b128 v[192:195], v20 offset:3072
    ds_read_b64_tr_b16 v[160:161], v2 offset:0
    ds_read_b64_tr_b16 v[162:163], v2 offset:6144
    ds_read_b64_tr_b16 v[164:165], v5 offset:0
    ds_read_b64_tr_b16 v[166:167], v5 offset:6144
    ds_read_b64_tr_b16 v[168:169], v8 offset:0
    ds_read_b64_tr_b16 v[170:171], v8 offset:6144
    s_waitcnt vmcnt(5)
    s_barrier
    s_waitcnt lgkmcnt(6)
    s_waitcnt lgkmcnt(4)
    v_mfma_f32_16x16x32_bf16 v[64:67], v[160:163], v[180:183], 0
    ds_read_b64_tr_b16 v[172:173], v11 offset:0
    v_mfma_f32_16x16x32_bf16 v[68:71], v[160:163], v[184:187], 0
    ds_read_b64_tr_b16 v[174:175], v11 offset:6144
    v_mfma_f32_16x16x32_bf16 v[72:75], v[160:163], v[188:191], 0
    s_mov_b32 s28, 110592
    v_mfma_f32_16x16x32_bf16 v[76:79], v[160:163], v[192:195], 0
    s_add_u32 m0, s33, 61440
    s_nop 0
    buffer_load_dwordx4 v23, s[8:11], s28 offen lds
    s_waitcnt lgkmcnt(4)
    v_mfma_f32_16x16x32_bf16 v[80:83], v[164:167], v[180:183], 0
    ds_read_b64_tr_b16 v[176:177], v14 offset:0
    v_mfma_f32_16x16x32_bf16 v[84:87], v[164:167], v[184:187], 0
    ds_read_b64_tr_b16 v[178:179], v14 offset:6144
    v_mfma_f32_16x16x32_bf16 v[88:91], v[164:167], v[188:191], 0
    ds_read_b128 v[196:199], v20 offset:20480
    v_mfma_f32_16x16x32_bf16 v[92:95], v[164:167], v[192:195], 0
    s_add_u32 m0, s34, 61440
    s_nop 0
    buffer_load_dwordx4 v24, s[8:11], s28 offen lds
    s_waitcnt lgkmcnt(5)
    v_mfma_f32_16x16x32_bf16 v[96:99], v[168:171], v[180:183], 0
    ds_read_b64_tr_b16 v[160:161], v17 offset:0
    v_mfma_f32_16x16x32_bf16 v[100:103], v[168:171], v[184:187], 0
    ds_read_b64_tr_b16 v[162:163], v17 offset:6144
    v_mfma_f32_16x16x32_bf16 v[104:107], v[168:171], v[188:191], 0
    ds_read_b128 v[200:203], v20 offset:21504
    v_mfma_f32_16x16x32_bf16 v[108:111], v[168:171], v[192:195], 0
    s_add_u32 m0, s35, 61440
    s_nop 0
    buffer_load_dwordx4 v25, s[8:11], s28 offen lds
    s_waitcnt lgkmcnt(6)
    v_mfma_f32_16x16x32_bf16 v[112:115], v[172:175], v[180:183], 0
    ds_read_b64_tr_b16 v[164:165], v2 offset:20480
    v_mfma_f32_16x16x32_bf16 v[116:119], v[172:175], v[184:187], 0
    ds_read_b64_tr_b16 v[166:167], v2 offset:26624
    v_mfma_f32_16x16x32_bf16 v[120:123], v[172:175], v[188:191], 0
    ds_read_b128 v[204:207], v20 offset:22528
    v_mfma_f32_16x16x32_bf16 v[124:127], v[172:175], v[192:195], 0
    s_add_u32 m0, s36, 61440
    s_nop 0
    buffer_load_dwordx4 v26, s[16:19], s29 offen lds
    s_waitcnt lgkmcnt(7)
    v_mfma_f32_16x16x32_bf16 v[128:131], v[176:179], v[180:183], 0
    ds_read_b64_tr_b16 v[168:169], v5 offset:20480
    v_mfma_f32_16x16x32_bf16 v[132:135], v[176:179], v[184:187], 0
    ds_read_b64_tr_b16 v[170:171], v5 offset:26624
    v_mfma_f32_16x16x32_bf16 v[136:139], v[176:179], v[188:191], 0
    ds_read_b128 v[208:211], v20 offset:23552
    v_mfma_f32_16x16x32_bf16 v[140:143], v[176:179], v[192:195], 0
    s_add_u32 m0, s37, 61440
    s_nop 0
    buffer_load_dwordx4 v27, s[16:19], s29 offen lds
    s_waitcnt lgkmcnt(7)
    v_mfma_f32_16x16x32_bf16 v[144:147], v[160:163], v[180:183], 0
    ds_read_b64_tr_b16 v[172:173], v8 offset:20480
    v_mfma_f32_16x16x32_bf16 v[148:151], v[160:163], v[184:187], 0
    ds_read_b64_tr_b16 v[174:175], v8 offset:26624
    v_mfma_f32_16x16x32_bf16 v[152:155], v[160:163], v[188:191], 0
    s_add_u32 s29, s29, 1024
    v_mfma_f32_16x16x32_bf16 v[156:159], v[160:163], v[192:195], 0
    s_waitcnt vmcnt(5)
    s_barrier
    s_waitcnt lgkmcnt(2)
    v_mfma_f32_16x16x32_bf16 v[64:67], v[164:167], v[196:199], v[64:67]
    ds_read_b64_tr_b16 v[176:177], v11 offset:20480
    v_mfma_f32_16x16x32_bf16 v[68:71], v[164:167], v[200:203], v[68:71]
    ds_read_b64_tr_b16 v[178:179], v11 offset:26624
    v_mfma_f32_16x16x32_bf16 v[72:75], v[164:167], v[204:207], v[72:75]
    s_mov_b32 s28, 165888
    v_mfma_f32_16x16x32_bf16 v[76:79], v[164:167], v[208:211], v[76:79]
    s_add_u32 m0, s33, 81920
    s_nop 0
    buffer_load_dwordx4 v23, s[8:11], s28 offen lds
    v_mfma_f32_16x16x32_bf16 v[80:83], v[168:171], v[196:199], v[80:83]
    ds_read_b64_tr_b16 v[160:161], v14 offset:20480
    v_mfma_f32_16x16x32_bf16 v[84:87], v[168:171], v[200:203], v[84:87]
    ds_read_b64_tr_b16 v[162:163], v14 offset:26624
    v_mfma_f32_16x16x32_bf16 v[88:91], v[168:171], v[204:207], v[88:91]
    ds_read_b128 v[180:183], v20 offset:40960
    v_mfma_f32_16x16x32_bf16 v[92:95], v[168:171], v[208:211], v[92:95]
    s_add_u32 m0, s34, 81920
    s_nop 0
    buffer_load_dwordx4 v24, s[8:11], s28 offen lds
    s_waitcnt lgkmcnt(5)
    v_mfma_f32_16x16x32_bf16 v[96:99], v[172:175], v[196:199], v[96:99]
    ds_read_b64_tr_b16 v[164:165], v17 offset:20480
    v_mfma_f32_16x16x32_bf16 v[100:103], v[172:175], v[200:203], v[100:103]
    ds_read_b64_tr_b16 v[166:167], v17 offset:26624
    v_mfma_f32_16x16x32_bf16 v[104:107], v[172:175], v[204:207], v[104:107]
    ds_read_b128 v[184:187], v20 offset:41984
    v_mfma_f32_16x16x32_bf16 v[108:111], v[172:175], v[208:211], v[108:111]
    s_add_u32 m0, s35, 81920
    s_nop 0
    buffer_load_dwordx4 v25, s[8:11], s28 offen lds
    s_waitcnt lgkmcnt(6)
    v_mfma_f32_16x16x32_bf16 v[112:115], v[176:179], v[196:199], v[112:115]
    ds_read_b64_tr_b16 v[168:169], v2 offset:40960
    v_mfma_f32_16x16x32_bf16 v[116:119], v[176:179], v[200:203], v[116:119]
    ds_read_b64_tr_b16 v[170:171], v2 offset:47104
    v_mfma_f32_16x16x32_bf16 v[120:123], v[176:179], v[204:207], v[120:123]
    ds_read_b128 v[188:191], v20 offset:43008
    v_mfma_f32_16x16x32_bf16 v[124:127], v[176:179], v[208:211], v[124:127]
    s_add_u32 m0, s36, 81920
    s_nop 0
    buffer_load_dwordx4 v26, s[16:19], s29 offen lds
    s_waitcnt lgkmcnt(7)
    v_mfma_f32_16x16x32_bf16 v[128:131], v[160:163], v[196:199], v[128:131]
    ds_read_b64_tr_b16 v[172:173], v5 offset:40960
    v_mfma_f32_16x16x32_bf16 v[132:135], v[160:163], v[200:203], v[132:135]
    ds_read_b64_tr_b16 v[174:175], v5 offset:47104
    v_mfma_f32_16x16x32_bf16 v[136:139], v[160:163], v[204:207], v[136:139]
    ds_read_b128 v[192:195], v20 offset:44032
    v_mfma_f32_16x16x32_bf16 v[140:143], v[160:163], v[208:211], v[140:143]
    s_add_u32 m0, s37, 81920
    s_nop 0
    buffer_load_dwordx4 v27, s[16:19], s29 offen lds
    s_waitcnt lgkmcnt(7)
    v_mfma_f32_16x16x32_bf16 v[144:147], v[164:167], v[196:199], v[144:147]
    ds_read_b64_tr_b16 v[176:177], v8 offset:40960
    v_mfma_f32_16x16x32_bf16 v[148:151], v[164:167], v[200:203], v[148:151]
    ds_read_b64_tr_b16 v[178:179], v8 offset:47104
    v_mfma_f32_16x16x32_bf16 v[152:155], v[164:167], v[204:207], v[152:155]
    s_add_u32 s29, s29, 1024
    v_mfma_f32_16x16x32_bf16 v[156:159], v[164:167], v[208:211], v[156:159]
    s_waitcnt vmcnt(5)
    s_barrier
    s_waitcnt lgkmcnt(2)
    v_mfma_f32_16x16x32_bf16 v[64:67], v[168:171], v[180:183], v[64:67]
    ds_read_b64_tr_b16 v[160:161], v11 offset:40960
    v_mfma_f32_16x16x32_bf16 v[68:71], v[168:171], v[184:187], v[68:71]
    ds_read_b64_tr_b16 v[162:163], v11 offset:47104
    v_mfma_f32_16x16x32_bf16 v[72:75], v[168:171], v[188:191], v[72:75]
    s_mov_b32 s28, 202752
    v_mfma_f32_16x16x32_bf16 v[76:79], v[168:171], v[192:195], v[76:79]
    s_add_u32 m0, s33, 102400
    s_nop 0
    buffer_load_dwordx4 v23, s[8:11], s28 offen lds
    v_mfma_f32_16x16x32_bf16 v[80:83], v[172:175], v[180:183], v[80:83]
    ds_read_b64_tr_b16 v[164:165], v14 offset:40960
    v_mfma_f32_16x16x32_bf16 v[84:87], v[172:175], v[184:187], v[84:87]
    ds_read_b64_tr_b16 v[166:167], v14 offset:47104
    v_mfma_f32_16x16x32_bf16 v[88:91], v[172:175], v[188:191], v[88:91]
    ds_read_b128 v[196:199], v21 offset:0
    v_mfma_f32_16x16x32_bf16 v[92:95], v[172:175], v[192:195], v[92:95]
    s_add_u32 m0, s34, 102400
    s_nop 0
    buffer_load_dwordx4 v24, s[8:11], s28 offen lds
    s_waitcnt lgkmcnt(5)
    v_mfma_f32_16x16x32_bf16 v[96:99], v[176:179], v[180:183], v[96:99]
    ds_read_b64_tr_b16 v[168:169], v17 offset:40960
    v_mfma_f32_16x16x32_bf16 v[100:103], v[176:179], v[184:187], v[100:103]
    ds_read_b64_tr_b16 v[170:171], v17 offset:47104
    v_mfma_f32_16x16x32_bf16 v[104:107], v[176:179], v[188:191], v[104:107]
    ds_read_b128 v[200:203], v21 offset:1024
    v_mfma_f32_16x16x32_bf16 v[108:111], v[176:179], v[192:195], v[108:111]
    s_add_u32 m0, s35, 102400
    s_nop 0
    buffer_load_dwordx4 v25, s[8:11], s28 offen lds
    s_waitcnt lgkmcnt(6)
    v_mfma_f32_16x16x32_bf16 v[112:115], v[160:163], v[180:183], v[112:115]
    ds_read_b64_tr_b16 v[172:173], v3 offset:0
    v_mfma_f32_16x16x32_bf16 v[116:119], v[160:163], v[184:187], v[116:119]
    ds_read_b64_tr_b16 v[174:175], v3 offset:6144
    v_mfma_f32_16x16x32_bf16 v[120:123], v[160:163], v[188:191], v[120:123]
    ds_read_b128 v[204:207], v21 offset:2048
    v_mfma_f32_16x16x32_bf16 v[124:127], v[160:163], v[192:195], v[124:127]
    s_add_u32 m0, s36, 102400
    s_nop 0
    buffer_load_dwordx4 v26, s[16:19], s29 offen lds
    s_waitcnt lgkmcnt(7)
    v_mfma_f32_16x16x32_bf16 v[128:131], v[164:167], v[180:183], v[128:131]
    ds_read_b64_tr_b16 v[176:177], v6 offset:0
    v_mfma_f32_16x16x32_bf16 v[132:135], v[164:167], v[184:187], v[132:135]
    ds_read_b64_tr_b16 v[178:179], v6 offset:6144
    v_mfma_f32_16x16x32_bf16 v[136:139], v[164:167], v[188:191], v[136:139]
    ds_read_b128 v[208:211], v21 offset:3072
    v_mfma_f32_16x16x32_bf16 v[140:143], v[164:167], v[192:195], v[140:143]
    s_add_u32 m0, s37, 102400
    s_nop 0
    buffer_load_dwordx4 v27, s[16:19], s29 offen lds
    s_waitcnt lgkmcnt(7)
    v_mfma_f32_16x16x32_bf16 v[144:147], v[168:171], v[180:183], v[144:147]
    ds_read_b64_tr_b16 v[160:161], v9 offset:0
    v_mfma_f32_16x16x32_bf16 v[148:151], v[168:171], v[184:187], v[148:151]
    ds_read_b64_tr_b16 v[162:163], v9 offset:6144
    v_mfma_f32_16x16x32_bf16 v[152:155], v[168:171], v[188:191], v[152:155]
    s_add_u32 s29, s29, 1024
    v_mfma_f32_16x16x32_bf16 v[156:159], v[168:171], v[192:195], v[156:159]
    s_waitcnt vmcnt(5)
    s_barrier
    s_waitcnt lgkmcnt(2)
    v_mfma_f32_16x16x32_bf16 v[64:67], v[172:175], v[196:199], v[64:67]
    ds_read_b64_tr_b16 v[164:165], v12 offset:0
    v_mfma_f32_16x16x32_bf16 v[68:71], v[172:175], v[200:203], v[68:71]
    ds_read_b64_tr_b16 v[166:167], v12 offset:6144
    v_mfma_f32_16x16x32_bf16 v[72:75], v[172:175], v[204:207], v[72:75]
    s_mov_b32 s28, 239616
    v_mfma_f32_16x16x32_bf16 v[76:79], v[172:175], v[208:211], v[76:79]
    s_add_u32 m0, s33, 122880
    s_nop 0
    buffer_load_dwordx4 v23, s[8:11], s28 offen lds
    v_mfma_f32_16x16x32_bf16 v[80:83], v[176:179], v[196:199], v[80:83]
    ds_read_b64_tr_b16 v[168:169], v15 offset:0
    v_mfma_f32_16x16x32_bf16 v[84:87], v[176:179], v[200:203], v[84:87]
    ds_read_b64_tr_b16 v[170:171], v15 offset:6144
    v_mfma_f32_16x16x32_bf16 v[88:91], v[176:179], v[204:207], v[88:91]
    ds_read_b128 v[180:183], v21 offset:20480
    v_mfma_f32_16x16x32_bf16 v[92:95], v[176:179], v[208:211], v[92:95]
    s_add_u32 m0, s34, 122880
    s_nop 0
    buffer_load_dwordx4 v24, s[8:11], s28 offen lds
    s_waitcnt lgkmcnt(5)
    v_mfma_f32_16x16x32_bf16 v[96:99], v[160:163], v[196:199], v[96:99]
    ds_read_b64_tr_b16 v[172:173], v18 offset:0
    v_mfma_f32_16x16x32_bf16 v[100:103], v[160:163], v[200:203], v[100:103]
    ds_read_b64_tr_b16 v[174:175], v18 offset:6144
    v_mfma_f32_16x16x32_bf16 v[104:107], v[160:163], v[204:207], v[104:107]
    ds_read_b128 v[184:187], v21 offset:21504
    v_mfma_f32_16x16x32_bf16 v[108:111], v[160:163], v[208:211], v[108:111]
    s_add_u32 m0, s35, 122880
    s_nop 0
    buffer_load_dwordx4 v25, s[8:11], s28 offen lds
    s_waitcnt lgkmcnt(6)
    v_mfma_f32_16x16x32_bf16 v[112:115], v[164:167], v[196:199], v[112:115]
    ds_read_b64_tr_b16 v[176:177], v3 offset:20480
    v_mfma_f32_16x16x32_bf16 v[116:119], v[164:167], v[200:203], v[116:119]
    ds_read_b64_tr_b16 v[178:179], v3 offset:26624
    v_mfma_f32_16x16x32_bf16 v[120:123], v[164:167], v[204:207], v[120:123]
    ds_read_b128 v[188:191], v21 offset:22528
    v_mfma_f32_16x16x32_bf16 v[124:127], v[164:167], v[208:211], v[124:127]
    s_add_u32 m0, s36, 122880
    s_nop 0
    buffer_load_dwordx4 v26, s[16:19], s29 offen lds
    s_waitcnt lgkmcnt(7)
    v_mfma_f32_16x16x32_bf16 v[128:131], v[168:171], v[196:199], v[128:131]
    ds_read_b64_tr_b16 v[160:161], v6 offset:20480
    v_mfma_f32_16x16x32_bf16 v[132:135], v[168:171], v[200:203], v[132:135]
    ds_read_b64_tr_b16 v[162:163], v6 offset:26624
    v_mfma_f32_16x16x32_bf16 v[136:139], v[168:171], v[204:207], v[136:139]
    ds_read_b128 v[192:195], v21 offset:23552
    v_mfma_f32_16x16x32_bf16 v[140:143], v[168:171], v[208:211], v[140:143]
    s_add_u32 m0, s37, 122880
    s_nop 0
    buffer_load_dwordx4 v27, s[16:19], s29 offen lds
    s_waitcnt lgkmcnt(7)
    v_mfma_f32_16x16x32_bf16 v[144:147], v[172:175], v[196:199], v[144:147]
    ds_read_b64_tr_b16 v[164:165], v9 offset:20480
    v_mfma_f32_16x16x32_bf16 v[148:151], v[172:175], v[200:203], v[148:151]
    ds_read_b64_tr_b16 v[166:167], v9 offset:26624
    v_mfma_f32_16x16x32_bf16 v[152:155], v[172:175], v[204:207], v[152:155]
    s_add_u32 s29, s29, 1024
    v_mfma_f32_16x16x32_bf16 v[156:159], v[172:175], v[208:211], v[156:159]
    s_waitcnt vmcnt(5)
    s_barrier
    s_waitcnt lgkmcnt(2)
    v_mfma_f32_16x16x32_bf16 v[64:67], v[176:179], v[180:183], v[64:67]
    ds_read_b64_tr_b16 v[168:169], v12 offset:20480
    v_mfma_f32_16x16x32_bf16 v[68:71], v[176:179], v[184:187], v[68:71]
    ds_read_b64_tr_b16 v[170:171], v12 offset:26624
    v_mfma_f32_16x16x32_bf16 v[72:75], v[176:179], v[188:191], v[72:75]
    s_mov_b32 s28, 276480
    v_mfma_f32_16x16x32_bf16 v[76:79], v[176:179], v[192:195], v[76:79]
    s_add_u32 m0, s33, 0
    s_nop 0
    buffer_load_dwordx4 v23, s[8:11], s28 offen lds
    v_mfma_f32_16x16x32_bf16 v[80:83], v[160:163], v[180:183], v[80:83]
    ds_read_b64_tr_b16 v[172:173], v15 offset:20480
    v_mfma_f32_16x16x32_bf16 v[84:87], v[160:163], v[184:187], v[84:87]
    ds_read_b64_tr_b16 v[174:175], v15 offset:26624
    v_mfma_f32_16x16x32_bf16 v[88:91], v[160:163], v[188:191], v[88:91]
    ds_read_b128 v[196:199], v21 offset:40960
    v_mfma_f32_16x16x32_bf16 v[92:95], v[160:163], v[192:195], v[92:95]
    s_add_u32 m0, s34, 0
    s_nop 0
    buffer_load_dwordx4 v24, s[8:11], s28 offen lds
    s_waitcnt lgkmcnt(5)
    v_mfma_f32_16x16x32_bf16 v[96:99], v[164:167], v[180:183], v[96:99]
    ds_read_b64_tr_b16 v[176:177], v18 offset:20480
    v_mfma_f32_16x16x32_bf16 v[100:103], v[164:167], v[184:187], v[100:103]
    ds_read_b64_tr_b16 v[178:179], v18 offset:26624
    v_mfma_f32_16x16x32_bf16 v[104:107], v[164:167], v[188:191], v[104:107]
    ds_read_b128 v[200:203], v21 offset:41984
    v_mfma_f32_16x16x32_bf16 v[108:111], v[164:167], v[192:195], v[108:111]
    s_add_u32 m0, s35, 0
    s_nop 0
    buffer_load_dwordx4 v25, s[8:11], s28 offen lds
    s_waitcnt lgkmcnt(6)
    v_mfma_f32_16x16x32_bf16 v[112:115], v[168:171], v[180:183], v[112:115]
    ds_read_b64_tr_b16 v[160:161], v3 offset:40960
    v_mfma_f32_16x16x32_bf16 v[116:119], v[168:171], v[184:187], v[116:119]
    ds_read_b64_tr_b16 v[162:163], v3 offset:47104
    v_mfma_f32_16x16x32_bf16 v[120:123], v[168:171], v[188:191], v[120:123]
    ds_read_b128 v[204:207], v21 offset:43008
    v_mfma_f32_16x16x32_bf16 v[124:127], v[168:171], v[192:195], v[124:127]
    s_add_u32 m0, s36, 0
    s_nop 0
    buffer_load_dwordx4 v26, s[16:19], s29 offen lds
    s_waitcnt lgkmcnt(7)
    v_mfma_f32_16x16x32_bf16 v[128:131], v[172:175], v[180:183], v[128:131]
    ds_read_b64_tr_b16 v[164:165], v6 offset:40960
    v_mfma_f32_16x16x32_bf16 v[132:135], v[172:175], v[184:187], v[132:135]
    ds_read_b64_tr_b16 v[166:167], v6 offset:47104
    v_mfma_f32_16x16x32_bf16 v[136:139], v[172:175], v[188:191], v[136:139]
    ds_read_b128 v[208:211], v21 offset:44032
    v_mfma_f32_16x16x32_bf16 v[140:143], v[172:175], v[192:195], v[140:143]
    s_add_u32 m0, s37, 0
    s_nop 0
    buffer_load_dwordx4 v27, s[16:19], s29 offen lds
    s_waitcnt lgkmcnt(7)
    v_mfma_f32_16x16x32_bf16 v[144:147], v[176:179], v[180:183], v[144:147]
    ds_read_b64_tr_b16 v[168:169], v9 offset:40960
    v_mfma_f32_16x16x32_bf16 v[148:151], v[176:179], v[184:187], v[148:151]
    ds_read_b64_tr_b16 v[170:171], v9 offset:47104
    v_mfma_f32_16x16x32_bf16 v[152:155], v[176:179], v[188:191], v[152:155]
    s_add_u32 s29, s29, 1024
    v_mfma_f32_16x16x32_bf16 v[156:159], v[176:179], v[192:195], v[156:159]
    s_waitcnt vmcnt(5)
    s_barrier
    s_waitcnt lgkmcnt(2)
    v_mfma_f32_16x16x32_bf16 v[64:67], v[160:163], v[196:199], v[64:67]
    ds_read_b64_tr_b16 v[172:173], v12 offset:40960
    v_mfma_f32_16x16x32_bf16 v[68:71], v[160:163], v[200:203], v[68:71]
    ds_read_b64_tr_b16 v[174:175], v12 offset:47104
    v_mfma_f32_16x16x32_bf16 v[72:75], v[160:163], v[204:207], v[72:75]
    s_mov_b32 s28, 147456
    v_mfma_f32_16x16x32_bf16 v[76:79], v[160:163], v[208:211], v[76:79]
    s_add_u32 m0, s33, 20480
    s_nop 0
    buffer_load_dwordx4 v29, s[8:11], s28 offen lds
    v_mfma_f32_16x16x32_bf16 v[80:83], v[164:167], v[196:199], v[80:83]
    ds_read_b64_tr_b16 v[176:177], v15 offset:40960
    v_mfma_f32_16x16x32_bf16 v[84:87], v[164:167], v[200:203], v[84:87]
    ds_read_b64_tr_b16 v[178:179], v15 offset:47104
    v_mfma_f32_16x16x32_bf16 v[88:91], v[164:167], v[204:207], v[88:91]
    ds_read_b128 v[180:183], v22 offset:0
    v_mfma_f32_16x16x32_bf16 v[92:95], v[164:167], v[208:211], v[92:95]
    s_add_u32 m0, s34, 20480
    s_nop 0
    buffer_load_dwordx4 v30, s[8:11], s28 offen lds
    s_waitcnt lgkmcnt(5)
    v_mfma_f32_16x16x32_bf16 v[96:99], v[168:171], v[196:199], v[96:99]
    ds_read_b64_tr_b16 v[160:161], v18 offset:40960
    v_mfma_f32_16x16x32_bf16 v[100:103], v[168:171], v[200:203], v[100:103]
    ds_read_b64_tr_b16 v[162:163], v18 offset:47104
    v_mfma_f32_16x16x32_bf16 v[104:107], v[168:171], v[204:207], v[104:107]
    ds_read_b128 v[184:187], v22 offset:1024
    v_mfma_f32_16x16x32_bf16 v[108:111], v[168:171], v[208:211], v[108:111]
    s_add_u32 m0, s35, 20480
    s_nop 0
    buffer_load_dwordx4 v31, s[8:11], s28 offen lds
    s_waitcnt lgkmcnt(6)
    v_mfma_f32_16x16x32_bf16 v[112:115], v[172:175], v[196:199], v[112:115]
    ds_read_b64_tr_b16 v[164:165], v4 offset:0
    v_mfma_f32_16x16x32_bf16 v[116:119], v[172:175], v[200:203], v[116:119]
    ds_read_b64_tr_b16 v[166:167], v4 offset:6144
    v_mfma_f32_16x16x32_bf16 v[120:123], v[172:175], v[204:207], v[120:123]
    ds_read_b128 v[188:191], v22 offset:2048
    v_mfma_f32_16x16x32_bf16 v[124:127], v[172:175], v[208:211], v[124:127]
    s_add_u32 m0, s36, 20480
    s_nop 0
    buffer_load_dwordx4 v26, s[16:19], s29 offen lds
    s_waitcnt lgkmcnt(7)
    v_mfma_f32_16x16x32_bf16 v[128:131], v[176:179], v[196:199], v[128:131]
    ds_read_b64_tr_b16 v[168:169], v7 offset:0
    v_mfma_f32_16x16x32_bf16 v[132:135], v[176:179], v[200:203], v[132:135]
    ds_read_b64_tr_b16 v[170:171], v7 offset:6144
    v_mfma_f32_16x16x32_bf16 v[136:139], v[176:179], v[204:207], v[136:139]
    ds_read_b128 v[192:195], v22 offset:3072
    v_mfma_f32_16x16x32_bf16 v[140:143], v[176:179], v[208:211], v[140:143]
    s_add_u32 m0, s37, 20480
    s_nop 0
    buffer_load_dwordx4 v27, s[16:19], s29 offen lds
    s_waitcnt lgkmcnt(7)
    v_mfma_f32_16x16x32_bf16 v[144:147], v[160:163], v[196:199], v[144:147]
    ds_read_b64_tr_b16 v[172:173], v10 offset:0
    v_mfma_f32_16x16x32_bf16 v[148:151], v[160:163], v[200:203], v[148:151]
    ds_read_b64_tr_b16 v[174:175], v10 offset:6144
    v_mfma_f32_16x16x32_bf16 v[152:155], v[160:163], v[204:207], v[152:155]
    s_add_u32 s29, s29, 1024
    v_mfma_f32_16x16x32_bf16 v[156:159], v[160:163], v[208:211], v[156:159]
    s_waitcnt vmcnt(5)
    s_barrier
    s_waitcnt lgkmcnt(2)
    v_mfma_f32_16x16x32_bf16 v[64:67], v[164:167], v[180:183], v[64:67]
    ds_read_b64_tr_b16 v[176:177], v13 offset:0
    v_mfma_f32_16x16x32_bf16 v[68:71], v[164:167], v[184:187], v[68:71]
    ds_read_b64_tr_b16 v[178:179], v13 offset:6144
    v_mfma_f32_16x16x32_bf16 v[72:75], v[164:167], v[188:191], v[72:75]
    s_mov_b32 s28, 331776
    v_mfma_f32_16x16x32_bf16 v[76:79], v[164:167], v[192:195], v[76:79]
    s_add_u32 m0, s33, 40960
    s_nop 0
    buffer_load_dwordx4 v23, s[8:11], s28 offen lds
    v_mfma_f32_16x16x32_bf16 v[80:83], v[168:171], v[180:183], v[80:83]
    ds_read_b64_tr_b16 v[160:161], v16 offset:0
    v_mfma_f32_16x16x32_bf16 v[84:87], v[168:171], v[184:187], v[84:87]
    ds_read_b64_tr_b16 v[162:163], v16 offset:6144
    v_mfma_f32_16x16x32_bf16 v[88:91], v[168:171], v[188:191], v[88:91]
    ds_read_b128 v[196:199], v20 offset:0
    v_mfma_f32_16x16x32_bf16 v[92:95], v[168:171], v[192:195], v[92:95]
    s_add_u32 m0, s34, 40960
    s_nop 0
    buffer_load_dwordx4 v24, s[8:11], s28 offen lds
    s_waitcnt lgkmcnt(5)
    v_mfma_f32_16x16x32_bf16 v[96:99], v[172:175], v[180:183], v[96:99]
    ds_read_b64_tr_b16 v[164:165], v19 offset:0
    v_mfma_f32_16x16x32_bf16 v[100:103], v[172:175], v[184:187], v[100:103]
    ds_read_b64_tr_b16 v[166:167], v19 offset:6144
    v_mfma_f32_16x16x32_bf16 v[104:107], v[172:175], v[188:191], v[104:107]
    ds_read_b128 v[200:203], v20 offset:1024
    v_mfma_f32_16x16x32_bf16 v[108:111], v[172:175], v[192:195], v[108:111]
    s_add_u32 m0, s35, 40960
    s_nop 0
    buffer_load_dwordx4 v25, s[8:11], s28 offen lds
    s_waitcnt lgkmcnt(6)
    v_mfma_f32_16x16x32_bf16 v[112:115], v[176:179], v[180:183], v[112:115]
    ds_read_b64_tr_b16 v[168:169], v2 offset:0
    v_mfma_f32_16x16x32_bf16 v[116:119], v[176:179], v[184:187], v[116:119]
    ds_read_b64_tr_b16 v[170:171], v2 offset:6144
    v_mfma_f32_16x16x32_bf16 v[120:123], v[176:179], v[188:191], v[120:123]
    ds_read_b128 v[204:207], v20 offset:2048
    v_mfma_f32_16x16x32_bf16 v[124:127], v[176:179], v[192:195], v[124:127]
    s_add_u32 m0, s36, 40960
    s_nop 0
    buffer_load_dwordx4 v26, s[16:19], s29 offen lds
    s_waitcnt lgkmcnt(7)
    v_mfma_f32_16x16x32_bf16 v[128:131], v[160:163], v[180:183], v[128:131]
    ds_read_b64_tr_b16 v[172:173], v5 offset:0
    v_mfma_f32_16x16x32_bf16 v[132:135], v[160:163], v[184:187], v[132:135]
    ds_read_b64_tr_b16 v[174:175], v5 offset:6144
    v_mfma_f32_16x16x32_bf16 v[136:139], v[160:163], v[188:191], v[136:139]
    ds_read_b128 v[208:211], v20 offset:3072
    v_mfma_f32_16x16x32_bf16 v[140:143], v[160:163], v[192:195], v[140:143]
    s_add_u32 m0, s37, 40960
    s_nop 0
    buffer_load_dwordx4 v27, s[16:19], s29 offen lds
    s_waitcnt lgkmcnt(7)
    v_mfma_f32_16x16x32_bf16 v[144:147], v[164:167], v[180:183], v[144:147]
    ds_read_b64_tr_b16 v[176:177], v8 offset:0
    v_mfma_f32_16x16x32_bf16 v[148:151], v[164:167], v[184:187], v[148:151]
    ds_read_b64_tr_b16 v[178:179], v8 offset:6144
    v_mfma_f32_16x16x32_bf16 v[152:155], v[164:167], v[188:191], v[152:155]
    s_add_u32 s29, s29, 1024
    v_mfma_f32_16x16x32_bf16 v[156:159], v[164:167], v[192:195], v[156:159]
    s_waitcnt vmcnt(5)
    s_barrier
    s_waitcnt lgkmcnt(2)
    v_mfma_f32_16x16x32_bf16 v[64:67], v[168:171], v[196:199], v[64:67]
    ds_read_b64_tr_b16 v[160:161], v11 offset:0
    v_mfma_f32_16x16x32_bf16 v[68:71], v[168:171], v[200:203], v[68:71]
    ds_read_b64_tr_b16 v[162:163], v11 offset:6144
    v_mfma_f32_16x16x32_bf16 v[72:75], v[168:171], v[204:207], v[72:75]
    s_mov_b32 s28, 368640
    v_mfma_f32_16x16x32_bf16 v[76:79], v[168:171], v[208:211], v[76:79]
    s_add_u32 m0, s33, 61440
    s_nop 0
    buffer_load_dwordx4 v23, s[8:11], s28 offen lds
    v_mfma_f32_16x16x32_bf16 v[80:83], v[172:175], v[196:199], v[80:83]
    ds_read_b64_tr_b16 v[164:165], v14 offset:0
    v_mfma_f32_16x16x32_bf16 v[84:87], v[172:175], v[200:203], v[84:87]
    ds_read_b64_tr_b16 v[166:167], v14 offset:6144
    v_mfma_f32_16x16x32_bf16 v[88:91], v[172:175], v[204:207], v[88:91]
    ds_read_b128 v[180:183], v20 offset:20480
    v_mfma_f32_16x16x32_bf16 v[92:95], v[172:175], v[208:211], v[92:95]
    s_add_u32 m0, s34, 61440
    s_nop 0
    buffer_load_dwordx4 v24, s[8:11], s28 offen lds
    s_waitcnt lgkmcnt(5)
    v_mfma_f32_16x16x32_bf16 v[96:99], v[176:179], v[196:199], v[96:99]
    ds_read_b64_tr_b16 v[168:169], v17 offset:0
    v_mfma_f32_16x16x32_bf16 v[100:103], v[176:179], v[200:203], v[100:103]
    ds_read_b64_tr_b16 v[170:171], v17 offset:6144
    v_mfma_f32_16x16x32_bf16 v[104:107], v[176:179], v[204:207], v[104:107]
    ds_read_b128 v[184:187], v20 offset:21504
    v_mfma_f32_16x16x32_bf16 v[108:111], v[176:179], v[208:211], v[108:111]
    s_add_u32 m0, s35, 61440
    s_nop 0
    buffer_load_dwordx4 v25, s[8:11], s28 offen lds
    s_waitcnt lgkmcnt(6)
    v_mfma_f32_16x16x32_bf16 v[112:115], v[160:163], v[196:199], v[112:115]
    ds_read_b64_tr_b16 v[172:173], v2 offset:20480
    v_mfma_f32_16x16x32_bf16 v[116:119], v[160:163], v[200:203], v[116:119]
    ds_read_b64_tr_b16 v[174:175], v2 offset:26624
    v_mfma_f32_16x16x32_bf16 v[120:123], v[160:163], v[204:207], v[120:123]
    ds_read_b128 v[188:191], v20 offset:22528
    v_mfma_f32_16x16x32_bf16 v[124:127], v[160:163], v[208:211], v[124:127]
    s_add_u32 m0, s36, 61440
    s_nop 0
    buffer_load_dwordx4 v26, s[16:19], s29 offen lds
    s_waitcnt lgkmcnt(7)
    v_mfma_f32_16x16x32_bf16 v[128:131], v[164:167], v[196:199], v[128:131]
    ds_read_b64_tr_b16 v[176:177], v5 offset:20480
    v_mfma_f32_16x16x32_bf16 v[132:135], v[164:167], v[200:203], v[132:135]
    ds_read_b64_tr_b16 v[178:179], v5 offset:26624
    v_mfma_f32_16x16x32_bf16 v[136:139], v[164:167], v[204:207], v[136:139]
    ds_read_b128 v[192:195], v20 offset:23552
    v_mfma_f32_16x16x32_bf16 v[140:143], v[164:167], v[208:211], v[140:143]
    s_add_u32 m0, s37, 61440
    s_nop 0
    buffer_load_dwordx4 v27, s[16:19], s29 offen lds
    s_waitcnt lgkmcnt(7)
    v_mfma_f32_16x16x32_bf16 v[144:147], v[168:171], v[196:199], v[144:147]
    ds_read_b64_tr_b16 v[160:161], v8 offset:20480
    v_mfma_f32_16x16x32_bf16 v[148:151], v[168:171], v[200:203], v[148:151]
    ds_read_b64_tr_b16 v[162:163], v8 offset:26624
    v_mfma_f32_16x16x32_bf16 v[152:155], v[168:171], v[204:207], v[152:155]
    s_add_u32 s29, s29, 1024
    v_mfma_f32_16x16x32_bf16 v[156:159], v[168:171], v[208:211], v[156:159]
    s_waitcnt vmcnt(5)
    s_barrier
    s_waitcnt lgkmcnt(2)
    v_mfma_f32_16x16x32_bf16 v[64:67], v[172:175], v[180:183], v[64:67]
    ds_read_b64_tr_b16 v[164:165], v11 offset:20480
    v_mfma_f32_16x16x32_bf16 v[68:71], v[172:175], v[184:187], v[68:71]
    ds_read_b64_tr_b16 v[166:167], v11 offset:26624
    v_mfma_f32_16x16x32_bf16 v[72:75], v[172:175], v[188:191], v[72:75]
    s_mov_b32 s28, 405504
    v_mfma_f32_16x16x32_bf16 v[76:79], v[172:175], v[192:195], v[76:79]
    s_add_u32 m0, s33, 81920
    s_nop 0
    buffer_load_dwordx4 v23, s[8:11], s28 offen lds
    v_mfma_f32_16x16x32_bf16 v[80:83], v[176:179], v[180:183], v[80:83]
    ds_read_b64_tr_b16 v[168:169], v14 offset:20480
    v_mfma_f32_16x16x32_bf16 v[84:87], v[176:179], v[184:187], v[84:87]
    ds_read_b64_tr_b16 v[170:171], v14 offset:26624
    v_mfma_f32_16x16x32_bf16 v[88:91], v[176:179], v[188:191], v[88:91]
    ds_read_b128 v[196:199], v20 offset:40960
    v_mfma_f32_16x16x32_bf16 v[92:95], v[176:179], v[192:195], v[92:95]
    s_add_u32 m0, s34, 81920
    s_nop 0
    buffer_load_dwordx4 v24, s[8:11], s28 offen lds
    s_waitcnt lgkmcnt(5)
    v_mfma_f32_16x16x32_bf16 v[96:99], v[160:163], v[180:183], v[96:99]
    ds_read_b64_tr_b16 v[172:173], v17 offset:20480
    v_mfma_f32_16x16x32_bf16 v[100:103], v[160:163], v[184:187], v[100:103]
    ds_read_b64_tr_b16 v[174:175], v17 offset:26624
    v_mfma_f32_16x16x32_bf16 v[104:107], v[160:163], v[188:191], v[104:107]
    ds_read_b128 v[200:203], v20 offset:41984
    v_mfma_f32_16x16x32_bf16 v[108:111], v[160:163], v[192:195], v[108:111]
    s_add_u32 m0, s35, 81920
    s_nop 0
    buffer_load_dwordx4 v25, s[8:11], s28 offen lds
    s_waitcnt lgkmcnt(6)
    v_mfma_f32_16x16x32_bf16 v[112:115], v[164:167], v[180:183], v[112:115]
    ds_read_b64_tr_b16 v[176:177], v2 offset:40960
    v_mfma_f32_16x16x32_bf16 v[116:119], v[164:167], v[184:187], v[116:119]
    ds_read_b64_tr_b16 v[178:179], v2 offset:47104
    v_mfma_f32_16x16x32_bf16 v[120:123], v[164:167], v[188:191], v[120:123]
    ds_read_b128 v[204:207], v20 offset:43008
    v_mfma_f32_16x16x32_bf16 v[124:127], v[164:167], v[192:195], v[124:127]
    s_add_u32 m0, s36, 81920
    s_nop 0
    buffer_load_dwordx4 v26, s[16:19], s29 offen lds
    s_waitcnt lgkmcnt(7)
    v_mfma_f32_16x16x32_bf16 v[128:131], v[168:171], v[180:183], v[128:131]
    ds_read_b64_tr_b16 v[160:161], v5 offset:40960
    v_mfma_f32_16x16x32_bf16 v[132:135], v[168:171], v[184:187], v[132:135]
    ds_read_b64_tr_b16 v[162:163], v5 offset:47104
    v_mfma_f32_16x16x32_bf16 v[136:139], v[168:171], v[188:191], v[136:139]
    ds_read_b128 v[208:211], v20 offset:44032
    v_mfma_f32_16x16x32_bf16 v[140:143], v[168:171], v[192:195], v[140:143]
    s_add_u32 m0, s37, 81920
    s_nop 0
    buffer_load_dwordx4 v27, s[16:19], s29 offen lds
    s_waitcnt lgkmcnt(7)
    v_mfma_f32_16x16x32_bf16 v[144:147], v[172:175], v[180:183], v[144:147]
    ds_read_b64_tr_b16 v[164:165], v8 offset:40960
    v_mfma_f32_16x16x32_bf16 v[148:151], v[172:175], v[184:187], v[148:151]
    ds_read_b64_tr_b16 v[166:167], v8 offset:47104
    v_mfma_f32_16x16x32_bf16 v[152:155], v[172:175], v[188:191], v[152:155]
    s_add_u32 s29, s29, 1024
    v_mfma_f32_16x16x32_bf16 v[156:159], v[172:175], v[192:195], v[156:159]
    s_waitcnt vmcnt(5)
    s_barrier
    s_waitcnt lgkmcnt(2)
    v_mfma_f32_16x16x32_bf16 v[64:67], v[176:179], v[196:199], v[64:67]
    ds_read_b64_tr_b16 v[168:169], v11 offset:40960
    v_mfma_f32_16x16x32_bf16 v[68:71], v[176:179], v[200:203], v[68:71]
    ds_read_b64_tr_b16 v[170:171], v11 offset:47104
    v_mfma_f32_16x16x32_bf16 v[72:75], v[176:179], v[204:207], v[72:75]
    s_mov_b32 s28, 442368
    v_mfma_f32_16x16x32_bf16 v[76:79], v[176:179], v[208:211], v[76:79]
    s_add_u32 m0, s33, 102400
    s_nop 0
    buffer_load_dwordx4 v23, s[8:11], s28 offen lds
    v_mfma_f32_16x16x32_bf16 v[80:83], v[160:163], v[196:199], v[80:83]
    ds_read_b64_tr_b16 v[172:173], v14 offset:40960
    v_mfma_f32_16x16x32_bf16 v[84:87], v[160:163], v[200:203], v[84:87]
    ds_read_b64_tr_b16 v[174:175], v14 offset:47104
    v_mfma_f32_16x16x32_bf16 v[88:91], v[160:163], v[204:207], v[88:91]
    ds_read_b128 v[180:183], v21 offset:0
    v_mfma_f32_16x16x32_bf16 v[92:95], v[160:163], v[208:211], v[92:95]
    s_add_u32 m0, s34, 102400
    s_nop 0
    buffer_load_dwordx4 v24, s[8:11], s28 offen lds
    s_waitcnt lgkmcnt(5)
    v_mfma_f32_16x16x32_bf16 v[96:99], v[164:167], v[196:199], v[96:99]
    ds_read_b64_tr_b16 v[176:177], v17 offset:40960
    v_mfma_f32_16x16x32_bf16 v[100:103], v[164:167], v[200:203], v[100:103]
    ds_read_b64_tr_b16 v[178:179], v17 offset:47104
    v_mfma_f32_16x16x32_bf16 v[104:107], v[164:167], v[204:207], v[104:107]
    ds_read_b128 v[184:187], v21 offset:1024
    v_mfma_f32_16x16x32_bf16 v[108:111], v[164:167], v[208:211], v[108:111]
    s_add_u32 m0, s35, 102400
    s_nop 0
    buffer_load_dwordx4 v25, s[8:11], s28 offen lds
    s_waitcnt lgkmcnt(6)
    v_mfma_f32_16x16x32_bf16 v[112:115], v[168:171], v[196:199], v[112:115]
    ds_read_b64_tr_b16 v[160:161], v3 offset:0
    v_mfma_f32_16x16x32_bf16 v[116:119], v[168:171], v[200:203], v[116:119]
    ds_read_b64_tr_b16 v[162:163], v3 offset:6144
    v_mfma_f32_16x16x32_bf16 v[120:123], v[168:171], v[204:207], v[120:123]
    ds_read_b128 v[188:191], v21 offset:2048
    v_mfma_f32_16x16x32_bf16 v[124:127], v[168:171], v[208:211], v[124:127]
    s_add_u32 m0, s36, 102400
    s_nop 0
    buffer_load_dwordx4 v26, s[16:19], s29 offen lds
    s_waitcnt lgkmcnt(7)
    v_mfma_f32_16x16x32_bf16 v[128:131], v[172:175], v[196:199], v[128:131]
    ds_read_b64_tr_b16 v[164:165], v6 offset:0
    v_mfma_f32_16x16x32_bf16 v[132:135], v[172:175], v[200:203], v[132:135]
    ds_read_b64_tr_b16 v[166:167], v6 offset:6144
    v_mfma_f32_16x16x32_bf16 v[136:139], v[172:175], v[204:207], v[136:139]
    ds_read_b128 v[192:195], v21 offset:3072
    v_mfma_f32_16x16x32_bf16 v[140:143], v[172:175], v[208:211], v[140:143]
    s_add_u32 m0, s37, 102400
    s_nop 0
    buffer_load_dwordx4 v27, s[16:19], s29 offen lds
    s_waitcnt lgkmcnt(7)
    v_mfma_f32_16x16x32_bf16 v[144:147], v[176:179], v[196:199], v[144:147]
    ds_read_b64_tr_b16 v[168:169], v9 offset:0
    v_mfma_f32_16x16x32_bf16 v[148:151], v[176:179], v[200:203], v[148:151]
    ds_read_b64_tr_b16 v[170:171], v9 offset:6144
    v_mfma_f32_16x16x32_bf16 v[152:155], v[176:179], v[204:207], v[152:155]
    s_add_u32 s29, s29, 1024
    v_mfma_f32_16x16x32_bf16 v[156:159], v[176:179], v[208:211], v[156:159]
    s_waitcnt vmcnt(5)
    s_barrier
    s_waitcnt lgkmcnt(2)
    v_mfma_f32_16x16x32_bf16 v[64:67], v[160:163], v[180:183], v[64:67]
    ds_read_b64_tr_b16 v[172:173], v12 offset:0
    v_mfma_f32_16x16x32_bf16 v[68:71], v[160:163], v[184:187], v[68:71]
    ds_read_b64_tr_b16 v[174:175], v12 offset:6144
    v_mfma_f32_16x16x32_bf16 v[72:75], v[160:163], v[188:191], v[72:75]
    s_mov_b32 s28, 497664
    v_mfma_f32_16x16x32_bf16 v[76:79], v[160:163], v[192:195], v[76:79]
    s_add_u32 m0, s33, 122880
    s_nop 0
    buffer_load_dwordx4 v23, s[8:11], s28 offen lds
    v_mfma_f32_16x16x32_bf16 v[80:83], v[164:167], v[180:183], v[80:83]
    ds_read_b64_tr_b16 v[176:177], v15 offset:0
    v_mfma_f32_16x16x32_bf16 v[84:87], v[164:167], v[184:187], v[84:87]
    ds_read_b64_tr_b16 v[178:179], v15 offset:6144
    v_mfma_f32_16x16x32_bf16 v[88:91], v[164:167], v[188:191], v[88:91]
    ds_read_b128 v[196:199], v21 offset:20480
    v_mfma_f32_16x16x32_bf16 v[92:95], v[164:167], v[192:195], v[92:95]
    s_add_u32 m0, s34, 122880
    s_nop 0
    buffer_load_dwordx4 v24, s[8:11], s28 offen lds
    s_waitcnt lgkmcnt(5)
    v_mfma_f32_16x16x32_bf16 v[96:99], v[168:171], v[180:183], v[96:99]
    ds_read_b64_tr_b16 v[160:161], v18 offset:0
    v_mfma_f32_16x16x32_bf16 v[100:103], v[168:171], v[184:187], v[100:103]
    ds_read_b64_tr_b16 v[162:163], v18 offset:6144
    v_mfma_f32_16x16x32_bf16 v[104:107], v[168:171], v[188:191], v[104:107]
    ds_read_b128 v[200:203], v21 offset:21504
    v_mfma_f32_16x16x32_bf16 v[108:111], v[168:171], v[192:195], v[108:111]
    s_add_u32 m0, s35, 122880
    s_nop 0
    buffer_load_dwordx4 v25, s[8:11], s28 offen lds
    s_waitcnt lgkmcnt(6)
    v_mfma_f32_16x16x32_bf16 v[112:115], v[172:175], v[180:183], v[112:115]
    ds_read_b64_tr_b16 v[164:165], v3 offset:20480
    v_mfma_f32_16x16x32_bf16 v[116:119], v[172:175], v[184:187], v[116:119]
    ds_read_b64_tr_b16 v[166:167], v3 offset:26624
    v_mfma_f32_16x16x32_bf16 v[120:123], v[172:175], v[188:191], v[120:123]
    ds_read_b128 v[204:207], v21 offset:22528
    v_mfma_f32_16x16x32_bf16 v[124:127], v[172:175], v[192:195], v[124:127]
    s_add_u32 m0, s36, 122880
    s_nop 0
    buffer_load_dwordx4 v26, s[16:19], s29 offen lds
    s_waitcnt lgkmcnt(7)
    v_mfma_f32_16x16x32_bf16 v[128:131], v[176:179], v[180:183], v[128:131]
    ds_read_b64_tr_b16 v[168:169], v6 offset:20480
    v_mfma_f32_16x16x32_bf16 v[132:135], v[176:179], v[184:187], v[132:135]
    ds_read_b64_tr_b16 v[170:171], v6 offset:26624
    v_mfma_f32_16x16x32_bf16 v[136:139], v[176:179], v[188:191], v[136:139]
    ds_read_b128 v[208:211], v21 offset:23552
    v_mfma_f32_16x16x32_bf16 v[140:143], v[176:179], v[192:195], v[140:143]
    s_add_u32 m0, s37, 122880
    s_nop 0
    buffer_load_dwordx4 v27, s[16:19], s29 offen lds
    s_waitcnt lgkmcnt(7)
    v_mfma_f32_16x16x32_bf16 v[144:147], v[160:163], v[180:183], v[144:147]
    ds_read_b64_tr_b16 v[172:173], v9 offset:20480
    v_mfma_f32_16x16x32_bf16 v[148:151], v[160:163], v[184:187], v[148:151]
    ds_read_b64_tr_b16 v[174:175], v9 offset:26624
    v_mfma_f32_16x16x32_bf16 v[152:155], v[160:163], v[188:191], v[152:155]
    s_add_u32 s29, s29, 1024
    v_mfma_f32_16x16x32_bf16 v[156:159], v[160:163], v[192:195], v[156:159]
    s_waitcnt vmcnt(5)
    s_barrier
    s_waitcnt lgkmcnt(2)
    v_mfma_f32_16x16x32_bf16 v[64:67], v[164:167], v[196:199], v[64:67]
    ds_read_b64_tr_b16 v[176:177], v12 offset:20480
    v_mfma_f32_16x16x32_bf16 v[68:71], v[164:167], v[200:203], v[68:71]
    ds_read_b64_tr_b16 v[178:179], v12 offset:26624
    v_mfma_f32_16x16x32_bf16 v[72:75], v[164:167], v[204:207], v[72:75]
    s_mov_b32 s28, 534528
    v_mfma_f32_16x16x32_bf16 v[76:79], v[164:167], v[208:211], v[76:79]
    s_add_u32 m0, s33, 0
    s_nop 0
    buffer_load_dwordx4 v23, s[8:11], s28 offen lds
    v_mfma_f32_16x16x32_bf16 v[80:83], v[168:171], v[196:199], v[80:83]
    ds_read_b64_tr_b16 v[160:161], v15 offset:20480
    v_mfma_f32_16x16x32_bf16 v[84:87], v[168:171], v[200:203], v[84:87]
    ds_read_b64_tr_b16 v[162:163], v15 offset:26624
    v_mfma_f32_16x16x32_bf16 v[88:91], v[168:171], v[204:207], v[88:91]
    ds_read_b128 v[180:183], v21 offset:40960
    v_mfma_f32_16x16x32_bf16 v[92:95], v[168:171], v[208:211], v[92:95]
    s_add_u32 m0, s34, 0
    s_nop 0
    buffer_load_dwordx4 v24, s[8:11], s28 offen lds
    s_waitcnt lgkmcnt(5)
    v_mfma_f32_16x16x32_bf16 v[96:99], v[172:175], v[196:199], v[96:99]
    ds_read_b64_tr_b16 v[164:165], v18 offset:20480
    v_mfma_f32_16x16x32_bf16 v[100:103], v[172:175], v[200:203], v[100:103]
    ds_read_b64_tr_b16 v[166:167], v18 offset:26624
    v_mfma_f32_16x16x32_bf16 v[104:107], v[172:175], v[204:207], v[104:107]
    ds_read_b128 v[184:187], v21 offset:41984
    v_mfma_f32_16x16x32_bf16 v[108:111], v[172:175], v[208:211], v[108:111]
    s_add_u32 m0, s35, 0
    s_nop 0
    buffer_load_dwordx4 v25, s[8:11], s28 offen lds
    s_waitcnt lgkmcnt(6)
    v_mfma_f32_16x16x32_bf16 v[112:115], v[176:179], v[196:199], v[112:115]
    ds_read_b64_tr_b16 v[168:169], v3 offset:40960
    v_mfma_f32_16x16x32_bf16 v[116:119], v[176:179], v[200:203], v[116:119]
    ds_read_b64_tr_b16 v[170:171], v3 offset:47104
    v_mfma_f32_16x16x32_bf16 v[120:123], v[176:179], v[204:207], v[120:123]
    ds_read_b128 v[188:191], v21 offset:43008
    v_mfma_f32_16x16x32_bf16 v[124:127], v[176:179], v[208:211], v[124:127]
    s_add_u32 m0, s36, 0
    s_nop 0
    buffer_load_dwordx4 v26, s[16:19], s29 offen lds
    s_waitcnt lgkmcnt(7)
    v_mfma_f32_16x16x32_bf16 v[128:131], v[160:163], v[196:199], v[128:131]
    ds_read_b64_tr_b16 v[172:173], v6 offset:40960
    v_mfma_f32_16x16x32_bf16 v[132:135], v[160:163], v[200:203], v[132:135]
    ds_read_b64_tr_b16 v[174:175], v6 offset:47104
    v_mfma_f32_16x16x32_bf16 v[136:139], v[160:163], v[204:207], v[136:139]
    ds_read_b128 v[192:195], v21 offset:44032
    v_mfma_f32_16x16x32_bf16 v[140:143], v[160:163], v[208:211], v[140:143]
    s_add_u32 m0, s37, 0
    s_nop 0
    buffer_load_dwordx4 v27, s[16:19], s29 offen lds
    s_waitcnt lgkmcnt(7)
    v_mfma_f32_16x16x32_bf16 v[144:147], v[164:167], v[196:199], v[144:147]
    ds_read_b64_tr_b16 v[176:177], v9 offset:40960
    v_mfma_f32_16x16x32_bf16 v[148:151], v[164:167], v[200:203], v[148:151]
    ds_read_b64_tr_b16 v[178:179], v9 offset:47104
    v_mfma_f32_16x16x32_bf16 v[152:155], v[164:167], v[204:207], v[152:155]
    s_add_u32 s29, s29, 1024
    v_mfma_f32_16x16x32_bf16 v[156:159], v[164:167], v[208:211], v[156:159]
    s_waitcnt vmcnt(5)
    s_barrier
    s_waitcnt lgkmcnt(2)
    v_mfma_f32_16x16x32_bf16 v[64:67], v[168:171], v[180:183], v[64:67]
    ds_read_b64_tr_b16 v[160:161], v12 offset:40960
    v_mfma_f32_16x16x32_bf16 v[68:71], v[168:171], v[184:187], v[68:71]
    ds_read_b64_tr_b16 v[162:163], v12 offset:47104
    v_mfma_f32_16x16x32_bf16 v[72:75], v[168:171], v[188:191], v[72:75]
    s_mov_b32 s28, 571392
    v_mfma_f32_16x16x32_bf16 v[76:79], v[168:171], v[192:195], v[76:79]
    s_add_u32 m0, s33, 20480
    s_nop 0
    buffer_load_dwordx4 v23, s[8:11], s28 offen lds
    v_mfma_f32_16x16x32_bf16 v[80:83], v[172:175], v[180:183], v[80:83]
    ds_read_b64_tr_b16 v[164:165], v15 offset:40960
    v_mfma_f32_16x16x32_bf16 v[84:87], v[172:175], v[184:187], v[84:87]
    ds_read_b64_tr_b16 v[166:167], v15 offset:47104
    v_mfma_f32_16x16x32_bf16 v[88:91], v[172:175], v[188:191], v[88:91]
    ds_read_b128 v[196:199], v22 offset:0
    s_add_u32 m0, s34, 20480
    v_mfma_f32_16x16x32_bf16 v[92:95], v[172:175], v[192:195], v[92:95]
    buffer_load_dwordx4 v24, s[8:11], s28 offen lds
    s_add_u32 m0, s35, 20480
    s_waitcnt lgkmcnt(5)
    v_mfma_f32_16x16x32_bf16 v[96:99], v[176:179], v[180:183], v[96:99]
    ds_read_b64_tr_b16 v[168:169], v18 offset:40960
    v_mfma_f32_16x16x32_bf16 v[100:103], v[176:179], v[184:187], v[100:103]
    ds_read_b64_tr_b16 v[170:171], v18 offset:47104
    v_mfma_f32_16x16x32_bf16 v[104:107], v[176:179], v[188:191], v[104:107]
    ds_read_b128 v[200:203], v22 offset:1024
    buffer_load_dwordx4 v25, s[8:11], s28 offen lds
    v_mfma_f32_16x16x32_bf16 v[108:111], v[176:179], v[192:195], v[108:111]
    s_add_u32 m0, s36, 20480
    s_nop 0
    buffer_load_dwordx4 v26, s[16:19], s29 offen lds
    s_waitcnt lgkmcnt(6)
    v_mfma_f32_16x16x32_bf16 v[112:115], v[160:163], v[180:183], v[112:115]
    ds_read_b64_tr_b16 v[172:173], v4 offset:0
    v_mfma_f32_16x16x32_bf16 v[116:119], v[160:163], v[184:187], v[116:119]
    ds_read_b64_tr_b16 v[174:175], v4 offset:6144
    v_mfma_f32_16x16x32_bf16 v[120:123], v[160:163], v[188:191], v[120:123]
    ds_read_b128 v[204:207], v22 offset:2048
    s_add_u32 m0, s37, 20480
    v_mfma_f32_16x16x32_bf16 v[124:127], v[160:163], v[192:195], v[124:127]
    buffer_load_dwordx4 v27, s[16:19], s29 offen lds
    s_add_u32 s29, s29, 1024
    s_waitcnt lgkmcnt(7)
    v_mfma_f32_16x16x32_bf16 v[128:131], v[164:167], v[180:183], v[128:131]
    ds_read_b64_tr_b16 v[176:177], v7 offset:0
    v_mfma_f32_16x16x32_bf16 v[132:135], v[164:167], v[184:187], v[132:135]
    ds_read_b64_tr_b16 v[178:179], v7 offset:6144
    v_mfma_f32_16x16x32_bf16 v[136:139], v[164:167], v[188:191], v[136:139]
    ds_read_b128 v[208:211], v22 offset:3072
    v_mfma_f32_16x16x32_bf16 v[140:143], v[164:167], v[192:195], v[140:143]
    global_load_dwordx4 a[0:3], v[252:253], off offset:0
    global_load_dwordx4 a[4:7], v[252:253], off offset:1024
    s_waitcnt lgkmcnt(7)
    v_mfma_f32_16x16x32_bf16 v[144:147], v[168:171], v[180:183], v[144:147]
    ds_read_b64_tr_b16 v[160:161], v10 offset:0
    v_mfma_f32_16x16x32_bf16 v[148:151], v[168:171], v[184:187], v[148:151]
    ds_read_b64_tr_b16 v[162:163], v10 offset:6144
    v_mfma_f32_16x16x32_bf16 v[152:155], v[168:171], v[188:191], v[152:155]
    global_load_dwordx4 a[8:11], v[252:253], off offset:2048
    v_mfma_f32_16x16x32_bf16 v[156:159], v[168:171], v[192:195], v[156:159]
    global_load_dwordx4 a[12:15], v[252:253], off offset:3072
    global_load_dwordx4 a[16:19], v[254:255], off
    v_add_co_u32 v252, s[62:63], s47, v252
    v_add_co_u32 v254, s[94:95], s47, v254
    s_nop 0
    v_addc_co_u32 v253, s[62:63], 0, v253, s[62:63]
    v_addc_co_u32 v255, s[94:95], 0, v255, s[94:95]
    s_waitcnt vmcnt(10)
    s_barrier
    s_waitcnt lgkmcnt(2)
    v_mfma_f32_16x16x32_bf16 v[64:67], v[172:175], v[196:199], v[64:67]
    ds_read_b64_tr_b16 v[164:165], v13 offset:0
    v_mfma_f32_16x16x32_bf16 v[68:71], v[172:175], v[200:203], v[68:71]
    ds_read_b64_tr_b16 v[166:167], v13 offset:6144
    v_mfma_f32_16x16x32_bf16 v[72:75], v[172:175], v[204:207], v[72:75]
    s_mov_b32 s28, 608256
    v_mfma_f32_16x16x32_bf16 v[76:79], v[172:175], v[208:211], v[76:79]
    s_add_u32 m0, s33, 40960
    s_nop 0
    buffer_load_dwordx4 v23, s[8:11], s28 offen lds
    v_mfma_f32_16x16x32_bf16 v[80:83], v[176:179], v[196:199], v[80:83]
    ds_read_b64_tr_b16 v[168:169], v16 offset:0
    v_mfma_f32_16x16x32_bf16 v[84:87], v[176:179], v[200:203], v[84:87]
    ds_read_b64_tr_b16 v[170:171], v16 offset:6144
    v_mfma_f32_16x16x32_bf16 v[88:91], v[176:179], v[204:207], v[88:91]
    ds_read_b128 v[180:183], v20 offset:0
    v_mfma_f32_16x16x32_bf16 v[92:95], v[176:179], v[208:211], v[92:95]
    s_add_u32 m0, s34, 40960
    s_nop 0
    buffer_load_dwordx4 v24, s[8:11], s28 offen lds
    s_waitcnt lgkmcnt(5)
    v_mfma_f32_16x16x32_bf16 v[96:99], v[160:163], v[196:199], v[96:99]
    ds_read_b64_tr_b16 v[172:173], v19 offset:0
    v_mfma_f32_16x16x32_bf16 v[100:103], v[160:163], v[200:203], v[100:103]
    ds_read_b64_tr_b16 v[174:175], v19 offset:6144
    v_mfma_f32_16x16x32_bf16 v[104:107], v[160:163], v[204:207], v[104:107]
    ds_read_b128 v[184:187], v20 offset:1024
    v_mfma_f32_16x16x32_bf16 v[108:111], v[160:163], v[208:211], v[108:111]
    s_add_u32 m0, s35, 40960
    s_nop 0
    buffer_load_dwordx4 v25, s[8:11], s28 offen lds
    s_waitcnt lgkmcnt(6)
    v_mfma_f32_16x16x32_bf16 v[112:115], v[164:167], v[196:199], v[112:115]
    ds_read_b64_tr_b16 v[176:177], v2 offset:0
    v_mfma_f32_16x16x32_bf16 v[116:119], v[164:167], v[200:203], v[116:119]
    ds_read_b64_tr_b16 v[178:179], v2 offset:6144
    v_mfma_f32_16x16x32_bf16 v[120:123], v[164:167], v[204:207], v[120:123]
    ds_read_b128 v[188:191], v20 offset:2048
    v_mfma_f32_16x16x32_bf16 v[124:127], v[164:167], v[208:211], v[124:127]
    s_add_u32 m0, s36, 40960
    s_nop 0
    buffer_load_dwordx4 v26, s[16:19], s29 offen lds
    s_waitcnt lgkmcnt(7)
    v_mfma_f32_16x16x32_bf16 v[128:131], v[168:171], v[196:199], v[128:131]
    ds_read_b64_tr_b16 v[160:161], v5 offset:0
    v_mfma_f32_16x16x32_bf16 v[132:135], v[168:171], v[200:203], v[132:135]
    ds_read_b64_tr_b16 v[162:163], v5 offset:6144
    v_mfma_f32_16x16x32_bf16 v[136:139], v[168:171], v[204:207], v[136:139]
    ds_read_b128 v[192:195], v20 offset:3072
    v_mfma_f32_16x16x32_bf16 v[140:143], v[168:171], v[208:211], v[140:143]
    s_add_u32 m0, s37, 40960
    s_nop 0
    buffer_load_dwordx4 v27, s[16:19], s29 offen lds
    s_waitcnt lgkmcnt(7)
    v_mfma_f32_16x16x32_bf16 v[144:147], v[172:175], v[196:199], v[144:147]
    ds_read_b64_tr_b16 v[164:165], v8 offset:0
    v_mfma_f32_16x16x32_bf16 v[148:151], v[172:175], v[200:203], v[148:151]
    ds_read_b64_tr_b16 v[166:167], v8 offset:6144
    v_mfma_f32_16x16x32_bf16 v[152:155], v[172:175], v[204:207], v[152:155]
    s_add_u32 s29, s29, 1024
    v_mfma_f32_16x16x32_bf16 v[156:159], v[172:175], v[208:211], v[156:159]
    s_waitcnt vmcnt(10)
    s_barrier
    s_waitcnt lgkmcnt(2)
    v_mfma_f32_16x16x32_bf16 v[64:67], v[176:179], v[180:183], v[64:67]
    ds_read_b64_tr_b16 v[168:169], v11 offset:0
    v_mfma_f32_16x16x32_bf16 v[68:71], v[176:179], v[184:187], v[68:71]
    ds_read_b64_tr_b16 v[170:171], v11 offset:6144
    v_mfma_f32_16x16x32_bf16 v[72:75], v[176:179], v[188:191], v[72:75]
    s_mov_b32 s28, 479232
    v_mfma_f32_16x16x32_bf16 v[76:79], v[176:179], v[192:195], v[76:79]
    s_add_u32 m0, s33, 61440
    s_nop 0
    buffer_load_dwordx4 v29, s[8:11], s28 offen lds
    v_mfma_f32_16x16x32_bf16 v[80:83], v[160:163], v[180:183], v[80:83]
    ds_read_b64_tr_b16 v[172:173], v14 offset:0
    v_mfma_f32_16x16x32_bf16 v[84:87], v[160:163], v[184:187], v[84:87]
    ds_read_b64_tr_b16 v[174:175], v14 offset:6144
    v_mfma_f32_16x16x32_bf16 v[88:91], v[160:163], v[188:191], v[88:91]
    ds_read_b128 v[196:199], v20 offset:20480
    s_add_u32 m0, s34, 61440
    v_mfma_f32_16x16x32_bf16 v[92:95], v[160:163], v[192:195], v[92:95]
    buffer_load_dwordx4 v30, s[8:11], s28 offen lds
    s_add_u32 m0, s35, 61440
    s_waitcnt lgkmcnt(5)
    v_mfma_f32_16x16x32_bf16 v[96:99], v[164:167], v[180:183], v[96:99]
    ds_read_b64_tr_b16 v[176:177], v17 offset:0
    v_mfma_f32_16x16x32_bf16 v[100:103], v[164:167], v[184:187], v[100:103]
    ds_read_b64_tr_b16 v[178:179], v17 offset:6144
    v_mfma_f32_16x16x32_bf16 v[104:107], v[164:167], v[188:191], v[104:107]
    ds_read_b128 v[200:203], v20 offset:21504
    buffer_load_dwordx4 v31, s[8:11], s28 offen lds
    v_mfma_f32_16x16x32_bf16 v[108:111], v[164:167], v[192:195], v[108:111]
    s_add_u32 m0, s36, 61440
    s_nop 0
    buffer_load_dwordx4 v26, s[16:19], s29 offen lds
    s_waitcnt lgkmcnt(6)
    v_mfma_f32_16x16x32_bf16 v[112:115], v[168:171], v[180:183], v[112:115]
    ds_read_b64_tr_b16 v[160:161], v2 offset:20480
    v_mfma_f32_16x16x32_bf16 v[116:119], v[168:171], v[184:187], v[116:119]
    ds_read_b64_tr_b16 v[162:163], v2 offset:26624
    v_mfma_f32_16x16x32_bf16 v[120:123], v[168:171], v[188:191], v[120:123]
    ds_read_b128 v[204:207], v20 offset:22528
    s_add_u32 m0, s37, 61440
    v_mfma_f32_16x16x32_bf16 v[124:127], v[168:171], v[192:195], v[124:127]
    buffer_load_dwordx4 v27, s[16:19], s29 offen lds
    s_add_u32 s29, s29, 1024
    s_waitcnt lgkmcnt(7)
    v_mfma_f32_16x16x32_bf16 v[128:131], v[172:175], v[180:183], v[128:131]
    ds_read_b64_tr_b16 v[164:165], v5 offset:20480
    v_mfma_f32_16x16x32_bf16 v[132:135], v[172:175], v[184:187], v[132:135]
    ds_read_b64_tr_b16 v[166:167], v5 offset:26624
    v_mfma_f32_16x16x32_bf16 v[136:139], v[172:175], v[188:191], v[136:139]
    ds_read_b128 v[208:211], v20 offset:23552
    v_mfma_f32_16x16x32_bf16 v[140:143], v[172:175], v[192:195], v[140:143]
    global_load_dwordx4 a[20:23], v[252:253], off offset:0
    global_load_dwordx4 a[24:27], v[252:253], off offset:1024
    s_waitcnt lgkmcnt(7)
    v_mfma_f32_16x16x32_bf16 v[144:147], v[176:179], v[180:183], v[144:147]
    ds_read_b64_tr_b16 v[168:169], v8 offset:20480
    v_mfma_f32_16x16x32_bf16 v[148:151], v[176:179], v[184:187], v[148:151]
    ds_read_b64_tr_b16 v[170:171], v8 offset:26624
    v_mfma_f32_16x16x32_bf16 v[152:155], v[176:179], v[188:191], v[152:155]
    global_load_dwordx4 a[28:31], v[252:253], off offset:2048
    v_mfma_f32_16x16x32_bf16 v[156:159], v[176:179], v[192:195], v[156:159]
    global_load_dwordx4 a[32:35], v[252:253], off offset:3072
    global_load_dwordx4 a[36:39], v[254:255], off
    v_add_co_u32 v252, s[62:63], s47, v252
    v_add_co_u32 v254, s[94:95], s47, v254
    s_nop 0
    v_addc_co_u32 v253, s[62:63], 0, v253, s[62:63]
    v_addc_co_u32 v255, s[94:95], 0, v255, s[94:95]
    s_waitcnt vmcnt(10)
    s_barrier
    s_waitcnt lgkmcnt(2)
    v_mfma_f32_16x16x32_bf16 v[64:67], v[160:163], v[196:199], v[64:67]
    ds_read_b64_tr_b16 v[172:173], v11 offset:20480
    v_mfma_f32_16x16x32_bf16 v[68:71], v[160:163], v[200:203], v[68:71]
    ds_read_b64_tr_b16 v[174:175], v11 offset:26624
    v_mfma_f32_16x16x32_bf16 v[72:75], v[160:163], v[204:207], v[72:75]
    s_mov_b32 s28, 663552
    v_mfma_f32_16x16x32_bf16 v[76:79], v[160:163], v[208:211], v[76:79]
    s_add_u32 m0, s33, 81920
    s_nop 0
    buffer_load_dwordx4 v23, s[8:11], s28 offen lds
    v_mfma_f32_16x16x32_bf16 v[80:83], v[164:167], v[196:199], v[80:83]
    ds_read_b64_tr_b16 v[176:177], v14 offset:20480
    v_mfma_f32_16x16x32_bf16 v[84:87], v[164:167], v[200:203], v[84:87]
    ds_read_b64_tr_b16 v[178:179], v14 offset:26624
    v_mfma_f32_16x16x32_bf16 v[88:91], v[164:167], v[204:207], v[88:91]
    ds_read_b128 v[180:183], v20 offset:40960
    v_mfma_f32_16x16x32_bf16 v[92:95], v[164:167], v[208:211], v[92:95]
    s_add_u32 m0, s34, 81920
    s_nop 0
    buffer_load_dwordx4 v24, s[8:11], s28 offen lds
    s_waitcnt lgkmcnt(5)
    v_mfma_f32_16x16x32_bf16 v[96:99], v[168:171], v[196:199], v[96:99]
    ds_read_b64_tr_b16 v[160:161], v17 offset:20480
    v_mfma_f32_16x16x32_bf16 v[100:103], v[168:171], v[200:203], v[100:103]
    ds_read_b64_tr_b16 v[162:163], v17 offset:26624
    v_mfma_f32_16x16x32_bf16 v[104:107], v[168:171], v[204:207], v[104:107]
    ds_read_b128 v[184:187], v20 offset:41984
    v_mfma_f32_16x16x32_bf16 v[108:111], v[168:171], v[208:211], v[108:111]
    s_add_u32 m0, s35, 81920
    s_nop 0
    buffer_load_dwordx4 v25, s[8:11], s28 offen lds
    s_waitcnt lgkmcnt(6)
    v_mfma_f32_16x16x32_bf16 v[112:115], v[172:175], v[196:199], v[112:115]
    ds_read_b64_tr_b16 v[164:165], v2 offset:40960
    v_mfma_f32_16x16x32_bf16 v[116:119], v[172:175], v[200:203], v[116:119]
    ds_read_b64_tr_b16 v[166:167], v2 offset:47104
    v_mfma_f32_16x16x32_bf16 v[120:123], v[172:175], v[204:207], v[120:123]
    ds_read_b128 v[188:191], v20 offset:43008
    v_mfma_f32_16x16x32_bf16 v[124:127], v[172:175], v[208:211], v[124:127]
    s_add_u32 m0, s36, 81920
    s_nop 0
    buffer_load_dwordx4 v26, s[16:19], s29 offen lds
    s_waitcnt lgkmcnt(7)
    v_mfma_f32_16x16x32_bf16 v[128:131], v[176:179], v[196:199], v[128:131]
    ds_read_b64_tr_b16 v[168:169], v5 offset:40960
    v_mfma_f32_16x16x32_bf16 v[132:135], v[176:179], v[200:203], v[132:135]
    ds_read_b64_tr_b16 v[170:171], v5 offset:47104
    v_mfma_f32_16x16x32_bf16 v[136:139], v[176:179], v[204:207], v[136:139]
    ds_read_b128 v[192:195], v20 offset:44032
    v_mfma_f32_16x16x32_bf16 v[140:143], v[176:179], v[208:211], v[140:143]
    s_add_u32 m0, s37, 81920
    s_nop 0
    buffer_load_dwordx4 v27, s[16:19], s29 offen lds
    s_waitcnt lgkmcnt(7)
    v_mfma_f32_16x16x32_bf16 v[144:147], v[160:163], v[196:199], v[144:147]
    ds_read_b64_tr_b16 v[172:173], v8 offset:40960
    v_mfma_f32_16x16x32_bf16 v[148:151], v[160:163], v[200:203], v[148:151]
    ds_read_b64_tr_b16 v[174:175], v8 offset:47104
    v_mfma_f32_16x16x32_bf16 v[152:155], v[160:163], v[204:207], v[152:155]
    s_add_u32 s29, s29, 1024
    v_mfma_f32_16x16x32_bf16 v[156:159], v[160:163], v[208:211], v[156:159]
    s_waitcnt vmcnt(10)
    s_barrier
    s_waitcnt lgkmcnt(2)
    v_mfma_f32_16x16x32_bf16 v[64:67], v[164:167], v[180:183], v[64:67]
    ds_read_b64_tr_b16 v[176:177], v11 offset:40960
    v_mfma_f32_16x16x32_bf16 v[68:71], v[164:167], v[184:187], v[68:71]
    ds_read_b64_tr_b16 v[178:179], v11 offset:47104
    v_mfma_f32_16x16x32_bf16 v[72:75], v[164:167], v[188:191], v[72:75]
    s_mov_b32 s28, 700416
    v_mfma_f32_16x16x32_bf16 v[76:79], v[164:167], v[192:195], v[76:79]
    s_add_u32 m0, s33, 102400
    s_nop 0
    buffer_load_dwordx4 v23, s[8:11], s28 offen lds
    v_mfma_f32_16x16x32_bf16 v[80:83], v[168:171], v[180:183], v[80:83]
    ds_read_b64_tr_b16 v[160:161], v14 offset:40960
    v_mfma_f32_16x16x32_bf16 v[84:87], v[168:171], v[184:187], v[84:87]
    ds_read_b64_tr_b16 v[162:163], v14 offset:47104
    v_mfma_f32_16x16x32_bf16 v[88:91], v[168:171], v[188:191], v[88:91]
    ds_read_b128 v[196:199], v21 offset:0
    s_add_u32 m0, s34, 102400
    v_mfma_f32_16x16x32_bf16 v[92:95], v[168:171], v[192:195], v[92:95]
    buffer_load_dwordx4 v24, s[8:11], s28 offen lds
    s_add_u32 m0, s35, 102400
    s_waitcnt lgkmcnt(5)
    v_mfma_f32_16x16x32_bf16 v[96:99], v[172:175], v[180:183], v[96:99]
    ds_read_b64_tr_b16 v[164:165], v17 offset:40960
    v_mfma_f32_16x16x32_bf16 v[100:103], v[172:175], v[184:187], v[100:103]
    ds_read_b64_tr_b16 v[166:167], v17 offset:47104
    v_mfma_f32_16x16x32_bf16 v[104:107], v[172:175], v[188:191], v[104:107]
    ds_read_b128 v[200:203], v21 offset:1024
    buffer_load_dwordx4 v25, s[8:11], s28 offen lds
    v_mfma_f32_16x16x32_bf16 v[108:111], v[172:175], v[192:195], v[108:111]
    s_add_u32 m0, s36, 102400
    s_nop 0
    buffer_load_dwordx4 v26, s[16:19], s29 offen lds
    s_waitcnt lgkmcnt(6)
    v_mfma_f32_16x16x32_bf16 v[112:115], v[176:179], v[180:183], v[112:115]
    ds_read_b64_tr_b16 v[168:169], v3 offset:0
    v_mfma_f32_16x16x32_bf16 v[116:119], v[176:179], v[184:187], v[116:119]
    ds_read_b64_tr_b16 v[170:171], v3 offset:6144
    v_mfma_f32_16x16x32_bf16 v[120:123], v[176:179], v[188:191], v[120:123]
    ds_read_b128 v[204:207], v21 offset:2048
    s_add_u32 m0, s37, 102400
    v_mfma_f32_16x16x32_bf16 v[124:127], v[176:179], v[192:195], v[124:127]
    buffer_load_dwordx4 v27, s[16:19], s29 offen lds
    s_add_u32 s29, s29, 1024
    s_waitcnt lgkmcnt(7)
    v_mfma_f32_16x16x32_bf16 v[128:131], v[160:163], v[180:183], v[128:131]
    ds_read_b64_tr_b16 v[172:173], v6 offset:0
    v_mfma_f32_16x16x32_bf16 v[132:135], v[160:163], v[184:187], v[132:135]
    ds_read_b64_tr_b16 v[174:175], v6 offset:6144
    v_mfma_f32_16x16x32_bf16 v[136:139], v[160:163], v[188:191], v[136:139]
    ds_read_b128 v[208:211], v21 offset:3072
    v_mfma_f32_16x16x32_bf16 v[140:143], v[160:163], v[192:195], v[140:143]
    global_load_dwordx4 a[40:43], v[252:253], off offset:0
    global_load_dwordx4 a[44:47], v[252:253], off offset:1024
    s_waitcnt lgkmcnt(7)
    v_mfma_f32_16x16x32_bf16 v[144:147], v[164:167], v[180:183], v[144:147]
    ds_read_b64_tr_b16 v[176:177], v9 offset:0
    v_mfma_f32_16x16x32_bf16 v[148:151], v[164:167], v[184:187], v[148:151]
    ds_read_b64_tr_b16 v[178:179], v9 offset:6144
    v_mfma_f32_16x16x32_bf16 v[152:155], v[164:167], v[188:191], v[152:155]
    global_load_dwordx4 a[48:51], v[252:253], off offset:2048
    v_mfma_f32_16x16x32_bf16 v[156:159], v[164:167], v[192:195], v[156:159]
    global_load_dwordx4 a[52:55], v[252:253], off offset:3072
    global_load_dwordx4 a[56:59], v[254:255], off
    v_add_co_u32 v252, s[62:63], s47, v252
    v_add_co_u32 v254, s[94:95], s47, v254
    s_nop 0
    v_addc_co_u32 v253, s[62:63], 0, v253, s[62:63]
    v_addc_co_u32 v255, s[94:95], 0, v255, s[94:95]
    s_waitcnt vmcnt(10)
    s_barrier
    s_waitcnt lgkmcnt(2)
    v_mfma_f32_16x16x32_bf16 v[64:67], v[168:171], v[196:199], v[64:67]
    ds_read_b64_tr_b16 v[160:161], v12 offset:0
    v_mfma_f32_16x16x32_bf16 v[68:71], v[168:171], v[200:203], v[68:71]
    ds_read_b64_tr_b16 v[162:163], v12 offset:6144
    v_mfma_f32_16x16x32_bf16 v[72:75], v[168:171], v[204:207], v[72:75]
    s_mov_b32 s28, 737280
    v_mfma_f32_16x16x32_bf16 v[76:79], v[168:171], v[208:211], v[76:79]
    s_add_u32 m0, s33, 122880
    s_nop 0
    buffer_load_dwordx4 v23, s[8:11], s28 offen lds
    v_mfma_f32_16x16x32_bf16 v[80:83], v[172:175], v[196:199], v[80:83]
    ds_read_b64_tr_b16 v[164:165], v15 offset:0
    v_mfma_f32_16x16x32_bf16 v[84:87], v[172:175], v[200:203], v[84:87]
    ds_read_b64_tr_b16 v[166:167], v15 offset:6144
    v_mfma_f32_16x16x32_bf16 v[88:91], v[172:175], v[204:207], v[88:91]
    ds_read_b128 v[180:183], v21 offset:20480
    v_mfma_f32_16x16x32_bf16 v[92:95], v[172:175], v[208:211], v[92:95]
    s_add_u32 m0, s34, 122880
    s_nop 0
    buffer_load_dwordx4 v24, s[8:11], s28 offen lds
    s_waitcnt lgkmcnt(5)
    v_mfma_f32_16x16x32_bf16 v[96:99], v[176:179], v[196:199], v[96:99]
    ds_read_b64_tr_b16 v[168:169], v18 offset:0
    v_mfma_f32_16x16x32_bf16 v[100:103], v[176:179], v[200:203], v[100:103]
    ds_read_b64_tr_b16 v[170:171], v18 offset:6144
    v_mfma_f32_16x16x32_bf16 v[104:107], v[176:179], v[204:207], v[104:107]
    ds_read_b128 v[184:187], v21 offset:21504
    v_mfma_f32_16x16x32_bf16 v[108:111], v[176:179], v[208:211], v[108:111]
    s_add_u32 m0, s35, 122880
    s_nop 0
    buffer_load_dwordx4 v25, s[8:11], s28 offen lds
    s_waitcnt lgkmcnt(6)
    v_mfma_f32_16x16x32_bf16 v[112:115], v[160:163], v[196:199], v[112:115]
    ds_read_b64_tr_b16 v[172:173], v3 offset:20480
    v_mfma_f32_16x16x32_bf16 v[116:119], v[160:163], v[200:203], v[116:119]
    ds_read_b64_tr_b16 v[174:175], v3 offset:26624
    v_mfma_f32_16x16x32_bf16 v[120:123], v[160:163], v[204:207], v[120:123]
    ds_read_b128 v[188:191], v21 offset:22528
    v_mfma_f32_16x16x32_bf16 v[124:127], v[160:163], v[208:211], v[124:127]
    s_add_u32 m0, s36, 122880
    s_nop 0
    buffer_load_dwordx4 v26, s[16:19], s29 offen lds
    s_waitcnt lgkmcnt(7)
    v_mfma_f32_16x16x32_bf16 v[128:131], v[164:167], v[196:199], v[128:131]
    ds_read_b64_tr_b16 v[176:177], v6 offset:20480
    v_mfma_f32_16x16x32_bf16 v[132:135], v[164:167], v[200:203], v[132:135]
    ds_read_b64_tr_b16 v[178:179], v6 offset:26624
    v_mfma_f32_16x16x32_bf16 v[136:139], v[164:167], v[204:207], v[136:139]
    ds_read_b128 v[192:195], v21 offset:23552
    v_mfma_f32_16x16x32_bf16 v[140:143], v[164:167], v[208:211], v[140:143]
    s_add_u32 m0, s37, 122880
    s_nop 0
    buffer_load_dwordx4 v27, s[16:19], s29 offen lds
    s_waitcnt lgkmcnt(7)
    v_mfma_f32_16x16x32_bf16 v[144:147], v[168:171], v[196:199], v[144:147]
    ds_read_b64_tr_b16 v[160:161], v9 offset:20480
    v_mfma_f32_16x16x32_bf16 v[148:151], v[168:171], v[200:203], v[148:151]
    ds_read_b64_tr_b16 v[162:163], v9 offset:26624
    v_mfma_f32_16x16x32_bf16 v[152:155], v[168:171], v[204:207], v[152:155]
    s_add_u32 s29, s29, 1024
    v_mfma_f32_16x16x32_bf16 v[156:159], v[168:171], v[208:211], v[156:159]
    s_waitcnt vmcnt(10)
    s_barrier
    s_waitcnt lgkmcnt(2)
    v_mfma_f32_16x16x32_bf16 v[64:67], v[172:175], v[180:183], v[64:67]
    ds_read_b64_tr_b16 v[164:165], v12 offset:20480
    v_mfma_f32_16x16x32_bf16 v[68:71], v[172:175], v[184:187], v[68:71]
    ds_read_b64_tr_b16 v[166:167], v12 offset:26624
    v_mfma_f32_16x16x32_bf16 v[72:75], v[172:175], v[188:191], v[72:75]
    s_mov_b32 s28, 774144
    v_mfma_f32_16x16x32_bf16 v[76:79], v[172:175], v[192:195], v[76:79]
    s_add_u32 m0, s33, 0
    s_nop 0
    buffer_load_dwordx4 v23, s[8:11], s28 offen lds
    v_mfma_f32_16x16x32_bf16 v[80:83], v[176:179], v[180:183], v[80:83]
    ds_read_b64_tr_b16 v[168:169], v15 offset:20480
    v_mfma_f32_16x16x32_bf16 v[84:87], v[176:179], v[184:187], v[84:87]
    ds_read_b64_tr_b16 v[170:171], v15 offset:26624
    v_mfma_f32_16x16x32_bf16 v[88:91], v[176:179], v[188:191], v[88:91]
    ds_read_b128 v[196:199], v21 offset:40960
    s_add_u32 m0, s34, 0
    v_mfma_f32_16x16x32_bf16 v[92:95], v[176:179], v[192:195], v[92:95]
    buffer_load_dwordx4 v24, s[8:11], s28 offen lds
    s_add_u32 m0, s35, 0
    s_waitcnt lgkmcnt(5)
    v_mfma_f32_16x16x32_bf16 v[96:99], v[160:163], v[180:183], v[96:99]
    ds_read_b64_tr_b16 v[172:173], v18 offset:20480
    v_mfma_f32_16x16x32_bf16 v[100:103], v[160:163], v[184:187], v[100:103]
    ds_read_b64_tr_b16 v[174:175], v18 offset:26624
    v_mfma_f32_16x16x32_bf16 v[104:107], v[160:163], v[188:191], v[104:107]
    ds_read_b128 v[200:203], v21 offset:41984
    buffer_load_dwordx4 v25, s[8:11], s28 offen lds
    v_mfma_f32_16x16x32_bf16 v[108:111], v[160:163], v[192:195], v[108:111]
    s_add_u32 m0, s36, 0
    s_nop 0
    buffer_load_dwordx4 v26, s[16:19], s29 offen lds
    s_waitcnt lgkmcnt(6)
    v_mfma_f32_16x16x32_bf16 v[112:115], v[164:167], v[180:183], v[112:115]
    ds_read_b64_tr_b16 v[176:177], v3 offset:40960
    v_mfma_f32_16x16x32_bf16 v[116:119], v[164:167], v[184:187], v[116:119]
    ds_read_b64_tr_b16 v[178:179], v3 offset:47104
    v_mfma_f32_16x16x32_bf16 v[120:123], v[164:167], v[188:191], v[120:123]
    ds_read_b128 v[204:207], v21 offset:43008
    s_add_u32 m0, s37, 0
    v_mfma_f32_16x16x32_bf16 v[124:127], v[164:167], v[192:195], v[124:127]
    buffer_load_dwordx4 v27, s[16:19], s29 offen lds
    s_add_u32 s29, s29, 1024
    s_waitcnt lgkmcnt(7)
    v_mfma_f32_16x16x32_bf16 v[128:131], v[168:171], v[180:183], v[128:131]
    ds_read_b64_tr_b16 v[160:161], v6 offset:40960
    v_mfma_f32_16x16x32_bf16 v[132:135], v[168:171], v[184:187], v[132:135]
    ds_read_b64_tr_b16 v[162:163], v6 offset:47104
    v_mfma_f32_16x16x32_bf16 v[136:139], v[168:171], v[188:191], v[136:139]
    ds_read_b128 v[208:211], v21 offset:44032
    v_mfma_f32_16x16x32_bf16 v[140:143], v[168:171], v[192:195], v[140:143]
    global_load_dwordx4 a[60:63], v[252:253], off offset:0
    global_load_dwordx4 a[64:67], v[252:253], off offset:1024
    s_waitcnt lgkmcnt(7)
    v_mfma_f32_16x16x32_bf16 v[144:147], v[172:175], v[180:183], v[144:147]
    ds_read_b64_tr_b16 v[164:165], v9 offset:40960
    v_mfma_f32_16x16x32_bf16 v[148:151], v[172:175], v[184:187], v[148:151]
    ds_read_b64_tr_b16 v[166:167], v9 offset:47104
    v_mfma_f32_16x16x32_bf16 v[152:155], v[172:175], v[188:191], v[152:155]
    global_load_dwordx4 a[68:71], v[252:253], off offset:2048
    v_mfma_f32_16x16x32_bf16 v[156:159], v[172:175], v[192:195], v[156:159]
    global_load_dwordx4 a[72:75], v[252:253], off offset:3072
    global_load_dwordx4 a[76:79], v[254:255], off
    v_add_co_u32 v252, s[62:63], s47, v252
    v_add_co_u32 v254, s[94:95], s47, v254
    s_nop 0
    v_addc_co_u32 v253, s[62:63], 0, v253, s[62:63]
    v_addc_co_u32 v255, s[94:95], 0, v255, s[94:95]
    s_waitcnt vmcnt(10)
    s_barrier
    s_waitcnt lgkmcnt(2)
    v_mfma_f32_16x16x32_bf16 v[64:67], v[176:179], v[196:199], v[64:67]
    ds_read_b64_tr_b16 v[168:169], v12 offset:40960
    v_mfma_f32_16x16x32_bf16 v[68:71], v[176:179], v[200:203], v[68:71]
    ds_read_b64_tr_b16 v[170:171], v12 offset:47104
    v_mfma_f32_16x16x32_bf16 v[72:75], v[176:179], v[204:207], v[72:75]
    s_mov_b32 s28, 829440
    v_mfma_f32_16x16x32_bf16 v[76:79], v[176:179], v[208:211], v[76:79]
    s_add_u32 m0, s33, 20480
    s_nop 0
    buffer_load_dwordx4 v23, s[8:11], s28 offen lds
    v_mfma_f32_16x16x32_bf16 v[80:83], v[160:163], v[196:199], v[80:83]
    ds_read_b64_tr_b16 v[172:173], v15 offset:40960
    v_mfma_f32_16x16x32_bf16 v[84:87], v[160:163], v[200:203], v[84:87]
    ds_read_b64_tr_b16 v[174:175], v15 offset:47104
    v_mfma_f32_16x16x32_bf16 v[88:91], v[160:163], v[204:207], v[88:91]
    ds_read_b128 v[180:183], v22 offset:0
    v_mfma_f32_16x16x32_bf16 v[92:95], v[160:163], v[208:211], v[92:95]
    s_add_u32 m0, s34, 20480
    s_nop 0
    buffer_load_dwordx4 v24, s[8:11], s28 offen lds
    s_waitcnt lgkmcnt(5)
    v_mfma_f32_16x16x32_bf16 v[96:99], v[164:167], v[196:199], v[96:99]
    ds_read_b64_tr_b16 v[176:177], v18 offset:40960
    v_mfma_f32_16x16x32_bf16 v[100:103], v[164:167], v[200:203], v[100:103]
    ds_read_b64_tr_b16 v[178:179], v18 offset:47104
    v_mfma_f32_16x16x32_bf16 v[104:107], v[164:167], v[204:207], v[104:107]
    ds_read_b128 v[184:187], v22 offset:1024
    v_mfma_f32_16x16x32_bf16 v[108:111], v[164:167], v[208:211], v[108:111]
    s_add_u32 m0, s35, 20480
    s_nop 0
    buffer_load_dwordx4 v25, s[8:11], s28 offen lds
    s_waitcnt lgkmcnt(6)
    v_mfma_f32_16x16x32_bf16 v[112:115], v[168:171], v[196:199], v[112:115]
    ds_read_b64_tr_b16 v[160:161], v4 offset:0
    v_mfma_f32_16x16x32_bf16 v[116:119], v[168:171], v[200:203], v[116:119]
    ds_read_b64_tr_b16 v[162:163], v4 offset:6144
    v_mfma_f32_16x16x32_bf16 v[120:123], v[168:171], v[204:207], v[120:123]
    ds_read_b128 v[188:191], v22 offset:2048
    v_mfma_f32_16x16x32_bf16 v[124:127], v[168:171], v[208:211], v[124:127]
    s_add_u32 m0, s36, 20480
    s_nop 0
    buffer_load_dwordx4 v26, s[16:19], s29 offen lds
    s_waitcnt lgkmcnt(7)
    v_mfma_f32_16x16x32_bf16 v[128:131], v[172:175], v[196:199], v[128:131]
    ds_read_b64_tr_b16 v[164:165], v7 offset:0
    v_mfma_f32_16x16x32_bf16 v[132:135], v[172:175], v[200:203], v[132:135]
    ds_read_b64_tr_b16 v[166:167], v7 offset:6144
    v_mfma_f32_16x16x32_bf16 v[136:139], v[172:175], v[204:207], v[136:139]
    ds_read_b128 v[192:195], v22 offset:3072
    v_mfma_f32_16x16x32_bf16 v[140:143], v[172:175], v[208:211], v[140:143]
    s_add_u32 m0, s37, 20480
    s_nop 0
    buffer_load_dwordx4 v27, s[16:19], s29 offen lds
    s_waitcnt lgkmcnt(7)
    v_mfma_f32_16x16x32_bf16 v[144:147], v[176:179], v[196:199], v[144:147]
    ds_read_b64_tr_b16 v[168:169], v10 offset:0
    v_mfma_f32_16x16x32_bf16 v[148:151], v[176:179], v[200:203], v[148:151]
    ds_read_b64_tr_b16 v[170:171], v10 offset:6144
    v_mfma_f32_16x16x32_bf16 v[152:155], v[176:179], v[204:207], v[152:155]
    s_add_u32 s29, s29, 1024
    v_mfma_f32_16x16x32_bf16 v[156:159], v[176:179], v[208:211], v[156:159]
    s_waitcnt vmcnt(10)
    s_barrier
    s_waitcnt lgkmcnt(2)
    v_mfma_f32_16x16x32_bf16 v[64:67], v[160:163], v[180:183], v[64:67]
    ds_read_b64_tr_b16 v[172:173], v13 offset:0
    v_mfma_f32_16x16x32_bf16 v[68:71], v[160:163], v[184:187], v[68:71]
    ds_read_b64_tr_b16 v[174:175], v13 offset:6144
    v_mfma_f32_16x16x32_bf16 v[72:75], v[160:163], v[188:191], v[72:75]
    s_mov_b32 s28, 866304
    v_mfma_f32_16x16x32_bf16 v[76:79], v[160:163], v[192:195], v[76:79]
    s_add_u32 m0, s33, 40960
    s_nop 0
    buffer_load_dwordx4 v23, s[8:11], s28 offen lds
    v_mfma_f32_16x16x32_bf16 v[80:83], v[164:167], v[180:183], v[80:83]
    ds_read_b64_tr_b16 v[176:177], v16 offset:0
    v_mfma_f32_16x16x32_bf16 v[84:87], v[164:167], v[184:187], v[84:87]
    ds_read_b64_tr_b16 v[178:179], v16 offset:6144
    v_mfma_f32_16x16x32_bf16 v[88:91], v[164:167], v[188:191], v[88:91]
    ds_read_b128 v[196:199], v20 offset:0
    s_add_u32 m0, s34, 40960
    v_mfma_f32_16x16x32_bf16 v[92:95], v[164:167], v[192:195], v[92:95]
    buffer_load_dwordx4 v24, s[8:11], s28 offen lds
    s_add_u32 m0, s35, 40960
    s_waitcnt lgkmcnt(5)
    v_mfma_f32_16x16x32_bf16 v[96:99], v[168:171], v[180:183], v[96:99]
    ds_read_b64_tr_b16 v[160:161], v19 offset:0
    v_mfma_f32_16x16x32_bf16 v[100:103], v[168:171], v[184:187], v[100:103]
    ds_read_b64_tr_b16 v[162:163], v19 offset:6144
    v_mfma_f32_16x16x32_bf16 v[104:107], v[168:171], v[188:191], v[104:107]
    ds_read_b128 v[200:203], v20 offset:1024
    buffer_load_dwordx4 v25, s[8:11], s28 offen lds
    v_mfma_f32_16x16x32_bf16 v[108:111], v[168:171], v[192:195], v[108:111]
    s_add_u32 m0, s36, 40960
    s_nop 0
    buffer_load_dwordx4 v26, s[16:19], s29 offen lds
    s_waitcnt lgkmcnt(6)
    v_mfma_f32_16x16x32_bf16 v[112:115], v[172:175], v[180:183], v[112:115]
    ds_read_b64_tr_b16 v[164:165], v2 offset:0
    v_mfma_f32_16x16x32_bf16 v[116:119], v[172:175], v[184:187], v[116:119]
    ds_read_b64_tr_b16 v[166:167], v2 offset:6144
    v_mfma_f32_16x16x32_bf16 v[120:123], v[172:175], v[188:191], v[120:123]
    ds_read_b128 v[204:207], v20 offset:2048
    s_add_u32 m0, s37, 40960
    v_mfma_f32_16x16x32_bf16 v[124:127], v[172:175], v[192:195], v[124:127]
    buffer_load_dwordx4 v27, s[16:19], s29 offen lds
    s_add_u32 s29, s29, 1024
    s_waitcnt lgkmcnt(7)
    v_mfma_f32_16x16x32_bf16 v[128:131], v[176:179], v[180:183], v[128:131]
    ds_read_b64_tr_b16 v[168:169], v5 offset:0
    v_mfma_f32_16x16x32_bf16 v[132:135], v[176:179], v[184:187], v[132:135]
    ds_read_b64_tr_b16 v[170:171], v5 offset:6144
    v_mfma_f32_16x16x32_bf16 v[136:139], v[176:179], v[188:191], v[136:139]
    ds_read_b128 v[208:211], v20 offset:3072
    v_mfma_f32_16x16x32_bf16 v[140:143], v[176:179], v[192:195], v[140:143]
    global_load_dwordx4 a[80:83], v[252:253], off offset:0
    global_load_dwordx4 a[84:87], v[252:253], off offset:1024
    s_waitcnt lgkmcnt(7)
    v_mfma_f32_16x16x32_bf16 v[144:147], v[160:163], v[180:183], v[144:147]
    ds_read_b64_tr_b16 v[172:173], v8 offset:0
    v_mfma_f32_16x16x32_bf16 v[148:151], v[160:163], v[184:187], v[148:151]
    ds_read_b64_tr_b16 v[174:175], v8 offset:6144
    v_mfma_f32_16x16x32_bf16 v[152:155], v[160:163], v[188:191], v[152:155]
    global_load_dwordx4 a[88:91], v[252:253], off offset:2048
    v_mfma_f32_16x16x32_bf16 v[156:159], v[160:163], v[192:195], v[156:159]
    global_load_dwordx4 a[92:95], v[252:253], off offset:3072
    global_load_dwordx4 a[96:99], v[254:255], off
    v_add_co_u32 v252, s[62:63], s47, v252
    v_add_co_u32 v254, s[94:95], s47, v254
    s_nop 0
    v_addc_co_u32 v253, s[62:63], 0, v253, s[62:63]
    v_addc_co_u32 v255, s[94:95], 0, v255, s[94:95]
    s_waitcnt vmcnt(10)
    s_barrier
    s_waitcnt lgkmcnt(2)
    v_mfma_f32_16x16x32_bf16 v[64:67], v[164:167], v[196:199], v[64:67]
    ds_read_b64_tr_b16 v[176:177], v11 offset:0
    v_mfma_f32_16x16x32_bf16 v[68:71], v[164:167], v[200:203], v[68:71]
    ds_read_b64_tr_b16 v[178:179], v11 offset:6144
    v_mfma_f32_16x16x32_bf16 v[72:75], v[164:167], v[204:207], v[72:75]
    s_mov_b32 s28, 903168
    v_mfma_f32_16x16x32_bf16 v[76:79], v[164:167], v[208:211], v[76:79]
    s_add_u32 m0, s33, 61440
    s_nop 0
    buffer_load_dwordx4 v23, s[8:11], s28 offen lds
    v_mfma_f32_16x16x32_bf16 v[80:83], v[168:171], v[196:199], v[80:83]
    ds_read_b64_tr_b16 v[160:161], v14 offset:0
    v_mfma_f32_16x16x32_bf16 v[84:87], v[168:171], v[200:203], v[84:87]
    ds_read_b64_tr_b16 v[162:163], v14 offset:6144
    v_mfma_f32_16x16x32_bf16 v[88:91], v[168:171], v[204:207], v[88:91]
    ds_read_b128 v[180:183], v20 offset:20480
    v_mfma_f32_16x16x32_bf16 v[92:95], v[168:171], v[208:211], v[92:95]
    s_add_u32 m0, s34, 61440
    s_nop 0
    buffer_load_dwordx4 v24, s[8:11], s28 offen lds
    s_waitcnt lgkmcnt(5)
    v_mfma_f32_16x16x32_bf16 v[96:99], v[172:175], v[196:199], v[96:99]
    ds_read_b64_tr_b16 v[164:165], v17 offset:0
    v_mfma_f32_16x16x32_bf16 v[100:103], v[172:175], v[200:203], v[100:103]
    ds_read_b64_tr_b16 v[166:167], v17 offset:6144
    v_mfma_f32_16x16x32_bf16 v[104:107], v[172:175], v[204:207], v[104:107]
    ds_read_b128 v[184:187], v20 offset:21504
    v_mfma_f32_16x16x32_bf16 v[108:111], v[172:175], v[208:211], v[108:111]
    s_add_u32 m0, s35, 61440
    s_nop 0
    buffer_load_dwordx4 v25, s[8:11], s28 offen lds
    s_waitcnt lgkmcnt(6)
    v_mfma_f32_16x16x32_bf16 v[112:115], v[176:179], v[196:199], v[112:115]
    ds_read_b64_tr_b16 v[168:169], v2 offset:20480
    v_mfma_f32_16x16x32_bf16 v[116:119], v[176:179], v[200:203], v[116:119]
    ds_read_b64_tr_b16 v[170:171], v2 offset:26624
    v_mfma_f32_16x16x32_bf16 v[120:123], v[176:179], v[204:207], v[120:123]
    ds_read_b128 v[188:191], v20 offset:22528
    v_mfma_f32_16x16x32_bf16 v[124:127], v[176:179], v[208:211], v[124:127]
    s_add_u32 m0, s36, 61440
    s_nop 0
    buffer_load_dwordx4 v26, s[16:19], s29 offen lds
    s_waitcnt lgkmcnt(7)
    v_mfma_f32_16x16x32_bf16 v[128:131], v[160:163], v[196:199], v[128:131]
    ds_read_b64_tr_b16 v[172:173], v5 offset:20480
    v_mfma_f32_16x16x32_bf16 v[132:135], v[160:163], v[200:203], v[132:135]
    ds_read_b64_tr_b16 v[174:175], v5 offset:26624
    v_mfma_f32_16x16x32_bf16 v[136:139], v[160:163], v[204:207], v[136:139]
    ds_read_b128 v[192:195], v20 offset:23552
    v_mfma_f32_16x16x32_bf16 v[140:143], v[160:163], v[208:211], v[140:143]
    s_add_u32 m0, s37, 61440
    s_nop 0
    buffer_load_dwordx4 v27, s[16:19], s29 offen lds
    s_waitcnt lgkmcnt(7)
    v_mfma_f32_16x16x32_bf16 v[144:147], v[164:167], v[196:199], v[144:147]
    ds_read_b64_tr_b16 v[176:177], v8 offset:20480
    v_mfma_f32_16x16x32_bf16 v[148:151], v[164:167], v[200:203], v[148:151]
    ds_read_b64_tr_b16 v[178:179], v8 offset:26624
    v_mfma_f32_16x16x32_bf16 v[152:155], v[164:167], v[204:207], v[152:155]
    s_add_u32 s29, s29, 1024
    v_mfma_f32_16x16x32_bf16 v[156:159], v[164:167], v[208:211], v[156:159]
    s_waitcnt vmcnt(10)
    s_barrier
    s_waitcnt lgkmcnt(2)
    v_mfma_f32_16x16x32_bf16 v[64:67], v[168:171], v[180:183], v[64:67]
    ds_read_b64_tr_b16 v[160:161], v11 offset:20480
    v_mfma_f32_16x16x32_bf16 v[68:71], v[168:171], v[184:187], v[68:71]
    ds_read_b64_tr_b16 v[162:163], v11 offset:26624
    v_mfma_f32_16x16x32_bf16 v[72:75], v[168:171], v[188:191], v[72:75]
    s_mov_b32 s28, 940032
    v_mfma_f32_16x16x32_bf16 v[76:79], v[168:171], v[192:195], v[76:79]
    s_add_u32 m0, s33, 81920
    s_nop 0
    buffer_load_dwordx4 v23, s[8:11], s28 offen lds
    v_mfma_f32_16x16x32_bf16 v[80:83], v[172:175], v[180:183], v[80:83]
    ds_read_b64_tr_b16 v[164:165], v14 offset:20480
    v_mfma_f32_16x16x32_bf16 v[84:87], v[172:175], v[184:187], v[84:87]
    ds_read_b64_tr_b16 v[166:167], v14 offset:26624
    v_mfma_f32_16x16x32_bf16 v[88:91], v[172:175], v[188:191], v[88:91]
    ds_read_b128 v[196:199], v20 offset:40960
    s_add_u32 m0, s34, 81920
    v_mfma_f32_16x16x32_bf16 v[92:95], v[172:175], v[192:195], v[92:95]
    buffer_load_dwordx4 v24, s[8:11], s28 offen lds
    s_add_u32 m0, s35, 81920
    s_waitcnt lgkmcnt(5)
    v_mfma_f32_16x16x32_bf16 v[96:99], v[176:179], v[180:183], v[96:99]
    ds_read_b64_tr_b16 v[168:169], v17 offset:20480
    v_mfma_f32_16x16x32_bf16 v[100:103], v[176:179], v[184:187], v[100:103]
    ds_read_b64_tr_b16 v[170:171], v17 offset:26624
    v_mfma_f32_16x16x32_bf16 v[104:107], v[176:179], v[188:191], v[104:107]
    ds_read_b128 v[200:203], v20 offset:41984
    buffer_load_dwordx4 v25, s[8:11], s28 offen lds
    v_mfma_f32_16x16x32_bf16 v[108:111], v[176:179], v[192:195], v[108:111]
    s_add_u32 m0, s36, 81920
    s_nop 0
    buffer_load_dwordx4 v26, s[16:19], s29 offen lds
    s_waitcnt lgkmcnt(6)
    v_mfma_f32_16x16x32_bf16 v[112:115], v[160:163], v[180:183], v[112:115]
    ds_read_b64_tr_b16 v[172:173], v2 offset:40960
    v_mfma_f32_16x16x32_bf16 v[116:119], v[160:163], v[184:187], v[116:119]
    ds_read_b64_tr_b16 v[174:175], v2 offset:47104
    v_mfma_f32_16x16x32_bf16 v[120:123], v[160:163], v[188:191], v[120:123]
    ds_read_b128 v[204:207], v20 offset:43008
    s_add_u32 m0, s37, 81920
    v_mfma_f32_16x16x32_bf16 v[124:127], v[160:163], v[192:195], v[124:127]
    buffer_load_dwordx4 v27, s[16:19], s29 offen lds
    s_add_u32 s29, s29, 1024
    s_waitcnt lgkmcnt(7)
    v_mfma_f32_16x16x32_bf16 v[128:131], v[164:167], v[180:183], v[128:131]
    ds_read_b64_tr_b16 v[176:177], v5 offset:40960
    v_mfma_f32_16x16x32_bf16 v[132:135], v[164:167], v[184:187], v[132:135]
    ds_read_b64_tr_b16 v[178:179], v5 offset:47104
    v_mfma_f32_16x16x32_bf16 v[136:139], v[164:167], v[188:191], v[136:139]
    ds_read_b128 v[208:211], v20 offset:44032
    v_mfma_f32_16x16x32_bf16 v[140:143], v[164:167], v[192:195], v[140:143]
    global_load_dwordx4 a[100:103], v[252:253], off offset:0
    global_load_dwordx4 a[104:107], v[252:253], off offset:1024
    s_waitcnt lgkmcnt(7)
    v_mfma_f32_16x16x32_bf16 v[144:147], v[168:171], v[180:183], v[144:147]
    ds_read_b64_tr_b16 v[160:161], v8 offset:40960
    v_mfma_f32_16x16x32_bf16 v[148:151], v[168:171], v[184:187], v[148:151]
    ds_read_b64_tr_b16 v[162:163], v8 offset:47104
    v_mfma_f32_16x16x32_bf16 v[152:155], v[168:171], v[188:191], v[152:155]
    global_load_dwordx4 a[108:111], v[252:253], off offset:2048
    v_mfma_f32_16x16x32_bf16 v[156:159], v[168:171], v[192:195], v[156:159]
    global_load_dwordx4 a[112:115], v[252:253], off offset:3072
    global_load_dwordx4 a[116:119], v[254:255], off
    v_add_co_u32 v252, s[62:63], s47, v252
    v_add_co_u32 v254, s[94:95], s47, v254
    s_nop 0
    v_addc_co_u32 v253, s[62:63], 0, v253, s[62:63]
    v_addc_co_u32 v255, s[94:95], 0, v255, s[94:95]
    s_waitcnt vmcnt(10)
    s_barrier
    s_waitcnt lgkmcnt(2)
    v_mfma_f32_16x16x32_bf16 v[64:67], v[172:175], v[196:199], v[64:67]
    ds_read_b64_tr_b16 v[164:165], v11 offset:40960
    v_mfma_f32_16x16x32_bf16 v[68:71], v[172:175], v[200:203], v[68:71]
    ds_read_b64_tr_b16 v[166:167], v11 offset:47104
    v_mfma_f32_16x16x32_bf16 v[72:75], v[172:175], v[204:207], v[72:75]
    s_mov_b32 s28, 811008
    v_mfma_f32_16x16x32_bf16 v[76:79], v[172:175], v[208:211], v[76:79]
    s_add_u32 m0, s33, 102400
    s_nop 0
    buffer_load_dwordx4 v29, s[8:11], s28 offen lds
    v_mfma_f32_16x16x32_bf16 v[80:83], v[176:179], v[196:199], v[80:83]
    ds_read_b64_tr_b16 v[168:169], v14 offset:40960
    v_mfma_f32_16x16x32_bf16 v[84:87], v[176:179], v[200:203], v[84:87]
    ds_read_b64_tr_b16 v[170:171], v14 offset:47104
    v_mfma_f32_16x16x32_bf16 v[88:91], v[176:179], v[204:207], v[88:91]
    ds_read_b128 v[180:183], v21 offset:0
    v_mfma_f32_16x16x32_bf16 v[92:95], v[176:179], v[208:211], v[92:95]
    s_add_u32 m0, s34, 102400
    s_nop 0
    buffer_load_dwordx4 v30, s[8:11], s28 offen lds
    s_waitcnt lgkmcnt(5)
    v_mfma_f32_16x16x32_bf16 v[96:99], v[160:163], v[196:199], v[96:99]
    ds_read_b64_tr_b16 v[172:173], v17 offset:40960
    v_mfma_f32_16x16x32_bf16 v[100:103], v[160:163], v[200:203], v[100:103]
    ds_read_b64_tr_b16 v[174:175], v17 offset:47104
    v_mfma_f32_16x16x32_bf16 v[104:107], v[160:163], v[204:207], v[104:107]
    ds_read_b128 v[184:187], v21 offset:1024
    v_mfma_f32_16x16x32_bf16 v[108:111], v[160:163], v[208:211], v[108:111]
    s_add_u32 m0, s35, 102400
    s_nop 0
    buffer_load_dwordx4 v31, s[8:11], s28 offen lds
    s_waitcnt lgkmcnt(6)
    v_mfma_f32_16x16x32_bf16 v[112:115], v[164:167], v[196:199], v[112:115]
    ds_read_b64_tr_b16 v[176:177], v3 offset:0
    v_mfma_f32_16x16x32_bf16 v[116:119], v[164:167], v[200:203], v[116:119]
    ds_read_b64_tr_b16 v[178:179], v3 offset:6144
    v_mfma_f32_16x16x32_bf16 v[120:123], v[164:167], v[204:207], v[120:123]
    ds_read_b128 v[188:191], v21 offset:2048
    v_mfma_f32_16x16x32_bf16 v[124:127], v[164:167], v[208:211], v[124:127]
    s_add_u32 m0, s36, 102400
    s_nop 0
    buffer_load_dwordx4 v26, s[16:19], s29 offen lds
    s_waitcnt lgkmcnt(7)
    v_mfma_f32_16x16x32_bf16 v[128:131], v[168:171], v[196:199], v[128:131]
    ds_read_b64_tr_b16 v[160:161], v6 offset:0
    v_mfma_f32_16x16x32_bf16 v[132:135], v[168:171], v[200:203], v[132:135]
    ds_read_b64_tr_b16 v[162:163], v6 offset:6144
    v_mfma_f32_16x16x32_bf16 v[136:139], v[168:171], v[204:207], v[136:139]
    ds_read_b128 v[192:195], v21 offset:3072
    v_mfma_f32_16x16x32_bf16 v[140:143], v[168:171], v[208:211], v[140:143]
    s_add_u32 m0, s37, 102400
    s_nop 0
    buffer_load_dwordx4 v27, s[16:19], s29 offen lds
    s_waitcnt lgkmcnt(7)
    v_mfma_f32_16x16x32_bf16 v[144:147], v[172:175], v[196:199], v[144:147]
    ds_read_b64_tr_b16 v[164:165], v9 offset:0
    v_mfma_f32_16x16x32_bf16 v[148:151], v[172:175], v[200:203], v[148:151]
    ds_read_b64_tr_b16 v[166:167], v9 offset:6144
    v_mfma_f32_16x16x32_bf16 v[152:155], v[172:175], v[204:207], v[152:155]
    s_add_u32 s29, s29, 1024
    v_mfma_f32_16x16x32_bf16 v[156:159], v[172:175], v[208:211], v[156:159]
    s_waitcnt vmcnt(10)
    s_barrier
    s_waitcnt lgkmcnt(2)
    v_mfma_f32_16x16x32_bf16 v[64:67], v[176:179], v[180:183], v[64:67]
    ds_read_b64_tr_b16 v[168:169], v12 offset:0
    v_mfma_f32_16x16x32_bf16 v[68:71], v[176:179], v[184:187], v[68:71]
    ds_read_b64_tr_b16 v[170:171], v12 offset:6144
    v_mfma_f32_16x16x32_bf16 v[72:75], v[176:179], v[188:191], v[72:75]
    s_mov_b32 s28, 995328
    v_mfma_f32_16x16x32_bf16 v[76:79], v[176:179], v[192:195], v[76:79]
    s_add_u32 m0, s33, 122880
    s_nop 0
    buffer_load_dwordx4 v23, s[8:11], s28 offen lds
    v_mfma_f32_16x16x32_bf16 v[80:83], v[160:163], v[180:183], v[80:83]
    ds_read_b64_tr_b16 v[172:173], v15 offset:0
    v_mfma_f32_16x16x32_bf16 v[84:87], v[160:163], v[184:187], v[84:87]
    ds_read_b64_tr_b16 v[174:175], v15 offset:6144
    v_mfma_f32_16x16x32_bf16 v[88:91], v[160:163], v[188:191], v[88:91]
    ds_read_b128 v[196:199], v21 offset:20480
    s_add_u32 m0, s34, 122880
    v_mfma_f32_16x16x32_bf16 v[92:95], v[160:163], v[192:195], v[92:95]
    buffer_load_dwordx4 v24, s[8:11], s28 offen lds
    s_add_u32 m0, s35, 122880
    s_waitcnt lgkmcnt(5)
    v_mfma_f32_16x16x32_bf16 v[96:99], v[164:167], v[180:183], v[96:99]
    ds_read_b64_tr_b16 v[176:177], v18 offset:0
    v_mfma_f32_16x16x32_bf16 v[100:103], v[164:167], v[184:187], v[100:103]
    ds_read_b64_tr_b16 v[178:179], v18 offset:6144
    v_mfma_f32_16x16x32_bf16 v[104:107], v[164:167], v[188:191], v[104:107]
    ds_read_b128 v[200:203], v21 offset:21504
    buffer_load_dwordx4 v25, s[8:11], s28 offen lds
    v_mfma_f32_16x16x32_bf16 v[108:111], v[164:167], v[192:195], v[108:111]
    s_add_u32 m0, s36, 122880
    s_nop 0
    buffer_load_dwordx4 v26, s[16:19], s29 offen lds
    s_waitcnt lgkmcnt(6)
    v_mfma_f32_16x16x32_bf16 v[112:115], v[168:171], v[180:183], v[112:115]
    ds_read_b64_tr_b16 v[160:161], v3 offset:20480
    v_mfma_f32_16x16x32_bf16 v[116:119], v[168:171], v[184:187], v[116:119]
    ds_read_b64_tr_b16 v[162:163], v3 offset:26624
    v_mfma_f32_16x16x32_bf16 v[120:123], v[168:171], v[188:191], v[120:123]
    ds_read_b128 v[204:207], v21 offset:22528
    s_add_u32 m0, s37, 122880
    v_mfma_f32_16x16x32_bf16 v[124:127], v[168:171], v[192:195], v[124:127]
    buffer_load_dwordx4 v27, s[16:19], s29 offen lds
    s_add_u32 s29, s29, 1024
    s_waitcnt lgkmcnt(7)
    v_mfma_f32_16x16x32_bf16 v[128:131], v[172:175], v[180:183], v[128:131]
    ds_read_b64_tr_b16 v[164:165], v6 offset:20480
    v_mfma_f32_16x16x32_bf16 v[132:135], v[172:175], v[184:187], v[132:135]
    ds_read_b64_tr_b16 v[166:167], v6 offset:26624
    v_mfma_f32_16x16x32_bf16 v[136:139], v[172:175], v[188:191], v[136:139]
    ds_read_b128 v[208:211], v21 offset:23552
    v_mfma_f32_16x16x32_bf16 v[140:143], v[172:175], v[192:195], v[140:143]
    global_load_dwordx4 a[120:123], v[252:253], off offset:0
    global_load_dwordx4 a[124:127], v[252:253], off offset:1024
    s_waitcnt lgkmcnt(7)
    v_mfma_f32_16x16x32_bf16 v[144:147], v[176:179], v[180:183], v[144:147]
    ds_read_b64_tr_b16 v[168:169], v9 offset:20480
    v_mfma_f32_16x16x32_bf16 v[148:151], v[176:179], v[184:187], v[148:151]
    ds_read_b64_tr_b16 v[170:171], v9 offset:26624
    v_mfma_f32_16x16x32_bf16 v[152:155], v[176:179], v[188:191], v[152:155]
    global_load_dwordx4 a[128:131], v[252:253], off offset:2048
    v_mfma_f32_16x16x32_bf16 v[156:159], v[176:179], v[192:195], v[156:159]
    global_load_dwordx4 a[132:135], v[252:253], off offset:3072
    global_load_dwordx4 a[136:139], v[254:255], off
    v_add_co_u32 v252, s[62:63], s47, v252
    v_add_co_u32 v254, s[94:95], s47, v254
    s_nop 0
    v_addc_co_u32 v253, s[62:63], 0, v253, s[62:63]
    v_addc_co_u32 v255, s[94:95], 0, v255, s[94:95]
    s_waitcnt vmcnt(10)
    s_barrier
    s_waitcnt lgkmcnt(2)
    v_mfma_f32_16x16x32_bf16 v[64:67], v[160:163], v[196:199], v[64:67]
    ds_read_b64_tr_b16 v[172:173], v12 offset:20480
    v_mfma_f32_16x16x32_bf16 v[68:71], v[160:163], v[200:203], v[68:71]
    ds_read_b64_tr_b16 v[174:175], v12 offset:26624
    v_mfma_f32_16x16x32_bf16 v[72:75], v[160:163], v[204:207], v[72:75]
    s_mov_b32 s28, 1032192
    v_mfma_f32_16x16x32_bf16 v[76:79], v[160:163], v[208:211], v[76:79]
    s_add_u32 m0, s33, 0
    s_nop 0
    buffer_load_dwordx4 v23, s[8:11], s28 offen lds
    v_mfma_f32_16x16x32_bf16 v[80:83], v[164:167], v[196:199], v[80:83]
    ds_read_b64_tr_b16 v[176:177], v15 offset:20480
    v_mfma_f32_16x16x32_bf16 v[84:87], v[164:167], v[200:203], v[84:87]
    ds_read_b64_tr_b16 v[178:179], v15 offset:26624
    v_mfma_f32_16x16x32_bf16 v[88:91], v[164:167], v[204:207], v[88:91]
    ds_read_b128 v[180:183], v21 offset:40960
    v_mfma_f32_16x16x32_bf16 v[92:95], v[164:167], v[208:211], v[92:95]
    s_add_u32 m0, s34, 0
    s_nop 0
    buffer_load_dwordx4 v24, s[8:11], s28 offen lds
    s_waitcnt lgkmcnt(5)
    v_mfma_f32_16x16x32_bf16 v[96:99], v[168:171], v[196:199], v[96:99]
    ds_read_b64_tr_b16 v[160:161], v18 offset:20480
    v_mfma_f32_16x16x32_bf16 v[100:103], v[168:171], v[200:203], v[100:103]
    ds_read_b64_tr_b16 v[162:163], v18 offset:26624
    v_mfma_f32_16x16x32_bf16 v[104:107], v[168:171], v[204:207], v[104:107]
    ds_read_b128 v[184:187], v21 offset:41984
    v_mfma_f32_16x16x32_bf16 v[108:111], v[168:171], v[208:211], v[108:111]
    s_add_u32 m0, s35, 0
    s_nop 0
    buffer_load_dwordx4 v25, s[8:11], s28 offen lds
    s_waitcnt lgkmcnt(6)
    v_mfma_f32_16x16x32_bf16 v[112:115], v[172:175], v[196:199], v[112:115]
    ds_read_b64_tr_b16 v[164:165], v3 offset:40960
    v_mfma_f32_16x16x32_bf16 v[116:119], v[172:175], v[200:203], v[116:119]
    ds_read_b64_tr_b16 v[166:167], v3 offset:47104
    v_mfma_f32_16x16x32_bf16 v[120:123], v[172:175], v[204:207], v[120:123]
    ds_read_b128 v[188:191], v21 offset:43008
    v_mfma_f32_16x16x32_bf16 v[124:127], v[172:175], v[208:211], v[124:127]
    s_add_u32 m0, s36, 0
    s_nop 0
    buffer_load_dwordx4 v26, s[16:19], s29 offen lds
    s_waitcnt lgkmcnt(7)
    v_mfma_f32_16x16x32_bf16 v[128:131], v[176:179], v[196:199], v[128:131]
    ds_read_b64_tr_b16 v[168:169], v6 offset:40960
    v_mfma_f32_16x16x32_bf16 v[132:135], v[176:179], v[200:203], v[132:135]
    ds_read_b64_tr_b16 v[170:171], v6 offset:47104
    v_mfma_f32_16x16x32_bf16 v[136:139], v[176:179], v[204:207], v[136:139]
    ds_read_b128 v[192:195], v21 offset:44032
    v_mfma_f32_16x16x32_bf16 v[140:143], v[176:179], v[208:211], v[140:143]
    s_add_u32 m0, s37, 0
    s_nop 0
    buffer_load_dwordx4 v27, s[16:19], s29 offen lds
    s_waitcnt lgkmcnt(7)
    v_mfma_f32_16x16x32_bf16 v[144:147], v[160:163], v[196:199], v[144:147]
    ds_read_b64_tr_b16 v[172:173], v9 offset:40960
    v_mfma_f32_16x16x32_bf16 v[148:151], v[160:163], v[200:203], v[148:151]
    ds_read_b64_tr_b16 v[174:175], v9 offset:47104
    v_mfma_f32_16x16x32_bf16 v[152:155], v[160:163], v[204:207], v[152:155]
    s_add_u32 s29, s29, 1024
    v_mfma_f32_16x16x32_bf16 v[156:159], v[160:163], v[208:211], v[156:159]
    s_waitcnt vmcnt(10)
    s_barrier
    s_waitcnt lgkmcnt(2)
    v_mfma_f32_16x16x32_bf16 v[64:67], v[164:167], v[180:183], v[64:67]
    ds_read_b64_tr_b16 v[176:177], v12 offset:40960
    v_mfma_f32_16x16x32_bf16 v[68:71], v[164:167], v[184:187], v[68:71]
    ds_read_b64_tr_b16 v[178:179], v12 offset:47104
    v_mfma_f32_16x16x32_bf16 v[72:75], v[164:167], v[188:191], v[72:75]
    s_mov_b32 s28, 1069056
    v_mfma_f32_16x16x32_bf16 v[76:79], v[164:167], v[192:195], v[76:79]
    s_add_u32 m0, s33, 20480
    s_nop 0
    buffer_load_dwordx4 v23, s[8:11], s28 offen lds
    v_mfma_f32_16x16x32_bf16 v[80:83], v[168:171], v[180:183], v[80:83]
    ds_read_b64_tr_b16 v[160:161], v15 offset:40960
    v_mfma_f32_16x16x32_bf16 v[84:87], v[168:171], v[184:187], v[84:87]
    ds_read_b64_tr_b16 v[162:163], v15 offset:47104
    v_mfma_f32_16x16x32_bf16 v[88:91], v[168:171], v[188:191], v[88:91]
    ds_read_b128 v[196:199], v22 offset:0
    s_add_u32 m0, s34, 20480
    v_mfma_f32_16x16x32_bf16 v[92:95], v[168:171], v[192:195], v[92:95]
    buffer_load_dwordx4 v24, s[8:11], s28 offen lds
    s_add_u32 m0, s35, 20480
    s_waitcnt lgkmcnt(5)
    v_mfma_f32_16x16x32_bf16 v[96:99], v[172:175], v[180:183], v[96:99]
    ds_read_b64_tr_b16 v[164:165], v18 offset:40960
    v_mfma_f32_16x16x32_bf16 v[100:103], v[172:175], v[184:187], v[100:103]
    ds_read_b64_tr_b16 v[166:167], v18 offset:47104
    v_mfma_f32_16x16x32_bf16 v[104:107], v[172:175], v[188:191], v[104:107]
    ds_read_b128 v[200:203], v22 offset:1024
    buffer_load_dwordx4 v25, s[8:11], s28 offen lds
    v_mfma_f32_16x16x32_bf16 v[108:111], v[172:175], v[192:195], v[108:111]
    s_add_u32 m0, s36, 20480
    s_nop 0
    buffer_load_dwordx4 v26, s[16:19], s29 offen lds
    s_waitcnt lgkmcnt(6)
    v_mfma_f32_16x16x32_bf16 v[112:115], v[176:179], v[180:183], v[112:115]
    ds_read_b64_tr_b16 v[168:169], v4 offset:0
    v_mfma_f32_16x16x32_bf16 v[116:119], v[176:179], v[184:187], v[116:119]
    ds_read_b64_tr_b16 v[170:171], v4 offset:6144
    v_mfma_f32_16x16x32_bf16 v[120:123], v[176:179], v[188:191], v[120:123]
    ds_read_b128 v[204:207], v22 offset:2048
    s_add_u32 m0, s37, 20480
    v_mfma_f32_16x16x32_bf16 v[124:127], v[176:179], v[192:195], v[124:127]
    buffer_load_dwordx4 v27, s[16:19], s29 offen lds
    s_add_u32 s29, s29, 1024
    s_waitcnt lgkmcnt(7)
    v_mfma_f32_16x16x32_bf16 v[128:131], v[160:163], v[180:183], v[128:131]
    ds_read_b64_tr_b16 v[172:173], v7 offset:0
    v_mfma_f32_16x16x32_bf16 v[132:135], v[160:163], v[184:187], v[132:135]
    ds_read_b64_tr_b16 v[174:175], v7 offset:6144
    v_mfma_f32_16x16x32_bf16 v[136:139], v[160:163], v[188:191], v[136:139]
    ds_read_b128 v[208:211], v22 offset:3072
    v_mfma_f32_16x16x32_bf16 v[140:143], v[160:163], v[192:195], v[140:143]
    global_load_dwordx4 a[140:143], v[252:253], off offset:0
    global_load_dwordx4 a[144:147], v[252:253], off offset:1024
    s_waitcnt lgkmcnt(7)
    v_mfma_f32_16x16x32_bf16 v[144:147], v[164:167], v[180:183], v[144:147]
    ds_read_b64_tr_b16 v[176:177], v10 offset:0
    v_mfma_f32_16x16x32_bf16 v[148:151], v[164:167], v[184:187], v[148:151]
    ds_read_b64_tr_b16 v[178:179], v10 offset:6144
    v_mfma_f32_16x16x32_bf16 v[152:155], v[164:167], v[188:191], v[152:155]
    global_load_dwordx4 a[148:151], v[252:253], off offset:2048
    v_mfma_f32_16x16x32_bf16 v[156:159], v[164:167], v[192:195], v[156:159]
    global_load_dwordx4 a[152:155], v[252:253], off offset:3072
    global_load_dwordx4 a[156:159], v[254:255], off
    v_add_co_u32 v252, s[62:63], s47, v252
    v_add_co_u32 v254, s[94:95], s47, v254
    s_nop 0
    v_addc_co_u32 v253, s[62:63], 0, v253, s[62:63]
    v_addc_co_u32 v255, s[94:95], 0, v255, s[94:95]
    s_waitcnt vmcnt(10)
    s_barrier
    s_waitcnt lgkmcnt(2)
    v_mfma_f32_16x16x32_bf16 v[64:67], v[168:171], v[196:199], v[64:67]
    ds_read_b64_tr_b16 v[160:161], v13 offset:0
    v_mfma_f32_16x16x32_bf16 v[68:71], v[168:171], v[200:203], v[68:71]
    ds_read_b64_tr_b16 v[162:163], v13 offset:6144
    v_mfma_f32_16x16x32_bf16 v[72:75], v[168:171], v[204:207], v[72:75]
    s_mov_b32 s28, 1105920
    v_mfma_f32_16x16x32_bf16 v[76:79], v[168:171], v[208:211], v[76:79]
    s_add_u32 m0, s33, 40960
    s_nop 0
    buffer_load_dwordx4 v23, s[8:11], s28 offen lds
    v_mfma_f32_16x16x32_bf16 v[80:83], v[172:175], v[196:199], v[80:83]
    ds_read_b64_tr_b16 v[164:165], v16 offset:0
    v_mfma_f32_16x16x32_bf16 v[84:87], v[172:175], v[200:203], v[84:87]
    ds_read_b64_tr_b16 v[166:167], v16 offset:6144
    v_mfma_f32_16x16x32_bf16 v[88:91], v[172:175], v[204:207], v[88:91]
    ds_read_b128 v[180:183], v20 offset:0
    v_mfma_f32_16x16x32_bf16 v[92:95], v[172:175], v[208:211], v[92:95]
    s_add_u32 m0, s34, 40960
    s_nop 0
    buffer_load_dwordx4 v24, s[8:11], s28 offen lds
    s_waitcnt lgkmcnt(5)
    v_mfma_f32_16x16x32_bf16 v[96:99], v[176:179], v[196:199], v[96:99]
    ds_read_b64_tr_b16 v[168:169], v19 offset:0
    v_mfma_f32_16x16x32_bf16 v[100:103], v[176:179], v[200:203], v[100:103]
    ds_read_b64_tr_b16 v[170:171], v19 offset:6144
    v_mfma_f32_16x16x32_bf16 v[104:107], v[176:179], v[204:207], v[104:107]
    ds_read_b128 v[184:187], v20 offset:1024
    v_mfma_f32_16x16x32_bf16 v[108:111], v[176:179], v[208:211], v[108:111]
    s_add_u32 m0, s35, 40960
    s_nop 0
    buffer_load_dwordx4 v25, s[8:11], s28 offen lds
    s_waitcnt lgkmcnt(6)
    v_mfma_f32_16x16x32_bf16 v[112:115], v[160:163], v[196:199], v[112:115]
    ds_read_b64_tr_b16 v[172:173], v2 offset:0
    v_mfma_f32_16x16x32_bf16 v[116:119], v[160:163], v[200:203], v[116:119]
    ds_read_b64_tr_b16 v[174:175], v2 offset:6144
    v_mfma_f32_16x16x32_bf16 v[120:123], v[160:163], v[204:207], v[120:123]
    ds_read_b128 v[188:191], v20 offset:2048
    v_mfma_f32_16x16x32_bf16 v[124:127], v[160:163], v[208:211], v[124:127]
    s_add_u32 m0, s36, 40960
    s_nop 0
    buffer_load_dwordx4 v26, s[16:19], s29 offen lds
    s_waitcnt lgkmcnt(7)
    v_mfma_f32_16x16x32_bf16 v[128:131], v[164:167], v[196:199], v[128:131]
    ds_read_b64_tr_b16 v[176:177], v5 offset:0
    v_mfma_f32_16x16x32_bf16 v[132:135], v[164:167], v[200:203], v[132:135]
    ds_read_b64_tr_b16 v[178:179], v5 offset:6144
    v_mfma_f32_16x16x32_bf16 v[136:139], v[164:167], v[204:207], v[136:139]
    ds_read_b128 v[192:195], v20 offset:3072
    v_mfma_f32_16x16x32_bf16 v[140:143], v[164:167], v[208:211], v[140:143]
    s_add_u32 m0, s37, 40960
    s_nop 0
    buffer_load_dwordx4 v27, s[16:19], s29 offen lds
    s_waitcnt lgkmcnt(7)
    v_mfma_f32_16x16x32_bf16 v[144:147], v[168:171], v[196:199], v[144:147]
    ds_read_b64_tr_b16 v[160:161], v8 offset:0
    v_mfma_f32_16x16x32_bf16 v[148:151], v[168:171], v[200:203], v[148:151]
    ds_read_b64_tr_b16 v[162:163], v8 offset:6144
    v_mfma_f32_16x16x32_bf16 v[152:155], v[168:171], v[204:207], v[152:155]
    s_add_u32 s29, s29, 1024
    v_mfma_f32_16x16x32_bf16 v[156:159], v[168:171], v[208:211], v[156:159]
    s_waitcnt vmcnt(10)
    s_barrier
    s_waitcnt lgkmcnt(2)
    v_mfma_f32_16x16x32_bf16 v[64:67], v[172:175], v[180:183], v[64:67]
    ds_read_b64_tr_b16 v[164:165], v11 offset:0
    v_mfma_f32_16x16x32_bf16 v[68:71], v[172:175], v[184:187], v[68:71]
    ds_read_b64_tr_b16 v[166:167], v11 offset:6144
    v_mfma_f32_16x16x32_bf16 v[72:75], v[172:175], v[188:191], v[72:75]
    s_mov_b32 s28, 1161216
    v_mfma_f32_16x16x32_bf16 v[76:79], v[172:175], v[192:195], v[76:79]
    s_add_u32 m0, s33, 61440
    s_nop 0
    buffer_load_dwordx4 v23, s[8:11], s28 offen lds
    v_mfma_f32_16x16x32_bf16 v[80:83], v[176:179], v[180:183], v[80:83]
    ds_read_b64_tr_b16 v[168:169], v14 offset:0
    v_mfma_f32_16x16x32_bf16 v[84:87], v[176:179], v[184:187], v[84:87]
    ds_read_b64_tr_b16 v[170:171], v14 offset:6144
    v_mfma_f32_16x16x32_bf16 v[88:91], v[176:179], v[188:191], v[88:91]
    ds_read_b128 v[196:199], v20 offset:20480
    s_add_u32 m0, s34, 61440
    v_mfma_f32_16x16x32_bf16 v[92:95], v[176:179], v[192:195], v[92:95]
    buffer_load_dwordx4 v24, s[8:11], s28 offen lds
    s_add_u32 m0, s35, 61440
    s_waitcnt lgkmcnt(5)
    v_mfma_f32_16x16x32_bf16 v[96:99], v[160:163], v[180:183], v[96:99]
    ds_read_b64_tr_b16 v[172:173], v17 offset:0
    v_mfma_f32_16x16x32_bf16 v[100:103], v[160:163], v[184:187], v[100:103]
    ds_read_b64_tr_b16 v[174:175], v17 offset:6144
    v_mfma_f32_16x16x32_bf16 v[104:107], v[160:163], v[188:191], v[104:107]
    ds_read_b128 v[200:203], v20 offset:21504
    buffer_load_dwordx4 v25, s[8:11], s28 offen lds
    v_mfma_f32_16x16x32_bf16 v[108:111], v[160:163], v[192:195], v[108:111]
    s_add_u32 m0, s36, 61440
    s_nop 0
    buffer_load_dwordx4 v26, s[16:19], s29 offen lds
    s_waitcnt lgkmcnt(6)
    v_mfma_f32_16x16x32_bf16 v[112:115], v[164:167], v[180:183], v[112:115]
    ds_read_b64_tr_b16 v[176:177], v2 offset:20480
    v_mfma_f32_16x16x32_bf16 v[116:119], v[164:167], v[184:187], v[116:119]
    ds_read_b64_tr_b16 v[178:179], v2 offset:26624
    v_mfma_f32_16x16x32_bf16 v[120:123], v[164:167], v[188:191], v[120:123]
    ds_read_b128 v[204:207], v20 offset:22528
    s_add_u32 m0, s37, 61440
    v_mfma_f32_16x16x32_bf16 v[124:127], v[164:167], v[192:195], v[124:127]
    buffer_load_dwordx4 v27, s[16:19], s29 offen lds
    s_add_u32 s29, s29, 1024
    s_waitcnt lgkmcnt(7)
    v_mfma_f32_16x16x32_bf16 v[128:131], v[168:171], v[180:183], v[128:131]
    ds_read_b64_tr_b16 v[160:161], v5 offset:20480
    v_mfma_f32_16x16x32_bf16 v[132:135], v[168:171], v[184:187], v[132:135]
    ds_read_b64_tr_b16 v[162:163], v5 offset:26624
    v_mfma_f32_16x16x32_bf16 v[136:139], v[168:171], v[188:191], v[136:139]
    ds_read_b128 v[208:211], v20 offset:23552
    global_load_dwordx4 a[160:163], v[252:253], off offset:0
    v_mfma_f32_16x16x32_bf16 v[140:143], v[168:171], v[192:195], v[140:143]
    global_load_dwordx4 a[164:167], v[252:253], off offset:1024
    global_load_dwordx4 a[168:171], v[252:253], off offset:2048
    s_waitcnt lgkmcnt(7)
    v_mfma_f32_16x16x32_bf16 v[144:147], v[172:175], v[180:183], v[144:147]
    ds_read_b64_tr_b16 v[164:165], v8 offset:20480
    v_mfma_f32_16x16x32_bf16 v[148:151], v[172:175], v[184:187], v[148:151]
    ds_read_b64_tr_b16 v[166:167], v8 offset:26624
    v_mfma_f32_16x16x32_bf16 v[152:155], v[172:175], v[188:191], v[152:155]
    global_load_dwordx4 a[172:175], v[252:253], off offset:3072
    v_mfma_f32_16x16x32_bf16 v[156:159], v[172:175], v[192:195], v[156:159]
    global_load_dwordx4 a[176:179], v[254:255], off
    s_lshr_b32 s55, s2, 3
    s_lshl_b32 s55, s55, 2
    s_add_u32 s55, s55, s52
    s_mul_i32 s55, s55, 24
    v_mbcnt_lo_u32_b32 v36, -1, 0
    v_mbcnt_hi_u32_b32 v36, -1, v36
    v_cmp_gt_u32 s[62:63], 24, v36
    v_add_u32 v36, s55, v36
    s_mov_b32 s55, 0x1c71c71d
    v_mul_hi_u32 v37, v36, s55
    v_mul_u32_u24 v38, 9, v37
    v_sub_u32 v38, v36, v38
    v_lshrrev_b32 v36, 5, v37
    v_and_b32 v37, 31, v37
    v_lshl_add_u32 v36, v37, 5, v36
    s_and_b32 s55, s2, 7
    s_and_b32 s56, s55, 3
    s_lshl_b32 s56, s56, 3
    s_lshr_b32 s55, s55, 2
    s_lshl_b32 s55, s55, 10
    s_add_u32 s55, s55, s56
    v_add_u32 v36, s55, v36
    v_mul_u32_u24 v36, 1152, v36
    v_lshl_add_u32 v36, v38, 7, v36
    v_mov_b32 v37, 2130706432
    s_mov_b32 s56, s96
    s_and_b32 s57, s97, 0xffff
    s_mov_b32 s58, 2359296
    s_mov_b32 s59, 0x20000
    v_cndmask_b32 v36, v37, v36, s[62:63]
    buffer_load_dword a201, v36, s[56:59], 0 offen
    s_waitcnt vmcnt(11)
    s_barrier
    s_waitcnt lgkmcnt(2)
    v_mfma_f32_16x16x32_bf16 v[64:67], v[176:179], v[196:199], v[64:67]
    ds_read_b64_tr_b16 v[168:169], v11 offset:20480
    v_mfma_f32_16x16x32_bf16 v[68:71], v[176:179], v[200:203], v[68:71]
    ds_read_b64_tr_b16 v[170:171], v11 offset:26624
    v_mfma_f32_16x16x32_bf16 v[72:75], v[176:179], v[204:207], v[72:75]
    s_mov_b32 s28, 1198080
    v_mfma_f32_16x16x32_bf16 v[76:79], v[176:179], v[208:211], v[76:79]
    s_add_u32 m0, s33, 81920
    s_nop 0
    buffer_load_dwordx4 v23, s[8:11], s28 offen lds
    v_mfma_f32_16x16x32_bf16 v[80:83], v[160:163], v[196:199], v[80:83]
    ds_read_b64_tr_b16 v[172:173], v14 offset:20480
    v_mfma_f32_16x16x32_bf16 v[84:87], v[160:163], v[200:203], v[84:87]
    ds_read_b64_tr_b16 v[174:175], v14 offset:26624
    v_mfma_f32_16x16x32_bf16 v[88:91], v[160:163], v[204:207], v[88:91]
    ds_read_b128 v[180:183], v20 offset:40960
    v_mfma_f32_16x16x32_bf16 v[92:95], v[160:163], v[208:211], v[92:95]
    s_add_u32 m0, s34, 81920
    s_nop 0
    buffer_load_dwordx4 v24, s[8:11], s28 offen lds
    s_waitcnt lgkmcnt(5)
    v_mfma_f32_16x16x32_bf16 v[96:99], v[164:167], v[196:199], v[96:99]
    ds_read_b64_tr_b16 v[176:177], v17 offset:20480
    v_mfma_f32_16x16x32_bf16 v[100:103], v[164:167], v[200:203], v[100:103]
    ds_read_b64_tr_b16 v[178:179], v17 offset:26624
    v_mfma_f32_16x16x32_bf16 v[104:107], v[164:167], v[204:207], v[104:107]
    ds_read_b128 v[184:187], v20 offset:41984
    v_mfma_f32_16x16x32_bf16 v[108:111], v[164:167], v[208:211], v[108:111]
    s_add_u32 m0, s35, 81920
    s_nop 0
    buffer_load_dwordx4 v25, s[8:11], s28 offen lds
    s_waitcnt lgkmcnt(6)
    v_mfma_f32_16x16x32_bf16 v[112:115], v[168:171], v[196:199], v[112:115]
    ds_read_b64_tr_b16 v[160:161], v2 offset:40960
    v_mfma_f32_16x16x32_bf16 v[116:119], v[168:171], v[200:203], v[116:119]
    ds_read_b64_tr_b16 v[162:163], v2 offset:47104
    v_mfma_f32_16x16x32_bf16 v[120:123], v[168:171], v[204:207], v[120:123]
    ds_read_b128 v[188:191], v20 offset:43008
    v_mfma_f32_16x16x32_bf16 v[124:127], v[168:171], v[208:211], v[124:127]
    s_add_u32 m0, s36, 81920
    s_nop 0
    buffer_load_dwordx4 v26, s[16:19], s29 offen lds
    s_waitcnt lgkmcnt(7)
    v_mfma_f32_16x16x32_bf16 v[128:131], v[172:175], v[196:199], v[128:131]
    ds_read_b64_tr_b16 v[164:165], v5 offset:40960
    v_mfma_f32_16x16x32_bf16 v[132:135], v[172:175], v[200:203], v[132:135]
    ds_read_b64_tr_b16 v[166:167], v5 offset:47104
    v_mfma_f32_16x16x32_bf16 v[136:139], v[172:175], v[204:207], v[136:139]
    ds_read_b128 v[192:195], v20 offset:44032
    v_mfma_f32_16x16x32_bf16 v[140:143], v[172:175], v[208:211], v[140:143]
    s_add_u32 m0, s37, 81920
    s_nop 0
    buffer_load_dwordx4 v27, s[16:19], s29 offen lds
    s_waitcnt lgkmcnt(7)
    v_mfma_f32_16x16x32_bf16 v[144:147], v[176:179], v[196:199], v[144:147]
    ds_read_b64_tr_b16 v[168:169], v8 offset:40960
    v_mfma_f32_16x16x32_bf16 v[148:151], v[176:179], v[200:203], v[148:151]
    ds_read_b64_tr_b16 v[170:171], v8 offset:47104
    v_mfma_f32_16x16x32_bf16 v[152:155], v[176:179], v[204:207], v[152:155]
    s_add_u32 s29, s29, 1024
    v_mfma_f32_16x16x32_bf16 v[156:159], v[176:179], v[208:211], v[156:159]
    s_waitcnt vmcnt(11)
    s_barrier
    s_waitcnt lgkmcnt(2)
    v_mfma_f32_16x16x32_bf16 v[64:67], v[160:163], v[180:183], v[64:67]
    ds_read_b64_tr_b16 v[172:173], v11 offset:40960
    v_mfma_f32_16x16x32_bf16 v[68:71], v[160:163], v[184:187], v[68:71]
    ds_read_b64_tr_b16 v[174:175], v11 offset:47104
    v_mfma_f32_16x16x32_bf16 v[72:75], v[160:163], v[188:191], v[72:75]
    s_mov_b32 s28, 1234944
    v_mfma_f32_16x16x32_bf16 v[76:79], v[160:163], v[192:195], v[76:79]
    s_add_u32 m0, s33, 102400
    s_nop 0
    buffer_load_dwordx4 v23, s[8:11], s28 offen lds
    v_mfma_f32_16x16x32_bf16 v[80:83], v[164:167], v[180:183], v[80:83]
    ds_read_b64_tr_b16 v[176:177], v14 offset:40960
    v_mfma_f32_16x16x32_bf16 v[84:87], v[164:167], v[184:187], v[84:87]
    ds_read_b64_tr_b16 v[178:179], v14 offset:47104
    v_mfma_f32_16x16x32_bf16 v[88:91], v[164:167], v[188:191], v[88:91]
    ds_read_b128 v[196:199], v21 offset:0
    s_add_u32 m0, s34, 102400
    v_mfma_f32_16x16x32_bf16 v[92:95], v[164:167], v[192:195], v[92:95]
    buffer_load_dwordx4 v24, s[8:11], s28 offen lds
    s_add_u32 m0, s35, 102400
    s_waitcnt lgkmcnt(5)
    v_mfma_f32_16x16x32_bf16 v[96:99], v[168:171], v[180:183], v[96:99]
    ds_read_b64_tr_b16 v[160:161], v17 offset:40960
    v_mfma_f32_16x16x32_bf16 v[100:103], v[168:171], v[184:187], v[100:103]
    ds_read_b64_tr_b16 v[162:163], v17 offset:47104
    v_mfma_f32_16x16x32_bf16 v[104:107], v[168:171], v[188:191], v[104:107]
    ds_read_b128 v[200:203], v21 offset:1024
    v_mfma_f32_16x16x32_bf16 v[108:111], v[168:171], v[192:195], v[108:111]
    buffer_load_dwordx4 v25, s[8:11], s28 offen lds
    s_add_u32 m0, s36, 102400
    s_waitcnt lgkmcnt(6)
    v_mfma_f32_16x16x32_bf16 v[112:115], v[172:175], v[180:183], v[112:115]
    ds_read_b64_tr_b16 v[164:165], v3 offset:0
    v_mfma_f32_16x16x32_bf16 v[116:119], v[172:175], v[184:187], v[116:119]
    ds_read_b64_tr_b16 v[166:167], v3 offset:6144
    v_mfma_f32_16x16x32_bf16 v[120:123], v[172:175], v[188:191], v[120:123]
    ds_read_b128 v[204:207], v21 offset:2048
    v_mfma_f32_16x16x32_bf16 v[124:127], v[172:175], v[192:195], v[124:127]
    buffer_load_dwordx4 v26, s[16:19], s29 offen lds
    s_add_u32 m0, s37, 102400
    s_waitcnt lgkmcnt(7)
    v_mfma_f32_16x16x32_bf16 v[128:131], v[176:179], v[180:183], v[128:131]
    ds_read_b64_tr_b16 v[168:169], v6 offset:0
    v_mfma_f32_16x16x32_bf16 v[132:135], v[176:179], v[184:187], v[132:135]
    ds_read_b64_tr_b16 v[170:171], v6 offset:6144
    v_mfma_f32_16x16x32_bf16 v[136:139], v[176:179], v[188:191], v[136:139]
    ds_read_b128 v[208:211], v21 offset:3072
    v_mfma_f32_16x16x32_bf16 v[140:143], v[176:179], v[192:195], v[140:143]
    buffer_load_dwordx4 v27, s[16:19], s29 offen lds
    s_add_u32 s29, s29, 1024
    s_waitcnt lgkmcnt(7)
    v_mfma_f32_16x16x32_bf16 v[144:147], v[160:163], v[180:183], v[144:147]
    ds_read_b64_tr_b16 v[172:173], v9 offset:0
    v_mfma_f32_16x16x32_bf16 v[148:151], v[160:163], v[184:187], v[148:151]
    ds_read_b64_tr_b16 v[174:175], v9 offset:6144
    v_mfma_f32_16x16x32_bf16 v[152:155], v[160:163], v[188:191], v[152:155]
    s_and_b32 s79, s2, 31
    v_mfma_f32_16x16x32_bf16 v[156:159], v[160:163], v[192:195], v[156:159]
    s_lshl_b32 s79, s79, 7
    s_add_u32 s79, s79, 11077632
    v_mov_b32 v254, s79
    s_waitcnt vmcnt(5)
    s_barrier
    s_waitcnt lgkmcnt(2)
    v_mfma_f32_16x16x32_bf16 v[64:67], v[164:167], v[196:199], v[64:67]
    ds_read_b64_tr_b16 v[176:177], v12 offset:0
    v_mfma_f32_16x16x32_bf16 v[68:71], v[164:167], v[200:203], v[68:71]
    ds_read_b64_tr_b16 v[178:179], v12 offset:6144
    v_mfma_f32_16x16x32_bf16 v[72:75], v[164:167], v[204:207], v[72:75]
    s_mov_b32 s28, 1271808
    v_mfma_f32_16x16x32_bf16 v[76:79], v[164:167], v[208:211], v[76:79]
    s_add_u32 m0, s33, 122880
    s_nop 0
    buffer_load_dwordx4 v23, s[8:11], s28 offen lds
    v_mfma_f32_16x16x32_bf16 v[80:83], v[168:171], v[196:199], v[80:83]
    ds_read_b64_tr_b16 v[160:161], v15 offset:0
    v_mfma_f32_16x16x32_bf16 v[84:87], v[168:171], v[200:203], v[84:87]
    ds_read_b64_tr_b16 v[162:163], v15 offset:6144
    v_mfma_f32_16x16x32_bf16 v[88:91], v[168:171], v[204:207], v[88:91]
    ds_read_b128 v[180:183], v21 offset:20480
    v_mfma_f32_16x16x32_bf16 v[92:95], v[168:171], v[208:211], v[92:95]
    s_add_u32 m0, s34, 122880
    s_nop 0
    buffer_load_dwordx4 v24, s[8:11], s28 offen lds
    s_waitcnt lgkmcnt(5)
    v_mfma_f32_16x16x32_bf16 v[96:99], v[172:175], v[196:199], v[96:99]
    ds_read_b64_tr_b16 v[164:165], v18 offset:0
    v_mfma_f32_16x16x32_bf16 v[100:103], v[172:175], v[200:203], v[100:103]
    ds_read_b64_tr_b16 v[166:167], v18 offset:6144
    v_mfma_f32_16x16x32_bf16 v[104:107], v[172:175], v[204:207], v[104:107]
    ds_read_b128 v[184:187], v21 offset:21504
    v_mfma_f32_16x16x32_bf16 v[108:111], v[172:175], v[208:211], v[108:111]
    s_add_u32 m0, s35, 122880
    s_nop 0
    buffer_load_dwordx4 v25, s[8:11], s28 offen lds
    s_waitcnt lgkmcnt(6)
    v_mfma_f32_16x16x32_bf16 v[112:115], v[176:179], v[196:199], v[112:115]
    ds_read_b64_tr_b16 v[168:169], v3 offset:20480
    v_mfma_f32_16x16x32_bf16 v[116:119], v[176:179], v[200:203], v[116:119]
    ds_read_b64_tr_b16 v[170:171], v3 offset:26624
    v_mfma_f32_16x16x32_bf16 v[120:123], v[176:179], v[204:207], v[120:123]
    ds_read_b128 v[188:191], v21 offset:22528
    v_mfma_f32_16x16x32_bf16 v[124:127], v[176:179], v[208:211], v[124:127]
    s_add_u32 m0, s36, 122880
    s_nop 0
    buffer_load_dwordx4 v26, s[16:19], s29 offen lds
    s_waitcnt lgkmcnt(7)
    v_mfma_f32_16x16x32_bf16 v[128:131], v[160:163], v[196:199], v[128:131]
    ds_read_b64_tr_b16 v[172:173], v6 offset:20480
    v_mfma_f32_16x16x32_bf16 v[132:135], v[160:163], v[200:203], v[132:135]
    ds_read_b64_tr_b16 v[174:175], v6 offset:26624
    v_mfma_f32_16x16x32_bf16 v[136:139], v[160:163], v[204:207], v[136:139]
    ds_read_b128 v[192:195], v21 offset:23552
    v_mfma_f32_16x16x32_bf16 v[140:143], v[160:163], v[208:211], v[140:143]
    s_add_u32 m0, s37, 122880
    s_nop 0
    buffer_load_dwordx4 v27, s[16:19], s29 offen lds
    s_waitcnt lgkmcnt(7)
    v_mfma_f32_16x16x32_bf16 v[144:147], v[164:167], v[196:199], v[144:147]
    ds_read_b64_tr_b16 v[176:177], v9 offset:20480
    v_mfma_f32_16x16x32_bf16 v[148:151], v[164:167], v[200:203], v[148:151]
    ds_read_b64_tr_b16 v[178:179], v9 offset:26624
    v_mfma_f32_16x16x32_bf16 v[152:155], v[164:167], v[204:207], v[152:155]
    s_add_u32 s29, s29, 1024
    v_mfma_f32_16x16x32_bf16 v[156:159], v[164:167], v[208:211], v[156:159]
    s_waitcnt vmcnt(5)
    s_barrier
    s_waitcnt lgkmcnt(2)
    v_mfma_f32_16x16x32_bf16 v[64:67], v[168:171], v[180:183], v[64:67]
    ds_read_b64_tr_b16 v[160:161], v12 offset:20480
    v_mfma_f32_16x16x32_bf16 v[68:71], v[168:171], v[184:187], v[68:71]
    ds_read_b64_tr_b16 v[162:163], v12 offset:26624
    v_mfma_f32_16x16x32_bf16 v[72:75], v[168:171], v[188:191], v[72:75]
    s_mov_b32 s28, 1142784
    v_mfma_f32_16x16x32_bf16 v[76:79], v[168:171], v[192:195], v[76:79]
    s_add_u32 m0, s33, 0
    s_nop 0
    buffer_load_dwordx4 v29, s[8:11], s28 offen lds
    v_mfma_f32_16x16x32_bf16 v[80:83], v[172:175], v[180:183], v[80:83]
    ds_read_b64_tr_b16 v[164:165], v15 offset:20480
    v_mfma_f32_16x16x32_bf16 v[84:87], v[172:175], v[184:187], v[84:87]
    ds_read_b64_tr_b16 v[166:167], v15 offset:26624
    v_mfma_f32_16x16x32_bf16 v[88:91], v[172:175], v[188:191], v[88:91]
    ds_read_b128 v[196:199], v21 offset:40960
    v_mfma_f32_16x16x32_bf16 v[92:95], v[172:175], v[192:195], v[92:95]
    s_add_u32 m0, s34, 0
    s_nop 0
    buffer_load_dwordx4 v30, s[8:11], s28 offen lds
    s_waitcnt lgkmcnt(5)
    v_mfma_f32_16x16x32_bf16 v[96:99], v[176:179], v[180:183], v[96:99]
    ds_read_b64_tr_b16 v[168:169], v18 offset:20480
    v_mfma_f32_16x16x32_bf16 v[100:103], v[176:179], v[184:187], v[100:103]
    ds_read_b64_tr_b16 v[170:171], v18 offset:26624
    v_mfma_f32_16x16x32_bf16 v[104:107], v[176:179], v[188:191], v[104:107]
    ds_read_b128 v[200:203], v21 offset:41984
    v_mfma_f32_16x16x32_bf16 v[108:111], v[176:179], v[192:195], v[108:111]
    s_add_u32 m0, s35, 0
    s_nop 0
    buffer_load_dwordx4 v31, s[8:11], s28 offen lds
    s_waitcnt lgkmcnt(6)
    v_mfma_f32_16x16x32_bf16 v[112:115], v[160:163], v[180:183], v[112:115]
    ds_read_b64_tr_b16 v[172:173], v3 offset:40960
    v_mfma_f32_16x16x32_bf16 v[116:119], v[160:163], v[184:187], v[116:119]
    ds_read_b64_tr_b16 v[174:175], v3 offset:47104
    v_mfma_f32_16x16x32_bf16 v[120:123], v[160:163], v[188:191], v[120:123]
    ds_read_b128 v[204:207], v21 offset:43008
    v_mfma_f32_16x16x32_bf16 v[124:127], v[160:163], v[192:195], v[124:127]
    s_add_u32 m0, s36, 0
    s_nop 0
    buffer_load_dwordx4 v26, s[16:19], s29 offen lds
    s_waitcnt lgkmcnt(7)
    v_mfma_f32_16x16x32_bf16 v[128:131], v[164:167], v[180:183], v[128:131]
    ds_read_b64_tr_b16 v[176:177], v6 offset:40960
    v_mfma_f32_16x16x32_bf16 v[132:135], v[164:167], v[184:187], v[132:135]
    ds_read_b64_tr_b16 v[178:179], v6 offset:47104
    v_mfma_f32_16x16x32_bf16 v[136:139], v[164:167], v[188:191], v[136:139]
    ds_read_b128 v[208:211], v21 offset:44032
    v_mfma_f32_16x16x32_bf16 v[140:143], v[164:167], v[192:195], v[140:143]
    s_add_u32 m0, s37, 0
    s_nop 0
    buffer_load_dwordx4 v27, s[16:19], s29 offen lds
    s_waitcnt lgkmcnt(7)
    v_mfma_f32_16x16x32_bf16 v[144:147], v[168:171], v[180:183], v[144:147]
    ds_read_b64_tr_b16 v[160:161], v9 offset:40960
    v_mfma_f32_16x16x32_bf16 v[148:151], v[168:171], v[184:187], v[148:151]
    ds_read_b64_tr_b16 v[162:163], v9 offset:47104
    v_mfma_f32_16x16x32_bf16 v[152:155], v[168:171], v[188:191], v[152:155]
    s_add_u32 s29, s29, 1024
    v_mfma_f32_16x16x32_bf16 v[156:159], v[168:171], v[192:195], v[156:159]
    s_waitcnt vmcnt(5)
    s_barrier
    s_waitcnt lgkmcnt(2)
    v_mfma_f32_16x16x32_bf16 v[64:67], v[172:175], v[196:199], v[64:67]
    ds_read_b64_tr_b16 v[164:165], v12 offset:40960
    v_mfma_f32_16x16x32_bf16 v[68:71], v[172:175], v[200:203], v[68:71]
    ds_read_b64_tr_b16 v[166:167], v12 offset:47104
    v_mfma_f32_16x16x32_bf16 v[72:75], v[172:175], v[204:207], v[72:75]
    v_mfma_f32_16x16x32_bf16 v[76:79], v[172:175], v[208:211], v[76:79]
    v_mfma_f32_16x16x32_bf16 v[80:83], v[176:179], v[196:199], v[80:83]
    ds_read_b64_tr_b16 v[168:169], v15 offset:40960
    v_mfma_f32_16x16x32_bf16 v[84:87], v[176:179], v[200:203], v[84:87]
    ds_read_b64_tr_b16 v[170:171], v15 offset:47104
    v_mfma_f32_16x16x32_bf16 v[88:91], v[176:179], v[204:207], v[88:91]
    ds_read_b128 v[180:183], v22 offset:0
    v_mfma_f32_16x16x32_bf16 v[92:95], v[176:179], v[208:211], v[92:95]
    s_waitcnt lgkmcnt(5)
    v_mfma_f32_16x16x32_bf16 v[96:99], v[160:163], v[196:199], v[96:99]
    ds_read_b64_tr_b16 v[172:173], v18 offset:40960
    v_mfma_f32_16x16x32_bf16 v[100:103], v[160:163], v[200:203], v[100:103]
    ds_read_b64_tr_b16 v[174:175], v18 offset:47104
    v_mfma_f32_16x16x32_bf16 v[104:107], v[160:163], v[204:207], v[104:107]
    ds_read_b128 v[184:187], v22 offset:1024
    v_mfma_f32_16x16x32_bf16 v[108:111], v[160:163], v[208:211], v[108:111]
    s_waitcnt lgkmcnt(6)
    v_mfma_f32_16x16x32_bf16 v[112:115], v[164:167], v[196:199], v[112:115]
    ds_read_b64_tr_b16 v[176:177], v4 offset:0
    v_mfma_f32_16x16x32_bf16 v[116:119], v[164:167], v[200:203], v[116:119]
    ds_read_b64_tr_b16 v[178:179], v4 offset:6144
    v_mfma_f32_16x16x32_bf16 v[120:123], v[164:167], v[204:207], v[120:123]
    ds_read_b128 v[188:191], v22 offset:2048
    v_mfma_f32_16x16x32_bf16 v[124:127], v[164:167], v[208:211], v[124:127]
    s_waitcnt lgkmcnt(7)
    v_mfma_f32_16x16x32_bf16 v[128:131], v[168:171], v[196:199], v[128:131]
    ds_read_b64_tr_b16 v[160:161], v7 offset:0
    v_mfma_f32_16x16x32_bf16 v[132:135], v[168:171], v[200:203], v[132:135]
    ds_read_b64_tr_b16 v[162:163], v7 offset:6144
    v_mfma_f32_16x16x32_bf16 v[136:139], v[168:171], v[204:207], v[136:139]
    ds_read_b128 v[192:195], v22 offset:3072
    v_mfma_f32_16x16x32_bf16 v[140:143], v[168:171], v[208:211], v[140:143]
    s_waitcnt lgkmcnt(7)
    v_mfma_f32_16x16x32_bf16 v[144:147], v[172:175], v[196:199], v[144:147]
    ds_read_b64_tr_b16 v[164:165], v10 offset:0
    v_mfma_f32_16x16x32_bf16 v[148:151], v[172:175], v[200:203], v[148:151]
    ds_read_b64_tr_b16 v[166:167], v10 offset:6144
    v_mfma_f32_16x16x32_bf16 v[152:155], v[172:175], v[204:207], v[152:155]
    v_mfma_f32_16x16x32_bf16 v[156:159], v[172:175], v[208:211], v[156:159]
    s_waitcnt vmcnt(0)
    s_barrier
    s_waitcnt lgkmcnt(2)
    v_mfma_f32_16x16x32_bf16 v[64:67], v[176:179], v[180:183], v[64:67]
    ds_read_b64_tr_b16 v[168:169], v13 offset:0
    v_mfma_f32_16x16x32_bf16 v[68:71], v[176:179], v[184:187], v[68:71]
    ds_read_b64_tr_b16 v[170:171], v13 offset:6144
    v_mfma_f32_16x16x32_bf16 v[72:75], v[176:179], v[188:191], v[72:75]
    v_mfma_f32_16x16x32_bf16 v[76:79], v[176:179], v[192:195], v[76:79]
    v_mfma_f32_16x16x32_bf16 v[80:83], v[160:163], v[180:183], v[80:83]
    ds_read_b64_tr_b16 v[172:173], v16 offset:0
    v_mfma_f32_16x16x32_bf16 v[84:87], v[160:163], v[184:187], v[84:87]
    ds_read_b64_tr_b16 v[174:175], v16 offset:6144
    v_mfma_f32_16x16x32_bf16 v[88:91], v[160:163], v[188:191], v[88:91]
    ds_read_b128 v[196:199], v20 offset:0
    v_mfma_f32_16x16x32_bf16 v[92:95], v[160:163], v[192:195], v[92:95]
    s_waitcnt lgkmcnt(5)
    v_mfma_f32_16x16x32_bf16 v[96:99], v[164:167], v[180:183], v[96:99]
    ds_read_b64_tr_b16 v[176:177], v19 offset:0
    v_mfma_f32_16x16x32_bf16 v[100:103], v[164:167], v[184:187], v[100:103]
    ds_read_b64_tr_b16 v[178:179], v19 offset:6144
    v_mfma_f32_16x16x32_bf16 v[104:107], v[164:167], v[188:191], v[104:107]
    ds_read_b128 v[200:203], v20 offset:1024
    v_mfma_f32_16x16x32_bf16 v[108:111], v[164:167], v[192:195], v[108:111]
    s_waitcnt lgkmcnt(6)
    v_mfma_f32_16x16x32_bf16 v[112:115], v[168:171], v[180:183], v[112:115]
    ds_read_b64_tr_b16 v[160:161], v2 offset:0
    v_mfma_f32_16x16x32_bf16 v[116:119], v[168:171], v[184:187], v[116:119]
    ds_read_b64_tr_b16 v[162:163], v2 offset:6144
    v_mfma_f32_16x16x32_bf16 v[120:123], v[168:171], v[188:191], v[120:123]
    ds_read_b128 v[204:207], v20 offset:2048
    v_mfma_f32_16x16x32_bf16 v[124:127], v[168:171], v[192:195], v[124:127]
    s_waitcnt lgkmcnt(7)
    v_mfma_f32_16x16x32_bf16 v[128:131], v[172:175], v[180:183], v[128:131]
    ds_read_b64_tr_b16 v[164:165], v5 offset:0
    v_mfma_f32_16x16x32_bf16 v[132:135], v[172:175], v[184:187], v[132:135]
    ds_read_b64_tr_b16 v[166:167], v5 offset:6144
    v_mfma_f32_16x16x32_bf16 v[136:139], v[172:175], v[188:191], v[136:139]
    ds_read_b128 v[208:211], v20 offset:3072
    v_mfma_f32_16x16x32_bf16 v[140:143], v[172:175], v[192:195], v[140:143]
    s_waitcnt lgkmcnt(7)
    v_mfma_f32_16x16x32_bf16 v[144:147], v[176:179], v[180:183], v[144:147]
    ds_read_b64_tr_b16 v[168:169], v8 offset:0
    v_mfma_f32_16x16x32_bf16 v[148:151], v[176:179], v[184:187], v[148:151]
    ds_read_b64_tr_b16 v[170:171], v8 offset:6144
    v_mfma_f32_16x16x32_bf16 v[152:155], v[176:179], v[188:191], v[152:155]
    v_mfma_f32_16x16x32_bf16 v[156:159], v[176:179], v[192:195], v[156:159]
    s_waitcnt lgkmcnt(2)
    v_mfma_f32_16x16x32_bf16 v[64:67], v[160:163], v[196:199], v[64:67]
    ds_read_b64_tr_b16 v[172:173], v11 offset:0
    v_mfma_f32_16x16x32_bf16 v[68:71], v[160:163], v[200:203], v[68:71]
    ds_read_b64_tr_b16 v[174:175], v11 offset:6144
    v_mfma_f32_16x16x32_bf16 v[72:75], v[160:163], v[204:207], v[72:75]
    buffer_load_dword v253, v254, s[16:19], 0 offen sc1
    v_mfma_f32_16x16x32_bf16 v[76:79], v[160:163], v[208:211], v[76:79]
    v_mfma_f32_16x16x32_bf16 v[80:83], v[164:167], v[196:199], v[80:83]
    ds_read_b64_tr_b16 v[176:177], v14 offset:0
    v_mfma_f32_16x16x32_bf16 v[84:87], v[164:167], v[200:203], v[84:87]
    ds_read_b64_tr_b16 v[178:179], v14 offset:6144
    v_mfma_f32_16x16x32_bf16 v[88:91], v[164:167], v[204:207], v[88:91]
    v_mfma_f32_16x16x32_bf16 v[92:95], v[164:167], v[208:211], v[92:95]
    s_waitcnt lgkmcnt(4)
    v_mfma_f32_16x16x32_bf16 v[96:99], v[168:171], v[196:199], v[96:99]
    ds_read_b64_tr_b16 v[160:161], v17 offset:0
    v_mfma_f32_16x16x32_bf16 v[100:103], v[168:171], v[200:203], v[100:103]
    ds_read_b64_tr_b16 v[162:163], v17 offset:6144
    v_mfma_f32_16x16x32_bf16 v[104:107], v[168:171], v[204:207], v[104:107]
    v_mfma_f32_16x16x32_bf16 v[108:111], v[168:171], v[208:211], v[108:111]
    s_waitcnt lgkmcnt(4)
    v_mfma_f32_16x16x32_bf16 v[112:115], v[172:175], v[196:199], v[112:115]
    v_mfma_f32_16x16x32_bf16 v[116:119], v[172:175], v[200:203], v[116:119]
    v_mfma_f32_16x16x32_bf16 v[120:123], v[172:175], v[204:207], v[120:123]
    v_mfma_f32_16x16x32_bf16 v[124:127], v[172:175], v[208:211], v[124:127]
    s_waitcnt lgkmcnt(2)
    v_mfma_f32_16x16x32_bf16 v[128:131], v[176:179], v[196:199], v[128:131]
    v_mfma_f32_16x16x32_bf16 v[132:135], v[176:179], v[200:203], v[132:135]
    v_mfma_f32_16x16x32_bf16 v[136:139], v[176:179], v[204:207], v[136:139]
    v_mfma_f32_16x16x32_bf16 v[140:143], v[176:179], v[208:211], v[140:143]
    s_waitcnt lgkmcnt(0)
    v_mfma_f32_16x16x32_bf16 v[144:147], v[160:163], v[196:199], v[144:147]
    v_mfma_f32_16x16x32_bf16 v[148:151], v[160:163], v[200:203], v[148:151]
    v_mfma_f32_16x16x32_bf16 v[152:155], v[160:163], v[204:207], v[152:155]
    v_mfma_f32_16x16x32_bf16 v[156:159], v[160:163], v[208:211], v[156:159]
    s_waitcnt vmcnt(0)
    v_readfirstlane_b32 s30, v253
    s_mov_b32 s89, 0
    s_nop 2
    s_cmp_lt_u32 s30, 37
    s_cbranch_scc1 K2_noy
    s_mov_b32 s89, 1
    s_mov_b32 s46, 0
    buffer_load_dwordx4 v[212:215], v48, s[16:19], s46 offen sc1
    s_mov_b32 s46, 256
    buffer_load_dwordx4 v[216:219], v48, s[16:19], s46 offen sc1
    s_mov_b32 s46, 131072
    buffer_load_dwordx4 v[220:223], v48, s[16:19], s46 offen sc1
    s_mov_b32 s46, 131328
    buffer_load_dwordx4 v[224:227], v48, s[16:19], s46 offen sc1
    s_mov_b32 s46, 262144
    buffer_load_dwordx4 v[228:231], v48, s[16:19], s46 offen sc1
    s_mov_b32 s46, 262400
    buffer_load_dwordx4 v[232:235], v48, s[16:19], s46 offen sc1
    s_mov_b32 s46, 393216
    buffer_load_dwordx4 v[236:239], v48, s[16:19], s46 offen sc1
    s_mov_b32 s46, 393472
    buffer_load_dwordx4 v[240:243], v48, s[16:19], s46 offen sc1
    buffer_load_dwordx4 v[244:247], v49, s[16:19], 0 offen offset:0 sc1
    buffer_load_dwordx4 v[248:251], v49, s[16:19], 0 offen offset:256 sc1
    s_branch K2_ydone
K2_noy:
    buffer_load_dword v253, v254, s[16:19], 0 offen sc1
K2_ydone:
    s_nop 7
    v_cvt_pk_bf16_f32 v32, v64, v65
    v_cvt_pk_bf16_f32 v33, v66, v67
    v_cvt_pk_bf16_f32 v34, v68, v69
    v_cvt_pk_bf16_f32 v35, v70, v71
    s_mov_b32 s43, 0
    buffer_store_dwordx2 v[32:33], v28, s[16:19], s43 offen sc1
    s_mov_b32 s43, 18432
    buffer_store_dwordx2 v[34:35], v28, s[16:19], s43 offen sc1
    v_cvt_pk_bf16_f32 v36, v72, v73
    v_cvt_pk_bf16_f32 v37, v74, v75
    v_cvt_pk_bf16_f32 v38, v76, v77
    v_cvt_pk_bf16_f32 v39, v78, v79
    s_mov_b32 s43, 36864
    buffer_store_dwordx2 v[36:37], v28, s[16:19], s43 offen sc1
    s_mov_b32 s43, 55296
    buffer_store_dwordx2 v[38:39], v28, s[16:19], s43 offen sc1
    v_cvt_pk_bf16_f32 v40, v80, v81
    v_cvt_pk_bf16_f32 v41, v82, v83
    v_cvt_pk_bf16_f32 v42, v84, v85
    v_cvt_pk_bf16_f32 v43, v86, v87
    s_mov_b32 s43, 512
    buffer_store_dwordx2 v[40:41], v28, s[16:19], s43 offen sc1
    s_mov_b32 s43, 18944
    buffer_store_dwordx2 v[42:43], v28, s[16:19], s43 offen sc1
    v_cvt_pk_bf16_f32 v44, v88, v89
    v_cvt_pk_bf16_f32 v45, v90, v91
    v_cvt_pk_bf16_f32 v46, v92, v93
    v_cvt_pk_bf16_f32 v47, v94, v95
    s_mov_b32 s43, 37376
    buffer_store_dwordx2 v[44:45], v28, s[16:19], s43 offen sc1
    s_mov_b32 s43, 55808
    buffer_store_dwordx2 v[46:47], v28, s[16:19], s43 offen sc1
    v_cvt_pk_bf16_f32 v32, v96, v97
    v_cvt_pk_bf16_f32 v33, v98, v99
    v_cvt_pk_bf16_f32 v34, v100, v101
    v_cvt_pk_bf16_f32 v35, v102, v103
    s_mov_b32 s43, 1024
    buffer_store_dwordx2 v[32:33], v28, s[16:19], s43 offen sc1
    s_mov_b32 s43, 19456
    buffer_store_dwordx2 v[34:35], v28, s[16:19], s43 offen sc1
    v_cvt_pk_bf16_f32 v36, v104, v105
    v_cvt_pk_bf16_f32 v37, v106, v107
    v_cvt_pk_bf16_f32 v38, v108, v109
    v_cvt_pk_bf16_f32 v39, v110, v111
    s_mov_b32 s43, 37888
    buffer_store_dwordx2 v[36:37], v28, s[16:19], s43 offen sc1
    s_mov_b32 s43, 56320
    buffer_store_dwordx2 v[38:39], v28, s[16:19], s43 offen sc1
    v_cvt_pk_bf16_f32 v40, v112, v113
    v_cvt_pk_bf16_f32 v41, v114, v115
    v_cvt_pk_bf16_f32 v42, v116, v117
    v_cvt_pk_bf16_f32 v43, v118, v119
    s_mov_b32 s43, 1536
    buffer_store_dwordx2 v[40:41], v28, s[16:19], s43 offen sc1
    s_mov_b32 s43, 19968
    buffer_store_dwordx2 v[42:43], v28, s[16:19], s43 offen sc1
    v_cvt_pk_bf16_f32 v44, v120, v121
    v_cvt_pk_bf16_f32 v45, v122, v123
    v_cvt_pk_bf16_f32 v46, v124, v125
    v_cvt_pk_bf16_f32 v47, v126, v127
    s_mov_b32 s43, 38400
    buffer_store_dwordx2 v[44:45], v28, s[16:19], s43 offen sc1
    s_mov_b32 s43, 56832
    buffer_store_dwordx2 v[46:47], v28, s[16:19], s43 offen sc1
    v_cvt_pk_bf16_f32 v32, v128, v129
    v_cvt_pk_bf16_f32 v33, v130, v131
    v_cvt_pk_bf16_f32 v34, v132, v133
    v_cvt_pk_bf16_f32 v35, v134, v135
    s_mov_b32 s43, 2048
    buffer_store_dwordx2 v[32:33], v28, s[16:19], s43 offen sc1
    s_mov_b32 s43, 20480
    buffer_store_dwordx2 v[34:35], v28, s[16:19], s43 offen sc1
    v_cvt_pk_bf16_f32 v36, v136, v137
    v_cvt_pk_bf16_f32 v37, v138, v139
    v_cvt_pk_bf16_f32 v38, v140, v141
    v_cvt_pk_bf16_f32 v39, v142, v143
    s_mov_b32 s43, 38912
    buffer_store_dwordx2 v[36:37], v28, s[16:19], s43 offen sc1
    s_mov_b32 s43, 57344
    buffer_store_dwordx2 v[38:39], v28, s[16:19], s43 offen sc1
    v_cvt_pk_bf16_f32 v40, v144, v145
    v_cvt_pk_bf16_f32 v41, v146, v147
    v_cvt_pk_bf16_f32 v42, v148, v149
    v_cvt_pk_bf16_f32 v43, v150, v151
    s_mov_b32 s43, 2560
    buffer_store_dwordx2 v[40:41], v28, s[16:19], s43 offen sc1
    s_mov_b32 s43, 20992
    buffer_store_dwordx2 v[42:43], v28, s[16:19], s43 offen sc1
    v_cvt_pk_bf16_f32 v44, v152, v153
    v_cvt_pk_bf16_f32 v45, v154, v155
    v_cvt_pk_bf16_f32 v46, v156, v157
    v_cvt_pk_bf16_f32 v47, v158, v159
    s_mov_b32 s43, 39424
    buffer_store_dwordx2 v[44:45], v28, s[16:19], s43 offen sc1
    s_mov_b32 s43, 57856
    buffer_store_dwordx2 v[46:47], v28, s[16:19], s43 offen sc1
    s_lshl_b32 s91, s54, 7
    s_add_u32 s91, s91, 0xA90000
    s_mov_b32 s90, 1
    s_branch FP_gemm
K2_p3:
    s_load_dwordx2 s[50:51], s[0:1], 72
    v_and_b32 v1, 63, v0
    v_lshrrev_b32 v10, 6, v0
    s_sub_u32 s40, s2, 192
    v_lshlrev_b32 v2, 4, v1
    v_readfirstlane_b32 s52, v10
    v_add_u32 v3, 32768, v2
    v_lshrrev_b32 v12, 3, v1
    v_and_b32 v13, 7, v1
    v_xor_b32 v14, v12, v13
    v_mul_u32_u24 v12, 4736, v12
    v_lshl_add_u32 v12, v14, 4, v12
    s_lshl_b32 s41, s40, 7
    s_add_u32 s41, s41, 2359296
    v_add_u32 v4, s41, v12
    v_xor_b32 v13, s52, v13
    v_lshlrev_b32 v13, 4, v13
    v_lshl_add_u32 v13, v1, 7, v13
    v_add_u32 v5, 88064, v13
    s_mov_b32 s27, 0xffff0000
    v_lshlrev_b32 v11, 2, v0
    v_add_u32 v7, 32768, v11
    v_lshlrev_b32 v8, 4, v0
    v_and_b32 v10, 31, v1
    v_lshrrev_b32 v14, 5, v1
    v_lshlrev_b32 v15, 2, v10
    v_lshl_add_u32 v15, v14, 9, v15
    s_lshl_b32 s41, s52, 13
    s_add_u32 s41, s41, 32768
    v_add_u32 v6, s41, v15
    v_lshlrev_b32 v15, 2, v10
    v_lshl_add_u32 v15, v14, 9, v15
    v_add_u32 v9, 11010048, v15
    s_lshl_b32 s44, s40, 3
    s_add_u32 s44, s44, 0
    s_add_u32 s44, s44, s52
    s_min_u32 s42, s44, 288
    s_lshl_b32 s48, s42, 13
    s_mov_b32 s47, 0
    s_cmp_eq_u32 s42, 288
    s_cselect_b32 s48, 4096, s48
    s_cselect_b32 s47, 1, s47
    s_cmp_eq_u32 s42, 0
    s_cselect_b32 s47, 1, s47
    s_add_u32 s48, s48, 6291456
    s_add_u32 s49, s48, 4096
    s_waitcnt lgkmcnt(0)
    s_mov_b32 s16, s50
    s_and_b32 s17, s51, 0xffff
    s_mov_b32 s18, 39845888
    s_mov_b32 s19, 0x20000
    buffer_load_dwordx4 a[216:219], v2, s[16:19], s48 offen offset:0
    buffer_load_dwordx4 a[220:223], v2, s[16:19], s48 offen offset:1024
    buffer_load_dwordx4 a[224:227], v2, s[16:19], s48 offen offset:2048
    buffer_load_dwordx4 a[228:231], v2, s[16:19], s48 offen offset:3072
    s_cmp_eq_u32 s47, 1
    s_cbranch_scc1 P3_zero_a
    buffer_load_dwordx4 a[232:235], v2, s[16:19], s49 offen offset:0
    buffer_load_dwordx4 a[236:239], v2, s[16:19], s49 offen offset:1024
    buffer_load_dwordx4 a[240:243], v2, s[16:19], s49 offen offset:2048
    buffer_load_dwordx4 a[244:247], v2, s[16:19], s49 offen offset:3072
    s_branch P3_go_a
P3_zero_a:
    v_accvgpr_write_b32 a232, 0
    v_accvgpr_write_b32 a233, 0
    v_accvgpr_write_b32 a234, 0
    v_accvgpr_write_b32 a235, 0
    v_accvgpr_write_b32 a236, 0
    v_accvgpr_write_b32 a237, 0
    v_accvgpr_write_b32 a238, 0
    v_accvgpr_write_b32 a239, 0
    v_accvgpr_write_b32 a240, 0
    v_accvgpr_write_b32 a241, 0
    v_accvgpr_write_b32 a242, 0
    v_accvgpr_write_b32 a243, 0
    v_accvgpr_write_b32 a244, 0
    v_accvgpr_write_b32 a245, 0
    v_accvgpr_write_b32 a246, 0
    v_accvgpr_write_b32 a247, 0
P3_go_a:
    s_getpc_b64 s[54:55]
    s_add_u32 s54, s54, tab_small@rel32@lo+4
    s_addc_u32 s55, s55, tab_small@rel32@hi+12
    s_lshl_b32 s42, s52, 10
    v_lshlrev_b32 v11, 4, v1
    v_add_u32 v11, s42, v11
    v_add_co_u32 v12, s[56:57], s54, v11
    v_mov_b32 v13, s55
    s_nop 0
    v_addc_co_u32 v13, s[56:57], 0, v13, s[56:57]
    v_mov_b32 v14, v12
    v_mov_b32 v15, v13
    s_mov_b32 s58, 0
    v_add_co_u32 v14, s[56:57], s58, v12
    s_add_u32 m0, s42, 32768
    s_nop 0
    v_addc_co_u32 v15, s[56:57], 0, v13, s[56:57]
    global_load_lds_dwordx4 v[14:15], off
    s_mov_b32 s58, 4096
    v_add_co_u32 v14, s[56:57], s58, v12
    s_add_u32 m0, s42, 36864
    s_nop 0
    v_addc_co_u32 v15, s[56:57], 0, v13, s[56:57]
    global_load_lds_dwordx4 v[14:15], off
    s_mov_b32 s58, 8192
    v_add_co_u32 v14, s[56:57], s58, v12
    s_add_u32 m0, s42, 40960
    s_nop 0
    v_addc_co_u32 v15, s[56:57], 0, v13, s[56:57]
    global_load_lds_dwordx4 v[14:15], off
    s_mov_b32 s58, 12288
    v_add_co_u32 v14, s[56:57], s58, v12
    s_add_u32 m0, s42, 45056
    s_nop 0
    v_addc_co_u32 v15, s[56:57], 0, v13, s[56:57]
    global_load_lds_dwordx4 v[14:15], off
    s_mov_b32 s58, 16384
    v_add_co_u32 v14, s[56:57], s58, v12
    s_add_u32 m0, s42, 49152
    s_nop 0
    v_addc_co_u32 v15, s[56:57], 0, v13, s[56:57]
    global_load_lds_dwordx4 v[14:15], off
    s_mov_b32 s58, 20480
    v_add_co_u32 v14, s[56:57], s58, v12
    s_add_u32 m0, s42, 53248
    s_nop 0
    v_addc_co_u32 v15, s[56:57], 0, v13, s[56:57]
    global_load_lds_dwordx4 v[14:15], off
    s_mov_b32 s58, 55296
    v_add_co_u32 v14, s[56:57], s58, v12
    s_add_u32 m0, s42, 0
    s_nop 0
    v_addc_co_u32 v15, s[56:57], 0, v13, s[56:57]
    global_load_lds_dwordx4 v[14:15], off
    s_mov_b32 s58, 59392
    v_add_co_u32 v14, s[56:57], s58, v12
    s_add_u32 m0, s42, 4096
    s_nop 0
    v_addc_co_u32 v15, s[56:57], 0, v13, s[56:57]
    global_load_lds_dwordx4 v[14:15], off
    s_mov_b32 s58, 63488
    v_add_co_u32 v14, s[56:57], s58, v12
    s_add_u32 m0, s42, 8192
    s_nop 0
    v_addc_co_u32 v15, s[56:57], 0, v13, s[56:57]
    global_load_lds_dwordx4 v[14:15], off
    s_mov_b32 s58, 67584
    v_add_co_u32 v14, s[56:57], s58, v12
    s_add_u32 m0, s42, 12288
    s_nop 0
    v_addc_co_u32 v15, s[56:57], 0, v13, s[56:57]
    global_load_lds_dwordx4 v[14:15], off
    s_lshl_b32 s59, s52, 14
    s_mul_i32 s43, s52, 606208
    s_add_u32 m0, s59, 88064
    s_add_u32 s45, s43, 0
    buffer_load_dwordx4 v4, s[16:19], s45 offen lds
    s_add_u32 m0, s59, 89088
    s_add_u32 s45, s43, 37888
    buffer_load_dwordx4 v4, s[16:19], s45 offen lds
    s_add_u32 m0, s59, 90112
    s_add_u32 s45, s43, 75776
    buffer_load_dwordx4 v4, s[16:19], s45 offen lds
    s_add_u32 m0, s59, 91136
    s_add_u32 s45, s43, 113664
    buffer_load_dwordx4 v4, s[16:19], s45 offen lds
    s_add_u32 m0, s59, 92160
    s_add_u32 s45, s43, 151552
    buffer_load_dwordx4 v4, s[16:19], s45 offen lds
    s_add_u32 m0, s59, 93184
    s_add_u32 s45, s43, 189440
    buffer_load_dwordx4 v4, s[16:19], s45 offen lds
    s_add_u32 m0, s59, 94208
    s_add_u32 s45, s43, 227328
    buffer_load_dwordx4 v4, s[16:19], s45 offen lds
    s_add_u32 m0, s59, 95232
    s_add_u32 s45, s43, 265216
    buffer_load_dwordx4 v4, s[16:19], s45 offen lds
    s_add_u32 m0, s59, 96256
    s_add_u32 s45, s43, 303104
    buffer_load_dwordx4 v4, s[16:19], s45 offen lds
    s_add_u32 m0, s59, 97280
    s_add_u32 s45, s43, 340992
    buffer_load_dwordx4 v4, s[16:19], s45 offen lds
    s_add_u32 m0, s59, 98304
    s_add_u32 s45, s43, 378880
    buffer_load_dwordx4 v4, s[16:19], s45 offen lds
    s_add_u32 m0, s59, 99328
    s_add_u32 s45, s43, 416768
    buffer_load_dwordx4 v4, s[16:19], s45 offen lds
    s_add_u32 m0, s59, 100352
    s_add_u32 s45, s43, 454656
    buffer_load_dwordx4 v4, s[16:19], s45 offen lds
    s_add_u32 m0, s59, 101376
    s_add_u32 s45, s43, 492544
    buffer_load_dwordx4 v4, s[16:19], s45 offen lds
    s_add_u32 m0, s59, 102400
    s_add_u32 s45, s43, 530432
    buffer_load_dwordx4 v4, s[16:19], s45 offen lds
    s_add_u32 m0, s59, 103424
    s_add_u32 s45, s43, 568320
    buffer_load_dwordx4 v4, s[16:19], s45 offen lds
    s_waitcnt vmcnt(16)
    s_barrier
    ds_read_b128 a[0:3], v3 offset:0
    ds_read_b128 a[4:7], v3 offset:1024
    ds_read_b128 a[8:11], v3 offset:2048
    ds_read_b128 a[12:15], v3 offset:3072
    ds_read_b128 a[16:19], v3 offset:4096
    ds_read_b128 a[20:23], v3 offset:5120
    ds_read_b128 a[24:27], v3 offset:6144
    ds_read_b128 a[28:31], v3 offset:7168
    ds_read_b128 a[32:35], v3 offset:8192
    ds_read_b128 a[36:39], v3 offset:9216
    ds_read_b128 a[40:43], v3 offset:10240
    ds_read_b128 a[44:47], v3 offset:11264
    s_waitcnt lgkmcnt(4)
    ds_read_b128 a[48:51], v3 offset:12288
    ds_read_b128 a[52:55], v3 offset:13312
    ds_read_b128 a[56:59], v3 offset:14336
    ds_read_b128 a[60:63], v3 offset:15360
    ds_read_b128 a[64:67], v3 offset:16384
    ds_read_b128 a[68:71], v3 offset:17408
    ds_read_b128 a[72:75], v3 offset:18432
    ds_read_b128 a[76:79], v3 offset:19456
    ds_read_b128 a[80:83], v3 offset:20480
    ds_read_b128 a[84:87], v3 offset:21504
    ds_read_b128 a[88:91], v3 offset:22528
    ds_read_b128 a[92:95], v3 offset:23552
    s_waitcnt lgkmcnt(4)
    s_waitcnt lgkmcnt(0)
    s_cmp_le_u32 s44, 288
    s_cbranch_scc1 P3_latedma
    s_mov_b32 s58, 49152
    v_add_co_u32 v14, s[56:57], s58, v12
    s_add_u32 m0, s42, 81920
    s_nop 0
    v_addc_co_u32 v15, s[56:57], 0, v13, s[56:57]
    global_load_lds_dwordx4 v[14:15], off
    s_mov_b32 s58, 51200
    v_add_co_u32 v14, s[56:57], s58, v12
    s_add_u32 m0, s42, 83968
    s_nop 0
    v_addc_co_u32 v15, s[56:57], 0, v13, s[56:57]
    global_load_lds_dwordx4 v[14:15], off
    s_mov_b32 s58, 71680
    v_add_co_u32 v14, s[56:57], s58, v12
    s_add_u32 m0, s42, 16384
    s_nop 0
    v_addc_co_u32 v15, s[56:57], 0, v13, s[56:57]
    global_load_lds_dwordx4 v[14:15], off
    s_mov_b32 s58, 75776
    v_add_co_u32 v14, s[56:57], s58, v12
    s_add_u32 m0, s42, 20480
    s_nop 0
    v_addc_co_u32 v15, s[56:57], 0, v13, s[56:57]
    global_load_lds_dwordx4 v[14:15], off
    s_mov_b32 s58, 79872
    v_add_co_u32 v14, s[56:57], s58, v12
    s_add_u32 m0, s42, 24576
    s_nop 0
    v_addc_co_u32 v15, s[56:57], 0, v13, s[56:57]
    global_load_lds_dwordx4 v[14:15], off
    s_mov_b32 s58, 83968
    v_add_co_u32 v14, s[56:57], s58, v12
    s_add_u32 m0, s42, 28672
    s_nop 0
    v_addc_co_u32 v15, s[56:57], 0, v13, s[56:57]
    global_load_lds_dwordx4 v[14:15], off
    s_mov_b32 s58, 24576
    v_add_co_u32 v14, s[56:57], s58, v12
    s_add_u32 m0, s42, 57344
    s_nop 0
    v_addc_co_u32 v15, s[56:57], 0, v13, s[56:57]
    global_load_lds_dwordx4 v[14:15], off
    s_mov_b32 s58, 28672
    v_add_co_u32 v14, s[56:57], s58, v12
    s_add_u32 m0, s42, 61440
    s_nop 0
    v_addc_co_u32 v15, s[56:57], 0, v13, s[56:57]
    global_load_lds_dwordx4 v[14:15], off
    s_mov_b32 s58, 32768
    v_add_co_u32 v14, s[56:57], s58, v12
    s_add_u32 m0, s42, 65536
    s_nop 0
    v_addc_co_u32 v15, s[56:57], 0, v13, s[56:57]
    global_load_lds_dwordx4 v[14:15], off
    s_mov_b32 s58, 36864
    v_add_co_u32 v14, s[56:57], s58, v12
    s_add_u32 m0, s42, 69632
    s_nop 0
    v_addc_co_u32 v15, s[56:57], 0, v13, s[56:57]
    global_load_lds_dwordx4 v[14:15], off
    s_mov_b32 s58, 40960
    v_add_co_u32 v14, s[56:57], s58, v12
    s_add_u32 m0, s42, 73728
    s_nop 0
    v_addc_co_u32 v15, s[56:57], 0, v13, s[56:57]
    global_load_lds_dwordx4 v[14:15], off
    s_mov_b32 s58, 45056
    v_add_co_u32 v14, s[56:57], s58, v12
    s_add_u32 m0, s42, 77824
    s_nop 0
    v_addc_co_u32 v15, s[56:57], 0, v13, s[56:57]
    global_load_lds_dwordx4 v[14:15], off
P3_latedma:
    s_mov_b32 s46, s44
    s_cmp_gt_u32 s46, 288
    s_cbranch_scc1 P3_skip_0
    ds_read_b128 v[112:115], v2 offset:0
    ds_read_b128 v[116:119], v2 offset:1024
    ds_read_b128 v[120:123], v2 offset:2048
    ds_read_b128 v[124:127], v2 offset:3072
    ds_read_b128 v[128:131], v2 offset:4096
    ds_read_b128 v[132:135], v2 offset:5120
    ds_read_b128 v[136:139], v2 offset:6144
    ds_read_b128 v[140:143], v2 offset:7168
    ds_read_b128 v[144:147], v2 offset:8192
    ds_read_b128 v[148:151], v2 offset:9216
    ds_read_b128 v[152:155], v2 offset:10240
    ds_read_b128 v[156:159], v2 offset:11264
    ds_read_b128 v[160:163], v2 offset:12288
    ds_read_b128 v[164:167], v2 offset:13312
    ds_read_b128 v[168:171], v2 offset:14336
    ds_read_b128 v[172:175], v2 offset:15360
    v_mfma_f32_32x32x16_bf16 v[48:63], a[216:219], a[0:3], 0
    s_mov_b32 s58, 49152
    v_add_co_u32 v14, s[56:57], s58, v12
    s_add_u32 m0, s42, 81920
    s_nop 0
    v_addc_co_u32 v15, s[56:57], 0, v13, s[56:57]
    global_load_lds_dwordx4 v[14:15], off
    s_mov_b32 s58, 51200
    v_add_co_u32 v14, s[56:57], s58, v12
    s_add_u32 m0, s42, 83968
    s_nop 0
    v_mfma_f32_32x32x16_bf16 v[64:79], a[232:235], a[0:3], 0
    v_mfma_f32_32x32x16_bf16 v[48:63], a[232:235], a[32:35], v[48:63]
    v_addc_co_u32 v15, s[56:57], 0, v13, s[56:57]
    global_load_lds_dwordx4 v[14:15], off
    s_mov_b32 s58, 71680
    v_mfma_f32_32x32x16_bf16 v[64:79], a[216:219], a[64:67], v[64:79]
    v_add_co_u32 v14, s[56:57], s58, v12
    s_add_u32 m0, s42, 16384
    s_nop 0
    v_addc_co_u32 v15, s[56:57], 0, v13, s[56:57]
    global_load_lds_dwordx4 v[14:15], off
    v_mfma_f32_32x32x16_bf16 v[48:63], a[220:223], a[4:7], v[48:63]
    s_mov_b32 s58, 75776
    v_add_co_u32 v14, s[56:57], s58, v12
    s_add_u32 m0, s42, 20480
    s_nop 0
    v_mfma_f32_32x32x16_bf16 v[64:79], a[236:239], a[4:7], v[64:79]
    v_addc_co_u32 v15, s[56:57], 0, v13, s[56:57]
    global_load_lds_dwordx4 v[14:15], off
    s_mov_b32 s58, 79872
    v_add_co_u32 v14, s[56:57], s58, v12
    s_add_u32 m0, s42, 24576
    v_mfma_f32_32x32x16_bf16 v[48:63], a[236:239], a[36:39], v[48:63]
    s_nop 0
    v_addc_co_u32 v15, s[56:57], 0, v13, s[56:57]
    global_load_lds_dwordx4 v[14:15], off
    s_mov_b32 s58, 83968
    v_mfma_f32_32x32x16_bf16 v[64:79], a[220:223], a[68:71], v[64:79]
    v_add_co_u32 v14, s[56:57], s58, v12
    s_add_u32 m0, s42, 28672
    s_nop 0
    v_addc_co_u32 v15, s[56:57], 0, v13, s[56:57]
    global_load_lds_dwordx4 v[14:15], off
    v_mfma_f32_32x32x16_bf16 v[48:63], a[224:227], a[8:11], v[48:63]
    s_mov_b32 s58, 24576
    v_add_co_u32 v14, s[56:57], s58, v12
    s_add_u32 m0, s42, 57344
    s_nop 0
    v_mfma_f32_32x32x16_bf16 v[64:79], a[240:243], a[8:11], v[64:79]
    v_addc_co_u32 v15, s[56:57], 0, v13, s[56:57]
    global_load_lds_dwordx4 v[14:15], off
    s_mov_b32 s58, 28672
    v_add_co_u32 v14, s[56:57], s58, v12
    s_add_u32 m0, s42, 61440
    v_mfma_f32_32x32x16_bf16 v[48:63], a[240:243], a[40:43], v[48:63]
    s_nop 0
    v_addc_co_u32 v15, s[56:57], 0, v13, s[56:57]
    global_load_lds_dwordx4 v[14:15], off
    s_mov_b32 s58, 32768
    v_mfma_f32_32x32x16_bf16 v[64:79], a[224:227], a[72:75], v[64:79]
    v_add_co_u32 v14, s[56:57], s58, v12
    s_add_u32 m0, s42, 65536
    s_nop 0
    v_addc_co_u32 v15, s[56:57], 0, v13, s[56:57]
    global_load_lds_dwordx4 v[14:15], off
    v_mfma_f32_32x32x16_bf16 v[48:63], a[228:231], a[12:15], v[48:63]
    s_mov_b32 s58, 36864
    v_add_co_u32 v14, s[56:57], s58, v12
    s_add_u32 m0, s42, 69632
    s_nop 0
    v_mfma_f32_32x32x16_bf16 v[64:79], a[244:247], a[12:15], v[64:79]
    v_addc_co_u32 v15, s[56:57], 0, v13, s[56:57]
    global_load_lds_dwordx4 v[14:15], off
    s_mov_b32 s58, 40960
    v_add_co_u32 v14, s[56:57], s58, v12
    s_add_u32 m0, s42, 73728
    v_mfma_f32_32x32x16_bf16 v[48:63], a[244:247], a[44:47], v[48:63]
    s_nop 0
    v_addc_co_u32 v15, s[56:57], 0, v13, s[56:57]
    global_load_lds_dwordx4 v[14:15], off
    s_mov_b32 s58, 45056
    v_mfma_f32_32x32x16_bf16 v[64:79], a[228:231], a[76:79], v[64:79]
    v_add_co_u32 v14, s[56:57], s58, v12
    s_add_u32 m0, s42, 77824
    s_nop 0
    v_addc_co_u32 v15, s[56:57], 0, v13, s[56:57]
    global_load_lds_dwordx4 v[14:15], off
    s_waitcnt lgkmcnt(0)
    v_mfma_f32_32x32x16_bf16 v[80:95], a[216:219], a[16:19], 0
    v_mfma_f32_32x32x16_bf16 v[96:111], a[232:235], a[16:19], 0
    s_nop 9
    v_mul_f32 v240, v64, v128
    v_mul_f32 v241, v48, v128
    v_mul_f32 v242, v65, v129
    v_mul_f32 v243, v49, v129
    v_mul_f32 v244, v66, v130
    v_mfma_f32_32x32x16_bf16 v[80:95], a[232:235], a[48:51], v[80:95]
    v_mul_f32 v245, v50, v130
    v_mul_f32 v246, v67, v131
    v_mul_f32 v247, v51, v131
    v_fma_f32 v48, v48, v112, v240
    v_fma_f32 v64, v64, v112, -v241
    v_mfma_f32_32x32x16_bf16 v[96:111], a[216:219], a[80:83], v[96:111]
    v_fma_f32 v49, v49, v113, v242
    v_fma_f32 v65, v65, v113, -v243
    v_fma_f32 v50, v50, v114, v244
    v_fma_f32 v66, v66, v114, -v245
    v_fma_f32 v51, v51, v115, v246
    v_fma_f32 v67, v67, v115, -v247
    v_mfma_f32_32x32x16_bf16 v[80:95], a[220:223], a[20:23], v[80:95]
    v_mul_f32 v240, v68, v132
    v_mul_f32 v241, v52, v132
    v_mul_f32 v242, v69, v133
    v_mul_f32 v243, v53, v133
    v_mul_f32 v244, v70, v134
    v_mfma_f32_32x32x16_bf16 v[96:111], a[236:239], a[20:23], v[96:111]
    v_mul_f32 v245, v54, v134
    v_mul_f32 v246, v71, v135
    v_mul_f32 v247, v55, v135
    v_fma_f32 v52, v52, v116, v240
    v_fma_f32 v68, v68, v116, -v241
    v_mfma_f32_32x32x16_bf16 v[80:95], a[236:239], a[52:55], v[80:95]
    v_fma_f32 v53, v53, v117, v242
    v_fma_f32 v69, v69, v117, -v243
    v_fma_f32 v54, v54, v118, v244
    v_fma_f32 v70, v70, v118, -v245
    v_fma_f32 v55, v55, v119, v246
    v_fma_f32 v71, v71, v119, -v247
    v_mfma_f32_32x32x16_bf16 v[96:111], a[220:223], a[84:87], v[96:111]
    v_mul_f32 v240, v72, v136
    v_mul_f32 v241, v56, v136
    v_mul_f32 v242, v73, v137
    v_mul_f32 v243, v57, v137
    v_mul_f32 v244, v74, v138
    v_mfma_f32_32x32x16_bf16 v[80:95], a[224:227], a[24:27], v[80:95]
    v_mul_f32 v245, v58, v138
    v_mul_f32 v246, v75, v139
    v_mul_f32 v247, v59, v139
    v_fma_f32 v56, v56, v120, v240
    v_fma_f32 v72, v72, v120, -v241
    v_mfma_f32_32x32x16_bf16 v[96:111], a[240:243], a[24:27], v[96:111]
    v_fma_f32 v57, v57, v121, v242
    v_fma_f32 v73, v73, v121, -v243
    v_fma_f32 v58, v58, v122, v244
    v_fma_f32 v74, v74, v122, -v245
    v_fma_f32 v59, v59, v123, v246
    v_fma_f32 v75, v75, v123, -v247
    v_mfma_f32_32x32x16_bf16 v[80:95], a[240:243], a[56:59], v[80:95]
    v_mul_f32 v240, v76, v140
    v_mul_f32 v241, v60, v140
    v_mul_f32 v242, v77, v141
    v_mul_f32 v243, v61, v141
    v_mul_f32 v244, v78, v142
    v_mfma_f32_32x32x16_bf16 v[96:111], a[224:227], a[88:91], v[96:111]
    v_mul_f32 v245, v62, v142
    v_mul_f32 v246, v79, v143
    v_mul_f32 v247, v63, v143
    v_fma_f32 v60, v60, v124, v240
    v_fma_f32 v76, v76, v124, -v241
    v_mfma_f32_32x32x16_bf16 v[80:95], a[228:231], a[28:31], v[80:95]
    v_fma_f32 v61, v61, v125, v242
    v_fma_f32 v77, v77, v125, -v243
    v_fma_f32 v62, v62, v126, v244
    v_fma_f32 v78, v78, v126, -v245
    v_fma_f32 v63, v63, v127, v246
    v_fma_f32 v79, v79, v127, -v247
    v_mfma_f32_32x32x16_bf16 v[96:111], a[244:247], a[28:31], v[96:111]
    v_cvt_pk_bf16_f32 v176, v48, v49
    v_cvt_pk_bf16_f32 v184, v64, v65
    v_cvt_pk_bf16_f32 v177, v50, v51
    v_cvt_pk_bf16_f32 v185, v66, v67
    v_cvt_pk_bf16_f32 v178, v52, v53
    v_mfma_f32_32x32x16_bf16 v[80:95], a[244:247], a[60:63], v[80:95]
    v_cvt_pk_bf16_f32 v186, v68, v69
    v_cvt_pk_bf16_f32 v179, v54, v55
    v_cvt_pk_bf16_f32 v187, v70, v71
    v_cvt_pk_bf16_f32 v180, v56, v57
    v_cvt_pk_bf16_f32 v188, v72, v73
    v_mfma_f32_32x32x16_bf16 v[96:111], a[228:231], a[92:95], v[96:111]
    v_cvt_pk_bf16_f32 v181, v58, v59
    v_cvt_pk_bf16_f32 v189, v74, v75
    v_cvt_pk_bf16_f32 v182, v60, v61
    v_cvt_pk_bf16_f32 v190, v76, v77
    v_cvt_pk_bf16_f32 v183, v62, v63
    v_cvt_pk_bf16_f32 v191, v78, v79
    s_waitcnt vmcnt(6)
    s_barrier
    ds_read_b128 a[192:195], v3 offset:49152
    ds_read_b128 a[196:199], v3 offset:50176
    ds_read_b128 a[200:203], v3 offset:51200
    ds_read_b128 a[204:207], v3 offset:52224
    ds_read_b128 a[208:211], v3 offset:53248
    ds_read_b128 a[212:215], v3 offset:54272
    s_waitcnt lgkmcnt(0)
    s_nop 1
    v_mfma_f32_32x32x16_bf16 v[48:63], a[192:195], v[176:179], 0
    v_mfma_f32_32x32x16_bf16 v[64:79], a[192:195], v[184:187], 0
    ds_read_b128 v[112:115], v2 offset:16384
    ds_read_b128 v[116:119], v2 offset:17408
    ds_read_b128 v[120:123], v2 offset:18432
    ds_read_b128 v[124:127], v2 offset:19456
    ds_read_b128 v[128:131], v2 offset:20480
    ds_read_b128 v[132:135], v2 offset:21504
    ds_read_b128 v[136:139], v2 offset:22528
    ds_read_b128 v[140:143], v2 offset:23552
    s_nop 1
    v_mul_f32 v240, v96, v160
    v_mul_f32 v241, v80, v160
    v_mul_f32 v242, v97, v161
    v_mul_f32 v243, v81, v161
    v_mfma_f32_32x32x16_bf16 v[48:63], a[200:203], v[184:187], v[48:63]
    v_mul_f32 v244, v98, v162
    v_mul_f32 v245, v82, v162
    v_mul_f32 v246, v99, v163
    v_mul_f32 v247, v83, v163
    v_fma_f32 v80, v80, v144, v240
    v_fma_f32 v96, v96, v144, -v241
    v_fma_f32 v81, v81, v145, v242
    v_fma_f32 v97, v97, v145, -v243
    v_fma_f32 v82, v82, v146, v244
    v_fma_f32 v98, v98, v146, -v245
    v_fma_f32 v83, v83, v147, v246
    v_fma_f32 v99, v99, v147, -v247
    v_mul_f32 v240, v100, v164
    v_mfma_f32_32x32x16_bf16 v[64:79], a[208:211], v[176:179], v[64:79]
    v_mul_f32 v241, v84, v164
    v_mul_f32 v242, v101, v165
    v_mul_f32 v243, v85, v165
    v_mul_f32 v244, v102, v166
    v_mul_f32 v245, v86, v166
    v_mul_f32 v246, v103, v167
    v_mul_f32 v247, v87, v167
    v_fma_f32 v84, v84, v148, v240
    v_fma_f32 v100, v100, v148, -v241
    v_fma_f32 v85, v85, v149, v242
    v_fma_f32 v101, v101, v149, -v243
    v_fma_f32 v86, v86, v150, v244
    v_mfma_f32_32x32x16_bf16 v[48:63], a[196:199], v[180:183], v[48:63]
    v_fma_f32 v102, v102, v150, -v245
    v_fma_f32 v87, v87, v151, v246
    v_fma_f32 v103, v103, v151, -v247
    v_mul_f32 v240, v104, v168
    v_mul_f32 v241, v88, v168
    v_mul_f32 v242, v105, v169
    v_mul_f32 v243, v89, v169
    v_mul_f32 v244, v106, v170
    v_mul_f32 v245, v90, v170
    v_mul_f32 v246, v107, v171
    v_mul_f32 v247, v91, v171
    v_fma_f32 v88, v88, v152, v240
    v_fma_f32 v104, v104, v152, -v241
    v_mfma_f32_32x32x16_bf16 v[64:79], a[196:199], v[188:191], v[64:79]
    v_fma_f32 v89, v89, v153, v242
    v_fma_f32 v105, v105, v153, -v243
    v_fma_f32 v90, v90, v154, v244
    v_fma_f32 v106, v106, v154, -v245
    v_fma_f32 v91, v91, v155, v246
    v_fma_f32 v107, v107, v155, -v247
    v_mul_f32 v240, v108, v172
    v_mul_f32 v241, v92, v172
    v_mul_f32 v242, v109, v173
    v_mul_f32 v243, v93, v173
    v_mul_f32 v244, v110, v174
    v_mul_f32 v245, v94, v174
    v_mfma_f32_32x32x16_bf16 v[48:63], a[204:207], v[188:191], v[48:63]
    v_mul_f32 v246, v111, v175
    v_mul_f32 v247, v95, v175
    v_fma_f32 v92, v92, v156, v240
    v_fma_f32 v108, v108, v156, -v241
    v_fma_f32 v93, v93, v157, v242
    v_fma_f32 v109, v109, v157, -v243
    v_fma_f32 v94, v94, v158, v244
    v_fma_f32 v110, v110, v158, -v245
    v_fma_f32 v95, v95, v159, v246
    v_fma_f32 v111, v111, v159, -v247
    v_cvt_pk_bf16_f32 v192, v80, v81
    v_cvt_pk_bf16_f32 v200, v96, v97
    v_cvt_pk_bf16_f32 v193, v82, v83
    v_mfma_f32_32x32x16_bf16 v[64:79], a[212:215], v[180:183], v[64:79]
    v_cvt_pk_bf16_f32 v201, v98, v99
    v_cvt_pk_bf16_f32 v194, v84, v85
    v_cvt_pk_bf16_f32 v202, v100, v101
    v_cvt_pk_bf16_f32 v195, v86, v87
    v_cvt_pk_bf16_f32 v203, v102, v103
    v_cvt_pk_bf16_f32 v196, v88, v89
    v_cvt_pk_bf16_f32 v204, v104, v105
    v_cvt_pk_bf16_f32 v197, v90, v91
    v_cvt_pk_bf16_f32 v205, v106, v107
    v_cvt_pk_bf16_f32 v198, v92, v93
    v_cvt_pk_bf16_f32 v206, v108, v109
    v_cvt_pk_bf16_f32 v199, v94, v95
    v_cvt_pk_bf16_f32 v207, v110, v111
    s_lshl_b32 s44, s40, 3
    s_add_u32 s44, s44, 4
    s_add_u32 s44, s44, s52
    s_min_u32 s42, s44, 288
    s_lshl_b32 s48, s42, 13
    s_mov_b32 s47, 0
    s_cmp_eq_u32 s42, 288
    s_cselect_b32 s48, 4096, s48
    s_cselect_b32 s47, 1, s47
    s_cmp_eq_u32 s42, 0
    s_cselect_b32 s47, 1, s47
    s_add_u32 s48, s48, 6291456
    s_add_u32 s49, s48, 4096
    s_cmp_gt_u32 s44, 288
    s_cbranch_scc1 P3_nonexty
    buffer_load_dwordx4 a[216:219], v2, s[16:19], s48 offen offset:0
    buffer_load_dwordx4 a[220:223], v2, s[16:19], s48 offen offset:1024
    buffer_load_dwordx4 a[224:227], v2, s[16:19], s48 offen offset:2048
    buffer_load_dwordx4 a[228:231], v2, s[16:19], s48 offen offset:3072
    s_cmp_eq_u32 s47, 1
    s_cbranch_scc1 P3_zero_b
    buffer_load_dwordx4 a[232:235], v2, s[16:19], s49 offen offset:0
    buffer_load_dwordx4 a[236:239], v2, s[16:19], s49 offen offset:1024
    buffer_load_dwordx4 a[240:243], v2, s[16:19], s49 offen offset:2048
    buffer_load_dwordx4 a[244:247], v2, s[16:19], s49 offen offset:3072
    s_branch P3_go_b
P3_zero_b:
    v_accvgpr_write_b32 a232, 0
    v_accvgpr_write_b32 a233, 0
    v_accvgpr_write_b32 a234, 0
    v_accvgpr_write_b32 a235, 0
    v_accvgpr_write_b32 a236, 0
    v_accvgpr_write_b32 a237, 0
    v_accvgpr_write_b32 a238, 0
    v_accvgpr_write_b32 a239, 0
    v_accvgpr_write_b32 a240, 0
    v_accvgpr_write_b32 a241, 0
    v_accvgpr_write_b32 a242, 0
    v_accvgpr_write_b32 a243, 0
    v_accvgpr_write_b32 a244, 0
    v_accvgpr_write_b32 a245, 0
    v_accvgpr_write_b32 a246, 0
    v_accvgpr_write_b32 a247, 0
P3_go_b:
P3_nonexty:
    ds_read_b128 v[16:19], v5 offset:0
    ds_read_b128 v[20:23], v5 offset:8192
    ds_read_b128 v[24:27], v5 offset:16384
    ds_read_b128 v[28:31], v5 offset:24576
    ds_read_b128 v[32:35], v5 offset:32768
    ds_read_b128 v[36:39], v5 offset:40960
    ds_read_b128 v[40:43], v5 offset:49152
    ds_read_b128 v[44:47], v5 offset:57344
    v_xor_b32 v5, 64, v5
    s_waitcnt lgkmcnt(0)
    s_nop 1
    v_mfma_f32_32x32x16_bf16 v[80:95], a[192:195], v[192:195], 0
    v_mfma_f32_32x32x16_bf16 v[96:111], a[192:195], v[200:203], 0
    ds_read_b128 v[144:147], v2 offset:24576
    ds_read_b128 v[148:151], v2 offset:25600
    ds_read_b128 v[152:155], v2 offset:26624
    ds_read_b128 v[156:159], v2 offset:27648
    ds_read_b128 v[160:163], v2 offset:28672
    ds_read_b128 v[164:167], v2 offset:29696
    ds_read_b128 v[168:171], v2 offset:30720
    ds_read_b128 v[172:175], v2 offset:31744
    v_lshlrev_b32 v248, 16, v16
    v_lshlrev_b32 v249, 16, v24
    v_and_b32 v250, s27, v16
    v_and_b32 v251, s27, v24
    v_mul_f32 v252, v64, v249
    v_mul_f32 v253, v48, v249
    v_mul_f32 v254, v65, v251
    v_mul_f32 v255, v49, v251
    v_fma_f32 v48, v48, v248, -v252
    v_mfma_f32_32x32x16_bf16 v[80:95], a[200:203], v[200:203], v[80:95]
    v_fma_f32 v64, v64, v248, v253
    v_fma_f32 v49, v49, v250, -v254
    v_fma_f32 v65, v65, v250, v255
    v_lshlrev_b32 v248, 16, v17
    v_lshlrev_b32 v249, 16, v25
    v_and_b32 v250, s27, v17
    v_and_b32 v251, s27, v25
    v_mul_f32 v252, v66, v249
    v_mul_f32 v253, v50, v249
    v_mul_f32 v254, v67, v251
    v_mul_f32 v255, v51, v251
    v_fma_f32 v50, v50, v248, -v252
    v_fma_f32 v66, v66, v248, v253
    v_fma_f32 v51, v51, v250, -v254
    v_fma_f32 v67, v67, v250, v255
    v_lshlrev_b32 v248, 16, v18
    v_lshlrev_b32 v249, 16, v26
    v_mfma_f32_32x32x16_bf16 v[96:111], a[208:211], v[192:195], v[96:111]
    v_and_b32 v250, s27, v18
    v_and_b32 v251, s27, v26
    v_mul_f32 v252, v68, v249
    v_mul_f32 v253, v52, v249
    v_mul_f32 v254, v69, v251
    v_mul_f32 v255, v53, v251
    v_fma_f32 v52, v52, v248, -v252
    v_fma_f32 v68, v68, v248, v253
    v_fma_f32 v53, v53, v250, -v254
    v_fma_f32 v69, v69, v250, v255
    v_lshlrev_b32 v248, 16, v19
    v_lshlrev_b32 v249, 16, v27
    v_and_b32 v250, s27, v19
    v_and_b32 v251, s27, v27
    v_mul_f32 v252, v70, v249
    v_mul_f32 v253, v54, v249
    v_mul_f32 v254, v71, v251
    v_mfma_f32_32x32x16_bf16 v[80:95], a[196:199], v[196:199], v[80:95]
    v_mul_f32 v255, v55, v251
    v_fma_f32 v54, v54, v248, -v252
    v_fma_f32 v70, v70, v248, v253
    v_fma_f32 v55, v55, v250, -v254
    v_fma_f32 v71, v71, v250, v255
    v_lshlrev_b32 v248, 16, v20
    v_lshlrev_b32 v249, 16, v28
    v_and_b32 v250, s27, v20
    v_and_b32 v251, s27, v28
    v_mul_f32 v252, v72, v249
    v_mul_f32 v253, v56, v249
    v_mul_f32 v254, v73, v251
    v_mul_f32 v255, v57, v251
    v_fma_f32 v56, v56, v248, -v252
    v_fma_f32 v72, v72, v248, v253
    v_fma_f32 v57, v57, v250, -v254
    v_fma_f32 v73, v73, v250, v255
    v_mfma_f32_32x32x16_bf16 v[96:111], a[196:199], v[204:207], v[96:111]
    v_lshlrev_b32 v248, 16, v21
    v_lshlrev_b32 v249, 16, v29
    v_and_b32 v250, s27, v21
    v_and_b32 v251, s27, v29
    v_mul_f32 v252, v74, v249
    v_mul_f32 v253, v58, v249
    v_mul_f32 v254, v75, v251
    v_mul_f32 v255, v59, v251
    v_fma_f32 v58, v58, v248, -v252
    v_fma_f32 v74, v74, v248, v253
    v_fma_f32 v59, v59, v250, -v254
    v_fma_f32 v75, v75, v250, v255
    v_lshlrev_b32 v248, 16, v22
    v_lshlrev_b32 v249, 16, v30
    v_and_b32 v250, s27, v22
    v_and_b32 v251, s27, v30
    v_mul_f32 v252, v76, v249
    v_mfma_f32_32x32x16_bf16 v[80:95], a[204:207], v[204:207], v[80:95]
    v_mul_f32 v253, v60, v249
    v_mul_f32 v254, v77, v251
    v_mul_f32 v255, v61, v251
    v_fma_f32 v60, v60, v248, -v252
    v_fma_f32 v76, v76, v248, v253
    v_fma_f32 v61, v61, v250, -v254
    v_fma_f32 v77, v77, v250, v255
    v_lshlrev_b32 v248, 16, v23
    v_lshlrev_b32 v249, 16, v31
    v_and_b32 v250, s27, v23
    v_and_b32 v251, s27, v31
    v_mul_f32 v252, v78, v249
    v_mul_f32 v253, v62, v249
    v_mul_f32 v254, v79, v251
    v_mul_f32 v255, v63, v251
    v_fma_f32 v62, v62, v248, -v252
    v_fma_f32 v78, v78, v248, v253
    v_mfma_f32_32x32x16_bf16 v[96:111], a[212:215], v[196:199], v[96:111]
    v_fma_f32 v63, v63, v250, -v254
    v_fma_f32 v79, v79, v250, v255
    v_cvt_pk_bf16_f32 v176, v48, v49
    v_cvt_pk_bf16_f32 v184, v64, v65
    v_cvt_pk_bf16_f32 v177, v50, v51
    v_cvt_pk_bf16_f32 v185, v66, v67
    v_cvt_pk_bf16_f32 v178, v52, v53
    v_cvt_pk_bf16_f32 v186, v68, v69
    v_cvt_pk_bf16_f32 v179, v54, v55
    v_cvt_pk_bf16_f32 v187, v70, v71
    v_cvt_pk_bf16_f32 v180, v56, v57
    v_cvt_pk_bf16_f32 v188, v72, v73
    v_cvt_pk_bf16_f32 v181, v58, v59
    v_cvt_pk_bf16_f32 v189, v74, v75
    v_cvt_pk_bf16_f32 v182, v60, v61
    v_cvt_pk_bf16_f32 v190, v76, v77
    v_cvt_pk_bf16_f32 v183, v62, v63
    v_cvt_pk_bf16_f32 v191, v78, v79
    s_nop 1
    v_mfma_f32_32x32x16_bf16 v[48:63], v[176:179], a[192:195], 0
    v_mfma_f32_32x32x16_bf16 v[64:79], v[184:187], a[192:195], 0
    v_lshlrev_b32 v248, 16, v32
    v_lshlrev_b32 v249, 16, v40
    v_and_b32 v250, s27, v32
    v_and_b32 v251, s27, v40
    s_nop 5
    v_mul_f32 v252, v96, v249
    v_mul_f32 v253, v80, v249
    v_mul_f32 v254, v97, v251
    v_mul_f32 v255, v81, v251
    v_fma_f32 v80, v80, v248, -v252
    v_fma_f32 v96, v96, v248, v253
    v_fma_f32 v81, v81, v250, -v254
    v_fma_f32 v97, v97, v250, v255
    v_lshlrev_b32 v248, 16, v33
    v_lshlrev_b32 v249, 16, v41
    v_and_b32 v250, s27, v33
    v_and_b32 v251, s27, v41
    v_mfma_f32_32x32x16_bf16 v[48:63], v[184:187], a[208:211], v[48:63]
    v_mul_f32 v252, v98, v249
    v_mul_f32 v253, v82, v249
    v_mul_f32 v254, v99, v251
    v_mul_f32 v255, v83, v251
    v_fma_f32 v82, v82, v248, -v252
    v_fma_f32 v98, v98, v248, v253
    v_fma_f32 v83, v83, v250, -v254
    v_fma_f32 v99, v99, v250, v255
    v_lshlrev_b32 v248, 16, v34
    v_lshlrev_b32 v249, 16, v42
    v_and_b32 v250, s27, v34
    v_and_b32 v251, s27, v42
    v_mul_f32 v252, v100, v249
    v_mul_f32 v253, v84, v249
    v_mul_f32 v254, v101, v251
    v_mul_f32 v255, v85, v251
    v_mfma_f32_32x32x16_bf16 v[64:79], v[176:179], a[200:203], v[64:79]
    v_fma_f32 v84, v84, v248, -v252
    v_fma_f32 v100, v100, v248, v253
    v_fma_f32 v85, v85, v250, -v254
    v_fma_f32 v101, v101, v250, v255
    v_lshlrev_b32 v248, 16, v35
    v_lshlrev_b32 v249, 16, v43
    v_and_b32 v250, s27, v35
    v_and_b32 v251, s27, v43
    v_mul_f32 v252, v102, v249
    v_mul_f32 v253, v86, v249
    v_mul_f32 v254, v103, v251
    v_mul_f32 v255, v87, v251
    v_fma_f32 v86, v86, v248, -v252
    v_fma_f32 v102, v102, v248, v253
    v_fma_f32 v87, v87, v250, -v254
    v_fma_f32 v103, v103, v250, v255
    v_mfma_f32_32x32x16_bf16 v[48:63], v[180:183], a[196:199], v[48:63]
    v_lshlrev_b32 v248, 16, v36
    v_lshlrev_b32 v249, 16, v44
    v_and_b32 v250, s27, v36
    v_and_b32 v251, s27, v44
    v_mul_f32 v252, v104, v249
    v_mul_f32 v253, v88, v249
    v_mul_f32 v254, v105, v251
    v_mul_f32 v255, v89, v251
    v_fma_f32 v88, v88, v248, -v252
    v_fma_f32 v104, v104, v248, v253
    v_fma_f32 v89, v89, v250, -v254
    v_fma_f32 v105, v105, v250, v255
    v_lshlrev_b32 v248, 16, v37
    v_lshlrev_b32 v249, 16, v45
    v_and_b32 v250, s27, v37
    v_and_b32 v251, s27, v45
    v_mfma_f32_32x32x16_bf16 v[64:79], v[188:191], a[196:199], v[64:79]
    v_mul_f32 v252, v106, v249
    v_mul_f32 v253, v90, v249
    v_mul_f32 v254, v107, v251
    v_mul_f32 v255, v91, v251
    v_fma_f32 v90, v90, v248, -v252
    v_fma_f32 v106, v106, v248, v253
    v_fma_f32 v91, v91, v250, -v254
    v_fma_f32 v107, v107, v250, v255
    v_lshlrev_b32 v248, 16, v38
    v_lshlrev_b32 v249, 16, v46
    v_and_b32 v250, s27, v38
    v_and_b32 v251, s27, v46
    v_mul_f32 v252, v108, v249
    v_mul_f32 v253, v92, v249
    v_mul_f32 v254, v109, v251
    v_mul_f32 v255, v93, v251
    v_mfma_f32_32x32x16_bf16 v[48:63], v[188:191], a[212:215], v[48:63]
    v_fma_f32 v92, v92, v248, -v252
    v_fma_f32 v108, v108, v248, v253
    v_fma_f32 v93, v93, v250, -v254
    v_fma_f32 v109, v109, v250, v255
    v_lshlrev_b32 v248, 16, v39
    v_lshlrev_b32 v249, 16, v47
    v_and_b32 v250, s27, v39
    v_and_b32 v251, s27, v47
    v_mul_f32 v252, v110, v249
    v_mul_f32 v253, v94, v249
    v_mul_f32 v254, v111, v251
    v_mul_f32 v255, v95, v251
    v_fma_f32 v94, v94, v248, -v252
    v_fma_f32 v110, v110, v248, v253
    v_fma_f32 v95, v95, v250, -v254
    v_fma_f32 v111, v111, v250, v255
    v_mfma_f32_32x32x16_bf16 v[64:79], v[180:183], a[204:207], v[64:79]
    v_cvt_pk_bf16_f32 v192, v80, v81
    v_cvt_pk_bf16_f32 v200, v96, v97
    v_cvt_pk_bf16_f32 v193, v82, v83
    v_cvt_pk_bf16_f32 v201, v98, v99
    v_cvt_pk_bf16_f32 v194, v84, v85
    v_cvt_pk_bf16_f32 v202, v100, v101
    v_cvt_pk_bf16_f32 v195, v86, v87
    v_cvt_pk_bf16_f32 v203, v102, v103
    v_cvt_pk_bf16_f32 v196, v88, v89
    v_cvt_pk_bf16_f32 v204, v104, v105
    v_cvt_pk_bf16_f32 v197, v90, v91
    v_cvt_pk_bf16_f32 v205, v106, v107
    v_cvt_pk_bf16_f32 v198, v92, v93
    v_cvt_pk_bf16_f32 v206, v108, v109
    v_cvt_pk_bf16_f32 v199, v94, v95
    v_cvt_pk_bf16_f32 v207, v110, v111
    s_waitcnt lgkmcnt(0)
    s_nop 1
    s_waitcnt vmcnt(0)
    s_barrier
    v_mfma_f32_32x32x16_bf16 v[80:95], v[192:195], a[192:195], 0
    v_mfma_f32_32x32x16_bf16 v[96:111], v[200:203], a[192:195], 0
    ds_read_b128 a[96:99], v3 offset:24576
    ds_read_b128 a[100:103], v3 offset:25600
    ds_read_b128 a[104:107], v3 offset:26624
    ds_read_b128 a[108:111], v3 offset:27648
    ds_read_b128 a[112:115], v3 offset:28672
    ds_read_b128 a[116:119], v3 offset:29696
    ds_read_b128 a[120:123], v3 offset:30720
    ds_read_b128 a[124:127], v3 offset:31744
    ds_read_b128 a[128:131], v3 offset:32768
    ds_read_b128 a[132:135], v3 offset:33792
    v_mul_f32 v240, v64, v128
    v_mul_f32 v241, v48, v128
    v_mul_f32 v242, v65, v129
    v_mul_f32 v243, v49, v129
    v_mfma_f32_32x32x16_bf16 v[80:95], v[200:203], a[208:211], v[80:95]
    v_mul_f32 v244, v66, v130
    v_mul_f32 v245, v50, v130
    v_mul_f32 v246, v67, v131
    v_mul_f32 v247, v51, v131
    v_fma_f32 v48, v48, v112, -v240
    v_fma_f32 v64, v64, v112, v241
    v_fma_f32 v49, v49, v113, -v242
    v_fma_f32 v65, v65, v113, v243
    v_fma_f32 v50, v50, v114, -v244
    v_fma_f32 v66, v66, v114, v245
    v_fma_f32 v51, v51, v115, -v246
    v_fma_f32 v67, v67, v115, v247
    v_mul_f32 v240, v68, v132
    v_mul_f32 v241, v52, v132
    v_mul_f32 v242, v69, v133
    v_mfma_f32_32x32x16_bf16 v[96:111], v[192:195], a[200:203], v[96:111]
    v_mul_f32 v243, v53, v133
    v_mul_f32 v244, v70, v134
    v_mul_f32 v245, v54, v134
    v_mul_f32 v246, v71, v135
    v_mul_f32 v247, v55, v135
    v_fma_f32 v52, v52, v116, -v240
    v_fma_f32 v68, v68, v116, v241
    v_fma_f32 v53, v53, v117, -v242
    v_fma_f32 v69, v69, v117, v243
    v_fma_f32 v54, v54, v118, -v244
    v_fma_f32 v70, v70, v118, v245
    v_fma_f32 v55, v55, v119, -v246
    v_fma_f32 v71, v71, v119, v247
    v_mul_f32 v240, v72, v136
    v_mul_f32 v241, v56, v136
    v_mfma_f32_32x32x16_bf16 v[80:95], v[196:199], a[196:199], v[80:95]
    v_mul_f32 v242, v73, v137
    v_mul_f32 v243, v57, v137
    v_mul_f32 v244, v74, v138
    v_mul_f32 v245, v58, v138
    v_mul_f32 v246, v75, v139
    v_mul_f32 v247, v59, v139
    v_fma_f32 v56, v56, v120, -v240
    v_fma_f32 v72, v72, v120, v241
    v_fma_f32 v57, v57, v121, -v242
    v_fma_f32 v73, v73, v121, v243
    v_fma_f32 v58, v58, v122, -v244
    v_fma_f32 v74, v74, v122, v245
    v_fma_f32 v59, v59, v123, -v246
    v_fma_f32 v75, v75, v123, v247
    v_mul_f32 v240, v76, v140
    v_mfma_f32_32x32x16_bf16 v[96:111], v[204:207], a[196:199], v[96:111]
    v_mul_f32 v241, v60, v140
    v_mul_f32 v242, v77, v141
    v_mul_f32 v243, v61, v141
    v_mul_f32 v244, v78, v142
    v_mul_f32 v245, v62, v142
    v_mul_f32 v246, v79, v143
    v_mul_f32 v247, v63, v143
    v_fma_f32 v60, v60, v124, -v240
    v_fma_f32 v76, v76, v124, v241
    v_fma_f32 v61, v61, v125, -v242
    v_fma_f32 v77, v77, v125, v243
    v_fma_f32 v62, v62, v126, -v244
    v_fma_f32 v78, v78, v126, v245
    v_fma_f32 v63, v63, v127, -v246
    v_fma_f32 v79, v79, v127, v247
    v_mfma_f32_32x32x16_bf16 v[80:95], v[204:207], a[212:215], v[80:95]
    v_cvt_pk_bf16_f32 v208, v48, v49
    v_cvt_pk_bf16_f32 v216, v64, v65
    v_cvt_pk_bf16_f32 v209, v50, v51
    v_cvt_pk_bf16_f32 v217, v66, v67
    v_cvt_pk_bf16_f32 v210, v52, v53
    v_cvt_pk_bf16_f32 v218, v68, v69
    v_cvt_pk_bf16_f32 v211, v54, v55
    v_cvt_pk_bf16_f32 v219, v70, v71
    v_cvt_pk_bf16_f32 v212, v56, v57
    v_cvt_pk_bf16_f32 v220, v72, v73
    v_cvt_pk_bf16_f32 v213, v58, v59
    v_cvt_pk_bf16_f32 v221, v74, v75
    v_cvt_pk_bf16_f32 v214, v60, v61
    v_cvt_pk_bf16_f32 v222, v76, v77
    v_cvt_pk_bf16_f32 v215, v62, v63
    v_mfma_f32_32x32x16_bf16 v[96:111], v[196:199], a[204:207], v[96:111]
    v_cvt_pk_bf16_f32 v223, v78, v79
    ds_read_b128 a[136:139], v3 offset:34816
    ds_read_b128 a[140:143], v3 offset:35840
    ds_read_b128 a[144:147], v3 offset:36864
    ds_read_b128 a[148:151], v3 offset:37888
    ds_read_b128 a[152:155], v3 offset:38912
    ds_read_b128 a[156:159], v3 offset:39936
    ds_read_b128 a[160:163], v3 offset:40960
    ds_read_b128 a[164:167], v3 offset:41984
    ds_read_b128 a[168:171], v3 offset:43008
    ds_read_b128 a[172:175], v3 offset:44032
    ds_read_b128 a[176:179], v3 offset:45056
    ds_read_b128 a[180:183], v3 offset:46080
    ds_read_b128 a[184:187], v3 offset:47104
    ds_read_b128 a[188:191], v3 offset:48128
    s_nop 11
    v_mul_f32 v240, v96, v160
    v_mul_f32 v241, v80, v160
    v_mul_f32 v242, v97, v161
    v_mul_f32 v243, v81, v161
    v_mul_f32 v244, v98, v162
    v_mul_f32 v245, v82, v162
    v_mul_f32 v246, v99, v163
    v_mul_f32 v247, v83, v163
    v_fma_f32 v80, v80, v144, -v240
    v_fma_f32 v96, v96, v144, v241
    v_fma_f32 v81, v81, v145, -v242
    v_fma_f32 v97, v97, v145, v243
    v_fma_f32 v82, v82, v146, -v244
    v_fma_f32 v98, v98, v146, v245
    v_fma_f32 v83, v83, v147, -v246
    v_fma_f32 v99, v99, v147, v247
    v_mul_f32 v240, v100, v164
    v_mul_f32 v241, v84, v164
    v_mul_f32 v242, v101, v165
    v_mul_f32 v243, v85, v165
    v_mul_f32 v244, v102, v166
    v_mul_f32 v245, v86, v166
    v_mul_f32 v246, v103, v167
    v_mul_f32 v247, v87, v167
    v_fma_f32 v84, v84, v148, -v240
    v_fma_f32 v100, v100, v148, v241
    v_fma_f32 v85, v85, v149, -v242
    v_fma_f32 v101, v101, v149, v243
    v_fma_f32 v86, v86, v150, -v244
    v_fma_f32 v102, v102, v150, v245
    v_fma_f32 v87, v87, v151, -v246
    v_fma_f32 v103, v103, v151, v247
    v_mul_f32 v240, v104, v168
    v_mul_f32 v241, v88, v168
    v_mul_f32 v242, v105, v169
    v_mul_f32 v243, v89, v169
    v_mul_f32 v244, v106, v170
    v_mul_f32 v245, v90, v170
    v_mul_f32 v246, v107, v171
    v_mul_f32 v247, v91, v171
    v_fma_f32 v88, v88, v152, -v240
    v_fma_f32 v104, v104, v152, v241
    v_fma_f32 v89, v89, v153, -v242
    v_fma_f32 v105, v105, v153, v243
    v_fma_f32 v90, v90, v154, -v244
    v_fma_f32 v106, v106, v154, v245
    v_fma_f32 v91, v91, v155, -v246
    v_fma_f32 v107, v107, v155, v247
    v_mul_f32 v240, v108, v172
    v_mul_f32 v241, v92, v172
    v_mul_f32 v242, v109, v173
    v_mul_f32 v243, v93, v173
    v_mul_f32 v244, v110, v174
    v_mul_f32 v245, v94, v174
    v_mul_f32 v246, v111, v175
    v_mul_f32 v247, v95, v175
    v_fma_f32 v92, v92, v156, -v240
    v_fma_f32 v108, v108, v156, v241
    v_fma_f32 v93, v93, v157, -v242
    v_fma_f32 v109, v109, v157, v243
    v_fma_f32 v94, v94, v158, -v244
    v_fma_f32 v110, v110, v158, v245
    v_fma_f32 v95, v95, v159, -v246
    v_fma_f32 v111, v111, v159, v247
    v_cvt_pk_bf16_f32 v224, v80, v81
    v_cvt_pk_bf16_f32 v232, v96, v97
    v_cvt_pk_bf16_f32 v225, v82, v83
    v_cvt_pk_bf16_f32 v233, v98, v99
    v_cvt_pk_bf16_f32 v226, v84, v85
    v_cvt_pk_bf16_f32 v234, v100, v101
    v_cvt_pk_bf16_f32 v227, v86, v87
    v_cvt_pk_bf16_f32 v235, v102, v103
    v_cvt_pk_bf16_f32 v228, v88, v89
    v_cvt_pk_bf16_f32 v236, v104, v105
    v_cvt_pk_bf16_f32 v229, v90, v91
    v_cvt_pk_bf16_f32 v237, v106, v107
    v_cvt_pk_bf16_f32 v230, v92, v93
    v_cvt_pk_bf16_f32 v238, v108, v109
    v_cvt_pk_bf16_f32 v231, v94, v95
    v_cvt_pk_bf16_f32 v239, v110, v111
    s_waitcnt lgkmcnt(0)
    s_nop 0
    v_mfma_f32_32x32x16_bf16 v[48:63], v[208:211], a[96:99], 0
    v_mfma_f32_32x32x16_bf16 v[64:79], v[216:219], a[96:99], 0
    v_mfma_f32_32x32x16_bf16 v[48:63], v[216:219], a[160:163], v[48:63]
    v_mfma_f32_32x32x16_bf16 v[64:79], v[208:211], a[128:131], v[64:79]
    v_mfma_f32_32x32x16_bf16 v[48:63], v[212:215], a[100:103], v[48:63]
    v_mfma_f32_32x32x16_bf16 v[64:79], v[220:223], a[100:103], v[64:79]
    v_mfma_f32_32x32x16_bf16 v[48:63], v[220:223], a[164:167], v[48:63]
    v_mfma_f32_32x32x16_bf16 v[64:79], v[212:215], a[132:135], v[64:79]
    v_mfma_f32_32x32x16_bf16 v[48:63], v[224:227], a[104:107], v[48:63]
    v_mfma_f32_32x32x16_bf16 v[64:79], v[232:235], a[104:107], v[64:79]
    v_mfma_f32_32x32x16_bf16 v[48:63], v[232:235], a[168:171], v[48:63]
    v_mfma_f32_32x32x16_bf16 v[64:79], v[224:227], a[136:139], v[64:79]
    v_mfma_f32_32x32x16_bf16 v[48:63], v[228:231], a[108:111], v[48:63]
    v_mfma_f32_32x32x16_bf16 v[64:79], v[236:239], a[108:111], v[64:79]
    v_mfma_f32_32x32x16_bf16 v[48:63], v[236:239], a[172:175], v[48:63]
    v_mfma_f32_32x32x16_bf16 v[64:79], v[228:231], a[140:143], v[64:79]
    s_barrier
    s_cmp_eq_u32 s46, 288
    s_cbranch_scc1 P3_nyq_0
    v_mfma_f32_32x32x16_bf16 v[80:95], v[208:211], a[112:115], 0
    v_mfma_f32_32x32x16_bf16 v[96:111], v[216:219], a[112:115], 0
    s_nop 9
    v_cvt_pk_bf16_f32 v240, v48, v64
    ds_write_b32 v6, v240 offset:0
    v_mfma_f32_32x32x16_bf16 v[80:95], v[216:219], a[176:179], v[80:95]
    v_cvt_pk_bf16_f32 v241, v49, v65
    ds_write_b32 v6, v241 offset:128
    v_mfma_f32_32x32x16_bf16 v[96:111], v[208:211], a[144:147], v[96:111]
    v_cvt_pk_bf16_f32 v242, v50, v66
    ds_write_b32 v6, v242 offset:256
    v_mfma_f32_32x32x16_bf16 v[80:95], v[212:215], a[116:119], v[80:95]
    v_cvt_pk_bf16_f32 v243, v51, v67
    ds_write_b32 v6, v243 offset:384
    v_mfma_f32_32x32x16_bf16 v[96:111], v[220:223], a[116:119], v[96:111]
    v_cvt_pk_bf16_f32 v240, v52, v68
    ds_write_b32 v6, v240 offset:1024
    v_mfma_f32_32x32x16_bf16 v[80:95], v[220:223], a[180:183], v[80:95]
    v_cvt_pk_bf16_f32 v241, v53, v69
    ds_write_b32 v6, v241 offset:1152
    v_mfma_f32_32x32x16_bf16 v[96:111], v[212:215], a[148:151], v[96:111]
    v_cvt_pk_bf16_f32 v242, v54, v70
    ds_write_b32 v6, v242 offset:1280
    v_mfma_f32_32x32x16_bf16 v[80:95], v[224:227], a[120:123], v[80:95]
    v_cvt_pk_bf16_f32 v243, v55, v71
    ds_write_b32 v6, v243 offset:1408
    v_cvt_pk_bf16_f32 v240, v56, v72
    v_mfma_f32_32x32x16_bf16 v[96:111], v[232:235], a[120:123], v[96:111]
    ds_write_b32 v6, v240 offset:2048
    v_cvt_pk_bf16_f32 v241, v57, v73
    v_mfma_f32_32x32x16_bf16 v[80:95], v[232:235], a[184:187], v[80:95]
    ds_write_b32 v6, v241 offset:2176
    v_cvt_pk_bf16_f32 v242, v58, v74
    v_mfma_f32_32x32x16_bf16 v[96:111], v[224:227], a[152:155], v[96:111]
    ds_write_b32 v6, v242 offset:2304
    v_cvt_pk_bf16_f32 v243, v59, v75
    v_mfma_f32_32x32x16_bf16 v[80:95], v[228:231], a[124:127], v[80:95]
    ds_write_b32 v6, v243 offset:2432
    v_cvt_pk_bf16_f32 v240, v60, v76
    v_mfma_f32_32x32x16_bf16 v[96:111], v[236:239], a[124:127], v[96:111]
    ds_write_b32 v6, v240 offset:3072
    v_cvt_pk_bf16_f32 v241, v61, v77
    v_mfma_f32_32x32x16_bf16 v[80:95], v[236:239], a[188:191], v[80:95]
    ds_write_b32 v6, v241 offset:3200
    v_cvt_pk_bf16_f32 v242, v62, v78
    v_mfma_f32_32x32x16_bf16 v[96:111], v[228:231], a[156:159], v[96:111]
    ds_write_b32 v6, v242 offset:3328
    v_cvt_pk_bf16_f32 v243, v63, v79
    ds_write_b32 v6, v243 offset:3456
    s_nop 11
    v_cvt_pk_bf16_f32 v240, v80, v96
    ds_write_b32 v6, v240 offset:4096
    v_cvt_pk_bf16_f32 v241, v81, v97
    ds_write_b32 v6, v241 offset:4224
    v_cvt_pk_bf16_f32 v242, v82, v98
    ds_write_b32 v6, v242 offset:4352
    v_cvt_pk_bf16_f32 v243, v83, v99
    ds_write_b32 v6, v243 offset:4480
    v_cvt_pk_bf16_f32 v240, v84, v100
    ds_write_b32 v6, v240 offset:5120
    v_cvt_pk_bf16_f32 v241, v85, v101
    ds_write_b32 v6, v241 offset:5248
    v_cvt_pk_bf16_f32 v242, v86, v102
    ds_write_b32 v6, v242 offset:5376
    v_cvt_pk_bf16_f32 v243, v87, v103
    ds_write_b32 v6, v243 offset:5504
    v_cvt_pk_bf16_f32 v240, v88, v104
    ds_write_b32 v6, v240 offset:6144
    v_cvt_pk_bf16_f32 v241, v89, v105
    ds_write_b32 v6, v241 offset:6272
    v_cvt_pk_bf16_f32 v242, v90, v106
    ds_write_b32 v6, v242 offset:6400
    v_cvt_pk_bf16_f32 v243, v91, v107
    ds_write_b32 v6, v243 offset:6528
    v_cvt_pk_bf16_f32 v240, v92, v108
    ds_write_b32 v6, v240 offset:7168
    v_cvt_pk_bf16_f32 v241, v93, v109
    ds_write_b32 v6, v241 offset:7296
    v_cvt_pk_bf16_f32 v242, v94, v110
    ds_write_b32 v6, v242 offset:7424
    v_cvt_pk_bf16_f32 v243, v95, v111
    ds_write_b32 v6, v243 offset:7552
    s_branch P3_nyqend_0
P3_nyq_0:
    v_mfma_f32_32x32x16_bf16 v[80:95], v[208:211], a[112:115], 0
    v_mfma_f32_32x32x16_bf16 v[96:111], v[216:219], a[112:115], 0
    v_mfma_f32_32x32x16_bf16 v[80:95], v[216:219], a[176:179], v[80:95]
    v_mfma_f32_32x32x16_bf16 v[96:111], v[208:211], a[144:147], v[96:111]
    v_mfma_f32_32x32x16_bf16 v[80:95], v[212:215], a[116:119], v[80:95]
    v_mfma_f32_32x32x16_bf16 v[96:111], v[220:223], a[116:119], v[96:111]
    v_mfma_f32_32x32x16_bf16 v[80:95], v[220:223], a[180:183], v[80:95]
    v_mfma_f32_32x32x16_bf16 v[96:111], v[212:215], a[148:151], v[96:111]
    v_mfma_f32_32x32x16_bf16 v[80:95], v[224:227], a[120:123], v[80:95]
    v_mfma_f32_32x32x16_bf16 v[96:111], v[232:235], a[120:123], v[96:111]
    v_mfma_f32_32x32x16_bf16 v[80:95], v[232:235], a[184:187], v[80:95]
    v_mfma_f32_32x32x16_bf16 v[96:111], v[224:227], a[152:155], v[96:111]
    v_mfma_f32_32x32x16_bf16 v[80:95], v[228:231], a[124:127], v[80:95]
    v_mfma_f32_32x32x16_bf16 v[96:111], v[236:239], a[124:127], v[96:111]
    v_mfma_f32_32x32x16_bf16 v[80:95], v[236:239], a[188:191], v[80:95]
    v_mfma_f32_32x32x16_bf16 v[96:111], v[228:231], a[156:159], v[96:111]
    s_nop 11
    s_mov_b32 s45, 0
    buffer_store_dword v48, v9, s[16:19], s45 offen sc1
    s_mov_b32 s45, 128
    buffer_store_dword v49, v9, s[16:19], s45 offen sc1
    s_mov_b32 s45, 256
    buffer_store_dword v50, v9, s[16:19], s45 offen sc1
    s_mov_b32 s45, 384
    buffer_store_dword v51, v9, s[16:19], s45 offen sc1
    s_mov_b32 s45, 1024
    buffer_store_dword v52, v9, s[16:19], s45 offen sc1
    s_mov_b32 s45, 1152
    buffer_store_dword v53, v9, s[16:19], s45 offen sc1
    s_mov_b32 s45, 1280
    buffer_store_dword v54, v9, s[16:19], s45 offen sc1
    s_mov_b32 s45, 1408
    buffer_store_dword v55, v9, s[16:19], s45 offen sc1
    s_mov_b32 s45, 2048
    buffer_store_dword v56, v9, s[16:19], s45 offen sc1
    s_mov_b32 s45, 2176
    buffer_store_dword v57, v9, s[16:19], s45 offen sc1
    s_mov_b32 s45, 2304
    buffer_store_dword v58, v9, s[16:19], s45 offen sc1
    s_mov_b32 s45, 2432
    buffer_store_dword v59, v9, s[16:19], s45 offen sc1
    s_mov_b32 s45, 3072
    buffer_store_dword v60, v9, s[16:19], s45 offen sc1
    s_mov_b32 s45, 3200
    buffer_store_dword v61, v9, s[16:19], s45 offen sc1
    s_mov_b32 s45, 3328
    buffer_store_dword v62, v9, s[16:19], s45 offen sc1
    s_mov_b32 s45, 3456
    buffer_store_dword v63, v9, s[16:19], s45 offen sc1
    s_mov_b32 s45, 4096
    buffer_store_dword v80, v9, s[16:19], s45 offen sc1
    s_mov_b32 s45, 4224
    buffer_store_dword v81, v9, s[16:19], s45 offen sc1
    s_mov_b32 s45, 4352
    buffer_store_dword v82, v9, s[16:19], s45 offen sc1
    s_mov_b32 s45, 4480
    buffer_store_dword v83, v9, s[16:19], s45 offen sc1
    s_mov_b32 s45, 5120
    buffer_store_dword v84, v9, s[16:19], s45 offen sc1
    s_mov_b32 s45, 5248
    buffer_store_dword v85, v9, s[16:19], s45 offen sc1
    s_mov_b32 s45, 5376
    buffer_store_dword v86, v9, s[16:19], s45 offen sc1
    s_mov_b32 s45, 5504
    buffer_store_dword v87, v9, s[16:19], s45 offen sc1
    s_mov_b32 s45, 6144
    buffer_store_dword v88, v9, s[16:19], s45 offen sc1
    s_mov_b32 s45, 6272
    buffer_store_dword v89, v9, s[16:19], s45 offen sc1
    s_mov_b32 s45, 6400
    buffer_store_dword v90, v9, s[16:19], s45 offen sc1
    s_mov_b32 s45, 6528
    buffer_store_dword v91, v9, s[16:19], s45 offen sc1
    s_mov_b32 s45, 7168
    buffer_store_dword v92, v9, s[16:19], s45 offen sc1
    s_mov_b32 s45, 7296
    buffer_store_dword v93, v9, s[16:19], s45 offen sc1
    s_mov_b32 s45, 7424
    buffer_store_dword v94, v9, s[16:19], s45 offen sc1
    s_mov_b32 s45, 7552
    buffer_store_dword v95, v9, s[16:19], s45 offen sc1
P3_nyqend_0:
    s_branch P3_nocol_0
P3_skip_0:
    s_waitcnt vmcnt(0)
    s_barrier
    s_barrier
    s_barrier
P3_nocol_0:
    s_lshl_b32 s44, s40, 3
    s_add_u32 s44, s44, 4
    s_add_u32 s44, s44, s52
    s_waitcnt lgkmcnt(0)
    s_barrier
    s_lshl_b32 s45, s40, 1
    s_add_u32 s45, s45, 0
    s_cmp_ge_u32 s45, 72
    s_cbranch_scc1 P3_noflush_0
    s_lshl_b32 s45, s45, 15
    s_add_u32 s41, s45, 8650752
    ds_read_b32 v48, v7 offset:0
    ds_read_b32 v49, v7 offset:8192
    ds_read_b32 v50, v7 offset:16384
    ds_read_b32 v51, v7 offset:24576
    ds_read_b32 v52, v7 offset:1024
    ds_read_b32 v53, v7 offset:9216
    ds_read_b32 v54, v7 offset:17408
    ds_read_b32 v55, v7 offset:25600
    ds_read_b32 v56, v7 offset:2048
    ds_read_b32 v57, v7 offset:10240
    ds_read_b32 v58, v7 offset:18432
    ds_read_b32 v59, v7 offset:26624
    ds_read_b32 v60, v7 offset:3072
    ds_read_b32 v61, v7 offset:11264
    ds_read_b32 v62, v7 offset:19456
    ds_read_b32 v63, v7 offset:27648
    s_waitcnt lgkmcnt(12)
    ds_read_b32 v64, v7 offset:4096
    ds_read_b32 v65, v7 offset:12288
    ds_read_b32 v66, v7 offset:20480
    ds_read_b32 v67, v7 offset:28672
    s_waitcnt lgkmcnt(12)
    ds_read_b32 v68, v7 offset:5120
    ds_read_b32 v69, v7 offset:13312
    ds_read_b32 v70, v7 offset:21504
    ds_read_b32 v71, v7 offset:29696
    s_waitcnt lgkmcnt(12)
    ds_read_b32 v72, v7 offset:6144
    ds_read_b32 v73, v7 offset:14336
    ds_read_b32 v74, v7 offset:22528
    ds_read_b32 v75, v7 offset:30720
    s_waitcnt lgkmcnt(12)
    ds_read_b32 v76, v7 offset:7168
    ds_read_b32 v77, v7 offset:15360
    ds_read_b32 v78, v7 offset:23552
    ds_read_b32 v79, v7 offset:31744
    s_waitcnt lgkmcnt(12)
    s_waitcnt lgkmcnt(0)
    s_add_u32 s45, s41, 0
    buffer_store_dwordx4 v[48:51], v8, s[16:19], s45 offen sc1
    s_add_u32 s45, s41, 4096
    buffer_store_dwordx4 v[52:55], v8, s[16:19], s45 offen sc1
    s_add_u32 s45, s41, 8192
    buffer_store_dwordx4 v[56:59], v8, s[16:19], s45 offen sc1
    s_add_u32 s45, s41, 12288
    buffer_store_dwordx4 v[60:63], v8, s[16:19], s45 offen sc1
    s_add_u32 s45, s41, 16384
    buffer_store_dwordx4 v[64:67], v8, s[16:19], s45 offen sc1
    s_add_u32 s45, s41, 20480
    buffer_store_dwordx4 v[68:71], v8, s[16:19], s45 offen sc1
    s_add_u32 s45, s41, 24576
    buffer_store_dwordx4 v[72:75], v8, s[16:19], s45 offen sc1
    s_add_u32 s45, s41, 28672
    buffer_store_dwordx4 v[76:79], v8, s[16:19], s45 offen sc1
P3_noflush_0:
    s_mov_b32 s46, s44
    s_cmp_gt_u32 s46, 288
    s_cbranch_scc1 P3_skip_1
    ds_read_b128 v[112:115], v2 offset:0
    ds_read_b128 v[116:119], v2 offset:1024
    ds_read_b128 v[120:123], v2 offset:2048
    ds_read_b128 v[124:127], v2 offset:3072
    ds_read_b128 v[128:131], v2 offset:4096
    ds_read_b128 v[132:135], v2 offset:5120
    ds_read_b128 v[136:139], v2 offset:6144
    ds_read_b128 v[140:143], v2 offset:7168
    ds_read_b128 v[144:147], v2 offset:8192
    ds_read_b128 v[148:151], v2 offset:9216
    ds_read_b128 v[152:155], v2 offset:10240
    ds_read_b128 v[156:159], v2 offset:11264
    ds_read_b128 v[160:163], v2 offset:12288
    ds_read_b128 v[164:167], v2 offset:13312
    ds_read_b128 v[168:171], v2 offset:14336
    ds_read_b128 v[172:175], v2 offset:15360
    s_waitcnt vmcnt(8)
    v_mfma_f32_32x32x16_bf16 v[48:63], a[216:219], a[0:3], 0
    v_mfma_f32_32x32x16_bf16 v[64:79], a[232:235], a[0:3], 0
    v_mfma_f32_32x32x16_bf16 v[48:63], a[232:235], a[32:35], v[48:63]
    v_mfma_f32_32x32x16_bf16 v[64:79], a[216:219], a[64:67], v[64:79]
    v_mfma_f32_32x32x16_bf16 v[48:63], a[220:223], a[4:7], v[48:63]
    v_mfma_f32_32x32x16_bf16 v[64:79], a[236:239], a[4:7], v[64:79]
    v_mfma_f32_32x32x16_bf16 v[48:63], a[236:239], a[36:39], v[48:63]
    v_mfma_f32_32x32x16_bf16 v[64:79], a[220:223], a[68:71], v[64:79]
    v_mfma_f32_32x32x16_bf16 v[48:63], a[224:227], a[8:11], v[48:63]
    v_mfma_f32_32x32x16_bf16 v[64:79], a[240:243], a[8:11], v[64:79]
    v_mfma_f32_32x32x16_bf16 v[48:63], a[240:243], a[40:43], v[48:63]
    v_mfma_f32_32x32x16_bf16 v[64:79], a[224:227], a[72:75], v[64:79]
    v_mfma_f32_32x32x16_bf16 v[48:63], a[228:231], a[12:15], v[48:63]
    v_mfma_f32_32x32x16_bf16 v[64:79], a[244:247], a[12:15], v[64:79]
    v_mfma_f32_32x32x16_bf16 v[48:63], a[244:247], a[44:47], v[48:63]
    v_mfma_f32_32x32x16_bf16 v[64:79], a[228:231], a[76:79], v[64:79]
    s_waitcnt lgkmcnt(0)
    v_mfma_f32_32x32x16_bf16 v[80:95], a[216:219], a[16:19], 0
    v_mfma_f32_32x32x16_bf16 v[96:111], a[232:235], a[16:19], 0
    s_nop 9
    v_mul_f32 v240, v64, v128
    v_mul_f32 v241, v48, v128
    v_mul_f32 v242, v65, v129
    v_mul_f32 v243, v49, v129
    v_mul_f32 v244, v66, v130
    v_mfma_f32_32x32x16_bf16 v[80:95], a[232:235], a[48:51], v[80:95]
    v_mul_f32 v245, v50, v130
    v_mul_f32 v246, v67, v131
    v_mul_f32 v247, v51, v131
    v_fma_f32 v48, v48, v112, v240
    v_fma_f32 v64, v64, v112, -v241
    v_mfma_f32_32x32x16_bf16 v[96:111], a[216:219], a[80:83], v[96:111]
    v_fma_f32 v49, v49, v113, v242
    v_fma_f32 v65, v65, v113, -v243
    v_fma_f32 v50, v50, v114, v244
    v_fma_f32 v66, v66, v114, -v245
    v_fma_f32 v51, v51, v115, v246
    v_fma_f32 v67, v67, v115, -v247
    v_mfma_f32_32x32x16_bf16 v[80:95], a[220:223], a[20:23], v[80:95]
    v_mul_f32 v240, v68, v132
    v_mul_f32 v241, v52, v132
    v_mul_f32 v242, v69, v133
    v_mul_f32 v243, v53, v133
    v_mul_f32 v244, v70, v134
    v_mfma_f32_32x32x16_bf16 v[96:111], a[236:239], a[20:23], v[96:111]
    v_mul_f32 v245, v54, v134
    v_mul_f32 v246, v71, v135
    v_mul_f32 v247, v55, v135
    v_fma_f32 v52, v52, v116, v240
    v_fma_f32 v68, v68, v116, -v241
    v_mfma_f32_32x32x16_bf16 v[80:95], a[236:239], a[52:55], v[80:95]
    v_fma_f32 v53, v53, v117, v242
    v_fma_f32 v69, v69, v117, -v243
    v_fma_f32 v54, v54, v118, v244
    v_fma_f32 v70, v70, v118, -v245
    v_fma_f32 v55, v55, v119, v246
    v_fma_f32 v71, v71, v119, -v247
    v_mfma_f32_32x32x16_bf16 v[96:111], a[220:223], a[84:87], v[96:111]
    v_mul_f32 v240, v72, v136
    v_mul_f32 v241, v56, v136
    v_mul_f32 v242, v73, v137
    v_mul_f32 v243, v57, v137
    v_mul_f32 v244, v74, v138
    v_mfma_f32_32x32x16_bf16 v[80:95], a[224:227], a[24:27], v[80:95]
    v_mul_f32 v245, v58, v138
    v_mul_f32 v246, v75, v139
    v_mul_f32 v247, v59, v139
    v_fma_f32 v56, v56, v120, v240
    v_fma_f32 v72, v72, v120, -v241
    v_mfma_f32_32x32x16_bf16 v[96:111], a[240:243], a[24:27], v[96:111]
    v_fma_f32 v57, v57, v121, v242
    v_fma_f32 v73, v73, v121, -v243
    v_fma_f32 v58, v58, v122, v244
    v_fma_f32 v74, v74, v122, -v245
    v_fma_f32 v59, v59, v123, v246
    v_fma_f32 v75, v75, v123, -v247
    v_mfma_f32_32x32x16_bf16 v[80:95], a[240:243], a[56:59], v[80:95]
    v_mul_f32 v240, v76, v140
    v_mul_f32 v241, v60, v140
    v_mul_f32 v242, v77, v141
    v_mul_f32 v243, v61, v141
    v_mul_f32 v244, v78, v142
    v_mfma_f32_32x32x16_bf16 v[96:111], a[224:227], a[88:91], v[96:111]
    v_mul_f32 v245, v62, v142
    v_mul_f32 v246, v79, v143
    v_mul_f32 v247, v63, v143
    v_fma_f32 v60, v60, v124, v240
    v_fma_f32 v76, v76, v124, -v241
    v_mfma_f32_32x32x16_bf16 v[80:95], a[228:231], a[28:31], v[80:95]
    v_fma_f32 v61, v61, v125, v242
    v_fma_f32 v77, v77, v125, -v243
    v_fma_f32 v62, v62, v126, v244
    v_fma_f32 v78, v78, v126, -v245
    v_fma_f32 v63, v63, v127, v246
    v_fma_f32 v79, v79, v127, -v247
    v_mfma_f32_32x32x16_bf16 v[96:111], a[244:247], a[28:31], v[96:111]
    v_cvt_pk_bf16_f32 v176, v48, v49
    v_cvt_pk_bf16_f32 v184, v64, v65
    v_cvt_pk_bf16_f32 v177, v50, v51
    v_cvt_pk_bf16_f32 v185, v66, v67
    v_cvt_pk_bf16_f32 v178, v52, v53
    v_mfma_f32_32x32x16_bf16 v[80:95], a[244:247], a[60:63], v[80:95]
    v_cvt_pk_bf16_f32 v186, v68, v69
    v_cvt_pk_bf16_f32 v179, v54, v55
    v_cvt_pk_bf16_f32 v187, v70, v71
    v_cvt_pk_bf16_f32 v180, v56, v57
    v_cvt_pk_bf16_f32 v188, v72, v73
    v_mfma_f32_32x32x16_bf16 v[96:111], a[228:231], a[92:95], v[96:111]
    v_cvt_pk_bf16_f32 v181, v58, v59
    v_cvt_pk_bf16_f32 v189, v74, v75
    v_cvt_pk_bf16_f32 v182, v60, v61
    v_cvt_pk_bf16_f32 v190, v76, v77
    v_cvt_pk_bf16_f32 v183, v62, v63
    v_cvt_pk_bf16_f32 v191, v78, v79
    s_nop 1
    v_mfma_f32_32x32x16_bf16 v[48:63], a[192:195], v[176:179], 0
    v_mfma_f32_32x32x16_bf16 v[64:79], a[192:195], v[184:187], 0
    ds_read_b128 v[112:115], v2 offset:16384
    ds_read_b128 v[116:119], v2 offset:17408
    ds_read_b128 v[120:123], v2 offset:18432
    ds_read_b128 v[124:127], v2 offset:19456
    ds_read_b128 v[128:131], v2 offset:20480
    ds_read_b128 v[132:135], v2 offset:21504
    ds_read_b128 v[136:139], v2 offset:22528
    ds_read_b128 v[140:143], v2 offset:23552
    s_nop 1
    v_mul_f32 v240, v96, v160
    v_mul_f32 v241, v80, v160
    v_mul_f32 v242, v97, v161
    v_mul_f32 v243, v81, v161
    v_mfma_f32_32x32x16_bf16 v[48:63], a[200:203], v[184:187], v[48:63]
    v_mul_f32 v244, v98, v162
    v_mul_f32 v245, v82, v162
    v_mul_f32 v246, v99, v163
    v_mul_f32 v247, v83, v163
    v_fma_f32 v80, v80, v144, v240
    v_fma_f32 v96, v96, v144, -v241
    v_fma_f32 v81, v81, v145, v242
    v_fma_f32 v97, v97, v145, -v243
    v_fma_f32 v82, v82, v146, v244
    v_fma_f32 v98, v98, v146, -v245
    v_fma_f32 v83, v83, v147, v246
    v_fma_f32 v99, v99, v147, -v247
    v_mul_f32 v240, v100, v164
    v_mfma_f32_32x32x16_bf16 v[64:79], a[208:211], v[176:179], v[64:79]
    v_mul_f32 v241, v84, v164
    v_mul_f32 v242, v101, v165
    v_mul_f32 v243, v85, v165
    v_mul_f32 v244, v102, v166
    v_mul_f32 v245, v86, v166
    v_mul_f32 v246, v103, v167
    v_mul_f32 v247, v87, v167
    v_fma_f32 v84, v84, v148, v240
    v_fma_f32 v100, v100, v148, -v241
    v_fma_f32 v85, v85, v149, v242
    v_fma_f32 v101, v101, v149, -v243
    v_fma_f32 v86, v86, v150, v244
    v_mfma_f32_32x32x16_bf16 v[48:63], a[196:199], v[180:183], v[48:63]
    v_fma_f32 v102, v102, v150, -v245
    v_fma_f32 v87, v87, v151, v246
    v_fma_f32 v103, v103, v151, -v247
    v_mul_f32 v240, v104, v168
    v_mul_f32 v241, v88, v168
    v_mul_f32 v242, v105, v169
    v_mul_f32 v243, v89, v169
    v_mul_f32 v244, v106, v170
    v_mul_f32 v245, v90, v170
    v_mul_f32 v246, v107, v171
    v_mul_f32 v247, v91, v171
    v_fma_f32 v88, v88, v152, v240
    v_fma_f32 v104, v104, v152, -v241
    v_mfma_f32_32x32x16_bf16 v[64:79], a[196:199], v[188:191], v[64:79]
    v_fma_f32 v89, v89, v153, v242
    v_fma_f32 v105, v105, v153, -v243
    v_fma_f32 v90, v90, v154, v244
    v_fma_f32 v106, v106, v154, -v245
    v_fma_f32 v91, v91, v155, v246
    v_fma_f32 v107, v107, v155, -v247
    v_mul_f32 v240, v108, v172
    v_mul_f32 v241, v92, v172
    v_mul_f32 v242, v109, v173
    v_mul_f32 v243, v93, v173
    v_mul_f32 v244, v110, v174
    v_mul_f32 v245, v94, v174
    v_mfma_f32_32x32x16_bf16 v[48:63], a[204:207], v[188:191], v[48:63]
    v_mul_f32 v246, v111, v175
    v_mul_f32 v247, v95, v175
    v_fma_f32 v92, v92, v156, v240
    v_fma_f32 v108, v108, v156, -v241
    v_fma_f32 v93, v93, v157, v242
    v_fma_f32 v109, v109, v157, -v243
    v_fma_f32 v94, v94, v158, v244
    v_fma_f32 v110, v110, v158, -v245
    v_fma_f32 v95, v95, v159, v246
    v_fma_f32 v111, v111, v159, -v247
    v_cvt_pk_bf16_f32 v192, v80, v81
    v_cvt_pk_bf16_f32 v200, v96, v97
    v_cvt_pk_bf16_f32 v193, v82, v83
    v_mfma_f32_32x32x16_bf16 v[64:79], a[212:215], v[180:183], v[64:79]
    v_cvt_pk_bf16_f32 v201, v98, v99
    v_cvt_pk_bf16_f32 v194, v84, v85
    v_cvt_pk_bf16_f32 v202, v100, v101
    v_cvt_pk_bf16_f32 v195, v86, v87
    v_cvt_pk_bf16_f32 v203, v102, v103
    v_cvt_pk_bf16_f32 v196, v88, v89
    v_cvt_pk_bf16_f32 v204, v104, v105
    v_cvt_pk_bf16_f32 v197, v90, v91
    v_cvt_pk_bf16_f32 v205, v106, v107
    v_cvt_pk_bf16_f32 v198, v92, v93
    v_cvt_pk_bf16_f32 v206, v108, v109
    v_cvt_pk_bf16_f32 v199, v94, v95
    v_cvt_pk_bf16_f32 v207, v110, v111
    ds_read_b128 v[16:19], v5 offset:0
    ds_read_b128 v[20:23], v5 offset:8192
    ds_read_b128 v[24:27], v5 offset:16384
    ds_read_b128 v[28:31], v5 offset:24576
    ds_read_b128 v[32:35], v5 offset:32768
    ds_read_b128 v[36:39], v5 offset:40960
    ds_read_b128 v[40:43], v5 offset:49152
    ds_read_b128 v[44:47], v5 offset:57344
    s_waitcnt lgkmcnt(0)
    s_nop 1
    v_mfma_f32_32x32x16_bf16 v[80:95], a[192:195], v[192:195], 0
    v_mfma_f32_32x32x16_bf16 v[96:111], a[192:195], v[200:203], 0
    ds_read_b128 v[144:147], v2 offset:24576
    ds_read_b128 v[148:151], v2 offset:25600
    ds_read_b128 v[152:155], v2 offset:26624
    ds_read_b128 v[156:159], v2 offset:27648
    ds_read_b128 v[160:163], v2 offset:28672
    ds_read_b128 v[164:167], v2 offset:29696
    ds_read_b128 v[168:171], v2 offset:30720
    ds_read_b128 v[172:175], v2 offset:31744
    v_lshlrev_b32 v248, 16, v16
    v_lshlrev_b32 v249, 16, v24
    v_and_b32 v250, s27, v16
    v_and_b32 v251, s27, v24
    v_mul_f32 v252, v64, v249
    v_mul_f32 v253, v48, v249
    v_mul_f32 v254, v65, v251
    v_mul_f32 v255, v49, v251
    v_fma_f32 v48, v48, v248, -v252
    v_mfma_f32_32x32x16_bf16 v[80:95], a[200:203], v[200:203], v[80:95]
    v_fma_f32 v64, v64, v248, v253
    v_fma_f32 v49, v49, v250, -v254
    v_fma_f32 v65, v65, v250, v255
    v_lshlrev_b32 v248, 16, v17
    v_lshlrev_b32 v249, 16, v25
    v_and_b32 v250, s27, v17
    v_and_b32 v251, s27, v25
    v_mul_f32 v252, v66, v249
    v_mul_f32 v253, v50, v249
    v_mul_f32 v254, v67, v251
    v_mul_f32 v255, v51, v251
    v_fma_f32 v50, v50, v248, -v252
    v_fma_f32 v66, v66, v248, v253
    v_fma_f32 v51, v51, v250, -v254
    v_fma_f32 v67, v67, v250, v255
    v_lshlrev_b32 v248, 16, v18
    v_lshlrev_b32 v249, 16, v26
    v_mfma_f32_32x32x16_bf16 v[96:111], a[208:211], v[192:195], v[96:111]
    v_and_b32 v250, s27, v18
    v_and_b32 v251, s27, v26
    v_mul_f32 v252, v68, v249
    v_mul_f32 v253, v52, v249
    v_mul_f32 v254, v69, v251
    v_mul_f32 v255, v53, v251
    v_fma_f32 v52, v52, v248, -v252
    v_fma_f32 v68, v68, v248, v253
    v_fma_f32 v53, v53, v250, -v254
    v_fma_f32 v69, v69, v250, v255
    v_lshlrev_b32 v248, 16, v19
    v_lshlrev_b32 v249, 16, v27
    v_and_b32 v250, s27, v19
    v_and_b32 v251, s27, v27
    v_mul_f32 v252, v70, v249
    v_mul_f32 v253, v54, v249
    v_mul_f32 v254, v71, v251
    v_mfma_f32_32x32x16_bf16 v[80:95], a[196:199], v[196:199], v[80:95]
    v_mul_f32 v255, v55, v251
    v_fma_f32 v54, v54, v248, -v252
    v_fma_f32 v70, v70, v248, v253
    v_fma_f32 v55, v55, v250, -v254
    v_fma_f32 v71, v71, v250, v255
    v_lshlrev_b32 v248, 16, v20
    v_lshlrev_b32 v249, 16, v28
    v_and_b32 v250, s27, v20
    v_and_b32 v251, s27, v28
    v_mul_f32 v252, v72, v249
    v_mul_f32 v253, v56, v249
    v_mul_f32 v254, v73, v251
    v_mul_f32 v255, v57, v251
    v_fma_f32 v56, v56, v248, -v252
    v_fma_f32 v72, v72, v248, v253
    v_fma_f32 v57, v57, v250, -v254
    v_fma_f32 v73, v73, v250, v255
    v_mfma_f32_32x32x16_bf16 v[96:111], a[196:199], v[204:207], v[96:111]
    v_lshlrev_b32 v248, 16, v21
    v_lshlrev_b32 v249, 16, v29
    v_and_b32 v250, s27, v21
    v_and_b32 v251, s27, v29
    v_mul_f32 v252, v74, v249
    v_mul_f32 v253, v58, v249
    v_mul_f32 v254, v75, v251
    v_mul_f32 v255, v59, v251
    v_fma_f32 v58, v58, v248, -v252
    v_fma_f32 v74, v74, v248, v253
    v_fma_f32 v59, v59, v250, -v254
    v_fma_f32 v75, v75, v250, v255
    v_lshlrev_b32 v248, 16, v22
    v_lshlrev_b32 v249, 16, v30
    v_and_b32 v250, s27, v22
    v_and_b32 v251, s27, v30
    v_mul_f32 v252, v76, v249
    v_mfma_f32_32x32x16_bf16 v[80:95], a[204:207], v[204:207], v[80:95]
    v_mul_f32 v253, v60, v249
    v_mul_f32 v254, v77, v251
    v_mul_f32 v255, v61, v251
    v_fma_f32 v60, v60, v248, -v252
    v_fma_f32 v76, v76, v248, v253
    v_fma_f32 v61, v61, v250, -v254
    v_fma_f32 v77, v77, v250, v255
    v_lshlrev_b32 v248, 16, v23
    v_lshlrev_b32 v249, 16, v31
    v_and_b32 v250, s27, v23
    v_and_b32 v251, s27, v31
    v_mul_f32 v252, v78, v249
    v_mul_f32 v253, v62, v249
    v_mul_f32 v254, v79, v251
    v_mul_f32 v255, v63, v251
    v_fma_f32 v62, v62, v248, -v252
    v_fma_f32 v78, v78, v248, v253
    v_mfma_f32_32x32x16_bf16 v[96:111], a[212:215], v[196:199], v[96:111]
    v_fma_f32 v63, v63, v250, -v254
    v_fma_f32 v79, v79, v250, v255
    v_cvt_pk_bf16_f32 v176, v48, v49
    v_cvt_pk_bf16_f32 v184, v64, v65
    v_cvt_pk_bf16_f32 v177, v50, v51
    v_cvt_pk_bf16_f32 v185, v66, v67
    v_cvt_pk_bf16_f32 v178, v52, v53
    v_cvt_pk_bf16_f32 v186, v68, v69
    v_cvt_pk_bf16_f32 v179, v54, v55
    v_cvt_pk_bf16_f32 v187, v70, v71
    v_cvt_pk_bf16_f32 v180, v56, v57
    v_cvt_pk_bf16_f32 v188, v72, v73
    v_cvt_pk_bf16_f32 v181, v58, v59
    v_cvt_pk_bf16_f32 v189, v74, v75
    v_cvt_pk_bf16_f32 v182, v60, v61
    v_cvt_pk_bf16_f32 v190, v76, v77
    v_cvt_pk_bf16_f32 v183, v62, v63
    v_cvt_pk_bf16_f32 v191, v78, v79
    s_nop 1
    v_mfma_f32_32x32x16_bf16 v[48:63], v[176:179], a[192:195], 0
    v_mfma_f32_32x32x16_bf16 v[64:79], v[184:187], a[192:195], 0
    v_lshlrev_b32 v248, 16, v32
    v_lshlrev_b32 v249, 16, v40
    v_and_b32 v250, s27, v32
    v_and_b32 v251, s27, v40
    s_nop 5
    v_mul_f32 v252, v96, v249
    v_mul_f32 v253, v80, v249
    v_mul_f32 v254, v97, v251
    v_mul_f32 v255, v81, v251
    v_fma_f32 v80, v80, v248, -v252
    v_fma_f32 v96, v96, v248, v253
    v_fma_f32 v81, v81, v250, -v254
    v_fma_f32 v97, v97, v250, v255
    v_lshlrev_b32 v248, 16, v33
    v_lshlrev_b32 v249, 16, v41
    v_and_b32 v250, s27, v33
    v_and_b32 v251, s27, v41
    v_mfma_f32_32x32x16_bf16 v[48:63], v[184:187], a[208:211], v[48:63]
    v_mul_f32 v252, v98, v249
    v_mul_f32 v253, v82, v249
    v_mul_f32 v254, v99, v251
    v_mul_f32 v255, v83, v251
    v_fma_f32 v82, v82, v248, -v252
    v_fma_f32 v98, v98, v248, v253
    v_fma_f32 v83, v83, v250, -v254
    v_fma_f32 v99, v99, v250, v255
    v_lshlrev_b32 v248, 16, v34
    v_lshlrev_b32 v249, 16, v42
    v_and_b32 v250, s27, v34
    v_and_b32 v251, s27, v42
    v_mul_f32 v252, v100, v249
    v_mul_f32 v253, v84, v249
    v_mul_f32 v254, v101, v251
    v_mul_f32 v255, v85, v251
    v_mfma_f32_32x32x16_bf16 v[64:79], v[176:179], a[200:203], v[64:79]
    v_fma_f32 v84, v84, v248, -v252
    v_fma_f32 v100, v100, v248, v253
    v_fma_f32 v85, v85, v250, -v254
    v_fma_f32 v101, v101, v250, v255
    v_lshlrev_b32 v248, 16, v35
    v_lshlrev_b32 v249, 16, v43
    v_and_b32 v250, s27, v35
    v_and_b32 v251, s27, v43
    v_mul_f32 v252, v102, v249
    v_mul_f32 v253, v86, v249
    v_mul_f32 v254, v103, v251
    v_mul_f32 v255, v87, v251
    v_fma_f32 v86, v86, v248, -v252
    v_fma_f32 v102, v102, v248, v253
    v_fma_f32 v87, v87, v250, -v254
    v_fma_f32 v103, v103, v250, v255
    v_mfma_f32_32x32x16_bf16 v[48:63], v[180:183], a[196:199], v[48:63]
    v_lshlrev_b32 v248, 16, v36
    v_lshlrev_b32 v249, 16, v44
    v_and_b32 v250, s27, v36
    v_and_b32 v251, s27, v44
    v_mul_f32 v252, v104, v249
    v_mul_f32 v253, v88, v249
    v_mul_f32 v254, v105, v251
    v_mul_f32 v255, v89, v251
    v_fma_f32 v88, v88, v248, -v252
    v_fma_f32 v104, v104, v248, v253
    v_fma_f32 v89, v89, v250, -v254
    v_fma_f32 v105, v105, v250, v255
    v_lshlrev_b32 v248, 16, v37
    v_lshlrev_b32 v249, 16, v45
    v_and_b32 v250, s27, v37
    v_and_b32 v251, s27, v45
    v_mfma_f32_32x32x16_bf16 v[64:79], v[188:191], a[196:199], v[64:79]
    v_mul_f32 v252, v106, v249
    v_mul_f32 v253, v90, v249
    v_mul_f32 v254, v107, v251
    v_mul_f32 v255, v91, v251
    v_fma_f32 v90, v90, v248, -v252
    v_fma_f32 v106, v106, v248, v253
    v_fma_f32 v91, v91, v250, -v254
    v_fma_f32 v107, v107, v250, v255
    v_lshlrev_b32 v248, 16, v38
    v_lshlrev_b32 v249, 16, v46
    v_and_b32 v250, s27, v38
    v_and_b32 v251, s27, v46
    v_mul_f32 v252, v108, v249
    v_mul_f32 v253, v92, v249
    v_mul_f32 v254, v109, v251
    v_mul_f32 v255, v93, v251
    v_mfma_f32_32x32x16_bf16 v[48:63], v[188:191], a[212:215], v[48:63]
    v_fma_f32 v92, v92, v248, -v252
    v_fma_f32 v108, v108, v248, v253
    v_fma_f32 v93, v93, v250, -v254
    v_fma_f32 v109, v109, v250, v255
    v_lshlrev_b32 v248, 16, v39
    v_lshlrev_b32 v249, 16, v47
    v_and_b32 v250, s27, v39
    v_and_b32 v251, s27, v47
    v_mul_f32 v252, v110, v249
    v_mul_f32 v253, v94, v249
    v_mul_f32 v254, v111, v251
    v_mul_f32 v255, v95, v251
    v_fma_f32 v94, v94, v248, -v252
    v_fma_f32 v110, v110, v248, v253
    v_fma_f32 v95, v95, v250, -v254
    v_fma_f32 v111, v111, v250, v255
    v_mfma_f32_32x32x16_bf16 v[64:79], v[180:183], a[204:207], v[64:79]
    v_cvt_pk_bf16_f32 v192, v80, v81
    v_cvt_pk_bf16_f32 v200, v96, v97
    v_cvt_pk_bf16_f32 v193, v82, v83
    v_cvt_pk_bf16_f32 v201, v98, v99
    v_cvt_pk_bf16_f32 v194, v84, v85
    v_cvt_pk_bf16_f32 v202, v100, v101
    v_cvt_pk_bf16_f32 v195, v86, v87
    v_cvt_pk_bf16_f32 v203, v102, v103
    v_cvt_pk_bf16_f32 v196, v88, v89
    v_cvt_pk_bf16_f32 v204, v104, v105
    v_cvt_pk_bf16_f32 v197, v90, v91
    v_cvt_pk_bf16_f32 v205, v106, v107
    v_cvt_pk_bf16_f32 v198, v92, v93
    v_cvt_pk_bf16_f32 v206, v108, v109
    v_cvt_pk_bf16_f32 v199, v94, v95
    v_cvt_pk_bf16_f32 v207, v110, v111
    s_waitcnt lgkmcnt(0)
    s_nop 1
    v_mfma_f32_32x32x16_bf16 v[80:95], v[192:195], a[192:195], 0
    v_mfma_f32_32x32x16_bf16 v[96:111], v[200:203], a[192:195], 0
    s_nop 9
    v_mul_f32 v240, v64, v128
    v_mul_f32 v241, v48, v128
    v_mul_f32 v242, v65, v129
    v_mul_f32 v243, v49, v129
    v_mul_f32 v244, v66, v130
    v_mul_f32 v245, v50, v130
    v_mul_f32 v246, v67, v131
    v_mul_f32 v247, v51, v131
    v_fma_f32 v48, v48, v112, -v240
    v_fma_f32 v64, v64, v112, v241
    v_fma_f32 v49, v49, v113, -v242
    v_mfma_f32_32x32x16_bf16 v[80:95], v[200:203], a[208:211], v[80:95]
    v_fma_f32 v65, v65, v113, v243
    v_fma_f32 v50, v50, v114, -v244
    v_fma_f32 v66, v66, v114, v245
    v_fma_f32 v51, v51, v115, -v246
    v_fma_f32 v67, v67, v115, v247
    v_mul_f32 v240, v68, v132
    v_mul_f32 v241, v52, v132
    v_mul_f32 v242, v69, v133
    v_mul_f32 v243, v53, v133
    v_mul_f32 v244, v70, v134
    v_mul_f32 v245, v54, v134
    v_mfma_f32_32x32x16_bf16 v[96:111], v[192:195], a[200:203], v[96:111]
    v_mul_f32 v246, v71, v135
    v_mul_f32 v247, v55, v135
    v_fma_f32 v52, v52, v116, -v240
    v_fma_f32 v68, v68, v116, v241
    v_fma_f32 v53, v53, v117, -v242
    v_fma_f32 v69, v69, v117, v243
    v_fma_f32 v54, v54, v118, -v244
    v_fma_f32 v70, v70, v118, v245
    v_fma_f32 v55, v55, v119, -v246
    v_fma_f32 v71, v71, v119, v247
    v_mul_f32 v240, v72, v136
    v_mul_f32 v241, v56, v136
    v_mfma_f32_32x32x16_bf16 v[80:95], v[196:199], a[196:199], v[80:95]
    v_mul_f32 v242, v73, v137
    v_mul_f32 v243, v57, v137
    v_mul_f32 v244, v74, v138
    v_mul_f32 v245, v58, v138
    v_mul_f32 v246, v75, v139
    v_mul_f32 v247, v59, v139
    v_fma_f32 v56, v56, v120, -v240
    v_fma_f32 v72, v72, v120, v241
    v_fma_f32 v57, v57, v121, -v242
    v_fma_f32 v73, v73, v121, v243
    v_fma_f32 v58, v58, v122, -v244
    v_mfma_f32_32x32x16_bf16 v[96:111], v[204:207], a[196:199], v[96:111]
    v_fma_f32 v74, v74, v122, v245
    v_fma_f32 v59, v59, v123, -v246
    v_fma_f32 v75, v75, v123, v247
    v_mul_f32 v240, v76, v140
    v_mul_f32 v241, v60, v140
    v_mul_f32 v242, v77, v141
    v_mul_f32 v243, v61, v141
    v_mul_f32 v244, v78, v142
    v_mul_f32 v245, v62, v142
    v_mul_f32 v246, v79, v143
    v_mul_f32 v247, v63, v143
    v_fma_f32 v60, v60, v124, -v240
    v_mfma_f32_32x32x16_bf16 v[80:95], v[204:207], a[212:215], v[80:95]
    v_fma_f32 v76, v76, v124, v241
    v_fma_f32 v61, v61, v125, -v242
    v_fma_f32 v77, v77, v125, v243
    v_fma_f32 v62, v62, v126, -v244
    v_fma_f32 v78, v78, v126, v245
    v_fma_f32 v63, v63, v127, -v246
    v_fma_f32 v79, v79, v127, v247
    v_cvt_pk_bf16_f32 v208, v48, v49
    v_cvt_pk_bf16_f32 v216, v64, v65
    v_cvt_pk_bf16_f32 v209, v50, v51
    v_cvt_pk_bf16_f32 v217, v66, v67
    v_mfma_f32_32x32x16_bf16 v[96:111], v[196:199], a[204:207], v[96:111]
    v_cvt_pk_bf16_f32 v210, v52, v53
    v_cvt_pk_bf16_f32 v218, v68, v69
    v_cvt_pk_bf16_f32 v211, v54, v55
    v_cvt_pk_bf16_f32 v219, v70, v71
    v_cvt_pk_bf16_f32 v212, v56, v57
    v_cvt_pk_bf16_f32 v220, v72, v73
    v_cvt_pk_bf16_f32 v213, v58, v59
    v_cvt_pk_bf16_f32 v221, v74, v75
    v_cvt_pk_bf16_f32 v214, v60, v61
    v_cvt_pk_bf16_f32 v222, v76, v77
    v_cvt_pk_bf16_f32 v215, v62, v63
    v_cvt_pk_bf16_f32 v223, v78, v79
    s_nop 11
    v_mul_f32 v240, v96, v160
    v_mul_f32 v241, v80, v160
    v_mul_f32 v242, v97, v161
    v_mul_f32 v243, v81, v161
    v_mul_f32 v244, v98, v162
    v_mul_f32 v245, v82, v162
    v_mul_f32 v246, v99, v163
    v_mul_f32 v247, v83, v163
    v_fma_f32 v80, v80, v144, -v240
    v_fma_f32 v96, v96, v144, v241
    v_fma_f32 v81, v81, v145, -v242
    v_fma_f32 v97, v97, v145, v243
    v_fma_f32 v82, v82, v146, -v244
    v_fma_f32 v98, v98, v146, v245
    v_fma_f32 v83, v83, v147, -v246
    v_fma_f32 v99, v99, v147, v247
    v_mul_f32 v240, v100, v164
    v_mul_f32 v241, v84, v164
    v_mul_f32 v242, v101, v165
    v_mul_f32 v243, v85, v165
    v_mul_f32 v244, v102, v166
    v_mul_f32 v245, v86, v166
    v_mul_f32 v246, v103, v167
    v_mul_f32 v247, v87, v167
    v_fma_f32 v84, v84, v148, -v240
    v_fma_f32 v100, v100, v148, v241
    v_fma_f32 v85, v85, v149, -v242
    v_fma_f32 v101, v101, v149, v243
    v_fma_f32 v86, v86, v150, -v244
    v_fma_f32 v102, v102, v150, v245
    v_fma_f32 v87, v87, v151, -v246
    v_fma_f32 v103, v103, v151, v247
    v_mul_f32 v240, v104, v168
    v_mul_f32 v241, v88, v168
    v_mul_f32 v242, v105, v169
    v_mul_f32 v243, v89, v169
    v_mul_f32 v244, v106, v170
    v_mul_f32 v245, v90, v170
    v_mul_f32 v246, v107, v171
    v_mul_f32 v247, v91, v171
    v_fma_f32 v88, v88, v152, -v240
    v_fma_f32 v104, v104, v152, v241
    v_fma_f32 v89, v89, v153, -v242
    v_fma_f32 v105, v105, v153, v243
    v_fma_f32 v90, v90, v154, -v244
    v_fma_f32 v106, v106, v154, v245
    v_fma_f32 v91, v91, v155, -v246
    v_fma_f32 v107, v107, v155, v247
    v_mul_f32 v240, v108, v172
    v_mul_f32 v241, v92, v172
    v_mul_f32 v242, v109, v173
    v_mul_f32 v243, v93, v173
    v_mul_f32 v244, v110, v174
    v_mul_f32 v245, v94, v174
    v_mul_f32 v246, v111, v175
    v_mul_f32 v247, v95, v175
    v_fma_f32 v92, v92, v156, -v240
    v_fma_f32 v108, v108, v156, v241
    v_fma_f32 v93, v93, v157, -v242
    v_fma_f32 v109, v109, v157, v243
    v_fma_f32 v94, v94, v158, -v244
    v_fma_f32 v110, v110, v158, v245
    v_fma_f32 v95, v95, v159, -v246
    v_fma_f32 v111, v111, v159, v247
    v_cvt_pk_bf16_f32 v224, v80, v81
    v_cvt_pk_bf16_f32 v232, v96, v97
    v_cvt_pk_bf16_f32 v225, v82, v83
    v_cvt_pk_bf16_f32 v233, v98, v99
    v_cvt_pk_bf16_f32 v226, v84, v85
    v_cvt_pk_bf16_f32 v234, v100, v101
    v_cvt_pk_bf16_f32 v227, v86, v87
    v_cvt_pk_bf16_f32 v235, v102, v103
    v_cvt_pk_bf16_f32 v228, v88, v89
    v_cvt_pk_bf16_f32 v236, v104, v105
    v_cvt_pk_bf16_f32 v229, v90, v91
    v_cvt_pk_bf16_f32 v237, v106, v107
    v_cvt_pk_bf16_f32 v230, v92, v93
    v_cvt_pk_bf16_f32 v238, v108, v109
    v_cvt_pk_bf16_f32 v231, v94, v95
    v_cvt_pk_bf16_f32 v239, v110, v111
    s_waitcnt lgkmcnt(0)
    s_nop 0
    v_mfma_f32_32x32x16_bf16 v[48:63], v[208:211], a[96:99], 0
    v_mfma_f32_32x32x16_bf16 v[64:79], v[216:219], a[96:99], 0
    v_mfma_f32_32x32x16_bf16 v[48:63], v[216:219], a[160:163], v[48:63]
    v_mfma_f32_32x32x16_bf16 v[64:79], v[208:211], a[128:131], v[64:79]
    v_mfma_f32_32x32x16_bf16 v[48:63], v[212:215], a[100:103], v[48:63]
    v_mfma_f32_32x32x16_bf16 v[64:79], v[220:223], a[100:103], v[64:79]
    v_mfma_f32_32x32x16_bf16 v[48:63], v[220:223], a[164:167], v[48:63]
    v_mfma_f32_32x32x16_bf16 v[64:79], v[212:215], a[132:135], v[64:79]
    v_mfma_f32_32x32x16_bf16 v[48:63], v[224:227], a[104:107], v[48:63]
    v_mfma_f32_32x32x16_bf16 v[64:79], v[232:235], a[104:107], v[64:79]
    v_mfma_f32_32x32x16_bf16 v[48:63], v[232:235], a[168:171], v[48:63]
    v_mfma_f32_32x32x16_bf16 v[64:79], v[224:227], a[136:139], v[64:79]
    v_mfma_f32_32x32x16_bf16 v[48:63], v[228:231], a[108:111], v[48:63]
    v_mfma_f32_32x32x16_bf16 v[64:79], v[236:239], a[108:111], v[64:79]
    v_mfma_f32_32x32x16_bf16 v[48:63], v[236:239], a[172:175], v[48:63]
    v_mfma_f32_32x32x16_bf16 v[64:79], v[228:231], a[140:143], v[64:79]
    s_barrier
    s_cmp_eq_u32 s46, 288
    s_cbranch_scc1 P3_nyq_1
    v_mfma_f32_32x32x16_bf16 v[80:95], v[208:211], a[112:115], 0
    v_mfma_f32_32x32x16_bf16 v[96:111], v[216:219], a[112:115], 0
    s_nop 9
    v_cvt_pk_bf16_f32 v240, v48, v64
    ds_write_b32 v6, v240 offset:0
    v_mfma_f32_32x32x16_bf16 v[80:95], v[216:219], a[176:179], v[80:95]
    v_cvt_pk_bf16_f32 v241, v49, v65
    ds_write_b32 v6, v241 offset:128
    v_mfma_f32_32x32x16_bf16 v[96:111], v[208:211], a[144:147], v[96:111]
    v_cvt_pk_bf16_f32 v242, v50, v66
    ds_write_b32 v6, v242 offset:256
    v_mfma_f32_32x32x16_bf16 v[80:95], v[212:215], a[116:119], v[80:95]
    v_cvt_pk_bf16_f32 v243, v51, v67
    ds_write_b32 v6, v243 offset:384
    v_mfma_f32_32x32x16_bf16 v[96:111], v[220:223], a[116:119], v[96:111]
    v_cvt_pk_bf16_f32 v240, v52, v68
    ds_write_b32 v6, v240 offset:1024
    v_mfma_f32_32x32x16_bf16 v[80:95], v[220:223], a[180:183], v[80:95]
    v_cvt_pk_bf16_f32 v241, v53, v69
    ds_write_b32 v6, v241 offset:1152
    v_mfma_f32_32x32x16_bf16 v[96:111], v[212:215], a[148:151], v[96:111]
    v_cvt_pk_bf16_f32 v242, v54, v70
    ds_write_b32 v6, v242 offset:1280
    v_mfma_f32_32x32x16_bf16 v[80:95], v[224:227], a[120:123], v[80:95]
    v_cvt_pk_bf16_f32 v243, v55, v71
    ds_write_b32 v6, v243 offset:1408
    v_cvt_pk_bf16_f32 v240, v56, v72
    v_mfma_f32_32x32x16_bf16 v[96:111], v[232:235], a[120:123], v[96:111]
    ds_write_b32 v6, v240 offset:2048
    v_cvt_pk_bf16_f32 v241, v57, v73
    v_mfma_f32_32x32x16_bf16 v[80:95], v[232:235], a[184:187], v[80:95]
    ds_write_b32 v6, v241 offset:2176
    v_cvt_pk_bf16_f32 v242, v58, v74
    v_mfma_f32_32x32x16_bf16 v[96:111], v[224:227], a[152:155], v[96:111]
    ds_write_b32 v6, v242 offset:2304
    v_cvt_pk_bf16_f32 v243, v59, v75
    v_mfma_f32_32x32x16_bf16 v[80:95], v[228:231], a[124:127], v[80:95]
    ds_write_b32 v6, v243 offset:2432
    v_cvt_pk_bf16_f32 v240, v60, v76
    v_mfma_f32_32x32x16_bf16 v[96:111], v[236:239], a[124:127], v[96:111]
    ds_write_b32 v6, v240 offset:3072
    v_cvt_pk_bf16_f32 v241, v61, v77
    v_mfma_f32_32x32x16_bf16 v[80:95], v[236:239], a[188:191], v[80:95]
    ds_write_b32 v6, v241 offset:3200
    v_cvt_pk_bf16_f32 v242, v62, v78
    v_mfma_f32_32x32x16_bf16 v[96:111], v[228:231], a[156:159], v[96:111]
    ds_write_b32 v6, v242 offset:3328
    v_cvt_pk_bf16_f32 v243, v63, v79
    ds_write_b32 v6, v243 offset:3456
    s_nop 11
    v_cvt_pk_bf16_f32 v240, v80, v96
    ds_write_b32 v6, v240 offset:4096
    v_cvt_pk_bf16_f32 v241, v81, v97
    ds_write_b32 v6, v241 offset:4224
    v_cvt_pk_bf16_f32 v242, v82, v98
    ds_write_b32 v6, v242 offset:4352
    v_cvt_pk_bf16_f32 v243, v83, v99
    ds_write_b32 v6, v243 offset:4480
    v_cvt_pk_bf16_f32 v240, v84, v100
    ds_write_b32 v6, v240 offset:5120
    v_cvt_pk_bf16_f32 v241, v85, v101
    ds_write_b32 v6, v241 offset:5248
    v_cvt_pk_bf16_f32 v242, v86, v102
    ds_write_b32 v6, v242 offset:5376
    v_cvt_pk_bf16_f32 v243, v87, v103
    ds_write_b32 v6, v243 offset:5504
    v_cvt_pk_bf16_f32 v240, v88, v104
    ds_write_b32 v6, v240 offset:6144
    v_cvt_pk_bf16_f32 v241, v89, v105
    ds_write_b32 v6, v241 offset:6272
    v_cvt_pk_bf16_f32 v242, v90, v106
    ds_write_b32 v6, v242 offset:6400
    v_cvt_pk_bf16_f32 v243, v91, v107
    ds_write_b32 v6, v243 offset:6528
    v_cvt_pk_bf16_f32 v240, v92, v108
    ds_write_b32 v6, v240 offset:7168
    v_cvt_pk_bf16_f32 v241, v93, v109
    ds_write_b32 v6, v241 offset:7296
    v_cvt_pk_bf16_f32 v242, v94, v110
    ds_write_b32 v6, v242 offset:7424
    v_cvt_pk_bf16_f32 v243, v95, v111
    ds_write_b32 v6, v243 offset:7552
    s_branch P3_nyqend_1
P3_nyq_1:
    v_mfma_f32_32x32x16_bf16 v[80:95], v[208:211], a[112:115], 0
    v_mfma_f32_32x32x16_bf16 v[96:111], v[216:219], a[112:115], 0
    v_mfma_f32_32x32x16_bf16 v[80:95], v[216:219], a[176:179], v[80:95]
    v_mfma_f32_32x32x16_bf16 v[96:111], v[208:211], a[144:147], v[96:111]
    v_mfma_f32_32x32x16_bf16 v[80:95], v[212:215], a[116:119], v[80:95]
    v_mfma_f32_32x32x16_bf16 v[96:111], v[220:223], a[116:119], v[96:111]
    v_mfma_f32_32x32x16_bf16 v[80:95], v[220:223], a[180:183], v[80:95]
    v_mfma_f32_32x32x16_bf16 v[96:111], v[212:215], a[148:151], v[96:111]
    v_mfma_f32_32x32x16_bf16 v[80:95], v[224:227], a[120:123], v[80:95]
    v_mfma_f32_32x32x16_bf16 v[96:111], v[232:235], a[120:123], v[96:111]
    v_mfma_f32_32x32x16_bf16 v[80:95], v[232:235], a[184:187], v[80:95]
    v_mfma_f32_32x32x16_bf16 v[96:111], v[224:227], a[152:155], v[96:111]
    v_mfma_f32_32x32x16_bf16 v[80:95], v[228:231], a[124:127], v[80:95]
    v_mfma_f32_32x32x16_bf16 v[96:111], v[236:239], a[124:127], v[96:111]
    v_mfma_f32_32x32x16_bf16 v[80:95], v[236:239], a[188:191], v[80:95]
    v_mfma_f32_32x32x16_bf16 v[96:111], v[228:231], a[156:159], v[96:111]
    s_nop 11
    s_mov_b32 s45, 0
    buffer_store_dword v48, v9, s[16:19], s45 offen sc1
    s_mov_b32 s45, 128
    buffer_store_dword v49, v9, s[16:19], s45 offen sc1
    s_mov_b32 s45, 256
    buffer_store_dword v50, v9, s[16:19], s45 offen sc1
    s_mov_b32 s45, 384
    buffer_store_dword v51, v9, s[16:19], s45 offen sc1
    s_mov_b32 s45, 1024
    buffer_store_dword v52, v9, s[16:19], s45 offen sc1
    s_mov_b32 s45, 1152
    buffer_store_dword v53, v9, s[16:19], s45 offen sc1
    s_mov_b32 s45, 1280
    buffer_store_dword v54, v9, s[16:19], s45 offen sc1
    s_mov_b32 s45, 1408
    buffer_store_dword v55, v9, s[16:19], s45 offen sc1
    s_mov_b32 s45, 2048
    buffer_store_dword v56, v9, s[16:19], s45 offen sc1
    s_mov_b32 s45, 2176
    buffer_store_dword v57, v9, s[16:19], s45 offen sc1
    s_mov_b32 s45, 2304
    buffer_store_dword v58, v9, s[16:19], s45 offen sc1
    s_mov_b32 s45, 2432
    buffer_store_dword v59, v9, s[16:19], s45 offen sc1
    s_mov_b32 s45, 3072
    buffer_store_dword v60, v9, s[16:19], s45 offen sc1
    s_mov_b32 s45, 3200
    buffer_store_dword v61, v9, s[16:19], s45 offen sc1
    s_mov_b32 s45, 3328
    buffer_store_dword v62, v9, s[16:19], s45 offen sc1
    s_mov_b32 s45, 3456
    buffer_store_dword v63, v9, s[16:19], s45 offen sc1
    s_mov_b32 s45, 4096
    buffer_store_dword v80, v9, s[16:19], s45 offen sc1
    s_mov_b32 s45, 4224
    buffer_store_dword v81, v9, s[16:19], s45 offen sc1
    s_mov_b32 s45, 4352
    buffer_store_dword v82, v9, s[16:19], s45 offen sc1
    s_mov_b32 s45, 4480
    buffer_store_dword v83, v9, s[16:19], s45 offen sc1
    s_mov_b32 s45, 5120
    buffer_store_dword v84, v9, s[16:19], s45 offen sc1
    s_mov_b32 s45, 5248
    buffer_store_dword v85, v9, s[16:19], s45 offen sc1
    s_mov_b32 s45, 5376
    buffer_store_dword v86, v9, s[16:19], s45 offen sc1
    s_mov_b32 s45, 5504
    buffer_store_dword v87, v9, s[16:19], s45 offen sc1
    s_mov_b32 s45, 6144
    buffer_store_dword v88, v9, s[16:19], s45 offen sc1
    s_mov_b32 s45, 6272
    buffer_store_dword v89, v9, s[16:19], s45 offen sc1
    s_mov_b32 s45, 6400
    buffer_store_dword v90, v9, s[16:19], s45 offen sc1
    s_mov_b32 s45, 6528
    buffer_store_dword v91, v9, s[16:19], s45 offen sc1
    s_mov_b32 s45, 7168
    buffer_store_dword v92, v9, s[16:19], s45 offen sc1
    s_mov_b32 s45, 7296
    buffer_store_dword v93, v9, s[16:19], s45 offen sc1
    s_mov_b32 s45, 7424
    buffer_store_dword v94, v9, s[16:19], s45 offen sc1
    s_mov_b32 s45, 7552
    buffer_store_dword v95, v9, s[16:19], s45 offen sc1
P3_nyqend_1:
    s_branch P3_nocol_1
P3_skip_1:
    s_barrier
P3_nocol_1:
    s_waitcnt lgkmcnt(0)
    s_barrier
    s_lshl_b32 s45, s40, 1
    s_add_u32 s45, s45, 1
    s_cmp_ge_u32 s45, 72
    s_cbranch_scc1 P3_noflush_1
    s_lshl_b32 s45, s45, 15
    s_add_u32 s41, s45, 8650752
    ds_read_b32 v48, v7 offset:0
    ds_read_b32 v49, v7 offset:8192
    ds_read_b32 v50, v7 offset:16384
    ds_read_b32 v51, v7 offset:24576
    ds_read_b32 v52, v7 offset:1024
    ds_read_b32 v53, v7 offset:9216
    ds_read_b32 v54, v7 offset:17408
    ds_read_b32 v55, v7 offset:25600
    ds_read_b32 v56, v7 offset:2048
    ds_read_b32 v57, v7 offset:10240
    ds_read_b32 v58, v7 offset:18432
    ds_read_b32 v59, v7 offset:26624
    ds_read_b32 v60, v7 offset:3072
    ds_read_b32 v61, v7 offset:11264
    ds_read_b32 v62, v7 offset:19456
    ds_read_b32 v63, v7 offset:27648
    s_waitcnt lgkmcnt(12)
    ds_read_b32 v64, v7 offset:4096
    ds_read_b32 v65, v7 offset:12288
    ds_read_b32 v66, v7 offset:20480
    ds_read_b32 v67, v7 offset:28672
    s_waitcnt lgkmcnt(12)
    ds_read_b32 v68, v7 offset:5120
    ds_read_b32 v69, v7 offset:13312
    ds_read_b32 v70, v7 offset:21504
    ds_read_b32 v71, v7 offset:29696
    s_waitcnt lgkmcnt(12)
    ds_read_b32 v72, v7 offset:6144
    ds_read_b32 v73, v7 offset:14336
    ds_read_b32 v74, v7 offset:22528
    ds_read_b32 v75, v7 offset:30720
    s_waitcnt lgkmcnt(12)
    ds_read_b32 v76, v7 offset:7168
    ds_read_b32 v77, v7 offset:15360
    ds_read_b32 v78, v7 offset:23552
    ds_read_b32 v79, v7 offset:31744
    s_waitcnt lgkmcnt(12)
    s_waitcnt lgkmcnt(0)
    s_add_u32 s45, s41, 0
    buffer_store_dwordx4 v[48:51], v8, s[16:19], s45 offen sc1
    s_add_u32 s45, s41, 4096
    buffer_store_dwordx4 v[52:55], v8, s[16:19], s45 offen sc1
    s_add_u32 s45, s41, 8192
    buffer_store_dwordx4 v[56:59], v8, s[16:19], s45 offen sc1
    s_add_u32 s45, s41, 12288
    buffer_store_dwordx4 v[60:63], v8, s[16:19], s45 offen sc1
    s_add_u32 s45, s41, 16384
    buffer_store_dwordx4 v[64:67], v8, s[16:19], s45 offen sc1
    s_add_u32 s45, s41, 20480
    buffer_store_dwordx4 v[68:71], v8, s[16:19], s45 offen sc1
    s_add_u32 s45, s41, 24576
    buffer_store_dwordx4 v[72:75], v8, s[16:19], s45 offen sc1
    s_add_u32 s45, s41, 28672
    buffer_store_dwordx4 v[76:79], v8, s[16:19], s45 offen sc1
P3_noflush_1:
    s_waitcnt vmcnt(0)
    s_barrier
    s_cmp_lg_u32 s52, 0
    s_cbranch_scc1 FP_start
    v_lshlrev_b32 v14, 7, v1
    v_add_u32 v14, 11077632, v14
    v_mov_b32 v15, 1
    s_mov_b32 exec_lo, -1
    s_mov_b32 exec_hi, 0
    buffer_atomic_add v15, v14, s[16:19], 0 offen sc1
    s_mov_b64 exec, -1
    s_branch FP_start
K2_idle:
    s_load_dwordx2 s[50:51], s[0:1], 72
    v_lshrrev_b32 v1, 6, v0
    s_nop 0
    v_readfirstlane_b32 s52, v1
    s_mov_b32 s91, 0
    s_mov_b32 s90, 0
    s_waitcnt lgkmcnt(0)
    s_mov_b32 s16, s50
    s_and_b32 s17, s51, 0xffff
    s_mov_b32 s18, 39845888
    s_mov_b32 s19, 0x20000
FP_start:
    s_load_dwordx2 s[4:5], s[0:1], 0
    s_load_dwordx2 s[6:7], s[0:1], 56
    v_mbcnt_lo_u32_b32 v1, -1, 0
    v_mbcnt_hi_u32_b32 v1, -1, v1
    s_and_b32 s79, s2, 31
    s_lshl_b32 s79, s79, 7
    s_add_u32 s79, s79, 11077632
    v_mov_b32 v254, s79
    buffer_load_dword v253, v254, s[16:19], 0 offen sc1
    v_lshlrev_b32 v2, 4, v1
    s_and_b32 s55, s2, 7
    s_lshr_b32 s56, s2, 3
    s_and_b32 s53, s56, 3
    s_lshr_b32 s54, s56, 2
    s_lshl_b32 s55, s55, 3
    s_add_u32 s54, s54, s55
    s_mul_i32 s57, s52, 5
    s_cmp_eq_u32 s52, 3
    s_cselect_b32 s57, 14, s57
    s_getpc_b64 s[58:59]
    s_add_u32 s58, s58, tab_fi@rel32@lo+4
    s_addc_u32 s59, s59, tab_fi@rel32@hi+12
    s_mul_i32 s40, s53, 165888
    s_lshl_b32 s41, s57, 10
    s_add_u32 s40, s40, s41
    v_add_u32 v14, s40, v2
    v_add_co_u32 v10, s[60:61], s58, v14
    v_mov_b32 v11, s59
    s_nop 0
    v_addc_co_u32 v11, s[60:61], 0, v11, s[60:61]
    s_mov_b32 s41, 4096
    s_cmp_eq_u32 s52, 3
    s_cselect_b32 s41, 3072, s41
    v_add_u32 v14, s41, v14
    v_add_co_u32 v12, s[60:61], s58, v14
    v_mov_b32 v13, s59
    s_nop 0
    v_addc_co_u32 v13, s[60:61], 0, v13, s[60:61]
    s_mov_b32 s47, 18432
    global_load_dwordx4 a[0:3], v[10:11], off offset:0
    global_load_dwordx4 a[4:7], v[10:11], off offset:1024
    global_load_dwordx4 a[8:11], v[10:11], off offset:2048
    global_load_dwordx4 a[12:15], v[10:11], off offset:3072
    global_load_dwordx4 a[16:19], v[12:13], off
    v_add_co_u32 v10, s[62:63], s47, v10
    v_add_co_u32 v12, s[94:95], s47, v12
    s_nop 0
    v_addc_co_u32 v11, s[62:63], 0, v11, s[62:63]
    v_addc_co_u32 v13, s[94:95], 0, v13, s[94:95]
    global_load_dwordx4 a[20:23], v[10:11], off offset:0
    global_load_dwordx4 a[24:27], v[10:11], off offset:1024
    global_load_dwordx4 a[28:31], v[10:11], off offset:2048
    global_load_dwordx4 a[32:35], v[10:11], off offset:3072
    global_load_dwordx4 a[36:39], v[12:13], off
    v_add_co_u32 v10, s[62:63], s47, v10
    v_add_co_u32 v12, s[94:95], s47, v12
    s_nop 0
    v_addc_co_u32 v11, s[62:63], 0, v11, s[62:63]
    v_addc_co_u32 v13, s[94:95], 0, v13, s[94:95]
    global_load_dwordx4 a[40:43], v[10:11], off offset:0
    global_load_dwordx4 a[44:47], v[10:11], off offset:1024
    global_load_dwordx4 a[48:51], v[10:11], off offset:2048
    global_load_dwordx4 a[52:55], v[10:11], off offset:3072
    global_load_dwordx4 a[56:59], v[12:13], off
    v_add_co_u32 v10, s[62:63], s47, v10
    v_add_co_u32 v12, s[94:95], s47, v12
    s_nop 0
    v_addc_co_u32 v11, s[62:63], 0, v11, s[62:63]
    v_addc_co_u32 v13, s[94:95], 0, v13, s[94:95]
    global_load_dwordx4 a[60:63], v[10:11], off offset:0
    global_load_dwordx4 a[64:67], v[10:11], off offset:1024
    global_load_dwordx4 a[68:71], v[10:11], off offset:2048
    global_load_dwordx4 a[72:75], v[10:11], off offset:3072
    global_load_dwordx4 a[76:79], v[12:13], off
    v_add_co_u32 v10, s[62:63], s47, v10
    v_add_co_u32 v12, s[94:95], s47, v12
    s_nop 0
    v_addc_co_u32 v11, s[62:63], 0, v11, s[62:63]
    v_addc_co_u32 v13, s[94:95], 0, v13, s[94:95]
    global_load_dwordx4 a[80:83], v[10:11], off offset:0
    global_load_dwordx4 a[84:87], v[10:11], off offset:1024
    global_load_dwordx4 a[88:91], v[10:11], off offset:2048
    global_load_dwordx4 a[92:95], v[10:11], off offset:3072
    global_load_dwordx4 a[96:99], v[12:13], off
    v_add_co_u32 v10, s[62:63], s47, v10
    v_add_co_u32 v12, s[94:95], s47, v12
    s_nop 0
    v_addc_co_u32 v11, s[62:63], 0, v11, s[62:63]
    v_addc_co_u32 v13, s[94:95], 0, v13, s[94:95]
    global_load_dwordx4 a[100:103], v[10:11], off offset:0
    global_load_dwordx4 a[104:107], v[10:11], off offset:1024
    global_load_dwordx4 a[108:111], v[10:11], off offset:2048
    global_load_dwordx4 a[112:115], v[10:11], off offset:3072
    global_load_dwordx4 a[116:119], v[12:13], off
    v_add_co_u32 v10, s[62:63], s47, v10
    v_add_co_u32 v12, s[94:95], s47, v12
    s_nop 0
    v_addc_co_u32 v11, s[62:63], 0, v11, s[62:63]
    v_addc_co_u32 v13, s[94:95], 0, v13, s[94:95]
    global_load_dwordx4 a[120:123], v[10:11], off offset:0
    global_load_dwordx4 a[124:127], v[10:11], off offset:1024
    global_load_dwordx4 a[128:131], v[10:11], off offset:2048
    global_load_dwordx4 a[132:135], v[10:11], off offset:3072
    global_load_dwordx4 a[136:139], v[12:13], off
    v_add_co_u32 v10, s[62:63], s47, v10
    v_add_co_u32 v12, s[94:95], s47, v12
    s_nop 0
    v_addc_co_u32 v11, s[62:63], 0, v11, s[62:63]
    v_addc_co_u32 v13, s[94:95], 0, v13, s[94:95]
    global_load_dwordx4 a[140:143], v[10:11], off offset:0
    global_load_dwordx4 a[144:147], v[10:11], off offset:1024
    global_load_dwordx4 a[148:151], v[10:11], off offset:2048
    global_load_dwordx4 a[152:155], v[10:11], off offset:3072
    global_load_dwordx4 a[156:159], v[12:13], off
    v_add_co_u32 v10, s[62:63], s47, v10
    v_add_co_u32 v12, s[94:95], s47, v12
    s_nop 0
    v_addc_co_u32 v11, s[62:63], 0, v11, s[62:63]
    v_addc_co_u32 v13, s[94:95], 0, v13, s[94:95]
    global_load_dwordx4 a[160:163], v[10:11], off offset:0
    global_load_dwordx4 a[164:167], v[10:11], off offset:1024
    global_load_dwordx4 a[168:171], v[10:11], off offset:2048
    global_load_dwordx4 a[172:175], v[10:11], off offset:3072
    global_load_dwordx4 a[176:179], v[12:13], off
    v_and_b32 v14, 15, v1
    v_lshrrev_b32 v15, 4, v1
    v_lshlrev_b32 v3, 15, v15
    v_lshl_add_u32 v3, v14, 4, v3
    s_lshl_b32 s41, s54, 9
    s_lshl_b32 s42, s57, 17
    s_add_u32 s41, s41, s42
    s_add_u32 s41, s41, 8650752
    v_add_u32 v3, s41, v3
    v_add_u32 v4, 524288, v3
    s_cmp_lt_u32 s52, 2
    s_cselect_b64 s[30:31], -1, 0
    v_mov_b32 v14, 2130706432
    s_nop 0
    v_cndmask_b32 v4, v14, v4, s[30:31]
    v_and_b32 v14, 15, v1
    v_lshrrev_b32 v15, 4, v1
    s_mul_i32 s41, s54, 36864
    s_mul_i32 s42, s53, 4608
    s_add_u32 s41, s41, s42
    s_add_u32 s41, s41, 11534336
    v_lshlrev_b32 v5, 3, v1
    v_add_u32 v5, s41, v5
    s_lshr_b32 s41, s54, 3
    s_and_b32 s42, s54, 7
    s_and_b32 s43, s41, 3
    s_lshl_b32 s43, s43, 3
    s_add_u32 s43, s43, s42
    s_lshr_b32 s41, s41, 2
    s_lshl_b32 s41, s41, 10
    s_add_u32 s43, s43, s41
    v_lshlrev_b32 v6, 5, v14
    v_add_u32 v6, s43, v6
    v_mul_u32_u24 v6, 1152, v6
    v_lshl_add_u32 v6, v15, 3, v6
    s_mul_i32 s41, s53, 288
    v_add_u32 v6, s41, v6
    s_lshl_b32 s41, s54, 7
    s_add_u32 s41, s41, 11010048
    v_lshlrev_b32 v7, 2, v14
    v_add_u32 v7, s41, v7
    s_mul_i32 s41, s52, 18432
    v_add_u32 v8, s41, v2
    s_lshl_b32 s41, s57, 10
    v_add_u32 v9, s41, v2
    s_lshr_b32 s80, s54, 2
    s_lshl_b32 s80, s80, 7
    s_add_u32 s80, s80, 11075584
    v_mov_b32 v252, s80
    s_add_u32 s41, s57, 0
    s_lshr_b32 s42, s41, 1
    s_and_b32 s41, s41, 1
    s_mul_i32 s43, s41, 18432
    s_lshl_b32 s44, s42, 9
    s_add_u32 s64, s43, s44
    s_mul_i32 s43, s41, 589824
    s_lshl_b32 s44, s42, 5
    s_add_u32 s69, s43, s44
    s_lshl_b32 s74, s41, 6
    s_add_u32 s41, s57, 1
    s_lshr_b32 s42, s41, 1
    s_and_b32 s41, s41, 1
    s_mul_i32 s43, s41, 18432
    s_lshl_b32 s44, s42, 9
    s_add_u32 s65, s43, s44
    s_mul_i32 s43, s41, 589824
    s_lshl_b32 s44, s42, 5
    s_add_u32 s70, s43, s44
    s_lshl_b32 s75, s41, 6
    s_add_u32 s41, s57, 2
    s_lshr_b32 s42, s41, 1
    s_and_b32 s41, s41, 1
    s_mul_i32 s43, s41, 18432
    s_lshl_b32 s44, s42, 9
    s_add_u32 s66, s43, s44
    s_mul_i32 s43, s41, 589824
    s_lshl_b32 s44, s42, 5
    s_add_u32 s71, s43, s44
    s_lshl_b32 s76, s41, 6
    s_add_u32 s41, s57, 3
    s_lshr_b32 s42, s41, 1
    s_and_b32 s41, s41, 1
    s_mul_i32 s43, s41, 18432
    s_lshl_b32 s44, s42, 9
    s_add_u32 s67, s43, s44
    s_mul_i32 s43, s41, 589824
    s_lshl_b32 s44, s42, 5
    s_add_u32 s72, s43, s44
    s_lshl_b32 s77, s41, 6
    s_add_u32 s41, s57, 4
    s_lshr_b32 s42, s41, 1
    s_and_b32 s41, s41, 1
    s_mul_i32 s43, s41, 18432
    s_lshl_b32 s44, s42, 9
    s_add_u32 s68, s43, s44
    s_mul_i32 s43, s41, 589824
    s_lshl_b32 s44, s42, 5
    s_add_u32 s73, s43, s44
    s_lshl_b32 s78, s41, 6
    s_cmp_lt_u32 s52, 2
    s_cselect_b32 s68, s68, 2130706432
    s_cselect_b32 s73, s73, 2130706432
    s_cselect_b32 s78, s78, 2130706432
    s_mov_b32 s27, 0xffff0000
    s_mov_b32 s44, 0xb51dbac0
    s_mov_b32 s45, 0xb51dbac0
    s_mov_b32 s82, 0xbfb8aa3b
    s_mov_b32 s83, 0xbfb8aa3b
    s_mov_b32 s86, 1.0
    s_mov_b32 s87, 1.0
    s_waitcnt vmcnt(45) lgkmcnt(0)
    s_mov_b32 s8, s4
    s_and_b32 s9, s5, 0xffff
    s_mov_b32 s10, 2359296
    s_mov_b32 s11, 0x20000
    s_mov_b32 s12, s6
    s_and_b32 s13, s7, 0xffff
    s_mov_b32 s14, 2359296
    s_mov_b32 s15, 0x20000
    s_mov_b32 s3, 0
FP_cka:
    v_readfirstlane_b32 s30, v253
    s_add_u32 s3, s3, 1
    s_cmp_ge_u32 s30, 37
    s_cbranch_scc1 FP_oka
    s_cmp_ge_u32 s3, 100000
    s_cbranch_scc1 FP_oka
    s_sleep 8
    buffer_load_dword v253, v254, s[16:19], 0 offen sc1
    s_waitcnt vmcnt(0)
    s_branch FP_cka
FP_oka:
    s_mov_b32 s46, 0
    buffer_load_dwordx4 v[16:19], v3, s[16:19], s46 offen sc1
    s_mov_b32 s46, 256
    buffer_load_dwordx4 v[20:23], v3, s[16:19], s46 offen sc1
    s_mov_b32 s46, 131072
    buffer_load_dwordx4 v[24:27], v3, s[16:19], s46 offen sc1
    s_mov_b32 s46, 131328
    buffer_load_dwordx4 v[28:31], v3, s[16:19], s46 offen sc1
    s_mov_b32 s46, 262144
    buffer_load_dwordx4 v[32:35], v3, s[16:19], s46 offen sc1
    s_mov_b32 s46, 262400
    buffer_load_dwordx4 v[36:39], v3, s[16:19], s46 offen sc1
    s_mov_b32 s46, 393216
    buffer_load_dwordx4 v[40:43], v3, s[16:19], s46 offen sc1
    s_mov_b32 s46, 393472
    buffer_load_dwordx4 v[44:47], v3, s[16:19], s46 offen sc1
    buffer_load_dwordx4 v[48:51], v4, s[16:19], 0 offen offset:0 sc1
    buffer_load_dwordx4 v[52:55], v4, s[16:19], 0 offen offset:256 sc1
    buffer_load_dwordx2 v[168:169], v6, s[8:11], s69 offen
    buffer_load_dword v178, v7, s[16:19], s74 offen sc1
    buffer_load_dwordx2 v[170:171], v6, s[8:11], s70 offen
    buffer_load_dword v179, v7, s[16:19], s75 offen sc1
    buffer_load_dwordx2 v[172:173], v6, s[8:11], s71 offen
    buffer_load_dword v180, v7, s[16:19], s76 offen sc1
    buffer_load_dwordx2 v[174:175], v6, s[8:11], s72 offen
    buffer_load_dword v181, v7, s[16:19], s77 offen sc1
    buffer_load_dwordx2 v[176:177], v6, s[8:11], s73 offen
    buffer_load_dword v182, v7, s[16:19], s78 offen sc1
    buffer_load_dword v253, v252, s[16:19], 0 offen sc1
    s_waitcnt vmcnt(11)
    v_mfma_f32_16x16x32_bf16 v[56:59], a[0:3], v[16:19], 0
    v_mfma_f32_16x16x32_bf16 v[60:63], a[0:3], v[20:23], 0
    v_mfma_f32_16x16x32_bf16 v[56:59], a[4:7], v[24:27], v[56:59]
    v_mfma_f32_16x16x32_bf16 v[60:63], a[4:7], v[28:31], v[60:63]
    v_mfma_f32_16x16x32_bf16 v[56:59], a[8:11], v[32:35], v[56:59]
    v_mfma_f32_16x16x32_bf16 v[60:63], a[8:11], v[36:39], v[60:63]
    v_mfma_f32_16x16x32_bf16 v[56:59], a[12:15], v[40:43], v[56:59]
    v_mfma_f32_16x16x32_bf16 v[60:63], a[12:15], v[44:47], v[60:63]
    v_mfma_f32_16x16x32_bf16 v[56:59], a[16:19], v[48:51], v[56:59]
    v_mfma_f32_16x16x32_bf16 v[60:63], a[16:19], v[52:55], v[60:63]
    v_mfma_f32_16x16x32_bf16 v[64:67], a[20:23], v[16:19], 0
    v_mfma_f32_16x16x32_bf16 v[68:71], a[20:23], v[20:23], 0
    v_mfma_f32_16x16x32_bf16 v[64:67], a[24:27], v[24:27], v[64:67]
    v_mfma_f32_16x16x32_bf16 v[68:71], a[24:27], v[28:31], v[68:71]
    v_mfma_f32_16x16x32_bf16 v[64:67], a[28:31], v[32:35], v[64:67]
    v_mfma_f32_16x16x32_bf16 v[68:71], a[28:31], v[36:39], v[68:71]
    v_mfma_f32_16x16x32_bf16 v[64:67], a[32:35], v[40:43], v[64:67]
    v_mfma_f32_16x16x32_bf16 v[68:71], a[32:35], v[44:47], v[68:71]
    v_mfma_f32_16x16x32_bf16 v[64:67], a[36:39], v[48:51], v[64:67]
    v_mfma_f32_16x16x32_bf16 v[68:71], a[36:39], v[52:55], v[68:71]
    v_mfma_f32_16x16x32_bf16 v[72:75], a[40:43], v[16:19], 0
    v_mfma_f32_16x16x32_bf16 v[76:79], a[40:43], v[20:23], 0
    v_mfma_f32_16x16x32_bf16 v[72:75], a[44:47], v[24:27], v[72:75]
    v_mfma_f32_16x16x32_bf16 v[76:79], a[44:47], v[28:31], v[76:79]
    v_mfma_f32_16x16x32_bf16 v[72:75], a[48:51], v[32:35], v[72:75]
    v_mfma_f32_16x16x32_bf16 v[76:79], a[48:51], v[36:39], v[76:79]
    v_mfma_f32_16x16x32_bf16 v[72:75], a[52:55], v[40:43], v[72:75]
    v_mfma_f32_16x16x32_bf16 v[76:79], a[52:55], v[44:47], v[76:79]
    v_mfma_f32_16x16x32_bf16 v[72:75], a[56:59], v[48:51], v[72:75]
    v_mfma_f32_16x16x32_bf16 v[76:79], a[56:59], v[52:55], v[76:79]
    v_mfma_f32_16x16x32_bf16 v[80:83], a[60:63], v[16:19], 0
    v_mfma_f32_16x16x32_bf16 v[84:87], a[60:63], v[20:23], 0
    v_mfma_f32_16x16x32_bf16 v[80:83], a[64:67], v[24:27], v[80:83]
    v_mfma_f32_16x16x32_bf16 v[84:87], a[64:67], v[28:31], v[84:87]
    v_mfma_f32_16x16x32_bf16 v[80:83], a[68:71], v[32:35], v[80:83]
    v_mfma_f32_16x16x32_bf16 v[84:87], a[68:71], v[36:39], v[84:87]
    v_mfma_f32_16x16x32_bf16 v[80:83], a[72:75], v[40:43], v[80:83]
    v_mfma_f32_16x16x32_bf16 v[84:87], a[72:75], v[44:47], v[84:87]
    v_mfma_f32_16x16x32_bf16 v[80:83], a[76:79], v[48:51], v[80:83]
    v_mfma_f32_16x16x32_bf16 v[84:87], a[76:79], v[52:55], v[84:87]
    v_mfma_f32_16x16x32_bf16 v[88:91], a[80:83], v[16:19], 0
    v_mfma_f32_16x16x32_bf16 v[92:95], a[80:83], v[20:23], 0
    v_mfma_f32_16x16x32_bf16 v[88:91], a[84:87], v[24:27], v[88:91]
    v_mfma_f32_16x16x32_bf16 v[92:95], a[84:87], v[28:31], v[92:95]
    v_mfma_f32_16x16x32_bf16 v[88:91], a[88:91], v[32:35], v[88:91]
    v_mfma_f32_16x16x32_bf16 v[92:95], a[88:91], v[36:39], v[92:95]
    v_mfma_f32_16x16x32_bf16 v[88:91], a[92:95], v[40:43], v[88:91]
    v_mfma_f32_16x16x32_bf16 v[92:95], a[92:95], v[44:47], v[92:95]
    v_mfma_f32_16x16x32_bf16 v[88:91], a[96:99], v[48:51], v[88:91]
    v_mfma_f32_16x16x32_bf16 v[92:95], a[96:99], v[52:55], v[92:95]
    v_mfma_f32_16x16x32_bf16 v[96:99], a[100:103], v[16:19], 0
    v_mfma_f32_16x16x32_bf16 v[100:103], a[100:103], v[20:23], 0
    v_mfma_f32_16x16x32_bf16 v[96:99], a[104:107], v[24:27], v[96:99]
    v_mfma_f32_16x16x32_bf16 v[100:103], a[104:107], v[28:31], v[100:103]
    v_mfma_f32_16x16x32_bf16 v[96:99], a[108:111], v[32:35], v[96:99]
    v_mfma_f32_16x16x32_bf16 v[100:103], a[108:111], v[36:39], v[100:103]
    v_mfma_f32_16x16x32_bf16 v[96:99], a[112:115], v[40:43], v[96:99]
    v_mfma_f32_16x16x32_bf16 v[100:103], a[112:115], v[44:47], v[100:103]
    v_mfma_f32_16x16x32_bf16 v[96:99], a[116:119], v[48:51], v[96:99]
    v_mfma_f32_16x16x32_bf16 v[100:103], a[116:119], v[52:55], v[100:103]
    v_mfma_f32_16x16x32_bf16 v[104:107], a[120:123], v[16:19], 0
    v_mfma_f32_16x16x32_bf16 v[108:111], a[120:123], v[20:23], 0
    v_mfma_f32_16x16x32_bf16 v[104:107], a[124:127], v[24:27], v[104:107]
    v_mfma_f32_16x16x32_bf16 v[108:111], a[124:127], v[28:31], v[108:111]
    v_mfma_f32_16x16x32_bf16 v[104:107], a[128:131], v[32:35], v[104:107]
    v_mfma_f32_16x16x32_bf16 v[108:111], a[128:131], v[36:39], v[108:111]
    v_mfma_f32_16x16x32_bf16 v[104:107], a[132:135], v[40:43], v[104:107]
    v_mfma_f32_16x16x32_bf16 v[108:111], a[132:135], v[44:47], v[108:111]
    v_mfma_f32_16x16x32_bf16 v[104:107], a[136:139], v[48:51], v[104:107]
    v_mfma_f32_16x16x32_bf16 v[108:111], a[136:139], v[52:55], v[108:111]
    v_mfma_f32_16x16x32_bf16 v[112:115], a[140:143], v[16:19], 0
    v_mfma_f32_16x16x32_bf16 v[116:119], a[140:143], v[20:23], 0
    v_mfma_f32_16x16x32_bf16 v[112:115], a[144:147], v[24:27], v[112:115]
    v_mfma_f32_16x16x32_bf16 v[116:119], a[144:147], v[28:31], v[116:119]
    v_mfma_f32_16x16x32_bf16 v[112:115], a[148:151], v[32:35], v[112:115]
    v_mfma_f32_16x16x32_bf16 v[116:119], a[148:151], v[36:39], v[116:119]
    v_mfma_f32_16x16x32_bf16 v[112:115], a[152:155], v[40:43], v[112:115]
    v_mfma_f32_16x16x32_bf16 v[116:119], a[152:155], v[44:47], v[116:119]
    v_mfma_f32_16x16x32_bf16 v[112:115], a[156:159], v[48:51], v[112:115]
    v_mfma_f32_16x16x32_bf16 v[116:119], a[156:159], v[52:55], v[116:119]
    v_mfma_f32_16x16x32_bf16 v[120:123], a[160:163], v[16:19], 0
    v_mfma_f32_16x16x32_bf16 v[124:127], a[160:163], v[20:23], 0
    v_mfma_f32_16x16x32_bf16 v[120:123], a[164:167], v[24:27], v[120:123]
    v_mfma_f32_16x16x32_bf16 v[124:127], a[164:167], v[28:31], v[124:127]
    v_mfma_f32_16x16x32_bf16 v[120:123], a[168:171], v[32:35], v[120:123]
    v_mfma_f32_16x16x32_bf16 v[124:127], a[168:171], v[36:39], v[124:127]
    v_mfma_f32_16x16x32_bf16 v[120:123], a[172:175], v[40:43], v[120:123]
    v_mfma_f32_16x16x32_bf16 v[124:127], a[172:175], v[44:47], v[124:127]
    v_mfma_f32_16x16x32_bf16 v[120:123], a[176:179], v[48:51], v[120:123]
    v_mfma_f32_16x16x32_bf16 v[124:127], a[176:179], v[52:55], v[124:127]
    s_branch FP_tail
FP_gemm:
    s_load_dwordx2 s[4:5], s[0:1], 0
    s_load_dwordx2 s[6:7], s[0:1], 56
    v_mbcnt_lo_u32_b32 v1, -1, 0
    v_mbcnt_hi_u32_b32 v1, -1, v1
    v_lshlrev_b32 v2, 4, v1
    s_cmp_eq_u32 s89, 0
    s_cbranch_scc1 FP_g0
    s_waitcnt vmcnt(24)
    v_mfma_f32_16x16x32_bf16 v[56:59], a[0:3], v[212:215], 0
    v_mfma_f32_16x16x32_bf16 v[60:63], a[0:3], v[216:219], 0
    v_mfma_f32_16x16x32_bf16 v[56:59], a[4:7], v[220:223], v[56:59]
    v_mfma_f32_16x16x32_bf16 v[60:63], a[4:7], v[224:227], v[60:63]
    v_mfma_f32_16x16x32_bf16 v[56:59], a[8:11], v[228:231], v[56:59]
    v_mfma_f32_16x16x32_bf16 v[60:63], a[8:11], v[232:235], v[60:63]
    v_mfma_f32_16x16x32_bf16 v[56:59], a[12:15], v[236:239], v[56:59]
    v_mfma_f32_16x16x32_bf16 v[60:63], a[12:15], v[240:243], v[60:63]
    v_mfma_f32_16x16x32_bf16 v[56:59], a[16:19], v[244:247], v[56:59]
    v_mfma_f32_16x16x32_bf16 v[60:63], a[16:19], v[248:251], v[60:63]
    v_mfma_f32_16x16x32_bf16 v[64:67], a[20:23], v[212:215], 0
    v_mfma_f32_16x16x32_bf16 v[68:71], a[20:23], v[216:219], 0
    v_mfma_f32_16x16x32_bf16 v[64:67], a[24:27], v[220:223], v[64:67]
    v_mfma_f32_16x16x32_bf16 v[68:71], a[24:27], v[224:227], v[68:71]
    v_mfma_f32_16x16x32_bf16 v[64:67], a[28:31], v[228:231], v[64:67]
    v_mfma_f32_16x16x32_bf16 v[68:71], a[28:31], v[232:235], v[68:71]
    v_mfma_f32_16x16x32_bf16 v[64:67], a[32:35], v[236:239], v[64:67]
    v_mfma_f32_16x16x32_bf16 v[68:71], a[32:35], v[240:243], v[68:71]
    v_mfma_f32_16x16x32_bf16 v[64:67], a[36:39], v[244:247], v[64:67]
    v_mfma_f32_16x16x32_bf16 v[68:71], a[36:39], v[248:251], v[68:71]
    v_mfma_f32_16x16x32_bf16 v[72:75], a[40:43], v[212:215], 0
    v_mfma_f32_16x16x32_bf16 v[76:79], a[40:43], v[216:219], 0
    v_mfma_f32_16x16x32_bf16 v[72:75], a[44:47], v[220:223], v[72:75]
    v_mfma_f32_16x16x32_bf16 v[76:79], a[44:47], v[224:227], v[76:79]
    v_mfma_f32_16x16x32_bf16 v[72:75], a[48:51], v[228:231], v[72:75]
    v_mfma_f32_16x16x32_bf16 v[76:79], a[48:51], v[232:235], v[76:79]
    v_mfma_f32_16x16x32_bf16 v[72:75], a[52:55], v[236:239], v[72:75]
    v_mfma_f32_16x16x32_bf16 v[76:79], a[52:55], v[240:243], v[76:79]
    v_mfma_f32_16x16x32_bf16 v[72:75], a[56:59], v[244:247], v[72:75]
    v_mfma_f32_16x16x32_bf16 v[76:79], a[56:59], v[248:251], v[76:79]
    v_mfma_f32_16x16x32_bf16 v[80:83], a[60:63], v[212:215], 0
    v_mfma_f32_16x16x32_bf16 v[84:87], a[60:63], v[216:219], 0
    v_mfma_f32_16x16x32_bf16 v[80:83], a[64:67], v[220:223], v[80:83]
    v_mfma_f32_16x16x32_bf16 v[84:87], a[64:67], v[224:227], v[84:87]
    v_mfma_f32_16x16x32_bf16 v[80:83], a[68:71], v[228:231], v[80:83]
    v_mfma_f32_16x16x32_bf16 v[84:87], a[68:71], v[232:235], v[84:87]
    v_mfma_f32_16x16x32_bf16 v[80:83], a[72:75], v[236:239], v[80:83]
    v_mfma_f32_16x16x32_bf16 v[84:87], a[72:75], v[240:243], v[84:87]
    v_mfma_f32_16x16x32_bf16 v[80:83], a[76:79], v[244:247], v[80:83]
    v_mfma_f32_16x16x32_bf16 v[84:87], a[76:79], v[248:251], v[84:87]
    v_mfma_f32_16x16x32_bf16 v[88:91], a[80:83], v[212:215], 0
    v_mfma_f32_16x16x32_bf16 v[92:95], a[80:83], v[216:219], 0
    v_mfma_f32_16x16x32_bf16 v[88:91], a[84:87], v[220:223], v[88:91]
    v_mfma_f32_16x16x32_bf16 v[92:95], a[84:87], v[224:227], v[92:95]
    v_mfma_f32_16x16x32_bf16 v[88:91], a[88:91], v[228:231], v[88:91]
    v_mfma_f32_16x16x32_bf16 v[92:95], a[88:91], v[232:235], v[92:95]
    v_mfma_f32_16x16x32_bf16 v[88:91], a[92:95], v[236:239], v[88:91]
    v_mfma_f32_16x16x32_bf16 v[92:95], a[92:95], v[240:243], v[92:95]
    v_mfma_f32_16x16x32_bf16 v[88:91], a[96:99], v[244:247], v[88:91]
    v_mfma_f32_16x16x32_bf16 v[92:95], a[96:99], v[248:251], v[92:95]
    v_mfma_f32_16x16x32_bf16 v[96:99], a[100:103], v[212:215], 0
    v_mfma_f32_16x16x32_bf16 v[100:103], a[100:103], v[216:219], 0
    v_mfma_f32_16x16x32_bf16 v[96:99], a[104:107], v[220:223], v[96:99]
    v_mfma_f32_16x16x32_bf16 v[100:103], a[104:107], v[224:227], v[100:103]
    v_mfma_f32_16x16x32_bf16 v[96:99], a[108:111], v[228:231], v[96:99]
    v_mfma_f32_16x16x32_bf16 v[100:103], a[108:111], v[232:235], v[100:103]
    v_mfma_f32_16x16x32_bf16 v[96:99], a[112:115], v[236:239], v[96:99]
    v_mfma_f32_16x16x32_bf16 v[100:103], a[112:115], v[240:243], v[100:103]
    v_mfma_f32_16x16x32_bf16 v[96:99], a[116:119], v[244:247], v[96:99]
    v_mfma_f32_16x16x32_bf16 v[100:103], a[116:119], v[248:251], v[100:103]
    v_mfma_f32_16x16x32_bf16 v[104:107], a[120:123], v[212:215], 0
    v_mfma_f32_16x16x32_bf16 v[108:111], a[120:123], v[216:219], 0
    v_mfma_f32_16x16x32_bf16 v[104:107], a[124:127], v[220:223], v[104:107]
    v_mfma_f32_16x16x32_bf16 v[108:111], a[124:127], v[224:227], v[108:111]
    v_mfma_f32_16x16x32_bf16 v[104:107], a[128:131], v[228:231], v[104:107]
    v_mfma_f32_16x16x32_bf16 v[108:111], a[128:131], v[232:235], v[108:111]
    v_mfma_f32_16x16x32_bf16 v[104:107], a[132:135], v[236:239], v[104:107]
    v_mfma_f32_16x16x32_bf16 v[108:111], a[132:135], v[240:243], v[108:111]
    v_mfma_f32_16x16x32_bf16 v[104:107], a[136:139], v[244:247], v[104:107]
    v_mfma_f32_16x16x32_bf16 v[108:111], a[136:139], v[248:251], v[108:111]
    v_mfma_f32_16x16x32_bf16 v[112:115], a[140:143], v[212:215], 0
    v_mfma_f32_16x16x32_bf16 v[116:119], a[140:143], v[216:219], 0
    v_mfma_f32_16x16x32_bf16 v[112:115], a[144:147], v[220:223], v[112:115]
    v_mfma_f32_16x16x32_bf16 v[116:119], a[144:147], v[224:227], v[116:119]
    v_mfma_f32_16x16x32_bf16 v[112:115], a[148:151], v[228:231], v[112:115]
    v_mfma_f32_16x16x32_bf16 v[116:119], a[148:151], v[232:235], v[116:119]
    v_mfma_f32_16x16x32_bf16 v[112:115], a[152:155], v[236:239], v[112:115]
    v_mfma_f32_16x16x32_bf16 v[116:119], a[152:155], v[240:243], v[116:119]
    v_mfma_f32_16x16x32_bf16 v[112:115], a[156:159], v[244:247], v[112:115]
    v_mfma_f32_16x16x32_bf16 v[116:119], a[156:159], v[248:251], v[116:119]
    v_mfma_f32_16x16x32_bf16 v[120:123], a[160:163], v[212:215], 0
    v_mfma_f32_16x16x32_bf16 v[124:127], a[160:163], v[216:219], 0
    v_mfma_f32_16x16x32_bf16 v[120:123], a[164:167], v[220:223], v[120:123]
    v_mfma_f32_16x16x32_bf16 v[124:127], a[164:167], v[224:227], v[124:127]
    v_mfma_f32_16x16x32_bf16 v[120:123], a[168:171], v[228:231], v[120:123]
    v_mfma_f32_16x16x32_bf16 v[124:127], a[168:171], v[232:235], v[124:127]
    v_mfma_f32_16x16x32_bf16 v[120:123], a[172:175], v[236:239], v[120:123]
    v_mfma_f32_16x16x32_bf16 v[124:127], a[172:175], v[240:243], v[124:127]
    v_mfma_f32_16x16x32_bf16 v[120:123], a[176:179], v[244:247], v[120:123]
    v_mfma_f32_16x16x32_bf16 v[124:127], a[176:179], v[248:251], v[124:127]
    s_branch FP_g1
FP_g0:
    s_waitcnt vmcnt(24)
    v_readfirstlane_b32 s30, v253
    s_nop 3
    s_cmp_lt_u32 s30, 37
    s_cbranch_scc1 FP_g1
    s_mov_b32 s89, 2
    s_mov_b32 s46, 0
    buffer_load_dwordx4 v[212:215], v48, s[16:19], s46 offen sc1
    s_mov_b32 s46, 256
    buffer_load_dwordx4 v[216:219], v48, s[16:19], s46 offen sc1
    s_mov_b32 s46, 131072
    buffer_load_dwordx4 v[220:223], v48, s[16:19], s46 offen sc1
    s_mov_b32 s46, 131328
    buffer_load_dwordx4 v[224:227], v48, s[16:19], s46 offen sc1
    s_mov_b32 s46, 262144
    buffer_load_dwordx4 v[228:231], v48, s[16:19], s46 offen sc1
    s_mov_b32 s46, 262400
    buffer_load_dwordx4 v[232:235], v48, s[16:19], s46 offen sc1
    s_mov_b32 s46, 393216
    buffer_load_dwordx4 v[236:239], v48, s[16:19], s46 offen sc1
    s_mov_b32 s46, 393472
    buffer_load_dwordx4 v[240:243], v48, s[16:19], s46 offen sc1
    buffer_load_dwordx4 v[244:247], v49, s[16:19], 0 offen offset:0 sc1
    buffer_load_dwordx4 v[248:251], v49, s[16:19], 0 offen offset:256 sc1
FP_g1:
    s_and_b32 s55, s2, 7
    s_lshr_b32 s56, s2, 3
    s_and_b32 s53, s56, 3
    s_lshr_b32 s54, s56, 2
    s_lshl_b32 s55, s55, 3
    s_add_u32 s54, s54, s55
    s_mul_i32 s57, s52, 5
    s_cmp_eq_u32 s52, 3
    s_cselect_b32 s57, 14, s57
    v_and_b32 v14, 15, v1
    v_lshrrev_b32 v15, 4, v1
    s_mul_i32 s41, s54, 36864
    s_mul_i32 s42, s53, 4608
    s_add_u32 s41, s41, s42
    s_add_u32 s41, s41, 11534336
    v_lshlrev_b32 v5, 3, v1
    v_add_u32 v5, s41, v5
    s_lshr_b32 s41, s54, 3
    s_and_b32 s42, s54, 7
    s_and_b32 s43, s41, 3
    s_lshl_b32 s43, s43, 3
    s_add_u32 s43, s43, s42
    s_lshr_b32 s41, s41, 2
    s_lshl_b32 s41, s41, 10
    s_add_u32 s43, s43, s41
    v_lshlrev_b32 v6, 5, v14
    v_add_u32 v6, s43, v6
    v_mul_u32_u24 v6, 1152, v6
    v_lshl_add_u32 v6, v15, 3, v6
    s_mul_i32 s41, s53, 288
    v_add_u32 v6, s41, v6
    s_lshl_b32 s41, s54, 7
    s_add_u32 s41, s41, 11010048
    v_lshlrev_b32 v7, 2, v14
    v_add_u32 v7, s41, v7
    s_mul_i32 s41, s52, 18432
    v_add_u32 v8, s41, v2
    s_lshl_b32 s41, s57, 10
    v_add_u32 v9, s41, v2
    s_lshr_b32 s80, s54, 2
    s_lshl_b32 s80, s80, 7
    s_add_u32 s80, s80, 11075584
    v_mov_b32 v252, s80
    s_add_u32 s41, s57, 0
    s_lshr_b32 s42, s41, 1
    s_and_b32 s41, s41, 1
    s_mul_i32 s43, s41, 18432
    s_lshl_b32 s44, s42, 9
    s_add_u32 s64, s43, s44
    s_mul_i32 s43, s41, 589824
    s_lshl_b32 s44, s42, 5
    s_add_u32 s69, s43, s44
    s_lshl_b32 s74, s41, 6
    s_add_u32 s41, s57, 1
    s_lshr_b32 s42, s41, 1
    s_and_b32 s41, s41, 1
    s_mul_i32 s43, s41, 18432
    s_lshl_b32 s44, s42, 9
    s_add_u32 s65, s43, s44
    s_mul_i32 s43, s41, 589824
    s_lshl_b32 s44, s42, 5
    s_add_u32 s70, s43, s44
    s_lshl_b32 s75, s41, 6
    s_add_u32 s41, s57, 2
    s_lshr_b32 s42, s41, 1
    s_and_b32 s41, s41, 1
    s_mul_i32 s43, s41, 18432
    s_lshl_b32 s44, s42, 9
    s_add_u32 s66, s43, s44
    s_mul_i32 s43, s41, 589824
    s_lshl_b32 s44, s42, 5
    s_add_u32 s71, s43, s44
    s_lshl_b32 s76, s41, 6
    s_add_u32 s41, s57, 3
    s_lshr_b32 s42, s41, 1
    s_and_b32 s41, s41, 1
    s_mul_i32 s43, s41, 18432
    s_lshl_b32 s44, s42, 9
    s_add_u32 s67, s43, s44
    s_mul_i32 s43, s41, 589824
    s_lshl_b32 s44, s42, 5
    s_add_u32 s72, s43, s44
    s_lshl_b32 s77, s41, 6
    s_add_u32 s41, s57, 4
    s_lshr_b32 s42, s41, 1
    s_and_b32 s41, s41, 1
    s_mul_i32 s43, s41, 18432
    s_lshl_b32 s44, s42, 9
    s_add_u32 s68, s43, s44
    s_mul_i32 s43, s41, 589824
    s_lshl_b32 s44, s42, 5
    s_add_u32 s73, s43, s44
    s_lshl_b32 s78, s41, 6
    s_cmp_lt_u32 s52, 2
    s_cselect_b32 s68, s68, 2130706432
    s_cselect_b32 s73, s73, 2130706432
    s_cselect_b32 s78, s78, 2130706432
    s_mov_b32 s27, 0xffff0000
    s_mov_b32 s44, 0xb51dbac0
    s_mov_b32 s45, 0xb51dbac0
    s_mov_b32 s82, 0xbfb8aa3b
    s_mov_b32 s83, 0xbfb8aa3b
    s_mov_b32 s86, 1.0
    s_mov_b32 s87, 1.0
    s_waitcnt vmcnt(0) lgkmcnt(0)
    s_barrier
    s_cmp_lg_u32 s52, 0
    s_cbranch_scc1 FP_nosigg
    s_cmp_eq_u32 s90, 0
    s_cbranch_scc1 FP_nosigg
    v_lshlrev_b32 v14, 7, v1
    v_add_u32 v14, s91, v14
    v_mov_b32 v15, 1
    s_mov_b32 exec_lo, s90
    s_mov_b32 exec_hi, 0
    buffer_atomic_add v15, v14, s[16:19], 0 offen sc1
    s_mov_b64 exec, -1
FP_nosigg:
    s_mov_b32 s8, s4
    s_and_b32 s9, s5, 0xffff
    s_mov_b32 s10, 2359296
    s_mov_b32 s11, 0x20000
    s_mov_b32 s12, s6
    s_and_b32 s13, s7, 0xffff
    s_mov_b32 s14, 2359296
    s_mov_b32 s15, 0x20000
    s_cmp_eq_u32 s89, 1
    s_cbranch_scc1 FP_g2
    s_cmp_eq_u32 s89, 2
    s_cbranch_scc1 FP_g3
    buffer_load_dword v253, v254, s[16:19], 0 offen sc1
    s_waitcnt vmcnt(0)
    s_mov_b32 s3, 0
FP_ckg:
    v_readfirstlane_b32 s30, v253
    s_add_u32 s3, s3, 1
    s_cmp_ge_u32 s30, 37
    s_cbranch_scc1 FP_okg
    s_cmp_ge_u32 s3, 100000
    s_cbranch_scc1 FP_okg
    s_sleep 8
    buffer_load_dword v253, v254, s[16:19], 0 offen sc1
    s_waitcnt vmcnt(0)
    s_branch FP_ckg
FP_okg:
    s_mov_b32 s46, 0
    buffer_load_dwordx4 v[212:215], v48, s[16:19], s46 offen sc1
    s_mov_b32 s46, 256
    buffer_load_dwordx4 v[216:219], v48, s[16:19], s46 offen sc1
    s_mov_b32 s46, 131072
    buffer_load_dwordx4 v[220:223], v48, s[16:19], s46 offen sc1
    s_mov_b32 s46, 131328
    buffer_load_dwordx4 v[224:227], v48, s[16:19], s46 offen sc1
    s_mov_b32 s46, 262144
    buffer_load_dwordx4 v[228:231], v48, s[16:19], s46 offen sc1
    s_mov_b32 s46, 262400
    buffer_load_dwordx4 v[232:235], v48, s[16:19], s46 offen sc1
    s_mov_b32 s46, 393216
    buffer_load_dwordx4 v[236:239], v48, s[16:19], s46 offen sc1
    s_mov_b32 s46, 393472
    buffer_load_dwordx4 v[240:243], v48, s[16:19], s46 offen sc1
    buffer_load_dwordx4 v[244:247], v49, s[16:19], 0 offen offset:0 sc1
    buffer_load_dwordx4 v[248:251], v49, s[16:19], 0 offen offset:256 sc1
    s_waitcnt vmcnt(0)
FP_g3:
    v_mfma_f32_16x16x32_bf16 v[56:59], a[0:3], v[212:215], 0
    v_mfma_f32_16x16x32_bf16 v[60:63], a[0:3], v[216:219], 0
    v_mfma_f32_16x16x32_bf16 v[56:59], a[4:7], v[220:223], v[56:59]
    v_mfma_f32_16x16x32_bf16 v[60:63], a[4:7], v[224:227], v[60:63]
    v_mfma_f32_16x16x32_bf16 v[56:59], a[8:11], v[228:231], v[56:59]
    v_mfma_f32_16x16x32_bf16 v[60:63], a[8:11], v[232:235], v[60:63]
    v_mfma_f32_16x16x32_bf16 v[56:59], a[12:15], v[236:239], v[56:59]
    v_mfma_f32_16x16x32_bf16 v[60:63], a[12:15], v[240:243], v[60:63]
    v_mfma_f32_16x16x32_bf16 v[56:59], a[16:19], v[244:247], v[56:59]
    v_mfma_f32_16x16x32_bf16 v[60:63], a[16:19], v[248:251], v[60:63]
    v_mfma_f32_16x16x32_bf16 v[64:67], a[20:23], v[212:215], 0
    v_mfma_f32_16x16x32_bf16 v[68:71], a[20:23], v[216:219], 0
    v_mfma_f32_16x16x32_bf16 v[64:67], a[24:27], v[220:223], v[64:67]
    v_mfma_f32_16x16x32_bf16 v[68:71], a[24:27], v[224:227], v[68:71]
    v_mfma_f32_16x16x32_bf16 v[64:67], a[28:31], v[228:231], v[64:67]
    v_mfma_f32_16x16x32_bf16 v[68:71], a[28:31], v[232:235], v[68:71]
    v_mfma_f32_16x16x32_bf16 v[64:67], a[32:35], v[236:239], v[64:67]
    v_mfma_f32_16x16x32_bf16 v[68:71], a[32:35], v[240:243], v[68:71]
    v_mfma_f32_16x16x32_bf16 v[64:67], a[36:39], v[244:247], v[64:67]
    v_mfma_f32_16x16x32_bf16 v[68:71], a[36:39], v[248:251], v[68:71]
    v_mfma_f32_16x16x32_bf16 v[72:75], a[40:43], v[212:215], 0
    v_mfma_f32_16x16x32_bf16 v[76:79], a[40:43], v[216:219], 0
    v_mfma_f32_16x16x32_bf16 v[72:75], a[44:47], v[220:223], v[72:75]
    v_mfma_f32_16x16x32_bf16 v[76:79], a[44:47], v[224:227], v[76:79]
    v_mfma_f32_16x16x32_bf16 v[72:75], a[48:51], v[228:231], v[72:75]
    v_mfma_f32_16x16x32_bf16 v[76:79], a[48:51], v[232:235], v[76:79]
    v_mfma_f32_16x16x32_bf16 v[72:75], a[52:55], v[236:239], v[72:75]
    v_mfma_f32_16x16x32_bf16 v[76:79], a[52:55], v[240:243], v[76:79]
    v_mfma_f32_16x16x32_bf16 v[72:75], a[56:59], v[244:247], v[72:75]
    v_mfma_f32_16x16x32_bf16 v[76:79], a[56:59], v[248:251], v[76:79]
    v_mfma_f32_16x16x32_bf16 v[80:83], a[60:63], v[212:215], 0
    v_mfma_f32_16x16x32_bf16 v[84:87], a[60:63], v[216:219], 0
    v_mfma_f32_16x16x32_bf16 v[80:83], a[64:67], v[220:223], v[80:83]
    v_mfma_f32_16x16x32_bf16 v[84:87], a[64:67], v[224:227], v[84:87]
    v_mfma_f32_16x16x32_bf16 v[80:83], a[68:71], v[228:231], v[80:83]
    v_mfma_f32_16x16x32_bf16 v[84:87], a[68:71], v[232:235], v[84:87]
    v_mfma_f32_16x16x32_bf16 v[80:83], a[72:75], v[236:239], v[80:83]
    v_mfma_f32_16x16x32_bf16 v[84:87], a[72:75], v[240:243], v[84:87]
    v_mfma_f32_16x16x32_bf16 v[80:83], a[76:79], v[244:247], v[80:83]
    v_mfma_f32_16x16x32_bf16 v[84:87], a[76:79], v[248:251], v[84:87]
    v_mfma_f32_16x16x32_bf16 v[88:91], a[80:83], v[212:215], 0
    v_mfma_f32_16x16x32_bf16 v[92:95], a[80:83], v[216:219], 0
    v_mfma_f32_16x16x32_bf16 v[88:91], a[84:87], v[220:223], v[88:91]
    v_mfma_f32_16x16x32_bf16 v[92:95], a[84:87], v[224:227], v[92:95]
    v_mfma_f32_16x16x32_bf16 v[88:91], a[88:91], v[228:231], v[88:91]
    v_mfma_f32_16x16x32_bf16 v[92:95], a[88:91], v[232:235], v[92:95]
    v_mfma_f32_16x16x32_bf16 v[88:91], a[92:95], v[236:239], v[88:91]
    v_mfma_f32_16x16x32_bf16 v[92:95], a[92:95], v[240:243], v[92:95]
    v_mfma_f32_16x16x32_bf16 v[88:91], a[96:99], v[244:247], v[88:91]
    v_mfma_f32_16x16x32_bf16 v[92:95], a[96:99], v[248:251], v[92:95]
    v_mfma_f32_16x16x32_bf16 v[96:99], a[100:103], v[212:215], 0
    v_mfma_f32_16x16x32_bf16 v[100:103], a[100:103], v[216:219], 0
    v_mfma_f32_16x16x32_bf16 v[96:99], a[104:107], v[220:223], v[96:99]
    v_mfma_f32_16x16x32_bf16 v[100:103], a[104:107], v[224:227], v[100:103]
    v_mfma_f32_16x16x32_bf16 v[96:99], a[108:111], v[228:231], v[96:99]
    v_mfma_f32_16x16x32_bf16 v[100:103], a[108:111], v[232:235], v[100:103]
    v_mfma_f32_16x16x32_bf16 v[96:99], a[112:115], v[236:239], v[96:99]
    v_mfma_f32_16x16x32_bf16 v[100:103], a[112:115], v[240:243], v[100:103]
    v_mfma_f32_16x16x32_bf16 v[96:99], a[116:119], v[244:247], v[96:99]
    v_mfma_f32_16x16x32_bf16 v[100:103], a[116:119], v[248:251], v[100:103]
    v_mfma_f32_16x16x32_bf16 v[104:107], a[120:123], v[212:215], 0
    v_mfma_f32_16x16x32_bf16 v[108:111], a[120:123], v[216:219], 0
    v_mfma_f32_16x16x32_bf16 v[104:107], a[124:127], v[220:223], v[104:107]
    v_mfma_f32_16x16x32_bf16 v[108:111], a[124:127], v[224:227], v[108:111]
    v_mfma_f32_16x16x32_bf16 v[104:107], a[128:131], v[228:231], v[104:107]
    v_mfma_f32_16x16x32_bf16 v[108:111], a[128:131], v[232:235], v[108:111]
    v_mfma_f32_16x16x32_bf16 v[104:107], a[132:135], v[236:239], v[104:107]
    v_mfma_f32_16x16x32_bf16 v[108:111], a[132:135], v[240:243], v[108:111]
    v_mfma_f32_16x16x32_bf16 v[104:107], a[136:139], v[244:247], v[104:107]
    v_mfma_f32_16x16x32_bf16 v[108:111], a[136:139], v[248:251], v[108:111]
    v_mfma_f32_16x16x32_bf16 v[112:115], a[140:143], v[212:215], 0
    v_mfma_f32_16x16x32_bf16 v[116:119], a[140:143], v[216:219], 0
    v_mfma_f32_16x16x32_bf16 v[112:115], a[144:147], v[220:223], v[112:115]
    v_mfma_f32_16x16x32_bf16 v[116:119], a[144:147], v[224:227], v[116:119]
    v_mfma_f32_16x16x32_bf16 v[112:115], a[148:151], v[228:231], v[112:115]
    v_mfma_f32_16x16x32_bf16 v[116:119], a[148:151], v[232:235], v[116:119]
    v_mfma_f32_16x16x32_bf16 v[112:115], a[152:155], v[236:239], v[112:115]
    v_mfma_f32_16x16x32_bf16 v[116:119], a[152:155], v[240:243], v[116:119]
    v_mfma_f32_16x16x32_bf16 v[112:115], a[156:159], v[244:247], v[112:115]
    v_mfma_f32_16x16x32_bf16 v[116:119], a[156:159], v[248:251], v[116:119]
    v_mfma_f32_16x16x32_bf16 v[120:123], a[160:163], v[212:215], 0
    v_mfma_f32_16x16x32_bf16 v[124:127], a[160:163], v[216:219], 0
    v_mfma_f32_16x16x32_bf16 v[120:123], a[164:167], v[220:223], v[120:123]
    v_mfma_f32_16x16x32_bf16 v[124:127], a[164:167], v[224:227], v[124:127]
    v_mfma_f32_16x16x32_bf16 v[120:123], a[168:171], v[228:231], v[120:123]
    v_mfma_f32_16x16x32_bf16 v[124:127], a[168:171], v[232:235], v[124:127]
    v_mfma_f32_16x16x32_bf16 v[120:123], a[172:175], v[236:239], v[120:123]
    v_mfma_f32_16x16x32_bf16 v[124:127], a[172:175], v[240:243], v[124:127]
    v_mfma_f32_16x16x32_bf16 v[120:123], a[176:179], v[244:247], v[120:123]
    v_mfma_f32_16x16x32_bf16 v[124:127], a[176:179], v[248:251], v[124:127]
FP_g2:
    buffer_load_dwordx2 v[168:169], v6, s[8:11], s69 offen
    buffer_load_dword v178, v7, s[16:19], s74 offen sc1
    buffer_load_dwordx2 v[170:171], v6, s[8:11], s70 offen
    buffer_load_dword v179, v7, s[16:19], s75 offen sc1
    buffer_load_dwordx2 v[172:173], v6, s[8:11], s71 offen
    buffer_load_dword v180, v7, s[16:19], s76 offen sc1
    buffer_load_dwordx2 v[174:175], v6, s[8:11], s72 offen
    buffer_load_dword v181, v7, s[16:19], s77 offen sc1
    buffer_load_dwordx2 v[176:177], v6, s[8:11], s73 offen
    buffer_load_dword v182, v7, s[16:19], s78 offen sc1
    buffer_load_dword v253, v252, s[16:19], 0 offen sc1
FP_tail:
    s_nop 7
    ds_write_b128 v8, v[56:59] offset:0
    ds_write_b128 v8, v[60:63] offset:1024
    ds_write_b128 v8, v[64:67] offset:2048
    ds_write_b128 v8, v[68:71] offset:3072
    ds_write_b128 v8, v[72:75] offset:4096
    ds_write_b128 v8, v[76:79] offset:5120
    ds_write_b128 v8, v[80:83] offset:6144
    ds_write_b128 v8, v[84:87] offset:7168
    ds_write_b128 v8, v[88:91] offset:8192
    ds_write_b128 v8, v[92:95] offset:9216
    ds_write_b128 v8, v[96:99] offset:10240
    ds_write_b128 v8, v[100:103] offset:11264
    ds_write_b128 v8, v[104:107] offset:12288
    ds_write_b128 v8, v[108:111] offset:13312
    ds_write_b128 v8, v[112:115] offset:14336
    ds_write_b128 v8, v[116:119] offset:15360
    ds_write_b128 v8, v[120:123] offset:16384
    ds_write_b128 v8, v[124:127] offset:17408
    s_waitcnt vmcnt(0)
    v_readfirstlane_b32 s30, v253
    s_mov_b32 s88, 1
    s_nop 2
    s_cmp_ge_u32 s30, 12
    s_cbranch_scc1 FP_p1
    s_mov_b32 s88, 0
    buffer_load_dword v253, v252, s[16:19], 0 offen sc1
    s_branch FP_p2
FP_p1:
    s_add_u32 s46, s64, 0
    buffer_load_dwordx2 v[128:129], v5, s[16:19], s46 offen sc1
    s_add_u32 s46, s64, 2359296
    buffer_load_dwordx2 v[138:139], v5, s[16:19], s46 offen sc1
    s_add_u32 s46, s64, 4718592
    buffer_load_dwordx2 v[148:149], v5, s[16:19], s46 offen sc1
    s_add_u32 s46, s64, 7077888
    buffer_load_dwordx2 v[158:159], v5, s[16:19], s46 offen sc1
    s_add_u32 s46, s65, 0
    buffer_load_dwordx2 v[130:131], v5, s[16:19], s46 offen sc1
    s_add_u32 s46, s65, 2359296
    buffer_load_dwordx2 v[140:141], v5, s[16:19], s46 offen sc1
    s_add_u32 s46, s65, 4718592
    buffer_load_dwordx2 v[150:151], v5, s[16:19], s46 offen sc1
    s_add_u32 s46, s65, 7077888
    buffer_load_dwordx2 v[160:161], v5, s[16:19], s46 offen sc1
    s_add_u32 s46, s66, 0
    buffer_load_dwordx2 v[132:133], v5, s[16:19], s46 offen sc1
    s_add_u32 s46, s66, 2359296
    buffer_load_dwordx2 v[142:143], v5, s[16:19], s46 offen sc1
    s_add_u32 s46, s66, 4718592
    buffer_load_dwordx2 v[152:153], v5, s[16:19], s46 offen sc1
    s_add_u32 s46, s66, 7077888
    buffer_load_dwordx2 v[162:163], v5, s[16:19], s46 offen sc1
    s_add_u32 s46, s67, 0
    buffer_load_dwordx2 v[134:135], v5, s[16:19], s46 offen sc1
    s_add_u32 s46, s67, 2359296
    buffer_load_dwordx2 v[144:145], v5, s[16:19], s46 offen sc1
    s_add_u32 s46, s67, 4718592
    buffer_load_dwordx2 v[154:155], v5, s[16:19], s46 offen sc1
    s_add_u32 s46, s67, 7077888
    buffer_load_dwordx2 v[164:165], v5, s[16:19], s46 offen sc1
    s_add_u32 s46, s68, 0
    buffer_load_dwordx2 v[136:137], v5, s[16:19], s46 offen sc1
    s_add_u32 s46, s68, 2359296
    buffer_load_dwordx2 v[146:147], v5, s[16:19], s46 offen sc1
    s_add_u32 s46, s68, 4718592
    buffer_load_dwordx2 v[156:157], v5, s[16:19], s46 offen sc1
    s_add_u32 s46, s68, 7077888
    buffer_load_dwordx2 v[166:167], v5, s[16:19], s46 offen sc1
FP_p2:
    s_waitcnt lgkmcnt(0)
    s_barrier
    v_add_u32 v14, 36864, v9
    ds_read_b128 v[16:19], v9 offset:0
    ds_read_b128 v[20:23], v9 offset:18432
    ds_read_b128 v[24:27], v14 offset:0
    ds_read_b128 v[28:31], v14 offset:18432
    ds_read_b128 v[32:35], v9 offset:1024
    ds_read_b128 v[36:39], v9 offset:19456
    ds_read_b128 v[40:43], v14 offset:1024
    ds_read_b128 v[44:47], v14 offset:19456
    ds_read_b128 v[48:51], v9 offset:2048
    ds_read_b128 v[52:55], v9 offset:20480
    ds_read_b128 v[56:59], v14 offset:2048
    ds_read_b128 v[60:63], v14 offset:20480
    ds_read_b128 v[64:67], v9 offset:3072
    ds_read_b128 v[68:71], v9 offset:21504
    ds_read_b128 v[72:75], v14 offset:3072
    ds_read_b128 v[76:79], v14 offset:21504
    ds_read_b128 v[80:83], v9 offset:4096
    ds_read_b128 v[84:87], v9 offset:22528
    ds_read_b128 v[88:91], v14 offset:4096
    ds_read_b128 v[92:95], v14 offset:22528
    s_waitcnt lgkmcnt(15)
    v_pk_add_f32 v[16:17], v[16:17], v[20:21]
    v_pk_add_f32 v[24:25], v[24:25], v[28:29]
    v_pk_add_f32 v[18:19], v[18:19], v[22:23]
    v_pk_add_f32 v[26:27], v[26:27], v[30:31]
    v_mov_b32 v14, v178
    v_sub_f32 v15, 0, v178
    v_pk_add_f32 v[16:17], v[16:17], v[24:25]
    v_pk_add_f32 v[18:19], v[18:19], v[26:27]
    v_pk_add_f32 v[16:17], v[16:17], v[14:15]
    v_pk_add_f32 v[18:19], v[18:19], v[14:15]
    v_pk_mul_f32 v[16:17], v[16:17], s[44:45]
    v_pk_mul_f32 v[18:19], v[18:19], s[44:45]
    v_lshlrev_b32 v20, 16, v168
    v_and_b32 v21, s27, v168
    v_lshlrev_b32 v22, 16, v169
    v_and_b32 v23, s27, v169
    s_waitcnt lgkmcnt(12)
    v_pk_add_f32 v[32:33], v[32:33], v[36:37]
    v_pk_add_f32 v[40:41], v[40:41], v[44:45]
    v_pk_add_f32 v[34:35], v[34:35], v[38:39]
    v_pk_add_f32 v[42:43], v[42:43], v[46:47]
    v_mov_b32 v14, v179
    v_sub_f32 v15, 0, v179
    v_pk_add_f32 v[32:33], v[32:33], v[40:41]
    v_pk_add_f32 v[34:35], v[34:35], v[42:43]
    v_pk_add_f32 v[32:33], v[32:33], v[14:15]
    v_pk_add_f32 v[34:35], v[34:35], v[14:15]
    v_pk_mul_f32 v[32:33], v[32:33], s[44:45]
    v_pk_mul_f32 v[34:35], v[34:35], s[44:45]
    v_lshlrev_b32 v36, 16, v170
    v_and_b32 v37, s27, v170
    v_lshlrev_b32 v38, 16, v171
    v_and_b32 v39, s27, v171
    s_waitcnt lgkmcnt(8)
    v_pk_add_f32 v[48:49], v[48:49], v[52:53]
    v_pk_add_f32 v[56:57], v[56:57], v[60:61]
    v_pk_add_f32 v[50:51], v[50:51], v[54:55]
    v_pk_add_f32 v[58:59], v[58:59], v[62:63]
    v_mov_b32 v14, v180
    v_sub_f32 v15, 0, v180
    v_pk_add_f32 v[48:49], v[48:49], v[56:57]
    v_pk_add_f32 v[50:51], v[50:51], v[58:59]
    v_pk_add_f32 v[48:49], v[48:49], v[14:15]
    v_pk_add_f32 v[50:51], v[50:51], v[14:15]
    v_pk_mul_f32 v[48:49], v[48:49], s[44:45]
    v_pk_mul_f32 v[50:51], v[50:51], s[44:45]
    v_lshlrev_b32 v52, 16, v172
    v_and_b32 v53, s27, v172
    v_lshlrev_b32 v54, 16, v173
    v_and_b32 v55, s27, v173
    s_waitcnt lgkmcnt(4)
    v_pk_add_f32 v[64:65], v[64:65], v[68:69]
    v_pk_add_f32 v[72:73], v[72:73], v[76:77]
    v_pk_add_f32 v[66:67], v[66:67], v[70:71]
    v_pk_add_f32 v[74:75], v[74:75], v[78:79]
    v_mov_b32 v14, v181
    v_sub_f32 v15, 0, v181
    v_pk_add_f32 v[64:65], v[64:65], v[72:73]
    v_pk_add_f32 v[66:67], v[66:67], v[74:75]
    v_pk_add_f32 v[64:65], v[64:65], v[14:15]
    v_pk_add_f32 v[66:67], v[66:67], v[14:15]
    v_pk_mul_f32 v[64:65], v[64:65], s[44:45]
    v_pk_mul_f32 v[66:67], v[66:67], s[44:45]
    v_lshlrev_b32 v68, 16, v174
    v_and_b32 v69, s27, v174
    v_lshlrev_b32 v70, 16, v175
    v_and_b32 v71, s27, v175
    s_waitcnt lgkmcnt(0)
    v_pk_add_f32 v[80:81], v[80:81], v[84:85]
    v_pk_add_f32 v[88:89], v[88:89], v[92:93]
    v_pk_add_f32 v[82:83], v[82:83], v[86:87]
    v_pk_add_f32 v[90:91], v[90:91], v[94:95]
    v_mov_b32 v14, v182
    v_sub_f32 v15, 0, v182
    v_pk_add_f32 v[80:81], v[80:81], v[88:89]
    v_pk_add_f32 v[82:83], v[82:83], v[90:91]
    v_pk_add_f32 v[80:81], v[80:81], v[14:15]
    v_pk_add_f32 v[82:83], v[82:83], v[14:15]
    v_pk_mul_f32 v[80:81], v[80:81], s[44:45]
    v_pk_mul_f32 v[82:83], v[82:83], s[44:45]
    v_lshlrev_b32 v84, 16, v176
    v_and_b32 v85, s27, v176
    v_lshlrev_b32 v86, 16, v177
    v_and_b32 v87, s27, v177
    s_cmp_eq_u32 s88, 1
    s_cbranch_scc1 FP_p3
    s_waitcnt vmcnt(0)
    s_mov_b32 s3, 0
FP_ckb:
    v_readfirstlane_b32 s30, v253
    s_add_u32 s3, s3, 1
    s_cmp_ge_u32 s30, 12
    s_cbranch_scc1 FP_okb
    s_cmp_ge_u32 s3, 100000
    s_cbranch_scc1 FP_okb
    s_sleep 1
    buffer_load_dword v253, v252, s[16:19], 0 offen sc1
    s_waitcnt vmcnt(0)
    s_branch FP_ckb
FP_okb:
    s_add_u32 s46, s64, 0
    buffer_load_dwordx2 v[128:129], v5, s[16:19], s46 offen sc1
    s_add_u32 s46, s64, 2359296
    buffer_load_dwordx2 v[138:139], v5, s[16:19], s46 offen sc1
    s_add_u32 s46, s64, 4718592
    buffer_load_dwordx2 v[148:149], v5, s[16:19], s46 offen sc1
    s_add_u32 s46, s64, 7077888
    buffer_load_dwordx2 v[158:159], v5, s[16:19], s46 offen sc1
    s_add_u32 s46, s65, 0
    buffer_load_dwordx2 v[130:131], v5, s[16:19], s46 offen sc1
    s_add_u32 s46, s65, 2359296
    buffer_load_dwordx2 v[140:141], v5, s[16:19], s46 offen sc1
    s_add_u32 s46, s65, 4718592
    buffer_load_dwordx2 v[150:151], v5, s[16:19], s46 offen sc1
    s_add_u32 s46, s65, 7077888
    buffer_load_dwordx2 v[160:161], v5, s[16:19], s46 offen sc1
    s_add_u32 s46, s66, 0
    buffer_load_dwordx2 v[132:133], v5, s[16:19], s46 offen sc1
    s_add_u32 s46, s66, 2359296
    buffer_load_dwordx2 v[142:143], v5, s[16:19], s46 offen sc1
    s_add_u32 s46, s66, 4718592
    buffer_load_dwordx2 v[152:153], v5, s[16:19], s46 offen sc1
    s_add_u32 s46, s66, 7077888
    buffer_load_dwordx2 v[162:163], v5, s[16:19], s46 offen sc1
    s_add_u32 s46, s67, 0
    buffer_load_dwordx2 v[134:135], v5, s[16:19], s46 offen sc1
    s_add_u32 s46, s67, 2359296
    buffer_load_dwordx2 v[144:145], v5, s[16:19], s46 offen sc1
    s_add_u32 s46, s67, 4718592
    buffer_load_dwordx2 v[154:155], v5, s[16:19], s46 offen sc1
    s_add_u32 s46, s67, 7077888
    buffer_load_dwordx2 v[164:165], v5, s[16:19], s46 offen sc1
    s_add_u32 s46, s68, 0
    buffer_load_dwordx2 v[136:137], v5, s[16:19], s46 offen sc1
    s_add_u32 s46, s68, 2359296
    buffer_load_dwordx2 v[146:147], v5, s[16:19], s46 offen sc1
    s_add_u32 s46, s68, 4718592
    buffer_load_dwordx2 v[156:157], v5, s[16:19], s46 offen sc1
    s_add_u32 s46, s68, 7077888
    buffer_load_dwordx2 v[166:167], v5, s[16:19], s46 offen sc1
FP_p3:
    s_waitcnt vmcnt(16)
    v_lshlrev_b32 v184, 16, v128
    v_and_b32 v185, s27, v128
    v_lshlrev_b32 v14, 16, v138
    v_and_b32 v15, s27, v138
    v_pk_add_f32 v[184:185], v[184:185], v[14:15]
    v_lshlrev_b32 v14, 16, v148
    v_and_b32 v15, s27, v148
    v_pk_add_f32 v[184:185], v[184:185], v[14:15]
    v_lshlrev_b32 v14, 16, v158
    v_and_b32 v15, s27, v158
    v_pk_add_f32 v[184:185], v[184:185], v[14:15]
    v_lshlrev_b32 v186, 16, v129
    v_and_b32 v187, s27, v129
    v_lshlrev_b32 v14, 16, v139
    v_and_b32 v15, s27, v139
    v_pk_add_f32 v[186:187], v[186:187], v[14:15]
    v_lshlrev_b32 v14, 16, v149
    v_and_b32 v15, s27, v149
    v_pk_add_f32 v[186:187], v[186:187], v[14:15]
    v_lshlrev_b32 v14, 16, v159
    v_and_b32 v15, s27, v159
    v_pk_add_f32 v[186:187], v[186:187], v[14:15]
    s_waitcnt vmcnt(12)
    v_lshlrev_b32 v188, 16, v130
    v_and_b32 v189, s27, v130
    v_lshlrev_b32 v14, 16, v140
    v_and_b32 v15, s27, v140
    v_pk_add_f32 v[188:189], v[188:189], v[14:15]
    v_lshlrev_b32 v14, 16, v150
    v_and_b32 v15, s27, v150
    v_pk_add_f32 v[188:189], v[188:189], v[14:15]
    v_lshlrev_b32 v14, 16, v160
    v_and_b32 v15, s27, v160
    v_pk_add_f32 v[188:189], v[188:189], v[14:15]
    v_lshlrev_b32 v190, 16, v131
    v_and_b32 v191, s27, v131
    v_lshlrev_b32 v14, 16, v141
    v_and_b32 v15, s27, v141
    v_pk_add_f32 v[190:191], v[190:191], v[14:15]
    v_lshlrev_b32 v14, 16, v151
    v_and_b32 v15, s27, v151
    v_pk_add_f32 v[190:191], v[190:191], v[14:15]
    v_lshlrev_b32 v14, 16, v161
    v_and_b32 v15, s27, v161
    v_pk_add_f32 v[190:191], v[190:191], v[14:15]
    s_waitcnt vmcnt(8)
    v_lshlrev_b32 v192, 16, v132
    v_and_b32 v193, s27, v132
    v_lshlrev_b32 v14, 16, v142
    v_and_b32 v15, s27, v142
    v_pk_add_f32 v[192:193], v[192:193], v[14:15]
    v_lshlrev_b32 v14, 16, v152
    v_and_b32 v15, s27, v152
    v_pk_add_f32 v[192:193], v[192:193], v[14:15]
    v_lshlrev_b32 v14, 16, v162
    v_and_b32 v15, s27, v162
    v_pk_add_f32 v[192:193], v[192:193], v[14:15]
    v_lshlrev_b32 v194, 16, v133
    v_and_b32 v195, s27, v133
    v_lshlrev_b32 v14, 16, v143
    v_and_b32 v15, s27, v143
    v_pk_add_f32 v[194:195], v[194:195], v[14:15]
    v_lshlrev_b32 v14, 16, v153
    v_and_b32 v15, s27, v153
    v_pk_add_f32 v[194:195], v[194:195], v[14:15]
    v_lshlrev_b32 v14, 16, v163
    v_and_b32 v15, s27, v163
    v_pk_add_f32 v[194:195], v[194:195], v[14:15]
    s_waitcnt vmcnt(4)
    v_lshlrev_b32 v196, 16, v134
    v_and_b32 v197, s27, v134
    v_lshlrev_b32 v14, 16, v144
    v_and_b32 v15, s27, v144
    v_pk_add_f32 v[196:197], v[196:197], v[14:15]
    v_lshlrev_b32 v14, 16, v154
    v_and_b32 v15, s27, v154
    v_pk_add_f32 v[196:197], v[196:197], v[14:15]
    v_lshlrev_b32 v14, 16, v164
    v_and_b32 v15, s27, v164
    v_pk_add_f32 v[196:197], v[196:197], v[14:15]
    v_lshlrev_b32 v198, 16, v135
    v_and_b32 v199, s27, v135
    v_lshlrev_b32 v14, 16, v145
    v_and_b32 v15, s27, v145
    v_pk_add_f32 v[198:199], v[198:199], v[14:15]
    v_lshlrev_b32 v14, 16, v155
    v_and_b32 v15, s27, v155
    v_pk_add_f32 v[198:199], v[198:199], v[14:15]
    v_lshlrev_b32 v14, 16, v165
    v_and_b32 v15, s27, v165
    v_pk_add_f32 v[198:199], v[198:199], v[14:15]
    s_waitcnt vmcnt(0)
    v_lshlrev_b32 v200, 16, v136
    v_and_b32 v201, s27, v136
    v_lshlrev_b32 v14, 16, v146
    v_and_b32 v15, s27, v146
    v_pk_add_f32 v[200:201], v[200:201], v[14:15]
    v_lshlrev_b32 v14, 16, v156
    v_and_b32 v15, s27, v156
    v_pk_add_f32 v[200:201], v[200:201], v[14:15]
    v_lshlrev_b32 v14, 16, v166
    v_and_b32 v15, s27, v166
    v_pk_add_f32 v[200:201], v[200:201], v[14:15]
    v_lshlrev_b32 v202, 16, v137
    v_and_b32 v203, s27, v137
    v_lshlrev_b32 v14, 16, v147
    v_and_b32 v15, s27, v147
    v_pk_add_f32 v[202:203], v[202:203], v[14:15]
    v_lshlrev_b32 v14, 16, v157
    v_and_b32 v15, s27, v157
    v_pk_add_f32 v[202:203], v[202:203], v[14:15]
    v_lshlrev_b32 v14, 16, v167
    v_and_b32 v15, s27, v167
    v_pk_add_f32 v[202:203], v[202:203], v[14:15]
    v_pk_mul_f32 v[204:205], v[184:185], s[82:83]
    v_pk_mul_f32 v[206:207], v[186:187], s[82:83]
    v_pk_mul_f32 v[208:209], v[188:189], s[82:83]
    v_pk_mul_f32 v[210:211], v[190:191], s[82:83]
    v_pk_mul_f32 v[212:213], v[192:193], s[82:83]
    v_pk_mul_f32 v[214:215], v[194:195], s[82:83]
    v_pk_mul_f32 v[216:217], v[196:197], s[82:83]
    v_pk_mul_f32 v[218:219], v[198:199], s[82:83]
    v_pk_mul_f32 v[220:221], v[200:201], s[82:83]
    v_pk_mul_f32 v[222:223], v[202:203], s[82:83]
    v_exp_f32 v204, v204
    v_exp_f32 v205, v205
    v_exp_f32 v206, v206
    v_exp_f32 v207, v207
    v_exp_f32 v208, v208
    v_exp_f32 v209, v209
    v_exp_f32 v210, v210
    v_exp_f32 v211, v211
    v_exp_f32 v212, v212
    v_exp_f32 v213, v213
    v_exp_f32 v214, v214
    v_exp_f32 v215, v215
    v_exp_f32 v216, v216
    v_exp_f32 v217, v217
    v_exp_f32 v218, v218
    v_exp_f32 v219, v219
    v_exp_f32 v220, v220
    v_exp_f32 v221, v221
    v_exp_f32 v222, v222
    v_exp_f32 v223, v223
    v_pk_add_f32 v[204:205], v[204:205], s[86:87]
    v_pk_add_f32 v[206:207], v[206:207], s[86:87]
    v_pk_add_f32 v[208:209], v[208:209], s[86:87]
    v_pk_add_f32 v[210:211], v[210:211], s[86:87]
    v_pk_add_f32 v[212:213], v[212:213], s[86:87]
    v_pk_add_f32 v[214:215], v[214:215], s[86:87]
    v_pk_add_f32 v[216:217], v[216:217], s[86:87]
    v_pk_add_f32 v[218:219], v[218:219], s[86:87]
    v_pk_add_f32 v[220:221], v[220:221], s[86:87]
    v_pk_add_f32 v[222:223], v[222:223], s[86:87]
    v_rcp_f32 v204, v204
    v_rcp_f32 v205, v205
    v_rcp_f32 v206, v206
    v_rcp_f32 v207, v207
    v_rcp_f32 v208, v208
    v_rcp_f32 v209, v209
    v_rcp_f32 v210, v210
    v_rcp_f32 v211, v211
    v_rcp_f32 v212, v212
    v_rcp_f32 v213, v213
    v_rcp_f32 v214, v214
    v_rcp_f32 v215, v215
    v_rcp_f32 v216, v216
    v_rcp_f32 v217, v217
    v_rcp_f32 v218, v218
    v_rcp_f32 v219, v219
    v_rcp_f32 v220, v220
    v_rcp_f32 v221, v221
    v_rcp_f32 v222, v222
    v_rcp_f32 v223, v223
    v_pk_mul_f32 v[204:205], v[204:205], v[184:185]
    v_pk_mul_f32 v[206:207], v[206:207], v[186:187]
    v_pk_mul_f32 v[208:209], v[208:209], v[188:189]
    v_pk_mul_f32 v[210:211], v[210:211], v[190:191]
    v_pk_mul_f32 v[212:213], v[212:213], v[192:193]
    v_pk_mul_f32 v[214:215], v[214:215], v[194:195]
    v_pk_mul_f32 v[216:217], v[216:217], v[196:197]
    v_pk_mul_f32 v[218:219], v[218:219], v[198:199]
    v_pk_mul_f32 v[220:221], v[220:221], v[200:201]
    v_pk_mul_f32 v[222:223], v[222:223], v[202:203]
    v_pk_fma_f32 v[16:17], v[16:17], v[204:205], v[20:21]
    v_pk_fma_f32 v[18:19], v[18:19], v[206:207], v[22:23]
    v_cvt_pk_bf16_f32 v168, v16, v17
    v_cvt_pk_bf16_f32 v169, v18, v19
    buffer_store_dwordx2 v[168:169], v6, s[12:15], s69 offen
    v_pk_fma_f32 v[32:33], v[32:33], v[208:209], v[36:37]
    v_pk_fma_f32 v[34:35], v[34:35], v[210:211], v[38:39]
    v_cvt_pk_bf16_f32 v170, v32, v33
    v_cvt_pk_bf16_f32 v171, v34, v35
    buffer_store_dwordx2 v[170:171], v6, s[12:15], s70 offen
    v_pk_fma_f32 v[48:49], v[48:49], v[212:213], v[52:53]
    v_pk_fma_f32 v[50:51], v[50:51], v[214:215], v[54:55]
    v_cvt_pk_bf16_f32 v172, v48, v49
    v_cvt_pk_bf16_f32 v173, v50, v51
    buffer_store_dwordx2 v[172:173], v6, s[12:15], s71 offen
    v_pk_fma_f32 v[64:65], v[64:65], v[216:217], v[68:69]
    v_pk_fma_f32 v[66:67], v[66:67], v[218:219], v[70:71]
    v_cvt_pk_bf16_f32 v174, v64, v65
    v_cvt_pk_bf16_f32 v175, v66, v67
    buffer_store_dwordx2 v[174:175], v6, s[12:15], s72 offen
    v_pk_fma_f32 v[80:81], v[80:81], v[220:221], v[84:85]
    v_pk_fma_f32 v[82:83], v[82:83], v[222:223], v[86:87]
    v_cvt_pk_bf16_f32 v176, v80, v81
    v_cvt_pk_bf16_f32 v177, v82, v83
    buffer_store_dwordx2 v[176:177], v6, s[12:15], s73 offen
    s_endpgm
K2_exit:
    s_endpgm
k2_kernel_end:
.section .rodata,"a"
.set CA0, 16256
.set CA1, 16256
.set CA2, 16256
.set CA3, 16256
.set CA4, 16256
.set CA5, 16256
.set CA6, 16255
.set CA7, 16255
.set CA8, 16255
.set CA9, 16255
.set CA10, 16254
.set CA11, 16254
.set CA12, 16254
.set CA13, 16253
.set CA14, 16253
.set CA15, 16253
.set CA16, 16252
.set CA17, 16252
.set CA18, 16251
.set CA19, 16251
.set CA20, 16250
.set CA21, 16249
.set CA22, 16249
.set CA23, 16248
.set CA24, 16247
.set CA25, 16247
.set CA26, 16246
.set CA27, 16245
.set CA28, 16244
.set CA29, 16243
.set CA30, 16242
.set CA31, 16242
.set CA32, 16241
.set CA33, 16240
.set CA34, 16239
.set CA35, 16238
.set CA36, 16237
.set CA37, 16235
.set CA38, 16234
.set CA39, 16233
.set CA40, 16232
.set CA41, 16231
.set CA42, 16230
.set CA43, 16228
.set CA44, 16227
.set CA45, 16226
.set CA46, 16224
.set CA47, 16223
.set CA48, 16222
.set CA49, 16220
.set CA50, 16219
.set CA51, 16217
.set CA52, 16216
.set CA53, 16214
.set CA54, 16213
.set CA55, 16211
.set CA56, 16210
.set CA57, 16208
.set CA58, 16206
.set CA59, 16205
.set CA60, 16203
.set CA61, 16201
.set CA62, 16200
.set CA63, 16198
.set CA64, 16196
.set CA65, 16194
.set CA66, 16192
.set CA67, 16191
.set CA68, 16189
.set CA69, 16187
.set CA70, 16185
.set CA71, 16183
.set CA72, 16181
.set CA73, 16179
.set CA74, 16177
.set CA75, 16175
.set CA76, 16173
.set CA77, 16171
.set CA78, 16169
.set CA79, 16167
.set CA80, 16165
.set CA81, 16162
.set CA82, 16160
.set CA83, 16158
.set CA84, 16156
.set CA85, 16154
.set CA86, 16151
.set CA87, 16149
.set CA88, 16147
.set CA89, 16145
.set CA90, 16142
.set CA91, 16140
.set CA92, 16138
.set CA93, 16135
.set CA94, 16133
.set CA95, 16130
.set CA96, 16128
.set CA97, 16123
.set CA98, 16118
.set CA99, 16113
.set CA100, 16108
.set CA101, 16103
.set CA102, 16098
.set CA103, 16093
.set CA104, 16088
.set CA105, 16083
.set CA106, 16078
.set CA107, 16073
.set CA108, 16068
.set CA109, 16063
.set CA110, 16058
.set CA111, 16052
.set CA112, 16047
.set CA113, 16042
.set CA114, 16037
.set CA115, 16031
.set CA116, 16026
.set CA117, 16021
.set CA118, 16015
.set CA119, 16010
.set CA120, 16005
.set CA121, 15998
.set CA122, 15987
.set CA123, 15977
.set CA124, 15966
.set CA125, 15955
.set CA126, 15944
.set CA127, 15933
.set CA128, 15922
.set CA129, 15911
.set CA130, 15900
.set CA131, 15889
.set CA132, 15878
.set CA133, 15861
.set CA134, 15839
.set CA135, 15817
.set CA136, 15794
.set CA137, 15772
.set CA138, 15750
.set CA139, 15711
.set CA140, 15667
.set CA141, 15622
.set CA142, 15539
.set CA143, 15411
.set CA144, 0
.set CA145, 48179
.set CA146, 48307
.set CA147, 48390
.set CA148, 48435
.set CA149, 48479
.set CA150, 48518
.set CA151, 48540
.set CA152, 48562
.set CA153, 48585
.set CA154, 48607
.set CA155, 48629
.set CA156, 48646
.set CA157, 48657
.set CA158, 48668
.set CA159, 48679
.set CA160, 48690
.set CA161, 48701
.set CA162, 48712
.set CA163, 48723
.set CA164, 48734
.set CA165, 48745
.set CA166, 48755
.set CA167, 48766
.set CA168, 48773
.set CA169, 48778
.set CA170, 48783
.set CA171, 48789
.set CA172, 48794
.set CA173, 48799
.set CA174, 48805
.set CA175, 48810
.set CA176, 48815
.set CA177, 48820
.set CA178, 48826
.set CA179, 48831
.set CA180, 48836
.set CA181, 48841
.set CA182, 48846
.set CA183, 48851
.set CA184, 48856
.set CA185, 48861
.set CA186, 48866
.set CA187, 48871
.set CA188, 48876
.set CA189, 48881
.set CA190, 48886
.set CA191, 48891
.set CA192, 48896
.set CA193, 48898
.set CA194, 48901
.set CA195, 48903
.set CA196, 48906
.set CA197, 48908
.set CA198, 48910
.set CA199, 48913
.set CA200, 48915
.set CA201, 48917
.set CA202, 48919
.set CA203, 48922
.set CA204, 48924
.set CA205, 48926
.set CA206, 48928
.set CA207, 48930
.set CA208, 48933
.set CA209, 48935
.set CA210, 48937
.set CA211, 48939
.set CA212, 48941
.set CA213, 48943
.set CA214, 48945
.set CA215, 48947
.set CA216, 48949
.set CA217, 48951
.set CA218, 48953
.set CA219, 48955
.set CA220, 48957
.set CA221, 48959
.set CA222, 48960
.set CA223, 48962
.set CA224, 48964
.set CA225, 48966
.set CA226, 48968
.set CA227, 48969
.set CA228, 48971
.set CA229, 48973
.set CA230, 48974
.set CA231, 48976
.set CA232, 48978
.set CA233, 48979
.set CA234, 48981
.set CA235, 48982
.set CA236, 48984
.set CA237, 48985
.set CA238, 48987
.set CA239, 48988
.set CA240, 48990
.set CA241, 48991
.set CA242, 48992
.set CA243, 48994
.set CA244, 48995
.set CA245, 48996
.set CA246, 48998
.set CA247, 48999
.set CA248, 49000
.set CA249, 49001
.set CA250, 49002
.set CA251, 49003
.set CA252, 49005
.set CA253, 49006
.set CA254, 49007
.set CA255, 49008
.set CA256, 49009
.set CA257, 49010
.set CA258, 49010
.set CA259, 49011
.set CA260, 49012
.set CA261, 49013
.set CA262, 49014
.set CA263, 49015
.set CA264, 49015
.set CA265, 49016
.set CA266, 49017
.set CA267, 49017
.set CA268, 49018
.set CA269, 49019
.set CA270, 49019
.set CA271, 49020
.set CA272, 49020
.set CA273, 49021
.set CA274, 49021
.set CA275, 49021
.set CA276, 49022
.set CA277, 49022
.set CA278, 49022
.set CA279, 49023
.set CA280, 49023
.set CA281, 49023
.set CA282, 49023
.set CA283, 49024
.set CA284, 49024
.set CA285, 49024
.set CA286, 49024
.set CA287, 49024
.set CA288, 49024
.set CA289, 49024
.set CA290, 49024
.set CA291, 49024
.set CA292, 49024
.set CA293, 49024
.set CA294, 49023
.set CA295, 49023
.set CA296, 49023
.set CA297, 49023
.set CA298, 49022
.set CA299, 49022
.set CA300, 49022
.set CA301, 49021
.set CA302, 49021
.set CA303, 49021
.set CA304, 49020
.set CA305, 49020
.set CA306, 49019
.set CA307, 49019
.set CA308, 49018
.set CA309, 49017
.set CA310, 49017
.set CA311, 49016
.set CA312, 49015
.set CA313, 49015
.set CA314, 49014
.set CA315, 49013
.set CA316, 49012
.set CA317, 49011
.set CA318, 49010
.set CA319, 49010
.set CA320, 49009
.set CA321, 49008
.set CA322, 49007
.set CA323, 49006
.set CA324, 49005
.set CA325, 49003
.set CA326, 49002
.set CA327, 49001
.set CA328, 49000
.set CA329, 48999
.set CA330, 48998
.set CA331, 48996
.set CA332, 48995
.set CA333, 48994
.set CA334, 48992
.set CA335, 48991
.set CA336, 48990
.set CA337, 48988
.set CA338, 48987
.set CA339, 48985
.set CA340, 48984
.set CA341, 48982
.set CA342, 48981
.set CA343, 48979
.set CA344, 48978
.set CA345, 48976
.set CA346, 48974
.set CA347, 48973
.set CA348, 48971
.set CA349, 48969
.set CA350, 48968
.set CA351, 48966
.set CA352, 48964
.set CA353, 48962
.set CA354, 48960
.set CA355, 48959
.set CA356, 48957
.set CA357, 48955
.set CA358, 48953
.set CA359, 48951
.set CA360, 48949
.set CA361, 48947
.set CA362, 48945
.set CA363, 48943
.set CA364, 48941
.set CA365, 48939
.set CA366, 48937
.set CA367, 48935
.set CA368, 48933
.set CA369, 48930
.set CA370, 48928
.set CA371, 48926
.set CA372, 48924
.set CA373, 48922
.set CA374, 48919
.set CA375, 48917
.set CA376, 48915
.set CA377, 48913
.set CA378, 48910
.set CA379, 48908
.set CA380, 48906
.set CA381, 48903
.set CA382, 48901
.set CA383, 48898
.set CA384, 48896
.set CA385, 48891
.set CA386, 48886
.set CA387, 48881
.set CA388, 48876
.set CA389, 48871
.set CA390, 48866
.set CA391, 48861
.set CA392, 48856
.set CA393, 48851
.set CA394, 48846
.set CA395, 48841
.set CA396, 48836
.set CA397, 48831
.set CA398, 48826
.set CA399, 48820
.set CA400, 48815
.set CA401, 48810
.set CA402, 48805
.set CA403, 48799
.set CA404, 48794
.set CA405, 48789
.set CA406, 48783
.set CA407, 48778
.set CA408, 48773
.set CA409, 48766
.set CA410, 48755
.set CA411, 48745
.set CA412, 48734
.set CA413, 48723
.set CA414, 48712
.set CA415, 48701
.set CA416, 48690
.set CA417, 48679
.set CA418, 48668
.set CA419, 48657
.set CA420, 48646
.set CA421, 48629
.set CA422, 48607
.set CA423, 48585
.set CA424, 48562
.set CA425, 48540
.set CA426, 48518
.set CA427, 48479
.set CA428, 48435
.set CA429, 48390
.set CA430, 48307
.set CA431, 48179
.set CA432, 0
.set CA433, 15411
.set CA434, 15539
.set CA435, 15622
.set CA436, 15667
.set CA437, 15711
.set CA438, 15750
.set CA439, 15772
.set CA440, 15794
.set CA441, 15817
.set CA442, 15839
.set CA443, 15861
.set CA444, 15878
.set CA445, 15889
.set CA446, 15900
.set CA447, 15911
.set CA448, 15922
.set CA449, 15933
.set CA450, 15944
.set CA451, 15955
.set CA452, 15966
.set CA453, 15977
.set CA454, 15987
.set CA455, 15998
.set CA456, 16005
.set CA457, 16010
.set CA458, 16015
.set CA459, 16021
.set CA460, 16026
.set CA461, 16031
.set CA462, 16037
.set CA463, 16042
.set CA464, 16047
.set CA465, 16052
.set CA466, 16058
.set CA467, 16063
.set CA468, 16068
.set CA469, 16073
.set CA470, 16078
.set CA471, 16083
.set CA472, 16088
.set CA473, 16093
.set CA474, 16098
.set CA475, 16103
.set CA476, 16108
.set CA477, 16113
.set CA478, 16118
.set CA479, 16123
.set CA480, 16128
.set CA481, 16130
.set CA482, 16133
.set CA483, 16135
.set CA484, 16138
.set CA485, 16140
.set CA486, 16142
.set CA487, 16145
.set CA488, 16147
.set CA489, 16149
.set CA490, 16151
.set CA491, 16154
.set CA492, 16156
.set CA493, 16158
.set CA494, 16160
.set CA495, 16162
.set CA496, 16165
.set CA497, 16167
.set CA498, 16169
.set CA499, 16171
.set CA500, 16173
.set CA501, 16175
.set CA502, 16177
.set CA503, 16179
.set CA504, 16181
.set CA505, 16183
.set CA506, 16185
.set CA507, 16187
.set CA508, 16189
.set CA509, 16191
.set CA510, 16192
.set CA511, 16194
.set CA512, 16196
.set CA513, 16198
.set CA514, 16200
.set CA515, 16201
.set CA516, 16203
.set CA517, 16205
.set CA518, 16206
.set CA519, 16208
.set CA520, 16210
.set CA521, 16211
.set CA522, 16213
.set CA523, 16214
.set CA524, 16216
.set CA525, 16217
.set CA526, 16219
.set CA527, 16220
.set CA528, 16222
.set CA529, 16223
.set CA530, 16224
.set CA531, 16226
.set CA532, 16227
.set CA533, 16228
.set CA534, 16230
.set CA535, 16231
.set CA536, 16232
.set CA537, 16233
.set CA538, 16234
.set CA539, 16235
.set CA540, 16237
.set CA541, 16238
.set CA542, 16239
.set CA543, 16240
.set CA544, 16241
.set CA545, 16242
.set CA546, 16242
.set CA547, 16243
.set CA548, 16244
.set CA549, 16245
.set CA550, 16246
.set CA551, 16247
.set CA552, 16247
.set CA553, 16248
.set CA554, 16249
.set CA555, 16249
.set CA556, 16250
.set CA557, 16251
.set CA558, 16251
.set CA559, 16252
.set CA560, 16252
.set CA561, 16253
.set CA562, 16253
.set CA563, 16253
.set CA564, 16254
.set CA565, 16254
.set CA566, 16254
.set CA567, 16255
.set CA568, 16255
.set CA569, 16255
.set CA570, 16255
.set CA571, 16256
.set CA572, 16256
.set CA573, 16256
.set CA574, 16256
.set CA575, 16256
.set CB0, 16384
.set CB1, 16384
.set CB2, 16384
.set CB3, 16384
.set CB4, 16384
.set CB5, 16384
.set CB6, 16383
.set CB7, 16383
.set CB8, 16383
.set CB9, 16383
.set CB10, 16382
.set CB11, 16382
.set CB12, 16382
.set CB13, 16381
.set CB14, 16381
.set CB15, 16381
.set CB16, 16380
.set CB17, 16380
.set CB18, 16379
.set CB19, 16379
.set CB20, 16378
.set CB21, 16377
.set CB22, 16377
.set CB23, 16376
.set CB24, 16375
.set CB25, 16375
.set CB26, 16374
.set CB27, 16373
.set CB28, 16372
.set CB29, 16371
.set CB30, 16370
.set CB31, 16370
.set CB32, 16369
.set CB33, 16368
.set CB34, 16367
.set CB35, 16366
.set CB36, 16365
.set CB37, 16363
.set CB38, 16362
.set CB39, 16361
.set CB40, 16360
.set CB41, 16359
.set CB42, 16358
.set CB43, 16356
.set CB44, 16355
.set CB45, 16354
.set CB46, 16352
.set CB47, 16351
.set CB48, 16350
.set CB49, 16348
.set CB50, 16347
.set CB51, 16345
.set CB52, 16344
.set CB53, 16342
.set CB54, 16341
.set CB55, 16339
.set CB56, 16338
.set CB57, 16336
.set CB58, 16334
.set CB59, 16333
.set CB60, 16331
.set CB61, 16329
.set CB62, 16328
.set CB63, 16326
.set CB64, 16324
.set CB65, 16322
.set CB66, 16320
.set CB67, 16319
.set CB68, 16317
.set CB69, 16315
.set CB70, 16313
.set CB71, 16311
.set CB72, 16309
.set CB73, 16307
.set CB74, 16305
.set CB75, 16303
.set CB76, 16301
.set CB77, 16299
.set CB78, 16297
.set CB79, 16295
.set CB80, 16293
.set CB81, 16290
.set CB82, 16288
.set CB83, 16286
.set CB84, 16284
.set CB85, 16282
.set CB86, 16279
.set CB87, 16277
.set CB88, 16275
.set CB89, 16273
.set CB90, 16270
.set CB91, 16268
.set CB92, 16266
.set CB93, 16263
.set CB94, 16261
.set CB95, 16258
.set CB96, 16256
.set CB97, 16251
.set CB98, 16246
.set CB99, 16241
.set CB100, 16236
.set CB101, 16231
.set CB102, 16226
.set CB103, 16221
.set CB104, 16216
.set CB105, 16211
.set CB106, 16206
.set CB107, 16201
.set CB108, 16196
.set CB109, 16191
.set CB110, 16186
.set CB111, 16180
.set CB112, 16175
.set CB113, 16170
.set CB114, 16165
.set CB115, 16159
.set CB116, 16154
.set CB117, 16149
.set CB118, 16143
.set CB119, 16138
.set CB120, 16133
.set CB121, 16126
.set CB122, 16115
.set CB123, 16105
.set CB124, 16094
.set CB125, 16083
.set CB126, 16072
.set CB127, 16061
.set CB128, 16050
.set CB129, 16039
.set CB130, 16028
.set CB131, 16017
.set CB132, 16006
.set CB133, 15989
.set CB134, 15967
.set CB135, 15945
.set CB136, 15922
.set CB137, 15900
.set CB138, 15878
.set CB139, 15839
.set CB140, 15795
.set CB141, 15750
.set CB142, 15667
.set CB143, 15539
.set CB144, 0
.set CB145, 48307
.set CB146, 48435
.set CB147, 48518
.set CB148, 48563
.set CB149, 48607
.set CB150, 48646
.set CB151, 48668
.set CB152, 48690
.set CB153, 48713
.set CB154, 48735
.set CB155, 48757
.set CB156, 48774
.set CB157, 48785
.set CB158, 48796
.set CB159, 48807
.set CB160, 48818
.set CB161, 48829
.set CB162, 48840
.set CB163, 48851
.set CB164, 48862
.set CB165, 48873
.set CB166, 48883
.set CB167, 48894
.set CB168, 48901
.set CB169, 48906
.set CB170, 48911
.set CB171, 48917
.set CB172, 48922
.set CB173, 48927
.set CB174, 48933
.set CB175, 48938
.set CB176, 48943
.set CB177, 48948
.set CB178, 48954
.set CB179, 48959
.set CB180, 48964
.set CB181, 48969
.set CB182, 48974
.set CB183, 48979
.set CB184, 48984
.set CB185, 48989
.set CB186, 48994
.set CB187, 48999
.set CB188, 49004
.set CB189, 49009
.set CB190, 49014
.set CB191, 49019
.set CB192, 49024
.set CB193, 49026
.set CB194, 49029
.set CB195, 49031
.set CB196, 49034
.set CB197, 49036
.set CB198, 49038
.set CB199, 49041
.set CB200, 49043
.set CB201, 49045
.set CB202, 49047
.set CB203, 49050
.set CB204, 49052
.set CB205, 49054
.set CB206, 49056
.set CB207, 49058
.set CB208, 49061
.set CB209, 49063
.set CB210, 49065
.set CB211, 49067
.set CB212, 49069
.set CB213, 49071
.set CB214, 49073
.set CB215, 49075
.set CB216, 49077
.set CB217, 49079
.set CB218, 49081
.set CB219, 49083
.set CB220, 49085
.set CB221, 49087
.set CB222, 49088
.set CB223, 49090
.set CB224, 49092
.set CB225, 49094
.set CB226, 49096
.set CB227, 49097
.set CB228, 49099
.set CB229, 49101
.set CB230, 49102
.set CB231, 49104
.set CB232, 49106
.set CB233, 49107
.set CB234, 49109
.set CB235, 49110
.set CB236, 49112
.set CB237, 49113
.set CB238, 49115
.set CB239, 49116
.set CB240, 49118
.set CB241, 49119
.set CB242, 49120
.set CB243, 49122
.set CB244, 49123
.set CB245, 49124
.set CB246, 49126
.set CB247, 49127
.set CB248, 49128
.set CB249, 49129
.set CB250, 49130
.set CB251, 49131
.set CB252, 49133
.set CB253, 49134
.set CB254, 49135
.set CB255, 49136
.set CB256, 49137
.set CB257, 49138
.set CB258, 49138
.set CB259, 49139
.set CB260, 49140
.set CB261, 49141
.set CB262, 49142
.set CB263, 49143
.set CB264, 49143
.set CB265, 49144
.set CB266, 49145
.set CB267, 49145
.set CB268, 49146
.set CB269, 49147
.set CB270, 49147
.set CB271, 49148
.set CB272, 49148
.set CB273, 49149
.set CB274, 49149
.set CB275, 49149
.set CB276, 49150
.set CB277, 49150
.set CB278, 49150
.set CB279, 49151
.set CB280, 49151
.set CB281, 49151
.set CB282, 49151
.set CB283, 49152
.set CB284, 49152
.set CB285, 49152
.set CB286, 49152
.set CB287, 49152
.set CB288, 49152
.set CB289, 49152
.set CB290, 49152
.set CB291, 49152
.set CB292, 49152
.set CB293, 49152
.set CB294, 49151
.set CB295, 49151
.set CB296, 49151
.set CB297, 49151
.set CB298, 49150
.set CB299, 49150
.set CB300, 49150
.set CB301, 49149
.set CB302, 49149
.set CB303, 49149
.set CB304, 49148
.set CB305, 49148
.set CB306, 49147
.set CB307, 49147
.set CB308, 49146
.set CB309, 49145
.set CB310, 49145
.set CB311, 49144
.set CB312, 49143
.set CB313, 49143
.set CB314, 49142
.set CB315, 49141
.set CB316, 49140
.set CB317, 49139
.set CB318, 49138
.set CB319, 49138
.set CB320, 49137
.set CB321, 49136
.set CB322, 49135
.set CB323, 49134
.set CB324, 49133
.set CB325, 49131
.set CB326, 49130
.set CB327, 49129
.set CB328, 49128
.set CB329, 49127
.set CB330, 49126
.set CB331, 49124
.set CB332, 49123
.set CB333, 49122
.set CB334, 49120
.set CB335, 49119
.set CB336, 49118
.set CB337, 49116
.set CB338, 49115
.set CB339, 49113
.set CB340, 49112
.set CB341, 49110
.set CB342, 49109
.set CB343, 49107
.set CB344, 49106
.set CB345, 49104
.set CB346, 49102
.set CB347, 49101
.set CB348, 49099
.set CB349, 49097
.set CB350, 49096
.set CB351, 49094
.set CB352, 49092
.set CB353, 49090
.set CB354, 49088
.set CB355, 49087
.set CB356, 49085
.set CB357, 49083
.set CB358, 49081
.set CB359, 49079
.set CB360, 49077
.set CB361, 49075
.set CB362, 49073
.set CB363, 49071
.set CB364, 49069
.set CB365, 49067
.set CB366, 49065
.set CB367, 49063
.set CB368, 49061
.set CB369, 49058
.set CB370, 49056
.set CB371, 49054
.set CB372, 49052
.set CB373, 49050
.set CB374, 49047
.set CB375, 49045
.set CB376, 49043
.set CB377, 49041
.set CB378, 49038
.set CB379, 49036
.set CB380, 49034
.set CB381, 49031
.set CB382, 49029
.set CB383, 49026
.set CB384, 49024
.set CB385, 49019
.set CB386, 49014
.set CB387, 49009
.set CB388, 49004
.set CB389, 48999
.set CB390, 48994
.set CB391, 48989
.set CB392, 48984
.set CB393, 48979
.set CB394, 48974
.set CB395, 48969
.set CB396, 48964
.set CB397, 48959
.set CB398, 48954
.set CB399, 48948
.set CB400, 48943
.set CB401, 48938
.set CB402, 48933
.set CB403, 48927
.set CB404, 48922
.set CB405, 48917
.set CB406, 48911
.set CB407, 48906
.set CB408, 48901
.set CB409, 48894
.set CB410, 48883
.set CB411, 48873
.set CB412, 48862
.set CB413, 48851
.set CB414, 48840
.set CB415, 48829
.set CB416, 48818
.set CB417, 48807
.set CB418, 48796
.set CB419, 48785
.set CB420, 48774
.set CB421, 48757
.set CB422, 48735
.set CB423, 48713
.set CB424, 48690
.set CB425, 48668
.set CB426, 48646
.set CB427, 48607
.set CB428, 48563
.set CB429, 48518
.set CB430, 48435
.set CB431, 48307
.set CB432, 0
.set CB433, 15539
.set CB434, 15667
.set CB435, 15750
.set CB436, 15795
.set CB437, 15839
.set CB438, 15878
.set CB439, 15900
.set CB440, 15922
.set CB441, 15945
.set CB442, 15967
.set CB443, 15989
.set CB444, 16006
.set CB445, 16017
.set CB446, 16028
.set CB447, 16039
.set CB448, 16050
.set CB449, 16061
.set CB450, 16072
.set CB451, 16083
.set CB452, 16094
.set CB453, 16105
.set CB454, 16115
.set CB455, 16126
.set CB456, 16133
.set CB457, 16138
.set CB458, 16143
.set CB459, 16149
.set CB460, 16154
.set CB461, 16159
.set CB462, 16165
.set CB463, 16170
.set CB464, 16175
.set CB465, 16180
.set CB466, 16186
.set CB467, 16191
.set CB468, 16196
.set CB469, 16201
.set CB470, 16206
.set CB471, 16211
.set CB472, 16216
.set CB473, 16221
.set CB474, 16226
.set CB475, 16231
.set CB476, 16236
.set CB477, 16241
.set CB478, 16246
.set CB479, 16251
.set CB480, 16256
.set CB481, 16258
.set CB482, 16261
.set CB483, 16263
.set CB484, 16266
.set CB485, 16268
.set CB486, 16270
.set CB487, 16273
.set CB488, 16275
.set CB489, 16277
.set CB490, 16279
.set CB491, 16282
.set CB492, 16284
.set CB493, 16286
.set CB494, 16288
.set CB495, 16290
.set CB496, 16293
.set CB497, 16295
.set CB498, 16297
.set CB499, 16299
.set CB500, 16301
.set CB501, 16303
.set CB502, 16305
.set CB503, 16307
.set CB504, 16309
.set CB505, 16311
.set CB506, 16313
.set CB507, 16315
.set CB508, 16317
.set CB509, 16319
.set CB510, 16320
.set CB511, 16322
.set CB512, 16324
.set CB513, 16326
.set CB514, 16328
.set CB515, 16329
.set CB516, 16331
.set CB517, 16333
.set CB518, 16334
.set CB519, 16336
.set CB520, 16338
.set CB521, 16339
.set CB522, 16341
.set CB523, 16342
.set CB524, 16344
.set CB525, 16345
.set CB526, 16347
.set CB527, 16348
.set CB528, 16350
.set CB529, 16351
.set CB530, 16352
.set CB531, 16354
.set CB532, 16355
.set CB533, 16356
.set CB534, 16358
.set CB535, 16359
.set CB536, 16360
.set CB537, 16361
.set CB538, 16362
.set CB539, 16363
.set CB540, 16365
.set CB541, 16366
.set CB542, 16367
.set CB543, 16368
.set CB544, 16369
.set CB545, 16370
.set CB546, 16370
.set CB547, 16371
.set CB548, 16372
.set CB549, 16373
.set CB550, 16374
.set CB551, 16375
.set CB552, 16375
.set CB553, 16376
.set CB554, 16377
.set CB555, 16377
.set CB556, 16378
.set CB557, 16379
.set CB558, 16379
.set CB559, 16380
.set CB560, 16380
.set CB561, 16381
.set CB562, 16381
.set CB563, 16381
.set CB564, 16382
.set CB565, 16382
.set CB566, 16382
.set CB567, 16383
.set CB568, 16383
.set CB569, 16383
.set CB570, 16383
.set CB571, 16384
.set CB572, 16384
.set CB573, 16384
.set CB574, 16384
.set CB575, 16384
.set CF0, 1065353216
.set CF1, 1065353137
.set CF2, 1065352900
.set CF3, 1065352505
.set CF4, 1065351953
.set CF5, 1065351242
.set CF6, 1065350374
.set CF7, 1065349347
.set CF8, 1065348163
.set CF9, 1065346821
.set CF10, 1065345321
.set CF11, 1065343663
.set CF12, 1065341847
.set CF13, 1065339874
.set CF14, 1065337743
.set CF15, 1065335454
.set CF16, 1065333007
.set CF17, 1065330403
.set CF18, 1065327640
.set CF19, 1065324721
.set CF20, 1065321643
.set CF21, 1065318408
.set CF22, 1065315015
.set CF23, 1065311465
.set CF24, 1065307757
.set CF25, 1065303892
.set CF26, 1065299869
.set CF27, 1065295689
.set CF28, 1065291352
.set CF29, 1065286857
.set CF30, 1065282205
.set CF31, 1065277396
.set CF32, 1065272429
.set CF33, 1065267305
.set CF34, 1065262025
.set CF35, 1065256587
.set CF36, 1065250992
.set CF37, 1065245240
.set CF38, 1065239331
.set CF39, 1065233266
.set CF40, 1065227044
.set CF41, 1065220664
.set CF42, 1065214129
.set CF43, 1065207436
.set CF44, 1065200588
.set CF45, 1065193582
.set CF46, 1065186420
.set CF47, 1065179102
.set CF48, 1065171628
.set CF49, 1065163997
.set CF50, 1065156211
.set CF51, 1065148268
.set CF52, 1065140169
.set CF53, 1065131914
.set CF54, 1065123504
.set CF55, 1065114938
.set CF56, 1065106216
.set CF57, 1065097338
.set CF58, 1065088305
.set CF59, 1065079117
.set CF60, 1065069773
.set CF61, 1065060274
.set CF62, 1065050620
.set CF63, 1065040811
.set CF64, 1065030846
.set CF65, 1065020727
.set CF66, 1065010454
.set CF67, 1065000025
.set CF68, 1064989442
.set CF69, 1064978704
.set CF70, 1064967812
.set CF71, 1064956766
.set CF72, 1064945565
.set CF73, 1064934211
.set CF74, 1064922702
.set CF75, 1064911040
.set CF76, 1064899224
.set CF77, 1064887254
.set CF78, 1064875131
.set CF79, 1064862854
.set CF80, 1064850424
.set CF81, 1064837841
.set CF82, 1064825104
.set CF83, 1064812215
.set CF84, 1064799173
.set CF85, 1064785978
.set CF86, 1064772631
.set CF87, 1064759131
.set CF88, 1064745479
.set CF89, 1064731675
.set CF90, 1064717719
.set CF91, 1064703610
.set CF92, 1064689350
.set CF93, 1064674939
.set CF94, 1064660375
.set CF95, 1064645661
.set CF96, 1064630795
.set CF97, 1064615778
.set CF98, 1064600610
.set CF99, 1064585291
.set CF100, 1064569821
.set CF101, 1064554201
.set CF102, 1064538431
.set CF103, 1064522510
.set CF104, 1064506439
.set CF105, 1064490219
.set CF106, 1064473848
.set CF107, 1064457328
.set CF108, 1064440658
.set CF109, 1064423839
.set CF110, 1064406871
.set CF111, 1064389754
.set CF112, 1064372488
.set CF113, 1064355073
.set CF114, 1064337510
.set CF115, 1064319799
.set CF116, 1064301939
.set CF117, 1064283931
.set CF118, 1064265776
.set CF119, 1064247472
.set CF120, 1064229022
.set CF121, 1064210424
.set CF122, 1064191678
.set CF123, 1064172786
.set CF124, 1064153747
.set CF125, 1064134561
.set CF126, 1064115229
.set CF127, 1064095751
.set CF128, 1064076126
.set CF129, 1064056356
.set CF130, 1064036440
.set CF131, 1064016379
.set CF132, 1063996172
.set CF133, 1063975820
.set CF134, 1063955323
.set CF135, 1063934681
.set CF136, 1063913895
.set CF137, 1063892964
.set CF138, 1063871889
.set CF139, 1063850670
.set CF140, 1063829308
.set CF141, 1063807801
.set CF142, 1063786152
.set CF143, 1063764359
.set CF144, 1063742424
.set CF145, 1063720345
.set CF146, 1063698124
.set CF147, 1063675761
.set CF148, 1063653256
.set CF149, 1063630608
.set CF150, 1063607819
.set CF151, 1063584889
.set CF152, 1063561817
.set CF153, 1063538604
.set CF154, 1063515251
.set CF155, 1063491756
.set CF156, 1063468122
.set CF157, 1063444347
.set CF158, 1063420432
.set CF159, 1063396378
.set CF160, 1063372184
.set CF161, 1063347850
.set CF162, 1063323378
.set CF163, 1063298767
.set CF164, 1063274017
.set CF165, 1063249129
.set CF166, 1063224103
.set CF167, 1063198939
.set CF168, 1063173637
.set CF169, 1063148198
.set CF170, 1063122622
.set CF171, 1063096909
.set CF172, 1063071059
.set CF173, 1063045073
.set CF174, 1063018951
.set CF175, 1062992692
.set CF176, 1062966298
.set CF177, 1062939769
.set CF178, 1062913104
.set CF179, 1062886304
.set CF180, 1062859370
.set CF181, 1062832301
.set CF182, 1062805098
.set CF183, 1062777761
.set CF184, 1062750291
.set CF185, 1062722687
.set CF186, 1062694950
.set CF187, 1062667080
.set CF188, 1062639077
.set CF189, 1062610942
.set CF190, 1062582675
.set CF191, 1062554276
.set CF192, 1062525745
.set CF193, 1062497083
.set CF194, 1062468291
.set CF195, 1062439367
.set CF196, 1062410313
.set CF197, 1062381129
.set CF198, 1062351814
.set CF199, 1062322370
.set CF200, 1062292797
.set CF201, 1062263095
.set CF202, 1062233263
.set CF203, 1062203304
.set CF204, 1062173215
.set CF205, 1062142999
.set CF206, 1062112656
.set CF207, 1062082185
.set CF208, 1062051586
.set CF209, 1062020861
.set CF210, 1061990009
.set CF211, 1061959032
.set CF212, 1061927928
.set CF213, 1061896698
.set CF214, 1061865343
.set CF215, 1061833863
.set CF216, 1061802258
.set CF217, 1061770529
.set CF218, 1061738675
.set CF219, 1061706698
.set CF220, 1061674597
.set CF221, 1061642373
.set CF222, 1061610026
.set CF223, 1061577556
.set CF224, 1061544963
.set CF225, 1061512249
.set CF226, 1061479413
.set CF227, 1061446455
.set CF228, 1061413376
.set CF229, 1061380177
.set CF230, 1061346857
.set CF231, 1061313417
.set CF232, 1061279856
.set CF233, 1061246177
.set CF234, 1061212378
.set CF235, 1061178460
.set CF236, 1061144423
.set CF237, 1061110268
.set CF238, 1061075995
.set CF239, 1061041605
.set CF240, 1061007097
.set CF241, 1060972472
.set CF242, 1060937731
.set CF243, 1060902873
.set CF244, 1060867899
.set CF245, 1060832809
.set CF246, 1060797604
.set CF247, 1060762284
.set CF248, 1060726850
.set CF249, 1060691301
.set CF250, 1060655638
.set CF251, 1060619861
.set CF252, 1060583971
.set CF253, 1060547967
.set CF254, 1060511852
.set CF255, 1060475623
.set CF256, 1060439283
.set CF257, 1060402831
.set CF258, 1060366268
.set CF259, 1060329594
.set CF260, 1060292809
.set CF261, 1060255914
.set CF262, 1060218909
.set CF263, 1060181794
.set CF264, 1060144571
.set CF265, 1060107238
.set CF266, 1060069797
.set CF267, 1060032247
.set CF268, 1059994590
.set CF269, 1059956825
.set CF270, 1059918953
.set CF271, 1059880975
.set CF272, 1059842890
.set CF273, 1059804699
.set CF274, 1059766402
.set CF275, 1059728000
.set CF276, 1059689493
.set CF277, 1059650881
.set CF278, 1059612165
.set CF279, 1059573345
.set CF280, 1059534422
.set CF281, 1059495395
.set CF282, 1059456266
.set CF283, 1059417035
.set CF284, 1059377701
.set CF285, 1059338266
.set CF286, 1059298729
.set CF287, 1059259091
.set CF288, 1059219353
.set CF289, 1059179515
.set CF290, 1059139577
.set CF291, 1059099539
.set CF292, 1059059403
.set CF293, 1059019167
.set CF294, 1058978834
.set CF295, 1058938402
.set CF296, 1058897873
.set CF297, 1058857247
.set CF298, 1058816524
.set CF299, 1058775705
.set CF300, 1058734790
.set CF301, 1058693779
.set CF302, 1058652672
.set CF303, 1058611471
.set CF304, 1058570176
.set CF305, 1058528786
.set CF306, 1058487303
.set CF307, 1058445727
.set CF308, 1058404057
.set CF309, 1058362295
.set CF310, 1058320441
.set CF311, 1058278495
.set CF312, 1058236458
.set CF313, 1058194330
.set CF314, 1058152112
.set CF315, 1058109803
.set CF316, 1058067405
.set CF317, 1058024917
.set CF318, 1057982340
.set CF319, 1057939675
.set CF320, 1057896922
.set CF321, 1057854081
.set CF322, 1057811152
.set CF323, 1057768137
.set CF324, 1057725035
.set CF325, 1057681847
.set CF326, 1057638573
.set CF327, 1057595214
.set CF328, 1057551771
.set CF329, 1057508242
.set CF330, 1057464630
.set CF331, 1057420934
.set CF332, 1057377154
.set CF333, 1057333292
.set CF334, 1057289348
.set CF335, 1057245321
.set CF336, 1057201213
.set CF337, 1057157023
.set CF338, 1057112753
.set CF339, 1057068403
.set CF340, 1057023972
.set CF341, 1056979462
.set CF342, 1056905138
.set CF343, 1056815803
.set CF344, 1056726311
.set CF345, 1056636663
.set CF346, 1056546861
.set CF347, 1056456904
.set CF348, 1056366795
.set CF349, 1056276533
.set CF350, 1056186119
.set CF351, 1056095555
.set CF352, 1056004842
.set CF353, 1055913979
.set CF354, 1055822969
.set CF355, 1055731811
.set CF356, 1055640507
.set CF357, 1055549057
.set CF358, 1055457463
.set CF359, 1055365725
.set CF360, 1055273845
.set CF361, 1055181822
.set CF362, 1055089658
.set CF363, 1054997354
.set CF364, 1054904911
.set CF365, 1054812329
.set CF366, 1054719609
.set CF367, 1054626753
.set CF368, 1054533760
.set CF369, 1054440633
.set CF370, 1054347371
.set CF371, 1054253977
.set CF372, 1054160449
.set CF373, 1054066791
.set CF374, 1053973001
.set CF375, 1053879082
.set CF376, 1053785034
.set CF377, 1053690858
.set CF378, 1053596555
.set CF379, 1053502126
.set CF380, 1053407571
.set CF381, 1053312892
.set CF382, 1053218089
.set CF383, 1053123164
.set CF384, 1053028117
.set CF385, 1052932949
.set CF386, 1052837662
.set CF387, 1052742255
.set CF388, 1052646730
.set CF389, 1052551087
.set CF390, 1052455328
.set CF391, 1052359454
.set CF392, 1052263466
.set CF393, 1052167363
.set CF394, 1052071148
.set CF395, 1051974821
.set CF396, 1051878383
.set CF397, 1051781835
.set CF398, 1051685178
.set CF399, 1051588412
.set CF400, 1051491540
.set CF401, 1051394561
.set CF402, 1051297476
.set CF403, 1051200287
.set CF404, 1051102994
.set CF405, 1051005599
.set CF406, 1050908101
.set CF407, 1050810503
.set CF408, 1050712805
.set CF409, 1050615007
.set CF410, 1050517112
.set CF411, 1050419119
.set CF412, 1050321030
.set CF413, 1050222846
.set CF414, 1050124567
.set CF415, 1050026194
.set CF416, 1049927729
.set CF417, 1049829173
.set CF418, 1049730525
.set CF419, 1049631788
.set CF420, 1049532962
.set CF421, 1049434048
.set CF422, 1049335047
.set CF423, 1049235959
.set CF424, 1049136787
.set CF425, 1049037530
.set CF426, 1048938190
.set CF427, 1048838768
.set CF428, 1048739264
.set CF429, 1048639680
.set CF430, 1048504033
.set CF431, 1048304548
.set CF432, 1048104908
.set CF433, 1047905114
.set CF434, 1047705169
.set CF435, 1047505074
.set CF436, 1047304831
.set CF437, 1047104442
.set CF438, 1046903910
.set CF439, 1046703235
.set CF440, 1046502419
.set CF441, 1046301466
.set CF442, 1046100375
.set CF443, 1045899151
.set CF444, 1045697793
.set CF445, 1045496305
.set CF446, 1045294688
.set CF447, 1045092943
.set CF448, 1044891074
.set CF449, 1044689081
.set CF450, 1044486967
.set CF451, 1044284734
.set CF452, 1044082383
.set CF453, 1043879916
.set CF454, 1043677336
.set CF455, 1043474644
.set CF456, 1043271842
.set CF457, 1043068932
.set CF458, 1042865916
.set CF459, 1042662796
.set CF460, 1042459574
.set CF461, 1042256251
.set CF462, 1042052830
.set CF463, 1041849312
.set CF464, 1041645699
.set CF465, 1041441994
.set CF466, 1041238199
.set CF467, 1041034314
.set CF468, 1040830342
.set CF469, 1040626286
.set CF470, 1040422146
.set CF471, 1040217925
.set CF472, 1039839859
.set CF473, 1039431104
.set CF474, 1039022198
.set CF475, 1038613146
.set CF476, 1038203950
.set CF477, 1037794615
.set CF478, 1037385145
.set CF479, 1036975543
.set CF480, 1036565814
.set CF481, 1036155961
.set CF482, 1035745987
.set CF483, 1035335898
.set CF484, 1034925696
.set CF485, 1034515386
.set CF486, 1034104972
.set CF487, 1033694457
.set CF488, 1033283845
.set CF489, 1032873140
.set CF490, 1032462346
.set CF491, 1032051466
.set CF492, 1031482228
.set CF493, 1030660152
.set CF494, 1029837929
.set CF495, 1029015566
.set CF496, 1028193072
.set CF497, 1027370453
.set CF498, 1026547719
.set CF499, 1025724875
.set CF500, 1024901932
.set CF501, 1024078895
.set CF502, 1023101370
.set CF503, 1021454970
.set CF504, 1019808432
.set CF505, 1018161769
.set CF506, 1016514998
.set CF507, 1014714699
.set CF508, 1011420816
.set CF509, 1008126808
.set CF510, 1003032456
.set CF511, 994643910
.set CF512, 0
.set CF513, 3142127558
.set CF514, 3150516104
.set CF515, 3155610456
.set CF516, 3158904464
.set CF517, 3162198347
.set CF518, 3163998646
.set CF519, 3165645417
.set CF520, 3167292080
.set CF521, 3168938618
.set CF522, 3170585018
.set CF523, 3171562543
.set CF524, 3172385580
.set CF525, 3173208523
.set CF526, 3174031367
.set CF527, 3174854101
.set CF528, 3175676720
.set CF529, 3176499214
.set CF530, 3177321577
.set CF531, 3178143800
.set CF532, 3178965876
.set CF533, 3179535114
.set CF534, 3179945994
.set CF535, 3180356788
.set CF536, 3180767493
.set CF537, 3181178105
.set CF538, 3181588620
.set CF539, 3181999034
.set CF540, 3182409344
.set CF541, 3182819546
.set CF542, 3183229635
.set CF543, 3183639609
.set CF544, 3184049462
.set CF545, 3184459191
.set CF546, 3184868793
.set CF547, 3185278263
.set CF548, 3185687598
.set CF549, 3186096794
.set CF550, 3186505846
.set CF551, 3186914752
.set CF552, 3187323507
.set CF553, 3187701573
.set CF554, 3187905794
.set CF555, 3188109934
.set CF556, 3188313990
.set CF557, 3188517962
.set CF558, 3188721847
.set CF559, 3188925642
.set CF560, 3189129347
.set CF561, 3189332960
.set CF562, 3189536478
.set CF563, 3189739899
.set CF564, 3189943222
.set CF565, 3190146444
.set CF566, 3190349564
.set CF567, 3190552580
.set CF568, 3190755490
.set CF569, 3190958292
.set CF570, 3191160984
.set CF571, 3191363564
.set CF572, 3191566031
.set CF573, 3191768382
.set CF574, 3191970615
.set CF575, 3192172729
.set CF576, 3192374722
.set CF577, 3192576591
.set CF578, 3192778336
.set CF579, 3192979953
.set CF580, 3193181441
.set CF581, 3193382799
.set CF582, 3193584023
.set CF583, 3193785114
.set CF584, 3193986067
.set CF585, 3194186883
.set CF586, 3194387558
.set CF587, 3194588090
.set CF588, 3194788479
.set CF589, 3194988722
.set CF590, 3195188817
.set CF591, 3195388762
.set CF592, 3195588556
.set CF593, 3195788196
.set CF594, 3195987681
.set CF595, 3196123328
.set CF596, 3196222912
.set CF597, 3196322416
.set CF598, 3196421838
.set CF599, 3196521178
.set CF600, 3196620435
.set CF601, 3196719607
.set CF602, 3196818695
.set CF603, 3196917696
.set CF604, 3197016610
.set CF605, 3197115436
.set CF606, 3197214173
.set CF607, 3197312821
.set CF608, 3197411377
.set CF609, 3197509842
.set CF610, 3197608215
.set CF611, 3197706494
.set CF612, 3197804678
.set CF613, 3197902767
.set CF614, 3198000760
.set CF615, 3198098655
.set CF616, 3198196453
.set CF617, 3198294151
.set CF618, 3198391749
.set CF619, 3198489247
.set CF620, 3198586642
.set CF621, 3198683935
.set CF622, 3198781124
.set CF623, 3198878209
.set CF624, 3198975188
.set CF625, 3199072060
.set CF626, 3199168826
.set CF627, 3199265483
.set CF628, 3199362031
.set CF629, 3199458469
.set CF630, 3199554796
.set CF631, 3199651011
.set CF632, 3199747114
.set CF633, 3199843102
.set CF634, 3199938976
.set CF635, 3200034735
.set CF636, 3200130378
.set CF637, 3200225903
.set CF638, 3200321310
.set CF639, 3200416597
.set CF640, 3200511765
.set CF641, 3200606812
.set CF642, 3200701737
.set CF643, 3200796540
.set CF644, 3200891219
.set CF645, 3200985774
.set CF646, 3201080203
.set CF647, 3201174506
.set CF648, 3201268682
.set CF649, 3201362730
.set CF650, 3201456649
.set CF651, 3201550439
.set CF652, 3201644097
.set CF653, 3201737625
.set CF654, 3201831019
.set CF655, 3201924281
.set CF656, 3202017408
.set CF657, 3202110401
.set CF658, 3202203257
.set CF659, 3202295977
.set CF660, 3202388559
.set CF661, 3202481002
.set CF662, 3202573306
.set CF663, 3202665470
.set CF664, 3202757493
.set CF665, 3202849373
.set CF666, 3202941111
.set CF667, 3203032705
.set CF668, 3203124155
.set CF669, 3203215459
.set CF670, 3203306617
.set CF671, 3203397627
.set CF672, 3203488490
.set CF673, 3203579203
.set CF674, 3203669767
.set CF675, 3203760181
.set CF676, 3203850443
.set CF677, 3203940552
.set CF678, 3204030509
.set CF679, 3204120311
.set CF680, 3204209959
.set CF681, 3204299451
.set CF682, 3204388786
.set CF683, 3204463110
.set CF684, 3204507620
.set CF685, 3204552051
.set CF686, 3204596401
.set CF687, 3204640671
.set CF688, 3204684861
.set CF689, 3204728969
.set CF690, 3204772996
.set CF691, 3204816940
.set CF692, 3204860802
.set CF693, 3204904582
.set CF694, 3204948278
.set CF695, 3204991890
.set CF696, 3205035419
.set CF697, 3205078862
.set CF698, 3205122221
.set CF699, 3205165495
.set CF700, 3205208683
.set CF701, 3205251785
.set CF702, 3205294800
.set CF703, 3205337729
.set CF704, 3205380570
.set CF705, 3205423323
.set CF706, 3205465988
.set CF707, 3205508565
.set CF708, 3205551053
.set CF709, 3205593451
.set CF710, 3205635760
.set CF711, 3205677978
.set CF712, 3205720106
.set CF713, 3205762143
.set CF714, 3205804089
.set CF715, 3205845943
.set CF716, 3205887705
.set CF717, 3205929375
.set CF718, 3205970951
.set CF719, 3206012434
.set CF720, 3206053824
.set CF721, 3206095119
.set CF722, 3206136320
.set CF723, 3206177427
.set CF724, 3206218438
.set CF725, 3206259353
.set CF726, 3206300172
.set CF727, 3206340895
.set CF728, 3206381521
.set CF729, 3206422050
.set CF730, 3206462482
.set CF731, 3206502815
.set CF732, 3206543051
.set CF733, 3206583187
.set CF734, 3206623225
.set CF735, 3206663163
.set CF736, 3206703001
.set CF737, 3206742739
.set CF738, 3206782377
.set CF739, 3206821914
.set CF740, 3206861349
.set CF741, 3206900683
.set CF742, 3206939914
.set CF743, 3206979043
.set CF744, 3207018070
.set CF745, 3207056993
.set CF746, 3207095813
.set CF747, 3207134529
.set CF748, 3207173141
.set CF749, 3207211648
.set CF750, 3207250050
.set CF751, 3207288347
.set CF752, 3207326538
.set CF753, 3207364623
.set CF754, 3207402601
.set CF755, 3207440473
.set CF756, 3207478238
.set CF757, 3207515895
.set CF758, 3207553445
.set CF759, 3207590886
.set CF760, 3207628219
.set CF761, 3207665442
.set CF762, 3207702557
.set CF763, 3207739562
.set CF764, 3207776457
.set CF765, 3207813242
.set CF766, 3207849916
.set CF767, 3207886479
.set CF768, 3207922931
.set CF769, 3207959271
.set CF770, 3207995500
.set CF771, 3208031615
.set CF772, 3208067619
.set CF773, 3208103509
.set CF774, 3208139286
.set CF775, 3208174949
.set CF776, 3208210498
.set CF777, 3208245932
.set CF778, 3208281252
.set CF779, 3208316457
.set CF780, 3208351547
.set CF781, 3208386521
.set CF782, 3208421379
.set CF783, 3208456120
.set CF784, 3208490745
.set CF785, 3208525253
.set CF786, 3208559643
.set CF787, 3208593916
.set CF788, 3208628071
.set CF789, 3208662108
.set CF790, 3208696026
.set CF791, 3208729825
.set CF792, 3208763504
.set CF793, 3208797065
.set CF794, 3208830505
.set CF795, 3208863825
.set CF796, 3208897024
.set CF797, 3208930103
.set CF798, 3208963061
.set CF799, 3208995897
.set CF800, 3209028611
.set CF801, 3209061204
.set CF802, 3209093674
.set CF803, 3209126021
.set CF804, 3209158245
.set CF805, 3209190346
.set CF806, 3209222323
.set CF807, 3209254177
.set CF808, 3209285906
.set CF809, 3209317511
.set CF810, 3209348991
.set CF811, 3209380346
.set CF812, 3209411576
.set CF813, 3209442680
.set CF814, 3209473657
.set CF815, 3209504509
.set CF816, 3209535234
.set CF817, 3209565833
.set CF818, 3209596304
.set CF819, 3209626647
.set CF820, 3209656863
.set CF821, 3209686952
.set CF822, 3209716911
.set CF823, 3209746743
.set CF824, 3209776445
.set CF825, 3209806018
.set CF826, 3209835462
.set CF827, 3209864777
.set CF828, 3209893961
.set CF829, 3209923015
.set CF830, 3209951939
.set CF831, 3209980731
.set CF832, 3210009393
.set CF833, 3210037924
.set CF834, 3210066323
.set CF835, 3210094590
.set CF836, 3210122725
.set CF837, 3210150728
.set CF838, 3210178598
.set CF839, 3210206335
.set CF840, 3210233939
.set CF841, 3210261409
.set CF842, 3210288746
.set CF843, 3210315949
.set CF844, 3210343018
.set CF845, 3210369952
.set CF846, 3210396752
.set CF847, 3210423417
.set CF848, 3210449946
.set CF849, 3210476340
.set CF850, 3210502599
.set CF851, 3210528721
.set CF852, 3210554707
.set CF853, 3210580557
.set CF854, 3210606270
.set CF855, 3210631846
.set CF856, 3210657285
.set CF857, 3210682587
.set CF858, 3210707751
.set CF859, 3210732777
.set CF860, 3210757665
.set CF861, 3210782415
.set CF862, 3210807026
.set CF863, 3210831498
.set CF864, 3210855832
.set CF865, 3210880026
.set CF866, 3210904080
.set CF867, 3210927995
.set CF868, 3210951770
.set CF869, 3210975404
.set CF870, 3210998899
.set CF871, 3211022252
.set CF872, 3211045465
.set CF873, 3211068537
.set CF874, 3211091467
.set CF875, 3211114256
.set CF876, 3211136904
.set CF877, 3211159409
.set CF878, 3211181772
.set CF879, 3211203993
.set CF880, 3211226072
.set CF881, 3211248007
.set CF882, 3211269800
.set CF883, 3211291449
.set CF884, 3211312956
.set CF885, 3211334318
.set CF886, 3211355537
.set CF887, 3211376612
.set CF888, 3211397543
.set CF889, 3211418329
.set CF890, 3211438971
.set CF891, 3211459468
.set CF892, 3211479820
.set CF893, 3211500027
.set CF894, 3211520088
.set CF895, 3211540004
.set CF896, 3211559774
.set CF897, 3211579399
.set CF898, 3211598877
.set CF899, 3211618209
.set CF900, 3211637395
.set CF901, 3211656434
.set CF902, 3211675326
.set CF903, 3211694072
.set CF904, 3211712670
.set CF905, 3211731120
.set CF906, 3211749424
.set CF907, 3211767579
.set CF908, 3211785587
.set CF909, 3211803447
.set CF910, 3211821158
.set CF911, 3211838721
.set CF912, 3211856136
.set CF913, 3211873402
.set CF914, 3211890519
.set CF915, 3211907487
.set CF916, 3211924306
.set CF917, 3211940976
.set CF918, 3211957496
.set CF919, 3211973867
.set CF920, 3211990087
.set CF921, 3212006158
.set CF922, 3212022079
.set CF923, 3212037849
.set CF924, 3212053469
.set CF925, 3212068939
.set CF926, 3212084258
.set CF927, 3212099426
.set CF928, 3212114443
.set CF929, 3212129309
.set CF930, 3212144023
.set CF931, 3212158587
.set CF932, 3212172998
.set CF933, 3212187258
.set CF934, 3212201367
.set CF935, 3212215323
.set CF936, 3212229127
.set CF937, 3212242779
.set CF938, 3212256279
.set CF939, 3212269626
.set CF940, 3212282821
.set CF941, 3212295863
.set CF942, 3212308752
.set CF943, 3212321489
.set CF944, 3212334072
.set CF945, 3212346502
.set CF946, 3212358779
.set CF947, 3212370902
.set CF948, 3212382872
.set CF949, 3212394688
.set CF950, 3212406350
.set CF951, 3212417859
.set CF952, 3212429213
.set CF953, 3212440414
.set CF954, 3212451460
.set CF955, 3212462352
.set CF956, 3212473090
.set CF957, 3212483673
.set CF958, 3212494102
.set CF959, 3212504375
.set CF960, 3212514494
.set CF961, 3212524459
.set CF962, 3212534268
.set CF963, 3212543922
.set CF964, 3212553421
.set CF965, 3212562765
.set CF966, 3212571953
.set CF967, 3212580986
.set CF968, 3212589864
.set CF969, 3212598586
.set CF970, 3212607152
.set CF971, 3212615562
.set CF972, 3212623817
.set CF973, 3212631916
.set CF974, 3212639859
.set CF975, 3212647645
.set CF976, 3212655276
.set CF977, 3212662750
.set CF978, 3212670068
.set CF979, 3212677230
.set CF980, 3212684236
.set CF981, 3212691084
.set CF982, 3212697777
.set CF983, 3212704312
.set CF984, 3212710692
.set CF985, 3212716914
.set CF986, 3212722979
.set CF987, 3212728888
.set CF988, 3212734640
.set CF989, 3212740235
.set CF990, 3212745673
.set CF991, 3212750953
.set CF992, 3212756077
.set CF993, 3212761044
.set CF994, 3212765853
.set CF995, 3212770505
.set CF996, 3212775000
.set CF997, 3212779337
.set CF998, 3212783517
.set CF999, 3212787540
.set CF1000, 3212791405
.set CF1001, 3212795113
.set CF1002, 3212798663
.set CF1003, 3212802056
.set CF1004, 3212805291
.set CF1005, 3212808369
.set CF1006, 3212811288
.set CF1007, 3212814051
.set CF1008, 3212816655
.set CF1009, 3212819102
.set CF1010, 3212821391
.set CF1011, 3212823522
.set CF1012, 3212825495
.set CF1013, 3212827311
.set CF1014, 3212828969
.set CF1015, 3212830469
.set CF1016, 3212831811
.set CF1017, 3212832995
.set CF1018, 3212834022
.set CF1019, 3212834890
.set CF1020, 3212835601
.set CF1021, 3212836153
.set CF1022, 3212836548
.set CF1023, 3212836785
.set CF1024, 3212836864
.set CF1025, 3212836785
.set CF1026, 3212836548
.set CF1027, 3212836153
.set CF1028, 3212835601
.set CF1029, 3212834890
.set CF1030, 3212834022
.set CF1031, 3212832995
.set CF1032, 3212831811
.set CF1033, 3212830469
.set CF1034, 3212828969
.set CF1035, 3212827311
.set CF1036, 3212825495
.set CF1037, 3212823522
.set CF1038, 3212821391
.set CF1039, 3212819102
.set CF1040, 3212816655
.set CF1041, 3212814051
.set CF1042, 3212811288
.set CF1043, 3212808369
.set CF1044, 3212805291
.set CF1045, 3212802056
.set CF1046, 3212798663
.set CF1047, 3212795113
.set CF1048, 3212791405
.set CF1049, 3212787540
.set CF1050, 3212783517
.set CF1051, 3212779337
.set CF1052, 3212775000
.set CF1053, 3212770505
.set CF1054, 3212765853
.set CF1055, 3212761044
.set CF1056, 3212756077
.set CF1057, 3212750953
.set CF1058, 3212745673
.set CF1059, 3212740235
.set CF1060, 3212734640
.set CF1061, 3212728888
.set CF1062, 3212722979
.set CF1063, 3212716914
.set CF1064, 3212710692
.set CF1065, 3212704312
.set CF1066, 3212697777
.set CF1067, 3212691084
.set CF1068, 3212684236
.set CF1069, 3212677230
.set CF1070, 3212670068
.set CF1071, 3212662750
.set CF1072, 3212655276
.set CF1073, 3212647645
.set CF1074, 3212639859
.set CF1075, 3212631916
.set CF1076, 3212623817
.set CF1077, 3212615562
.set CF1078, 3212607152
.set CF1079, 3212598586
.set CF1080, 3212589864
.set CF1081, 3212580986
.set CF1082, 3212571953
.set CF1083, 3212562765
.set CF1084, 3212553421
.set CF1085, 3212543922
.set CF1086, 3212534268
.set CF1087, 3212524459
.set CF1088, 3212514494
.set CF1089, 3212504375
.set CF1090, 3212494102
.set CF1091, 3212483673
.set CF1092, 3212473090
.set CF1093, 3212462352
.set CF1094, 3212451460
.set CF1095, 3212440414
.set CF1096, 3212429213
.set CF1097, 3212417859
.set CF1098, 3212406350
.set CF1099, 3212394688
.set CF1100, 3212382872
.set CF1101, 3212370902
.set CF1102, 3212358779
.set CF1103, 3212346502
.set CF1104, 3212334072
.set CF1105, 3212321489
.set CF1106, 3212308752
.set CF1107, 3212295863
.set CF1108, 3212282821
.set CF1109, 3212269626
.set CF1110, 3212256279
.set CF1111, 3212242779
.set CF1112, 3212229127
.set CF1113, 3212215323
.set CF1114, 3212201367
.set CF1115, 3212187258
.set CF1116, 3212172998
.set CF1117, 3212158587
.set CF1118, 3212144023
.set CF1119, 3212129309
.set CF1120, 3212114443
.set CF1121, 3212099426
.set CF1122, 3212084258
.set CF1123, 3212068939
.set CF1124, 3212053469
.set CF1125, 3212037849
.set CF1126, 3212022079
.set CF1127, 3212006158
.set CF1128, 3211990087
.set CF1129, 3211973867
.set CF1130, 3211957496
.set CF1131, 3211940976
.set CF1132, 3211924306
.set CF1133, 3211907487
.set CF1134, 3211890519
.set CF1135, 3211873402
.set CF1136, 3211856136
.set CF1137, 3211838721
.set CF1138, 3211821158
.set CF1139, 3211803447
.set CF1140, 3211785587
.set CF1141, 3211767579
.set CF1142, 3211749424
.set CF1143, 3211731120
.set CF1144, 3211712670
.set CF1145, 3211694072
.set CF1146, 3211675326
.set CF1147, 3211656434
.set CF1148, 3211637395
.set CF1149, 3211618209
.set CF1150, 3211598877
.set CF1151, 3211579399
.set CF1152, 3211559774
.set CF1153, 3211540004
.set CF1154, 3211520088
.set CF1155, 3211500027
.set CF1156, 3211479820
.set CF1157, 3211459468
.set CF1158, 3211438971
.set CF1159, 3211418329
.set CF1160, 3211397543
.set CF1161, 3211376612
.set CF1162, 3211355537
.set CF1163, 3211334318
.set CF1164, 3211312956
.set CF1165, 3211291449
.set CF1166, 3211269800
.set CF1167, 3211248007
.set CF1168, 3211226072
.set CF1169, 3211203993
.set CF1170, 3211181772
.set CF1171, 3211159409
.set CF1172, 3211136904
.set CF1173, 3211114256
.set CF1174, 3211091467
.set CF1175, 3211068537
.set CF1176, 3211045465
.set CF1177, 3211022252
.set CF1178, 3210998899
.set CF1179, 3210975404
.set CF1180, 3210951770
.set CF1181, 3210927995
.set CF1182, 3210904080
.set CF1183, 3210880026
.set CF1184, 3210855832
.set CF1185, 3210831498
.set CF1186, 3210807026
.set CF1187, 3210782415
.set CF1188, 3210757665
.set CF1189, 3210732777
.set CF1190, 3210707751
.set CF1191, 3210682587
.set CF1192, 3210657285
.set CF1193, 3210631846
.set CF1194, 3210606270
.set CF1195, 3210580557
.set CF1196, 3210554707
.set CF1197, 3210528721
.set CF1198, 3210502599
.set CF1199, 3210476340
.set CF1200, 3210449946
.set CF1201, 3210423417
.set CF1202, 3210396752
.set CF1203, 3210369952
.set CF1204, 3210343018
.set CF1205, 3210315949
.set CF1206, 3210288746
.set CF1207, 3210261409
.set CF1208, 3210233939
.set CF1209, 3210206335
.set CF1210, 3210178598
.set CF1211, 3210150728
.set CF1212, 3210122725
.set CF1213, 3210094590
.set CF1214, 3210066323
.set CF1215, 3210037924
.set CF1216, 3210009393
.set CF1217, 3209980731
.set CF1218, 3209951939
.set CF1219, 3209923015
.set CF1220, 3209893961
.set CF1221, 3209864777
.set CF1222, 3209835462
.set CF1223, 3209806018
.set CF1224, 3209776445
.set CF1225, 3209746743
.set CF1226, 3209716911
.set CF1227, 3209686952
.set CF1228, 3209656863
.set CF1229, 3209626647
.set CF1230, 3209596304
.set CF1231, 3209565833
.set CF1232, 3209535234
.set CF1233, 3209504509
.set CF1234, 3209473657
.set CF1235, 3209442680
.set CF1236, 3209411576
.set CF1237, 3209380346
.set CF1238, 3209348991
.set CF1239, 3209317511
.set CF1240, 3209285906
.set CF1241, 3209254177
.set CF1242, 3209222323
.set CF1243, 3209190346
.set CF1244, 3209158245
.set CF1245, 3209126021
.set CF1246, 3209093674
.set CF1247, 3209061204
.set CF1248, 3209028611
.set CF1249, 3208995897
.set CF1250, 3208963061
.set CF1251, 3208930103
.set CF1252, 3208897024
.set CF1253, 3208863825
.set CF1254, 3208830505
.set CF1255, 3208797065
.set CF1256, 3208763504
.set CF1257, 3208729825
.set CF1258, 3208696026
.set CF1259, 3208662108
.set CF1260, 3208628071
.set CF1261, 3208593916
.set CF1262, 3208559643
.set CF1263, 3208525253
.set CF1264, 3208490745
.set CF1265, 3208456120
.set CF1266, 3208421379
.set CF1267, 3208386521
.set CF1268, 3208351547
.set CF1269, 3208316457
.set CF1270, 3208281252
.set CF1271, 3208245932
.set CF1272, 3208210498
.set CF1273, 3208174949
.set CF1274, 3208139286
.set CF1275, 3208103509
.set CF1276, 3208067619
.set CF1277, 3208031615
.set CF1278, 3207995500
.set CF1279, 3207959271
.set CF1280, 3207922931
.set CF1281, 3207886479
.set CF1282, 3207849916
.set CF1283, 3207813242
.set CF1284, 3207776457
.set CF1285, 3207739562
.set CF1286, 3207702557
.set CF1287, 3207665442
.set CF1288, 3207628219
.set CF1289, 3207590886
.set CF1290, 3207553445
.set CF1291, 3207515895
.set CF1292, 3207478238
.set CF1293, 3207440473
.set CF1294, 3207402601
.set CF1295, 3207364623
.set CF1296, 3207326538
.set CF1297, 3207288347
.set CF1298, 3207250050
.set CF1299, 3207211648
.set CF1300, 3207173141
.set CF1301, 3207134529
.set CF1302, 3207095813
.set CF1303, 3207056993
.set CF1304, 3207018070
.set CF1305, 3206979043
.set CF1306, 3206939914
.set CF1307, 3206900683
.set CF1308, 3206861349
.set CF1309, 3206821914
.set CF1310, 3206782377
.set CF1311, 3206742739
.set CF1312, 3206703001
.set CF1313, 3206663163
.set CF1314, 3206623225
.set CF1315, 3206583187
.set CF1316, 3206543051
.set CF1317, 3206502815
.set CF1318, 3206462482
.set CF1319, 3206422050
.set CF1320, 3206381521
.set CF1321, 3206340895
.set CF1322, 3206300172
.set CF1323, 3206259353
.set CF1324, 3206218438
.set CF1325, 3206177427
.set CF1326, 3206136320
.set CF1327, 3206095119
.set CF1328, 3206053824
.set CF1329, 3206012434
.set CF1330, 3205970951
.set CF1331, 3205929375
.set CF1332, 3205887705
.set CF1333, 3205845943
.set CF1334, 3205804089
.set CF1335, 3205762143
.set CF1336, 3205720106
.set CF1337, 3205677978
.set CF1338, 3205635760
.set CF1339, 3205593451
.set CF1340, 3205551053
.set CF1341, 3205508565
.set CF1342, 3205465988
.set CF1343, 3205423323
.set CF1344, 3205380570
.set CF1345, 3205337729
.set CF1346, 3205294800
.set CF1347, 3205251785
.set CF1348, 3205208683
.set CF1349, 3205165495
.set CF1350, 3205122221
.set CF1351, 3205078862
.set CF1352, 3205035419
.set CF1353, 3204991890
.set CF1354, 3204948278
.set CF1355, 3204904582
.set CF1356, 3204860802
.set CF1357, 3204816940
.set CF1358, 3204772996
.set CF1359, 3204728969
.set CF1360, 3204684861
.set CF1361, 3204640671
.set CF1362, 3204596401
.set CF1363, 3204552051
.set CF1364, 3204507620
.set CF1365, 3204463110
.set CF1366, 3204388786
.set CF1367, 3204299451
.set CF1368, 3204209959
.set CF1369, 3204120311
.set CF1370, 3204030509
.set CF1371, 3203940552
.set CF1372, 3203850443
.set CF1373, 3203760181
.set CF1374, 3203669767
.set CF1375, 3203579203
.set CF1376, 3203488490
.set CF1377, 3203397627
.set CF1378, 3203306617
.set CF1379, 3203215459
.set CF1380, 3203124155
.set CF1381, 3203032705
.set CF1382, 3202941111
.set CF1383, 3202849373
.set CF1384, 3202757493
.set CF1385, 3202665470
.set CF1386, 3202573306
.set CF1387, 3202481002
.set CF1388, 3202388559
.set CF1389, 3202295977
.set CF1390, 3202203257
.set CF1391, 3202110401
.set CF1392, 3202017408
.set CF1393, 3201924281
.set CF1394, 3201831019
.set CF1395, 3201737625
.set CF1396, 3201644097
.set CF1397, 3201550439
.set CF1398, 3201456649
.set CF1399, 3201362730
.set CF1400, 3201268682
.set CF1401, 3201174506
.set CF1402, 3201080203
.set CF1403, 3200985774
.set CF1404, 3200891219
.set CF1405, 3200796540
.set CF1406, 3200701737
.set CF1407, 3200606812
.set CF1408, 3200511765
.set CF1409, 3200416597
.set CF1410, 3200321310
.set CF1411, 3200225903
.set CF1412, 3200130378
.set CF1413, 3200034735
.set CF1414, 3199938976
.set CF1415, 3199843102
.set CF1416, 3199747114
.set CF1417, 3199651011
.set CF1418, 3199554796
.set CF1419, 3199458469
.set CF1420, 3199362031
.set CF1421, 3199265483
.set CF1422, 3199168826
.set CF1423, 3199072060
.set CF1424, 3198975188
.set CF1425, 3198878209
.set CF1426, 3198781124
.set CF1427, 3198683935
.set CF1428, 3198586642
.set CF1429, 3198489247
.set CF1430, 3198391749
.set CF1431, 3198294151
.set CF1432, 3198196453
.set CF1433, 3198098655
.set CF1434, 3198000760
.set CF1435, 3197902767
.set CF1436, 3197804678
.set CF1437, 3197706494
.set CF1438, 3197608215
.set CF1439, 3197509842
.set CF1440, 3197411377
.set CF1441, 3197312821
.set CF1442, 3197214173
.set CF1443, 3197115436
.set CF1444, 3197016610
.set CF1445, 3196917696
.set CF1446, 3196818695
.set CF1447, 3196719607
.set CF1448, 3196620435
.set CF1449, 3196521178
.set CF1450, 3196421838
.set CF1451, 3196322416
.set CF1452, 3196222912
.set CF1453, 3196123328
.set CF1454, 3195987681
.set CF1455, 3195788196
.set CF1456, 3195588556
.set CF1457, 3195388762
.set CF1458, 3195188817
.set CF1459, 3194988722
.set CF1460, 3194788479
.set CF1461, 3194588090
.set CF1462, 3194387558
.set CF1463, 3194186883
.set CF1464, 3193986067
.set CF1465, 3193785114
.set CF1466, 3193584023
.set CF1467, 3193382799
.set CF1468, 3193181441
.set CF1469, 3192979953
.set CF1470, 3192778336
.set CF1471, 3192576591
.set CF1472, 3192374722
.set CF1473, 3192172729
.set CF1474, 3191970615
.set CF1475, 3191768382
.set CF1476, 3191566031
.set CF1477, 3191363564
.set CF1478, 3191160984
.set CF1479, 3190958292
.set CF1480, 3190755490
.set CF1481, 3190552580
.set CF1482, 3190349564
.set CF1483, 3190146444
.set CF1484, 3189943222
.set CF1485, 3189739899
.set CF1486, 3189536478
.set CF1487, 3189332960
.set CF1488, 3189129347
.set CF1489, 3188925642
.set CF1490, 3188721847
.set CF1491, 3188517962
.set CF1492, 3188313990
.set CF1493, 3188109934
.set CF1494, 3187905794
.set CF1495, 3187701573
.set CF1496, 3187323507
.set CF1497, 3186914752
.set CF1498, 3186505846
.set CF1499, 3186096794
.set CF1500, 3185687598
.set CF1501, 3185278263
.set CF1502, 3184868793
.set CF1503, 3184459191
.set CF1504, 3184049462
.set CF1505, 3183639609
.set CF1506, 3183229635
.set CF1507, 3182819546
.set CF1508, 3182409344
.set CF1509, 3181999034
.set CF1510, 3181588620
.set CF1511, 3181178105
.set CF1512, 3180767493
.set CF1513, 3180356788
.set CF1514, 3179945994
.set CF1515, 3179535114
.set CF1516, 3178965876
.set CF1517, 3178143800
.set CF1518, 3177321577
.set CF1519, 3176499214
.set CF1520, 3175676720
.set CF1521, 3174854101
.set CF1522, 3174031367
.set CF1523, 3173208523
.set CF1524, 3172385580
.set CF1525, 3171562543
.set CF1526, 3170585018
.set CF1527, 3168938618
.set CF1528, 3167292080
.set CF1529, 3165645417
.set CF1530, 3163998646
.set CF1531, 3162198347
.set CF1532, 3158904464
.set CF1533, 3155610456
.set CF1534, 3150516104
.set CF1535, 3142127558
.set CF1536, 0
.set CF1537, 994643910
.set CF1538, 1003032456
.set CF1539, 1008126808
.set CF1540, 1011420816
.set CF1541, 1014714699
.set CF1542, 1016514998
.set CF1543, 1018161769
.set CF1544, 1019808432
.set CF1545, 1021454970
.set CF1546, 1023101370
.set CF1547, 1024078895
.set CF1548, 1024901932
.set CF1549, 1025724875
.set CF1550, 1026547719
.set CF1551, 1027370453
.set CF1552, 1028193072
.set CF1553, 1029015566
.set CF1554, 1029837929
.set CF1555, 1030660152
.set CF1556, 1031482228
.set CF1557, 1032051466
.set CF1558, 1032462346
.set CF1559, 1032873140
.set CF1560, 1033283845
.set CF1561, 1033694457
.set CF1562, 1034104972
.set CF1563, 1034515386
.set CF1564, 1034925696
.set CF1565, 1035335898
.set CF1566, 1035745987
.set CF1567, 1036155961
.set CF1568, 1036565814
.set CF1569, 1036975543
.set CF1570, 1037385145
.set CF1571, 1037794615
.set CF1572, 1038203950
.set CF1573, 1038613146
.set CF1574, 1039022198
.set CF1575, 1039431104
.set CF1576, 1039839859
.set CF1577, 1040217925
.set CF1578, 1040422146
.set CF1579, 1040626286
.set CF1580, 1040830342
.set CF1581, 1041034314
.set CF1582, 1041238199
.set CF1583, 1041441994
.set CF1584, 1041645699
.set CF1585, 1041849312
.set CF1586, 1042052830
.set CF1587, 1042256251
.set CF1588, 1042459574
.set CF1589, 1042662796
.set CF1590, 1042865916
.set CF1591, 1043068932
.set CF1592, 1043271842
.set CF1593, 1043474644
.set CF1594, 1043677336
.set CF1595, 1043879916
.set CF1596, 1044082383
.set CF1597, 1044284734
.set CF1598, 1044486967
.set CF1599, 1044689081
.set CF1600, 1044891074
.set CF1601, 1045092943
.set CF1602, 1045294688
.set CF1603, 1045496305
.set CF1604, 1045697793
.set CF1605, 1045899151
.set CF1606, 1046100375
.set CF1607, 1046301466
.set CF1608, 1046502419
.set CF1609, 1046703235
.set CF1610, 1046903910
.set CF1611, 1047104442
.set CF1612, 1047304831
.set CF1613, 1047505074
.set CF1614, 1047705169
.set CF1615, 1047905114
.set CF1616, 1048104908
.set CF1617, 1048304548
.set CF1618, 1048504033
.set CF1619, 1048639680
.set CF1620, 1048739264
.set CF1621, 1048838768
.set CF1622, 1048938190
.set CF1623, 1049037530
.set CF1624, 1049136787
.set CF1625, 1049235959
.set CF1626, 1049335047
.set CF1627, 1049434048
.set CF1628, 1049532962
.set CF1629, 1049631788
.set CF1630, 1049730525
.set CF1631, 1049829173
.set CF1632, 1049927729
.set CF1633, 1050026194
.set CF1634, 1050124567
.set CF1635, 1050222846
.set CF1636, 1050321030
.set CF1637, 1050419119
.set CF1638, 1050517112
.set CF1639, 1050615007
.set CF1640, 1050712805
.set CF1641, 1050810503
.set CF1642, 1050908101
.set CF1643, 1051005599
.set CF1644, 1051102994
.set CF1645, 1051200287
.set CF1646, 1051297476
.set CF1647, 1051394561
.set CF1648, 1051491540
.set CF1649, 1051588412
.set CF1650, 1051685178
.set CF1651, 1051781835
.set CF1652, 1051878383
.set CF1653, 1051974821
.set CF1654, 1052071148
.set CF1655, 1052167363
.set CF1656, 1052263466
.set CF1657, 1052359454
.set CF1658, 1052455328
.set CF1659, 1052551087
.set CF1660, 1052646730
.set CF1661, 1052742255
.set CF1662, 1052837662
.set CF1663, 1052932949
.set CF1664, 1053028117
.set CF1665, 1053123164
.set CF1666, 1053218089
.set CF1667, 1053312892
.set CF1668, 1053407571
.set CF1669, 1053502126
.set CF1670, 1053596555
.set CF1671, 1053690858
.set CF1672, 1053785034
.set CF1673, 1053879082
.set CF1674, 1053973001
.set CF1675, 1054066791
.set CF1676, 1054160449
.set CF1677, 1054253977
.set CF1678, 1054347371
.set CF1679, 1054440633
.set CF1680, 1054533760
.set CF1681, 1054626753
.set CF1682, 1054719609
.set CF1683, 1054812329
.set CF1684, 1054904911
.set CF1685, 1054997354
.set CF1686, 1055089658
.set CF1687, 1055181822
.set CF1688, 1055273845
.set CF1689, 1055365725
.set CF1690, 1055457463
.set CF1691, 1055549057
.set CF1692, 1055640507
.set CF1693, 1055731811
.set CF1694, 1055822969
.set CF1695, 1055913979
.set CF1696, 1056004842
.set CF1697, 1056095555
.set CF1698, 1056186119
.set CF1699, 1056276533
.set CF1700, 1056366795
.set CF1701, 1056456904
.set CF1702, 1056546861
.set CF1703, 1056636663
.set CF1704, 1056726311
.set CF1705, 1056815803
.set CF1706, 1056905138
.set CF1707, 1056979462
.set CF1708, 1057023972
.set CF1709, 1057068403
.set CF1710, 1057112753
.set CF1711, 1057157023
.set CF1712, 1057201213
.set CF1713, 1057245321
.set CF1714, 1057289348
.set CF1715, 1057333292
.set CF1716, 1057377154
.set CF1717, 1057420934
.set CF1718, 1057464630
.set CF1719, 1057508242
.set CF1720, 1057551771
.set CF1721, 1057595214
.set CF1722, 1057638573
.set CF1723, 1057681847
.set CF1724, 1057725035
.set CF1725, 1057768137
.set CF1726, 1057811152
.set CF1727, 1057854081
.set CF1728, 1057896922
.set CF1729, 1057939675
.set CF1730, 1057982340
.set CF1731, 1058024917
.set CF1732, 1058067405
.set CF1733, 1058109803
.set CF1734, 1058152112
.set CF1735, 1058194330
.set CF1736, 1058236458
.set CF1737, 1058278495
.set CF1738, 1058320441
.set CF1739, 1058362295
.set CF1740, 1058404057
.set CF1741, 1058445727
.set CF1742, 1058487303
.set CF1743, 1058528786
.set CF1744, 1058570176
.set CF1745, 1058611471
.set CF1746, 1058652672
.set CF1747, 1058693779
.set CF1748, 1058734790
.set CF1749, 1058775705
.set CF1750, 1058816524
.set CF1751, 1058857247
.set CF1752, 1058897873
.set CF1753, 1058938402
.set CF1754, 1058978834
.set CF1755, 1059019167
.set CF1756, 1059059403
.set CF1757, 1059099539
.set CF1758, 1059139577
.set CF1759, 1059179515
.set CF1760, 1059219353
.set CF1761, 1059259091
.set CF1762, 1059298729
.set CF1763, 1059338266
.set CF1764, 1059377701
.set CF1765, 1059417035
.set CF1766, 1059456266
.set CF1767, 1059495395
.set CF1768, 1059534422
.set CF1769, 1059573345
.set CF1770, 1059612165
.set CF1771, 1059650881
.set CF1772, 1059689493
.set CF1773, 1059728000
.set CF1774, 1059766402
.set CF1775, 1059804699
.set CF1776, 1059842890
.set CF1777, 1059880975
.set CF1778, 1059918953
.set CF1779, 1059956825
.set CF1780, 1059994590
.set CF1781, 1060032247
.set CF1782, 1060069797
.set CF1783, 1060107238
.set CF1784, 1060144571
.set CF1785, 1060181794
.set CF1786, 1060218909
.set CF1787, 1060255914
.set CF1788, 1060292809
.set CF1789, 1060329594
.set CF1790, 1060366268
.set CF1791, 1060402831
.set CF1792, 1060439283
.set CF1793, 1060475623
.set CF1794, 1060511852
.set CF1795, 1060547967
.set CF1796, 1060583971
.set CF1797, 1060619861
.set CF1798, 1060655638
.set CF1799, 1060691301
.set CF1800, 1060726850
.set CF1801, 1060762284
.set CF1802, 1060797604
.set CF1803, 1060832809
.set CF1804, 1060867899
.set CF1805, 1060902873
.set CF1806, 1060937731
.set CF1807, 1060972472
.set CF1808, 1061007097
.set CF1809, 1061041605
.set CF1810, 1061075995
.set CF1811, 1061110268
.set CF1812, 1061144423
.set CF1813, 1061178460
.set CF1814, 1061212378
.set CF1815, 1061246177
.set CF1816, 1061279856
.set CF1817, 1061313417
.set CF1818, 1061346857
.set CF1819, 1061380177
.set CF1820, 1061413376
.set CF1821, 1061446455
.set CF1822, 1061479413
.set CF1823, 1061512249
.set CF1824, 1061544963
.set CF1825, 1061577556
.set CF1826, 1061610026
.set CF1827, 1061642373
.set CF1828, 1061674597
.set CF1829, 1061706698
.set CF1830, 1061738675
.set CF1831, 1061770529
.set CF1832, 1061802258
.set CF1833, 1061833863
.set CF1834, 1061865343
.set CF1835, 1061896698
.set CF1836, 1061927928
.set CF1837, 1061959032
.set CF1838, 1061990009
.set CF1839, 1062020861
.set CF1840, 1062051586
.set CF1841, 1062082185
.set CF1842, 1062112656
.set CF1843, 1062142999
.set CF1844, 1062173215
.set CF1845, 1062203304
.set CF1846, 1062233263
.set CF1847, 1062263095
.set CF1848, 1062292797
.set CF1849, 1062322370
.set CF1850, 1062351814
.set CF1851, 1062381129
.set CF1852, 1062410313
.set CF1853, 1062439367
.set CF1854, 1062468291
.set CF1855, 1062497083
.set CF1856, 1062525745
.set CF1857, 1062554276
.set CF1858, 1062582675
.set CF1859, 1062610942
.set CF1860, 1062639077
.set CF1861, 1062667080
.set CF1862, 1062694950
.set CF1863, 1062722687
.set CF1864, 1062750291
.set CF1865, 1062777761
.set CF1866, 1062805098
.set CF1867, 1062832301
.set CF1868, 1062859370
.set CF1869, 1062886304
.set CF1870, 1062913104
.set CF1871, 1062939769
.set CF1872, 1062966298
.set CF1873, 1062992692
.set CF1874, 1063018951
.set CF1875, 1063045073
.set CF1876, 1063071059
.set CF1877, 1063096909
.set CF1878, 1063122622
.set CF1879, 1063148198
.set CF1880, 1063173637
.set CF1881, 1063198939
.set CF1882, 1063224103
.set CF1883, 1063249129
.set CF1884, 1063274017
.set CF1885, 1063298767
.set CF1886, 1063323378
.set CF1887, 1063347850
.set CF1888, 1063372184
.set CF1889, 1063396378
.set CF1890, 1063420432
.set CF1891, 1063444347
.set CF1892, 1063468122
.set CF1893, 1063491756
.set CF1894, 1063515251
.set CF1895, 1063538604
.set CF1896, 1063561817
.set CF1897, 1063584889
.set CF1898, 1063607819
.set CF1899, 1063630608
.set CF1900, 1063653256
.set CF1901, 1063675761
.set CF1902, 1063698124
.set CF1903, 1063720345
.set CF1904, 1063742424
.set CF1905, 1063764359
.set CF1906, 1063786152
.set CF1907, 1063807801
.set CF1908, 1063829308
.set CF1909, 1063850670
.set CF1910, 1063871889
.set CF1911, 1063892964
.set CF1912, 1063913895
.set CF1913, 1063934681
.set CF1914, 1063955323
.set CF1915, 1063975820
.set CF1916, 1063996172
.set CF1917, 1064016379
.set CF1918, 1064036440
.set CF1919, 1064056356
.set CF1920, 1064076126
.set CF1921, 1064095751
.set CF1922, 1064115229
.set CF1923, 1064134561
.set CF1924, 1064153747
.set CF1925, 1064172786
.set CF1926, 1064191678
.set CF1927, 1064210424
.set CF1928, 1064229022
.set CF1929, 1064247472
.set CF1930, 1064265776
.set CF1931, 1064283931
.set CF1932, 1064301939
.set CF1933, 1064319799
.set CF1934, 1064337510
.set CF1935, 1064355073
.set CF1936, 1064372488
.set CF1937, 1064389754
.set CF1938, 1064406871
.set CF1939, 1064423839
.set CF1940, 1064440658
.set CF1941, 1064457328
.set CF1942, 1064473848
.set CF1943, 1064490219
.set CF1944, 1064506439
.set CF1945, 1064522510
.set CF1946, 1064538431
.set CF1947, 1064554201
.set CF1948, 1064569821
.set CF1949, 1064585291
.set CF1950, 1064600610
.set CF1951, 1064615778
.set CF1952, 1064630795
.set CF1953, 1064645661
.set CF1954, 1064660375
.set CF1955, 1064674939
.set CF1956, 1064689350
.set CF1957, 1064703610
.set CF1958, 1064717719
.set CF1959, 1064731675
.set CF1960, 1064745479
.set CF1961, 1064759131
.set CF1962, 1064772631
.set CF1963, 1064785978
.set CF1964, 1064799173
.set CF1965, 1064812215
.set CF1966, 1064825104
.set CF1967, 1064837841
.set CF1968, 1064850424
.set CF1969, 1064862854
.set CF1970, 1064875131
.set CF1971, 1064887254
.set CF1972, 1064899224
.set CF1973, 1064911040
.set CF1974, 1064922702
.set CF1975, 1064934211
.set CF1976, 1064945565
.set CF1977, 1064956766
.set CF1978, 1064967812
.set CF1979, 1064978704
.set CF1980, 1064989442
.set CF1981, 1065000025
.set CF1982, 1065010454
.set CF1983, 1065020727
.set CF1984, 1065030846
.set CF1985, 1065040811
.set CF1986, 1065050620
.set CF1987, 1065060274
.set CF1988, 1065069773
.set CF1989, 1065079117
.set CF1990, 1065088305
.set CF1991, 1065097338
.set CF1992, 1065106216
.set CF1993, 1065114938
.set CF1994, 1065123504
.set CF1995, 1065131914
.set CF1996, 1065140169
.set CF1997, 1065148268
.set CF1998, 1065156211
.set CF1999, 1065163997
.set CF2000, 1065171628
.set CF2001, 1065179102
.set CF2002, 1065186420
.set CF2003, 1065193582
.set CF2004, 1065200588
.set CF2005, 1065207436
.set CF2006, 1065214129
.set CF2007, 1065220664
.set CF2008, 1065227044
.set CF2009, 1065233266
.set CF2010, 1065239331
.set CF2011, 1065245240
.set CF2012, 1065250992
.set CF2013, 1065256587
.set CF2014, 1065262025
.set CF2015, 1065267305
.set CF2016, 1065272429
.set CF2017, 1065277396
.set CF2018, 1065282205
.set CF2019, 1065286857
.set CF2020, 1065291352
.set CF2021, 1065295689
.set CF2022, 1065299869
.set CF2023, 1065303892
.set CF2024, 1065307757
.set CF2025, 1065311465
.set CF2026, 1065315015
.set CF2027, 1065318408
.set CF2028, 1065321643
.set CF2029, 1065324721
.set CF2030, 1065327640
.set CF2031, 1065330403
.set CF2032, 1065333007
.set CF2033, 1065335454
.set CF2034, 1065337743
.set CF2035, 1065339874
.set CF2036, 1065341847
.set CF2037, 1065343663
.set CF2038, 1065345321
.set CF2039, 1065346821
.set CF2040, 1065348163
.set CF2041, 1065349347
.set CF2042, 1065350374
.set CF2043, 1065351242
.set CF2044, 1065351953
.set CF2045, 1065352505
.set CF2046, 1065352900
.set CF2047, 1065353137
.set CD0, 16256
.set CD1, 16255
.set CD2, 16251
.set CD3, 16245
.set CD4, 16237
.set CD5, 16226
.set CD6, 16213
.set CD7, 16198
.set CD8, 16181
.set CD9, 16162
.set CD10, 16142
.set CD11, 16113
.set CD12, 16068
.set CD13, 16021
.set CD14, 15944
.set CD15, 15817
.set CD16, 0
.set CD17, 48585
.set CD18, 48712
.set CD19, 48789
.set CD20, 48836
.set CD21, 48881
.set CD22, 48910
.set CD23, 48930
.set CD24, 48949
.set CD25, 48966
.set CD26, 48981
.set CD27, 48994
.set CD28, 49005
.set CD29, 49013
.set CD30, 49019
.set CD31, 49023
.set CD32, 49024
.set CD33, 49023
.set CD34, 49019
.set CD35, 49013
.set CD36, 49005
.set CD37, 48994
.set CD38, 48981
.set CD39, 48966
.set CD40, 48949
.set CD41, 48930
.set CD42, 48910
.set CD43, 48881
.set CD44, 48836
.set CD45, 48789
.set CD46, 48712
.set CD47, 48585
.set CD48, 0
.set CD49, 15817
.set CD50, 15944
.set CD51, 16021
.set CD52, 16068
.set CD53, 16113
.set CD54, 16142
.set CD55, 16162
.set CD56, 16181
.set CD57, 16198
.set CD58, 16213
.set CD59, 16226
.set CD60, 16237
.set CD61, 16245
.set CD62, 16251
.set CD63, 16255
.altmacro
.macro pa a, b
.long CA\a | (CA\b << 16)
.endm
.macro pb a, b
.long CB\a | (CB\b << 16)
.endm
.macro pd a, b
.long CD\a | (CD\b << 16)
.endm
.macro pf a
.long CF\a
.endm
.macro fflane dd, kk, ph
pa %(((\dd)*(\kk)+(\ph))%576), %(((\dd+1)*(\kk)+(\ph))%576)
pa %(((\dd+2)*(\kk)+(\ph))%576), %(((\dd+3)*(\kk)+(\ph))%576)
pa %(((\dd+4)*(\kk)+(\ph))%576), %(((\dd+5)*(\kk)+(\ph))%576)
pa %(((\dd+6)*(\kk)+(\ph))%576), %(((\dd+7)*(\kk)+(\ph))%576)
.endm
.macro filane kb, nn
.if \kb == 0
.long CA0
.else
pb %(((\kb)*(\nn))%576), %(((\kb)*(\nn)+144)%576)
.endif
pb %(((\kb+1)*(\nn))%576), %(((\kb+1)*(\nn)+144)%576)
pb %(((\kb+2)*(\nn))%576), %(((\kb+2)*(\nn)+144)%576)
pb %(((\kb+3)*(\nn))%576), %(((\kb+3)*(\nn)+144)%576)
.endm
.macro sdlane a0, mu, bb, sc, ph
pd %((((\a0)*(\bb))*(\sc)+(\ph))%64), %((((\a0+1)*(\bb))*(\sc)+(\ph))%64)
pd %((((\a0+2)*(\bb))*(\sc)+(\ph))%64), %((((\a0+3)*(\bb))*(\sc)+(\ph))%64)
pd %((((\a0+\mu)*(\bb))*(\sc)+(\ph))%64), %((((\a0+\mu+1)*(\bb))*(\sc)+(\ph))%64)
pd %((((\a0+\mu+2)*(\bb))*(\sc)+(\ph))%64), %((((\a0+\mu+3)*(\bb))*(\sc)+(\ph))%64)
.endm
.macro twlane a0, bb, ph
pf %(((\a0)*(\bb)+(\ph))%2048)
pf %(((\a0+1)*(\bb)+(\ph))%2048)
pf %(((\a0+2)*(\bb)+(\ph))%2048)
pf %(((\a0+3)*(\bb)+(\ph))%2048)
.endm
.p2align 8
tab_ff:
.set t_ct, 0
.rept 36
.set t_tt, 0
.rept 18
.set t_ll, 0
.rept 64
.set t_cc, 16*t_ct + (t_ll & 15)
.set t_kk, t_cc >> 1
.set t_ph, 144*(t_cc & 1)
.if t_cc == 1
.set t_kk, 288
.set t_ph, 0
.endif
.set t_dd, 32*t_tt + 8*(t_ll >> 4)
fflane %t_dd, %t_kk, %t_ph
.set t_ll, t_ll+1
.endr
.set t_tt, t_tt+1
.endr
.set t_ct, t_ct+1
.endr
tab_fi:
.set t_ct, 0
.rept 36
.set t_tt, 0
.rept 18
.set t_ll, 0
.rept 64
.set t_nn, 16*t_ct + (t_ll & 15)
.set t_kk, 16*t_tt + 4*(t_ll >> 4)
filane %t_kk, %t_nn
.set t_ll, t_ll+1
.endr
.set t_tt, t_tt+1
.endr
.set t_ct, t_ct+1
.endr
tab_small:
.set t_which, 0
.rept 2
.set t_kind, 0
.rept 3
.set t_jt, 0
.rept 2
.set t_tt, 0
.rept 4
.set t_ll, 0
.rept 64
.set t_ph, 0
.if t_kind == 1
.set t_ph, 48
.endif
.if t_kind == 2
.set t_ph, 16
.endif
.if t_which == 0
.set t_a0, 32*(t_tt >> 1) + 8*(t_tt & 1) + 4*(t_ll >> 5)
.set t_mu, 16
.else
.set t_a0, 16*t_tt + 4*(t_ll >> 5)
.set t_mu, 8
.endif
.set t_bb, 32*t_jt + (t_ll & 31)
sdlane %t_a0, %t_mu, %t_bb, 1, %t_ph
.set t_ll, t_ll+1
.endr
.set t_tt, t_tt+1
.endr
.set t_jt, t_jt+1
.endr
.set t_kind, t_kind+1
.endr
.set t_which, t_which+1
.endr
.set t_kind, 0
.rept 3
.set t_tt, 0
.rept 2
.set t_ll, 0
.rept 64
.set t_ph, 0
.if t_kind == 1
.set t_ph, 48
.endif
.if t_kind == 2
.set t_ph, 16
.endif
.set t_a0, 16*t_tt + 4*(t_ll >> 5)
.set t_bb, t_ll & 31
sdlane %t_a0, 8, %t_bb, 2, %t_ph
.set t_ll, t_ll+1
.endr
.set t_tt, t_tt+1
.endr
.set t_kind, t_kind+1
.endr
.set t_which, 0
.rept 2
.set t_jt, 0
.rept 2
.set t_cs, 0
.rept 2
.set t_qq, 0
.rept 4
.set t_ll, 0
.rept 64
.if t_which == 0
.set t_a0, 8*t_qq + 4*(t_ll >> 5)
.set t_bb, 32*t_jt + (t_ll & 31)
.else
.set t_a0, 32*t_jt + 8*t_qq + 4*(t_ll >> 5)
.set t_bb, t_ll & 31
.endif
twlane %t_a0, %t_bb, %(1536*t_cs)
.set t_ll, t_ll+1
.endr
.set t_qq, t_qq+1
.endr
.set t_cs, t_cs+1
.endr
.set t_jt, t_jt+1
.endr
.set t_which, t_which+1
.endr
tab_end:
.noaltmacro
.p2align 6
.amdhsa_kernel k0_kernel
  .amdhsa_next_free_vgpr 72
  .amdhsa_next_free_sgpr 102
  .amdhsa_accum_offset 72
  .amdhsa_group_segment_fixed_size 0
  .amdhsa_kernarg_size 80
  .amdhsa_user_sgpr_count 2
  .amdhsa_user_sgpr_kernarg_segment_ptr 1
  .amdhsa_system_sgpr_workgroup_id_x 1
  .amdhsa_float_denorm_mode_32 3
.end_amdhsa_kernel
.p2align 6
.amdhsa_kernel k1_kernel
  .amdhsa_next_free_vgpr 512
  .amdhsa_next_free_sgpr 102
  .amdhsa_accum_offset 256
  .amdhsa_group_segment_fixed_size 0
  .amdhsa_kernarg_size 80
  .amdhsa_user_sgpr_count 2
  .amdhsa_user_sgpr_kernarg_segment_ptr 1
  .amdhsa_system_sgpr_workgroup_id_x 1
  .amdhsa_float_denorm_mode_32 3
.end_amdhsa_kernel
.p2align 6
.amdhsa_kernel k2_kernel
  .amdhsa_next_free_vgpr 512
  .amdhsa_next_free_sgpr 102
  .amdhsa_accum_offset 256
  .amdhsa_group_segment_fixed_size 0
  .amdhsa_kernarg_size 80
  .amdhsa_user_sgpr_count 2
  .amdhsa_user_sgpr_kernarg_segment_ptr 1
  .amdhsa_system_sgpr_workgroup_id_x 1
  .amdhsa_float_denorm_mode_32 3
.end_amdhsa_kernel
```
